```python
import torch

def _softmax(x, axis=-1):
    return torch.softmax(x, dim=axis)
def _gelu(x):
    return torch.nn.functional.gelu(x, approximate="tanh")
def _silu(x):
    return torch.nn.functional.silu(x)
def _sigmoid(x):
    return torch.sigmoid(x)
def _layernorm(x, axis=-1, eps=1e-5):
    m = x.mean(dim=axis, keepdim=True)
    v = x.var(dim=axis, keepdim=True, unbiased=False)
    return (x - m) / torch.sqrt(v + eps)
def _scatter_add(tgt, idx, src, axis=0):
    return tgt.clone().index_add_(axis, idx, src)
def _segment_sum(src, seg, n):
    out = torch.zeros((n,) + src.shape[1:], dtype=src.dtype)
    return out.index_add_(0, seg, src)
def _pad(x, pw):
    flat = tuple(v for pair in reversed(pw) for v in pair)
    return torch.nn.functional.pad(x, flat)

kernel_name = 'sequential_preLN__linear_kernel_hedgehog__glu_gated_swiglu__prompt'

def setup_inputs():

    _w = (lambda a: (lambda t: t.to(torch.bfloat16) if t.is_floating_point() else t)(torch.as_tensor(a)))
    def _A_setup():
        B, S, D, H = 1, 2048, 1024, 32
        Dh = D // H
        return {
            "x": _w((lambda *s: torch.randn(*s, dtype=torch.bfloat16) * 0.05)(B, S, D)),
            "wqkv": _w((lambda *s: torch.randn(*s, dtype=torch.bfloat16) * 0.2)(D, 3 * D)),
            "w_phi": _w((lambda *s: torch.randn(*s, dtype=torch.bfloat16) * 0.2)(H, Dh, Dh) * (Dh ** -0.5)),
            "wo": _w((lambda *s: torch.randn(*s, dtype=torch.bfloat16) * 0.05)(D, D)),
        }
    _A_in = _A_setup()

    def _B_setup():
        B, S, D, F = 1, 2048, 1024, 3584
        return {
            "x": _w((lambda *s: torch.randn(*s, dtype=torch.bfloat16) * 0.05)(B, S, D)),
            "w1": _w((lambda *s: torch.randn(*s, dtype=torch.bfloat16) * 0.4)(D, F) * (2.0 / D) ** 0.5),
            "w3": _w((lambda *s: torch.randn(*s, dtype=torch.bfloat16) * 0.4)(D, F) * (2.0 / D) ** 0.5),
            "w2": _w((lambda *s: torch.randn(*s, dtype=torch.bfloat16) * 0.4)(F, D) * (2.0 / F) ** 0.5),
        }
    _B_in = _B_setup()

    return {
        "A_x": _A_in["x"],
        "A_wqkv": _A_in["wqkv"],
        "A_w_phi": _A_in["w_phi"],
        "A_wo": _A_in["wo"],
        "B_x": _B_in["x"],
        "B_w1": _B_in["w1"],
        "B_w3": _B_in["w3"],
        "B_w2": _B_in["w2"],
    }

def reference(A_x, A_wqkv, A_w_phi, A_wo, B_x, B_w1, B_w3, B_w2):
    def _A_ref(x, wqkv, w_phi, wo):
        B, S, D = x.shape
        H = 32; Dh = D // H
        qkv = (lambda x, *d: x.permute(*d))((x @ wqkv).reshape(B, S, 3, H, Dh), 2, 0, 3, 1, 4)
        q, k, v = qkv[0], qkv[1], qkv[2]
        pq = torch.einsum("bhsd,hdf->bhsf", q, w_phi)
        pk = torch.einsum("bhsd,hdf->bhsf", k, w_phi)
        phi_q = torch.concatenate([_softmax(pq, axis=-1), _softmax(-pq, axis=-1)], axis=-1)
        phi_k = torch.concatenate([_softmax(pk, axis=-1), _softmax(-pk, axis=-1)], axis=-1)
        kv = torch.einsum("bhsf,bhsd->bhfd", phi_k, v)
        z  = torch.einsum("bhsf->bhf", phi_k)
        num = torch.einsum("bhqf,bhfd->bhqd", phi_q, kv)
        den = torch.einsum("bhqf,bhf->bhq", phi_q, z)[..., None] + 1e-6
        o = num / den
        return (lambda x, *d: x.permute(*d))(o, 0, 2, 1, 3).reshape(B, S, D) @ wo

    def _B_ref(x, w1, w3, w2):
        gate = torch.einsum("bsd,df->bsf", x, w1)
        up = torch.einsum("bsd,df->bsf", x, w3)
        h = _silu(gate) * up
        out = torch.einsum("bsf,fd->bsd", h, w2)
        return out

    x = A_x
    h = x + _A_ref(_layernorm(x, axis=-1), A_wqkv, A_w_phi, A_wo)
    h2 = h + _B_ref(_layernorm(h, axis=-1), B_w1, B_w3, B_w2)
    return h2
```

```asm
; @launch grid=(256,1,1) block=(256,1,1) lds=163840
.amdgcn_target "amdgcn-amd-amdhsa--gfx950"
.text
.p2align 12
.globl sequential_preLN__linear_kernel_hedgehog__glu_gated_swiglu__prompt_kernel
.p2align 8
.type sequential_preLN__linear_kernel_hedgehog__glu_gated_swiglu__prompt_kernel,@function
sequential_preLN__linear_kernel_hedgehog__glu_gated_swiglu__prompt_kernel:
s_cmp_ge_u32 s2, 256
s_cbranch_scc1 L_end
s_load_dwordx16 s[40:55], s[0:1], 0
s_load_dwordx4 s[56:59], s[0:1], 72
s_getpc_b64 s[92:93]
L_m_pc:
s_and_b32 s92, s92, 0xffffff80
s_lshr_b32 s94, s2, 3
s_lshl_b32 s94, s94, 2
v_lshrrev_b32 v10, 6, v0
v_add_u32 v10, s94, v10
v_mul_u32_u24 v10, 6, v10
v_and_b32 v11, 63, v0
v_min_u32 v11, 5, v11
v_add_lshl_u32 v10, v10, v11, 7
v_min_u32 v10, L_fin-L_m_pc-128, v10
global_load_dwordx2 a[254:255], v10, s[92:93] offset:60
v_lshrrev_b32 v1, 6, v0
v_and_b32 v0, 63, v0
v_readfirstlane_b32 s3, v1
s_and_b32 s38, s2, 7
s_lshr_b32 s39, s2, 3
s_and_b32 s35, s38, 1
s_lshl_b32 s35, s35, 3
s_and_b32 s61, s39, 7
s_add_u32 s35, s35, s61
s_lshr_b32 s36, s38, 1
s_lshl_b32 s36, s36, 2
s_lshr_b32 s61, s39, 3
s_add_u32 s36, s36, s61
s_lshr_b32 s33, s3, 1
s_and_b32 s34, s3, 1
s_and_b32 s38, s36, 3
s_lshl_b32 s38, s38, 2
s_lshr_b32 s39, s36, 2
s_add_u32 s37, s38, s39
s_and_b32 s38, s35, 7
s_lshl_b32 s38, s38, 1
s_lshr_b32 s39, s35, 3
s_add_u32 s37, s37, s38
s_add_u32 s37, s37, s39
s_and_b32 s37, s37, 15
v_lshlrev_b32 v1, 4, v0
v_lshrrev_b32 v12, 3, v0
v_lshrrev_b32 v13, 4, v0
v_xor_b32 v13, v13, v0
v_and_b32 v13, 7, v13
v_lshlrev_b32 v14, 11, v12
s_lshl_b32 s38, s35, 18
s_lshl_b32 s39, s3, 16
s_add_u32 s38, s38, s39
v_add_u32 v14, s38, v14
v_lshl_add_u32 v2, v13, 4, v14
v_xor_b32 v13, 4, v13
v_lshl_add_u32 v3, v13, 4, v14
v_and_b32 v13, 2, v12
v_xor_b32 v13, v13, v0
v_and_b32 v13, 7, v13
v_mul_u32_u24 v14, 6144, v12
s_lshl_b32 s39, s36, 7
v_lshl_add_u32 v4, v13, 4, v14
v_xor_b32 v13, 4, v13
v_lshl_add_u32 v5, v13, 4, v14
s_mov_b32 s66, 15360
s_mov_b32 s67, 30720
s_mov_b32 s68, 46080
s_lshl_b32 s70, s3, 12
s_lshl_b32 s71, s3, 11
s_mul_i32 s88, s34, 196608
s_lshl_b32 s38, s33, 11
s_add_u32 s88, s88, s38
s_add_u32 s88, s88, 2048
s_add_u32 s88, s88, s39
s_add_u32 s89, s88, 48128
s_add_u32 s90, s88, 96256
s_add_u32 s91, s88, 144384
s_mul_i32 s94, s3, 98304
s_xor_b32 s39, s39, 0
s_add_u32 s94, s94, s39
s_add_u32 s95, s94, 48128
s_mov_b32 s6, 4192384
s_mov_b32 s7, 0x00020000
s_mov_b32 s10, 393216
s_mov_b32 s11, 0x00020000
s_waitcnt lgkmcnt(0)
s_cmp_le_u32 s37, 0
s_addc_u32 s69, 0, 0
s_lshl_b32 s38, s69, 7
s_add_u32 s4, s40, s38
s_addc_u32 s5, s41, 0
s_mul_i32 s38, s69, 393216
s_add_u32 s8, s42, s38
s_addc_u32 s9, s43, 0
s_add_u32 m0, s70, 0
s_nop 0
buffer_load_dwordx4 v2, s[4:7], 0 offen offset:0 lds
buffer_load_dwordx4 v3, s[4:7], s66 offen offset:1024 lds
buffer_load_dwordx4 v2, s[4:7], s67 offen offset:2048 lds
buffer_load_dwordx4 v3, s[4:7], s68 offen offset:3072 lds
s_add_u32 m0, s70, 57344
s_nop 0
buffer_load_dwordx4 v4, s[8:11], s88 offen offset:0 lds
buffer_load_dwordx4 v5, s[8:11], s89 offen offset:1024 lds
buffer_load_dwordx4 v4, s[8:11], s90 offen offset:2048 lds
buffer_load_dwordx4 v5, s[8:11], s91 offen offset:3072 lds
s_mov_b32 s69, s37
s_lshl_b32 s38, s69, 7
s_add_u32 s4, s40, s38
s_addc_u32 s5, s41, 0
s_mul_i32 s38, s69, 393216
s_add_u32 s8, s42, s38
s_addc_u32 s9, s43, 0
s_add_u32 m0, s70, 16384
s_nop 0
buffer_load_dwordx4 v2, s[4:7], 0 offen offset:0 lds
buffer_load_dwordx4 v3, s[4:7], s66 offen offset:1024 lds
buffer_load_dwordx4 v2, s[4:7], s67 offen offset:2048 lds
buffer_load_dwordx4 v3, s[4:7], s68 offen offset:3072 lds
s_add_u32 m0, s70, 81920
s_nop 0
buffer_load_dwordx4 v4, s[8:11], s88 offen offset:0 lds
buffer_load_dwordx4 v5, s[8:11], s89 offen offset:1024 lds
buffer_load_dwordx4 v4, s[8:11], s90 offen offset:2048 lds
buffer_load_dwordx4 v5, s[8:11], s91 offen offset:3072 lds
s_add_u32 m0, s71, 73728
s_nop 0
buffer_load_dwordx4 v4, s[8:11], s94 offen lds
buffer_load_dwordx4 v5, s[8:11], s95 offen offset:1024 lds
s_bitcmp1_b32 s2, 7
s_cselect_b32 s24, s52, s50
s_cselect_b32 s25, s53, s51
s_mov_b32 s26, 7340032
s_mov_b32 s27, 0x00020000
s_mov_b32 s20, s44
s_mov_b32 s21, s45
s_mov_b32 s22, 65536
s_mov_b32 s23, 0x00020000
s_mov_b32 s28, s46
s_mov_b32 s29, s47
s_mov_b32 s30, 2097152
s_mov_b32 s31, 0x00020000
s_mov_b32 s16, s56
s_mov_b32 s17, s57
s_mov_b32 s18, 256
s_mov_b32 s19, 0x00020000
s_mov_b32 s12, s58
s_mov_b32 s13, s59
s_mov_b32 s14, 268435456
s_mov_b32 s15, 0x00020000
s_lshl_b32 s38, s36, 1
s_add_u32 s38, s38, s34
s_lshl_b32 s38, s38, 11
s_add_u32 m0, s71, 122880
s_nop 0
buffer_load_dwordx4 v1, s[20:23], s38 offen offset:0 lds
buffer_load_dwordx4 v1, s[20:23], s38 offen offset:1024 lds
s_lshl_b32 s62, s35, 3
s_lshl_b32 s39, s33, 2
s_add_u32 s62, s62, s39
v_and_b32 v14, 15, v0
v_lshrrev_b32 v15, 1, v14
v_lshrrev_b32 v16, 4, v0
v_xor_b32 v15, v15, v16
v_lshlrev_b32 v14, 7, v14
s_lshl_b32 s38, s33, 13
s_lshl_b32 s39, s34, 12
s_add_u32 s38, s38, s39
v_add_u32 v14, s38, v14
v_lshl_add_u32 v6, v15, 4, v14
v_xor_b32 v7, 64, v6
v_xor_b32 v12, 4096, v6
v_xor_b32 v13, 4096, v7
v_lshrrev_b32 v14, 4, v0
v_bfe_u32 v15, v0, 2, 2
v_lshl_add_u32 v16, v14, 3, v15
v_lshlrev_b32 v16, 7, v16
v_and_b32 v17, 3, v0
v_lshl_add_u32 v16, v17, 3, v16
v_and_b32 v14, 1, v14
v_lshrrev_b32 v15, 1, v15
v_lshl_add_u32 v14, v14, 1, v15
s_lshl_b32 s38, s34, 1
v_xor_b32 v14, s38, v14
v_lshl_add_u32 v16, v14, 5, v16
v_add_u32 v8, 49152, v16
v_xor_b32_e64 v9, 32, v8
v_add_u32 v10, 49152, v8
v_add_u32 v11, 49152, v9
v_mov_b32 v220, 0x3f803f80
v_mov_b32 v221, 0x3f803f80
v_mov_b32 v222, 0x3f803f80
v_mov_b32 v223, 0x3f803f80
v_and_b32 v14, 15, v0
v_cmp_eq_u32 vcc, 0, v14
s_nop 1
v_cndmask_b32 v232, 0, v220, vcc
v_mov_b32 v233, v232
v_mov_b32 v234, v232
v_mov_b32 v235, v232
v_cmp_eq_u32 vcc, 1, v14
s_nop 1
v_cndmask_b32 v236, 0, v220, vcc
v_mov_b32 v237, v236
v_mov_b32 v238, v236
v_mov_b32 v239, v236
v_cmp_eq_u32 vcc, 2, v14
s_nop 1
v_cndmask_b32 v240, 0, v220, vcc
v_mov_b32 v241, v240
v_mov_b32 v242, v240
v_mov_b32 v243, v240
v_cmp_eq_u32 vcc, 3, v14
s_nop 1
v_cndmask_b32 v244, 0, v220, vcc
v_mov_b32 v245, v244
v_mov_b32 v246, v244
v_mov_b32 v247, v244
v_cmp_eq_u32 vcc, 4, v14
s_nop 1
v_cndmask_b32 v248, 0, v220, vcc
v_mov_b32 v249, v248
v_mov_b32 v250, v248
v_mov_b32 v251, v248
v_cmp_eq_u32 vcc, 5, v14
s_nop 1
v_cndmask_b32 v252, 0, v220, vcc
v_mov_b32 v253, v252
v_mov_b32 v254, v252
v_mov_b32 v255, v252
s_mov_b32 s48, 572662306
s_mov_b32 s49, 572662306
s_mov_b32 s50, 1145324612
s_mov_b32 s51, 1145324612
s_mov_b32 s52, 2290649224
s_mov_b32 s53, 2290649224
s_mov_b32 s44, 117835008
s_mov_b32 s45, 117835009
s_mov_b32 s46, 117835010
s_mov_b32 s47, 117835011
s_lshl_b32 s38, s35, 7
s_lshl_b32 s39, s36, 7
s_add_u32 s39, s39, 2048
v_mov_b32 v14, s38
v_mov_b32 v15, s39
v_cmp_gt_u32 vcc, 16, v0
s_nop 1
v_cndmask_b32 v225, v15, v14, vcc
v_and_b32_e64 v16, 15, v0
v_lshl_add_u32 v225, v16, 2, v225
v_lshl_add_u32 v14, s36, 2, v14
v_lshl_add_u32 v15, s35, 2, v15
v_cmp_eq_u32 vcc, 0, v0
s_nop 1
v_cndmask_b32 v224, v15, v14, vcc
v_mov_b32 v226, 0
s_brev_b32 s54, s2
s_lshr_b32 s54, s54, 28
s_xor_b32 s54, s54, 8
s_lshr_b32 s55, s2, 4
s_lshl_b32 s64, s54, 3
s_lshl_b32 s38, s3, 1
s_add_u32 s64, s64, s38
v_lshrrev_b32 v15, 3, v0
v_and_b32 v16, 6, v15
v_mul_u32_u24 v15, 2048, v15
v_xor_b32 v16, v16, v0
v_and_b32 v16, 7, v16
v_lshl_add_u32 v14, v16, 4, v15
v_accvgpr_write_b32 a253, v14
s_or_b32 s38, s2, s3
s_cmp_lg_u32 s38, 0
s_cbranch_scc1 L_nn
s_memtime s[96:97]
s_waitcnt lgkmcnt(0)
s_or_b32 s96, s96, 0x01010101
v_mov_b32 v14, s96
s_mov_b64 exec, 1
buffer_store_dword v14, v226, s[16:19], 0 offen sc1
s_mov_b64 exec, -1
L_nn:
s_waitcnt vmcnt(12)
s_barrier
ds_read_b64_tr_b16 v[40:41], v8 offset:8192
ds_read_b64_tr_b16 v[42:43], v8 offset:8704
ds_read_b128 a[0:3], v6 offset:0
ds_read_b128 a[4:7], v6 offset:2048
ds_read_b128 a[8:11], v12 offset:0
ds_read_b128 a[12:15], v12 offset:2048
ds_read_b64_tr_b16 v[44:45], v9 offset:8192
ds_read_b64_tr_b16 v[46:47], v9 offset:8704
ds_read_b64_tr_b16 v[48:49], v8 offset:16384
ds_read_b64_tr_b16 v[50:51], v8 offset:16896
ds_read_b64_tr_b16 v[52:53], v9 offset:16384
ds_read_b64_tr_b16 v[54:55], v9 offset:16896
s_waitcnt lgkmcnt(0)
v_mfma_f32_16x16x32_bf16 v[128:131], v[40:43], a[0:3], 0
ds_read_b64_tr_b16 v[80:81], v8 offset:12288
s_cmp_le_u32 s37, 1
s_addc_u32 s69, 0, 1
s_lshl_b32 s38, s69, 7
s_add_u32 s4, s40, s38
s_addc_u32 s5, s41, 0
v_mfma_f32_16x16x32_bf16 v[132:135], v[40:43], a[4:7], 0
ds_read_b64_tr_b16 v[82:83], v8 offset:12800
s_mul_i32 s38, s69, 393216
s_add_u32 s8, s42, s38
s_addc_u32 s9, s43, 0
v_mfma_f32_16x16x32_bf16 v[136:139], v[40:43], a[8:11], 0
ds_read_b128 a[16:19], v7 offset:0
s_add_u32 m0, s70, 32768
s_nop 0
buffer_load_dwordx4 v2, s[4:7], 0 offen offset:0 lds
v_mfma_f32_16x16x32_bf16 v[140:143], v[40:43], a[12:15], 0
ds_read_b128 a[20:23], v7 offset:2048
v_mfma_f32_16x16x32_bf16 v[156:159], v[44:47], a[12:15], 0
buffer_load_dwordx4 v3, s[4:7], s66 offen offset:1024 lds
ds_read_b128 a[24:27], v13 offset:0
v_mfma_f32_16x16x32_bf16 v[152:155], v[44:47], a[8:11], 0
buffer_load_dwordx4 v2, s[4:7], s67 offen offset:2048 lds
ds_read_b128 a[28:31], v13 offset:2048
v_mfma_f32_16x16x32_bf16 v[148:151], v[44:47], a[4:7], 0
ds_read_b64_tr_b16 v[84:85], v9 offset:12288
v_mfma_f32_16x16x32_bf16 v[144:147], v[44:47], a[0:3], 0
buffer_load_dwordx4 v3, s[4:7], s68 offen offset:3072 lds
ds_read_b64_tr_b16 v[86:87], v9 offset:12800
v_mfma_f32_16x16x32_bf16 v[160:163], v[48:51], a[0:3], 0
s_add_u32 m0, s70, 106496
s_nop 0
buffer_load_dwordx4 v4, s[8:11], s88 offen offset:0 lds
ds_read_b64_tr_b16 v[88:89], v8 offset:20480
v_mfma_f32_16x16x32_bf16 v[164:167], v[48:51], a[4:7], 0
buffer_load_dwordx4 v5, s[8:11], s89 offen offset:1024 lds
v_mfma_f32_16x16x32_bf16 v[168:171], v[48:51], a[8:11], 0
ds_read_b64_tr_b16 v[90:91], v8 offset:20992
buffer_load_dwordx4 v4, s[8:11], s90 offen offset:2048 lds
v_mfma_f32_16x16x32_bf16 v[172:175], v[48:51], a[12:15], 0
ds_read_b64_tr_b16 v[92:93], v9 offset:20480
buffer_load_dwordx4 v5, s[8:11], s91 offen offset:3072 lds
v_mfma_f32_16x16x32_bf16 v[188:191], v[52:55], a[12:15], 0
ds_read_b64_tr_b16 v[94:95], v9 offset:20992
v_mfma_f32_16x16x32_bf16 v[184:187], v[52:55], a[8:11], 0
v_mfma_f32_16x16x32_bf16 v[180:183], v[52:55], a[4:7], 0
v_mfma_f32_16x16x32_bf16 v[176:179], v[52:55], a[0:3], 0
s_mov_b64 exec, 0
s_cmp_eq_u32 s3, 0
s_cbranch_scc1 L_wca0
s_cmp_eq_u32 s3, 1
s_cbranch_scc1 L_wca1
s_cmp_eq_u32 s3, 2
s_cbranch_scc1 L_wca2
s_branch L_wca3
L_wra:
s_mov_b64 exec, -1
s_waitcnt vmcnt(10) lgkmcnt(0)
s_barrier
v_mfma_f32_16x16x32_bf16 v[128:131], v[80:83], a[16:19], v[128:131]
ds_read_b64_tr_b16 v[32:33], v8 offset:24576
s_cmp_le_u32 s37, 2
s_addc_u32 s69, 0, 2
s_lshl_b32 s38, s69, 7
s_add_u32 s4, s40, s38
s_addc_u32 s5, s41, 0
v_mfma_f32_16x16x32_bf16 v[132:135], v[80:83], a[20:23], v[132:135]
ds_read_b64_tr_b16 v[34:35], v8 offset:25088
ds_read_b128 v[16:19], v6 offset:16384
v_mfma_f32_16x16x32_bf16 v[136:139], v[80:83], a[24:27], v[136:139]
ds_read_b128 v[20:23], v6 offset:18432
s_mul_i32 s38, s69, 393216
s_add_u32 s8, s42, s38
s_addc_u32 s9, s43, 0
v_mfma_f32_16x16x32_bf16 v[140:143], v[80:83], a[28:31], v[140:143]
ds_read_b128 v[24:27], v12 offset:16384
v_mfma_f32_16x16x32_bf16 v[156:159], v[84:87], a[28:31], v[156:159]
ds_read_b128 v[28:31], v12 offset:18432
ds_read_b64_tr_b16 v[36:37], v9 offset:24576
v_mfma_f32_16x16x32_bf16 v[152:155], v[84:87], a[24:27], v[152:155]
s_add_u32 m0, s70, 0
s_nop 0
buffer_load_dwordx4 v2, s[4:7], 0 offen offset:0 lds
ds_read_b64_tr_b16 v[38:39], v9 offset:25088
v_mfma_f32_16x16x32_bf16 v[148:151], v[84:87], a[20:23], v[148:151]
ds_read_b64_tr_b16 v[40:41], v8 offset:32768
v_mfma_f32_16x16x32_bf16 v[144:147], v[84:87], a[16:19], v[144:147]
buffer_load_dwordx4 v3, s[4:7], s66 offen offset:1024 lds
ds_read_b64_tr_b16 v[42:43], v8 offset:33280
v_mfma_f32_16x16x32_bf16 v[160:163], v[88:91], a[16:19], v[160:163]
ds_read_b64_tr_b16 v[44:45], v9 offset:32768
ds_read_b64_tr_b16 v[46:47], v9 offset:33280
v_mfma_f32_16x16x32_bf16 v[164:167], v[88:91], a[20:23], v[164:167]
buffer_load_dwordx4 v2, s[4:7], s67 offen offset:2048 lds
v_mfma_f32_16x16x32_bf16 v[168:171], v[88:91], a[24:27], v[168:171]
ds_read_b64_tr_b16 v[48:49], v8 offset:40960
ds_read_b64_tr_b16 v[50:51], v8 offset:41472
v_mfma_f32_16x16x32_bf16 v[172:175], v[88:91], a[28:31], v[172:175]
ds_read_b64_tr_b16 v[52:53], v9 offset:40960
buffer_load_dwordx4 v3, s[4:7], s68 offen offset:3072 lds
v_mfma_f32_16x16x32_bf16 v[188:191], v[92:95], a[28:31], v[188:191]
ds_read_b64_tr_b16 v[54:55], v9 offset:41472
v_mfma_f32_16x16x32_bf16 v[184:187], v[92:95], a[24:27], v[184:187]
v_mfma_f32_16x16x32_bf16 v[180:183], v[92:95], a[20:23], v[180:183]
v_mfma_f32_16x16x32_bf16 v[176:179], v[92:95], a[16:19], v[176:179]
s_waitcnt lgkmcnt(0)
v_mfma_f32_16x16x32_bf16 v[96:99], v[32:35], v[16:19], 0
ds_read_b64_tr_b16 v[72:73], v8 offset:28672
v_mfma_f32_16x16x32_bf16 v[100:103], v[32:35], v[20:23], 0
ds_read_b64_tr_b16 v[74:75], v8 offset:29184
v_mfma_f32_16x16x32_bf16 v[104:107], v[32:35], v[24:27], 0
s_add_u32 m0, s70, 57344
s_nop 0
buffer_load_dwordx4 v4, s[8:11], s88 offen offset:0 lds
v_mfma_f32_16x16x32_bf16 v[108:111], v[32:35], v[28:31], 0
ds_read_b128 v[56:59], v7 offset:16384
v_mfma_f32_16x16x32_bf16 v[124:127], v[36:39], v[28:31], 0
ds_read_b128 v[60:63], v7 offset:18432
v_mfma_f32_16x16x32_bf16 v[120:123], v[36:39], v[24:27], 0
ds_read_b128 v[64:67], v13 offset:16384
v_mfma_f32_16x16x32_bf16 v[116:119], v[36:39], v[20:23], 0
ds_read_b128 v[68:71], v13 offset:18432
v_mfma_f32_16x16x32_bf16 v[112:115], v[36:39], v[16:19], 0
buffer_load_dwordx4 v5, s[8:11], s89 offen offset:1024 lds
s_mov_b32 s20, s42
s_mov_b32 s21, s43
s_mov_b32 s22, 6291456
s_mov_b32 s23, 0x00020000
v_mfma_f32_16x16x32_bf16 v[128:131], v[40:43], v[16:19], v[128:131]
ds_read_b64_tr_b16 v[76:77], v9 offset:28672
v_mfma_f32_16x16x32_bf16 v[132:135], v[40:43], v[20:23], v[132:135]
ds_read_b64_tr_b16 v[78:79], v9 offset:29184
v_mfma_f32_16x16x32_bf16 v[136:139], v[40:43], v[24:27], v[136:139]
ds_read_b64_tr_b16 v[80:81], v8 offset:36864
v_mfma_f32_16x16x32_bf16 v[140:143], v[40:43], v[28:31], v[140:143]
ds_read_b64_tr_b16 v[82:83], v8 offset:37376
v_and_b32 v14, 7, v0
v_mfma_f32_16x16x32_bf16 v[156:159], v[44:47], v[28:31], v[156:159]
buffer_load_dwordx4 v4, s[8:11], s90 offen offset:2048 lds
v_mfma_f32_16x16x32_bf16 v[152:155], v[44:47], v[24:27], v[152:155]
ds_read_b64_tr_b16 v[84:85], v9 offset:36864
v_mfma_f32_16x16x32_bf16 v[148:151], v[44:47], v[20:23], v[148:151]
ds_read_b64_tr_b16 v[86:87], v9 offset:37376
v_mul_u32_u24 v14, 6144, v14
v_mfma_f32_16x16x32_bf16 v[144:147], v[44:47], v[16:19], v[144:147]
ds_read_b64_tr_b16 v[88:89], v8 offset:45056
v_mfma_f32_16x16x32_bf16 v[160:163], v[48:51], v[16:19], v[160:163]
ds_read_b64_tr_b16 v[90:91], v8 offset:45568
v_mfma_f32_16x16x32_bf16 v[164:167], v[48:51], v[20:23], v[164:167]
buffer_load_dwordx4 v5, s[8:11], s91 offen offset:3072 lds
v_mfma_f32_16x16x32_bf16 v[168:171], v[48:51], v[24:27], v[168:171]
ds_read_b64_tr_b16 v[92:93], v9 offset:45056
v_lshrrev_b32 v15, 3, v0
v_mfma_f32_16x16x32_bf16 v[172:175], v[48:51], v[28:31], v[172:175]
ds_read_b64_tr_b16 v[94:95], v9 offset:45568
v_mfma_f32_16x16x32_bf16 v[188:191], v[52:55], v[28:31], v[188:191]
v_min_u32 v15, 2, v15
v_mfma_f32_16x16x32_bf16 v[184:187], v[52:55], v[24:27], v[184:187]
v_mfma_f32_16x16x32_bf16 v[180:183], v[52:55], v[20:23], v[180:183]
v_lshl_add_u32 v14, v15, 11, v14
v_mfma_f32_16x16x32_bf16 v[176:179], v[52:55], v[16:19], v[176:179]
v_mfma_f32_16x16x32_bf16 v[200:203], v[220:223], v[16:19], 0
v_mfma_f32_16x16x32_bf16 v[208:211], v[16:19], v[16:19], 0
v_mfma_f32_16x16x32_bf16 v[204:207], v[220:223], v[20:23], 0
s_lshr_b32 s39, s2, 3
s_lshl_b32 s39, s39, 2
s_add_u32 s39, s39, s3
s_mul_i32 s39, s39, 49152
v_mfma_f32_16x16x32_bf16 v[212:215], v[20:23], v[20:23], 0
v_mfma_f32_16x16x32_bf16 v[216:219], v[32:35], v[232:235], 0
v_mfma_f32_16x16x32_bf16 v[216:219], v[36:39], v[236:239], v[216:219]
v_mfma_f32_16x16x32_bf16 v[216:219], v[40:43], v[240:243], v[216:219]
v_mfma_f32_16x16x32_bf16 v[216:219], v[44:47], v[244:247], v[216:219]
v_mfma_f32_16x16x32_bf16 v[216:219], v[48:51], v[248:251], v[216:219]
v_mfma_f32_16x16x32_bf16 v[216:219], v[52:55], v[252:255], v[216:219]
s_or_b32 s61, s36, 3
s_lshl_b32 s61, s61, 7
s_add_u32 s39, s39, s61
s_bitcmp0_b32 s36, 2
s_cselect_b32 exec_lo, 0xffffff, 1
s_mov_b32 exec_hi, 0
buffer_load_dwordx2 a[254:255], v14, s[20:23], s39 offen offset:60
s_mov_b64 exec, -1
s_waitcnt vmcnt(9) lgkmcnt(0)
s_barrier
v_mfma_f32_16x16x32_bf16 v[96:99], v[72:75], v[56:59], v[96:99]
ds_read_b64_tr_b16 v[40:41], v10 offset:8192
v_mfma_f32_16x16x32_bf16 v[100:103], v[72:75], v[60:63], v[100:103]
s_cmp_le_u32 s37, 3
s_addc_u32 s69, 0, 3
s_lshl_b32 s38, s69, 7
s_add_u32 s4, s40, s38
s_addc_u32 s5, s41, 0
v_mfma_f32_16x16x32_bf16 v[104:107], v[72:75], v[64:67], v[104:107]
ds_read_b64_tr_b16 v[42:43], v10 offset:8704
v_mfma_f32_16x16x32_bf16 v[108:111], v[72:75], v[68:71], v[108:111]
ds_read_b128 a[32:35], v6 offset:32768
v_mfma_f32_16x16x32_bf16 v[124:127], v[76:79], v[68:71], v[124:127]
s_mul_i32 s38, s69, 393216
s_add_u32 s8, s42, s38
s_addc_u32 s9, s43, 0
v_mfma_f32_16x16x32_bf16 v[120:123], v[76:79], v[64:67], v[120:123]
ds_read_b128 a[36:39], v6 offset:34816
v_mfma_f32_16x16x32_bf16 v[116:119], v[76:79], v[60:63], v[116:119]
ds_read_b128 a[40:43], v12 offset:32768
v_mfma_f32_16x16x32_bf16 v[112:115], v[76:79], v[56:59], v[112:115]
s_add_u32 m0, s70, 16384
s_nop 0
buffer_load_dwordx4 v2, s[4:7], 0 offen offset:0 lds
v_mfma_f32_16x16x32_bf16 v[128:131], v[80:83], v[56:59], v[128:131]
ds_read_b128 a[44:47], v12 offset:34816
v_mfma_f32_16x16x32_bf16 v[132:135], v[80:83], v[60:63], v[132:135]
v_mfma_f32_16x16x32_bf16 v[136:139], v[80:83], v[64:67], v[136:139]
ds_read_b64_tr_b16 v[44:45], v11 offset:8192
v_mfma_f32_16x16x32_bf16 v[140:143], v[80:83], v[68:71], v[140:143]
buffer_load_dwordx4 v3, s[4:7], s66 offen offset:1024 lds
v_mfma_f32_16x16x32_bf16 v[156:159], v[84:87], v[68:71], v[156:159]
ds_read_b64_tr_b16 v[46:47], v11 offset:8704
v_mfma_f32_16x16x32_bf16 v[152:155], v[84:87], v[64:67], v[152:155]
ds_read_b64_tr_b16 v[48:49], v10 offset:16384
v_mfma_f32_16x16x32_bf16 v[148:151], v[84:87], v[60:63], v[148:151]
buffer_load_dwordx4 v2, s[4:7], s67 offen offset:2048 lds
v_mfma_f32_16x16x32_bf16 v[144:147], v[84:87], v[56:59], v[144:147]
ds_read_b64_tr_b16 v[50:51], v10 offset:16896
v_mfma_f32_16x16x32_bf16 v[160:163], v[88:91], v[56:59], v[160:163]
ds_read_b64_tr_b16 v[52:53], v11 offset:16384
v_mfma_f32_16x16x32_bf16 v[164:167], v[88:91], v[60:63], v[164:167]
buffer_load_dwordx4 v3, s[4:7], s68 offen offset:3072 lds
v_mfma_f32_16x16x32_bf16 v[168:171], v[88:91], v[64:67], v[168:171]
ds_read_b64_tr_b16 v[54:55], v11 offset:16896
v_mfma_f32_16x16x32_bf16 v[172:175], v[88:91], v[68:71], v[172:175]
v_mfma_f32_16x16x32_bf16 v[188:191], v[92:95], v[68:71], v[188:191]
v_mfma_f32_16x16x32_bf16 v[184:187], v[92:95], v[64:67], v[184:187]
v_mfma_f32_16x16x32_bf16 v[180:183], v[92:95], v[60:63], v[180:183]
v_mfma_f32_16x16x32_bf16 v[176:179], v[92:95], v[56:59], v[176:179]
v_mfma_f32_16x16x32_bf16 v[200:203], v[220:223], v[56:59], v[200:203]
v_mfma_f32_16x16x32_bf16 v[208:211], v[56:59], v[56:59], v[208:211]
v_mfma_f32_16x16x32_bf16 v[204:207], v[220:223], v[60:63], v[204:207]
v_mfma_f32_16x16x32_bf16 v[212:215], v[60:63], v[60:63], v[212:215]
v_mfma_f32_16x16x32_bf16 v[216:219], v[72:75], v[232:235], v[216:219]
v_mfma_f32_16x16x32_bf16 v[216:219], v[76:79], v[236:239], v[216:219]
v_mfma_f32_16x16x32_bf16 v[216:219], v[80:83], v[240:243], v[216:219]
v_mfma_f32_16x16x32_bf16 v[216:219], v[84:87], v[244:247], v[216:219]
v_mfma_f32_16x16x32_bf16 v[216:219], v[88:91], v[248:251], v[216:219]
v_mfma_f32_16x16x32_bf16 v[216:219], v[92:95], v[252:255], v[216:219]
s_waitcnt lgkmcnt(0)
v_mfma_f32_16x16x32_bf16 v[128:131], v[40:43], a[32:35], v[128:131]
ds_read_b64_tr_b16 v[80:81], v10 offset:12288
ds_read_b64_tr_b16 v[82:83], v10 offset:12800
v_mfma_f32_16x16x32_bf16 v[132:135], v[40:43], a[36:39], v[132:135]
s_add_u32 m0, s70, 81920
s_nop 0
buffer_load_dwordx4 v4, s[8:11], s88 offen offset:0 lds
v_mfma_f32_16x16x32_bf16 v[136:139], v[40:43], a[40:43], v[136:139]
ds_read_b128 a[48:51], v7 offset:32768
v_mfma_f32_16x16x32_bf16 v[140:143], v[40:43], a[44:47], v[140:143]
ds_read_b128 a[52:55], v7 offset:34816
v_mfma_f32_16x16x32_bf16 v[156:159], v[44:47], a[44:47], v[156:159]
ds_read_b128 a[56:59], v13 offset:32768
buffer_load_dwordx4 v5, s[8:11], s89 offen offset:1024 lds
v_mfma_f32_16x16x32_bf16 v[152:155], v[44:47], a[40:43], v[152:155]
ds_read_b128 a[60:63], v13 offset:34816
v_mfma_f32_16x16x32_bf16 v[148:151], v[44:47], a[36:39], v[148:151]
ds_read_b64_tr_b16 v[84:85], v11 offset:12288
v_cndmask_b32 v208, v208, v209, s[48:49]
v_cndmask_b32 v208, v208, v210, s[50:51]
v_mfma_f32_16x16x32_bf16 v[144:147], v[44:47], a[32:35], v[144:147]
ds_read_b64_tr_b16 v[86:87], v11 offset:12800
v_cndmask_b32 v201, v208, v211, s[52:53]
v_cndmask_b32 v212, v212, v213, s[48:49]
v_mfma_f32_16x16x32_bf16 v[160:163], v[48:51], a[32:35], v[160:163]
buffer_load_dwordx4 v4, s[8:11], s90 offen offset:2048 lds
ds_read_b64_tr_b16 v[88:89], v10 offset:20480
v_cndmask_b32 v212, v212, v214, s[50:51]
v_mfma_f32_16x16x32_bf16 v[164:167], v[48:51], a[36:39], v[164:167]
ds_read_b64_tr_b16 v[90:91], v10 offset:20992
v_cndmask_b32 v203, v212, v215, s[52:53]
v_mov_b32 v202, v204
v_mfma_f32_16x16x32_bf16 v[168:171], v[48:51], a[40:43], v[168:171]
ds_read_b64_tr_b16 v[92:93], v11 offset:20480
v_and_b32 v14, 15, v0
v_lshlrev_b32 v15, 4, v14
v_mfma_f32_16x16x32_bf16 v[172:175], v[48:51], a[44:47], v[172:175]
buffer_load_dwordx4 v5, s[8:11], s91 offen offset:3072 lds
s_lshr_b32 s39, s62, 1
s_add_u32 s39, s39, s34
s_lshl_b32 s39, s39, 12
s_lshl_b32 s61, s36, 8
s_add_u32 s39, s39, s61
s_add_u32 s39, s39, 63700992
v_mfma_f32_16x16x32_bf16 v[188:191], v[52:55], a[44:47], v[188:191]
ds_read_b64_tr_b16 v[94:95], v11 offset:20992
v_mfma_f32_16x16x32_bf16 v[184:187], v[52:55], a[40:43], v[184:187]
s_mov_b32 exec_lo, 0x00f0000f
s_mov_b32 exec_hi, 0xf0000f00
buffer_store_dwordx4 v[200:203], v15, s[12:15], s39 offen sc1
s_mov_b64 exec, -1
v_lshlrev_b32 v14, 10, v14
v_and_b32 v15, 48, v0
v_lshl_add_u32 v14, v15, 4, v14
v_mfma_f32_16x16x32_bf16 v[180:183], v[52:55], a[36:39], v[180:183]
s_lshl_b32 s39, s36, 1
s_add_u32 s39, s39, s34
s_mul_i32 s39, s39, 6144
s_lshl_b32 s61, s35, 4
s_add_u32 s39, s39, s61
s_add_u32 s39, s39, 63176704
v_mfma_f32_16x16x32_bf16 v[176:179], v[52:55], a[32:35], v[176:179]
s_mul_i32 s61, s33, 3
s_lshl_b32 s61, 0x00070007, s61
s_mov_b32 exec_lo, s61
s_mov_b32 exec_hi, s61
buffer_store_dwordx4 v[216:219], v14, s[12:15], s39 offen sc1
s_mov_b64 exec, -1
s_waitcnt vmcnt(11) lgkmcnt(0)
s_barrier
v_mfma_f32_16x16x32_bf16 v[128:131], v[80:83], a[48:51], v[128:131]
ds_read_b64_tr_b16 v[40:41], v8 offset:8192
s_cmp_le_u32 s37, 4
s_addc_u32 s69, 0, 4
s_lshl_b32 s38, s69, 7
s_add_u32 s4, s40, s38
s_addc_u32 s5, s41, 0
v_mfma_f32_16x16x32_bf16 v[132:135], v[80:83], a[52:55], v[132:135]
ds_read_b64_tr_b16 v[42:43], v8 offset:8704
v_mfma_f32_16x16x32_bf16 v[136:139], v[80:83], a[56:59], v[136:139]
ds_read_b128 a[64:67], v6 offset:0
s_mul_i32 s38, s69, 393216
s_add_u32 s8, s42, s38
s_addc_u32 s9, s43, 0
v_mfma_f32_16x16x32_bf16 v[140:143], v[80:83], a[60:63], v[140:143]
ds_read_b128 a[68:71], v6 offset:2048
v_mfma_f32_16x16x32_bf16 v[156:159], v[84:87], a[60:63], v[156:159]
ds_read_b128 a[72:75], v12 offset:0
v_mfma_f32_16x16x32_bf16 v[152:155], v[84:87], a[56:59], v[152:155]
s_add_u32 m0, s70, 32768
s_nop 0
buffer_load_dwordx4 v2, s[4:7], 0 offen offset:0 lds
ds_read_b128 a[76:79], v12 offset:2048
v_mfma_f32_16x16x32_bf16 v[148:151], v[84:87], a[52:55], v[148:151]
ds_read_b64_tr_b16 v[44:45], v9 offset:8192
v_lshrrev_b32 v14, 2, v0
v_mfma_f32_16x16x32_bf16 v[144:147], v[84:87], a[48:51], v[144:147]
buffer_load_dwordx4 v3, s[4:7], s66 offen offset:1024 lds
ds_read_b64_tr_b16 v[46:47], v9 offset:8704
v_mfma_f32_16x16x32_bf16 v[160:163], v[88:91], a[48:51], v[160:163]
ds_read_b64_tr_b16 v[48:49], v8 offset:16384
v_lshlrev_b32 v14, 6, v14
v_mfma_f32_16x16x32_bf16 v[164:167], v[88:91], a[52:55], v[164:167]
buffer_load_dwordx4 v2, s[4:7], s67 offen offset:2048 lds
v_and_b32 v15, 3, v0
v_mfma_f32_16x16x32_bf16 v[168:171], v[88:91], a[56:59], v[168:171]
ds_read_b64_tr_b16 v[50:51], v8 offset:16896
ds_read_b64_tr_b16 v[52:53], v9 offset:16384
L_wca0:
L_wp0:
s_cbranch_execz L_wp4
v_mfma_f32_16x16x32_bf16 v[172:175], v[88:91], a[60:63], v[172:175]
buffer_load_dwordx4 v3, s[4:7], s68 offen offset:3072 lds
v_lshl_add_u32 v14, v15, 3, v14
v_mfma_f32_16x16x32_bf16 v[188:191], v[92:95], a[60:63], v[188:191]
ds_read_b64_tr_b16 v[54:55], v9 offset:16896
v_mfma_f32_16x16x32_bf16 v[184:187], v[92:95], a[56:59], v[184:187]
s_lshl_b32 s39, s3, 11
s_add_u32 s39, s39, 122880
v_add_u32 v14, s39, v14
ds_read_b64_tr_b16 v[192:193], v14 offset:0
v_mfma_f32_16x16x32_bf16 v[180:183], v[92:95], a[52:55], v[180:183]
ds_read_b64_tr_b16 v[194:195], v14 offset:1024
ds_read_b64_tr_b16 v[196:197], v14 offset:32
v_mfma_f32_16x16x32_bf16 v[176:179], v[92:95], a[48:51], v[176:179]
ds_read_b64_tr_b16 v[198:199], v14 offset:1056
buffer_load_dword v227, v226, s[16:19], 0 offen sc1
s_waitcnt lgkmcnt(0)
v_mfma_f32_16x16x32_bf16 v[128:131], v[40:43], a[64:67], v[128:131]
ds_read_b64_tr_b16 v[80:81], v8 offset:12288
ds_read_b64_tr_b16 v[82:83], v8 offset:12800
v_mfma_f32_16x16x32_bf16 v[132:135], v[40:43], a[68:71], v[132:135]
s_add_u32 m0, s70, 106496
s_nop 0
buffer_load_dwordx4 v4, s[8:11], s88 offen offset:0 lds
v_mfma_f32_16x16x32_bf16 v[136:139], v[40:43], a[72:75], v[136:139]
ds_read_b128 a[80:83], v7 offset:0
v_mfma_f32_16x16x32_bf16 v[140:143], v[40:43], a[76:79], v[140:143]
ds_read_b128 a[84:87], v7 offset:2048
v_mfma_f32_16x16x32_bf16 v[156:159], v[44:47], a[76:79], v[156:159]
ds_read_b128 a[88:91], v13 offset:0
buffer_load_dwordx4 v5, s[8:11], s89 offen offset:1024 lds
v_mfma_f32_16x16x32_bf16 v[152:155], v[44:47], a[72:75], v[152:155]
ds_read_b128 a[92:95], v13 offset:2048
v_mfma_f32_16x16x32_bf16 v[148:151], v[44:47], a[68:71], v[148:151]
ds_read_b64_tr_b16 v[84:85], v9 offset:12288
v_mfma_f32_16x16x32_bf16 v[144:147], v[44:47], a[64:67], v[144:147]
ds_read_b64_tr_b16 v[86:87], v9 offset:12800
v_mfma_f32_16x16x32_bf16 v[160:163], v[48:51], a[64:67], v[160:163]
buffer_load_dwordx4 v4, s[8:11], s90 offen offset:2048 lds
ds_read_b64_tr_b16 v[88:89], v8 offset:20480
v_mfma_f32_16x16x32_bf16 v[164:167], v[48:51], a[68:71], v[164:167]
ds_read_b64_tr_b16 v[90:91], v8 offset:20992
v_mfma_f32_16x16x32_bf16 v[168:171], v[48:51], a[72:75], v[168:171]
ds_read_b64_tr_b16 v[92:93], v9 offset:20480
v_mfma_f32_16x16x32_bf16 v[172:175], v[48:51], a[76:79], v[172:175]
buffer_load_dwordx4 v5, s[8:11], s91 offen offset:3072 lds
v_mfma_f32_16x16x32_bf16 v[188:191], v[52:55], a[76:79], v[188:191]
ds_read_b64_tr_b16 v[94:95], v9 offset:20992
v_mfma_f32_16x16x32_bf16 v[184:187], v[52:55], a[72:75], v[184:187]
v_mfma_f32_16x16x32_bf16 v[180:183], v[52:55], a[68:71], v[180:183]
v_mfma_f32_16x16x32_bf16 v[176:179], v[52:55], a[64:67], v[176:179]
s_waitcnt vmcnt(11) lgkmcnt(0)
s_barrier
v_mfma_f32_16x16x32_bf16 v[128:131], v[80:83], a[80:83], v[128:131]
ds_read_b64_tr_b16 v[40:41], v8 offset:32768
s_cmp_le_u32 s37, 5
s_addc_u32 s69, 0, 5
s_lshl_b32 s38, s69, 7
s_add_u32 s4, s40, s38
s_addc_u32 s5, s41, 0
v_mfma_f32_16x16x32_bf16 v[132:135], v[80:83], a[84:87], v[132:135]
ds_read_b64_tr_b16 v[42:43], v8 offset:33280
v_mfma_f32_16x16x32_bf16 v[136:139], v[80:83], a[88:91], v[136:139]
ds_read_b128 a[96:99], v6 offset:16384
s_mul_i32 s38, s69, 393216
s_add_u32 s8, s42, s38
s_addc_u32 s9, s43, 0
v_mfma_f32_16x16x32_bf16 v[140:143], v[80:83], a[92:95], v[140:143]
ds_read_b128 a[100:103], v6 offset:18432
v_mfma_f32_16x16x32_bf16 v[156:159], v[84:87], a[92:95], v[156:159]
ds_read_b128 a[104:107], v12 offset:16384
v_mfma_f32_16x16x32_bf16 v[152:155], v[84:87], a[88:91], v[152:155]
s_add_u32 m0, s70, 0
s_nop 0
buffer_load_dwordx4 v2, s[4:7], 0 offen offset:0 lds
ds_read_b128 a[108:111], v12 offset:18432
v_mfma_f32_16x16x32_bf16 v[148:151], v[84:87], a[84:87], v[148:151]
ds_read_b64_tr_b16 v[44:45], v9 offset:32768
v_mfma_f32_16x16x32_bf16 v[144:147], v[84:87], a[80:83], v[144:147]
buffer_load_dwordx4 v3, s[4:7], s66 offen offset:1024 lds
ds_read_b64_tr_b16 v[46:47], v9 offset:33280
v_mfma_f32_16x16x32_bf16 v[160:163], v[88:91], a[80:83], v[160:163]
ds_read_b64_tr_b16 v[48:49], v8 offset:40960
v_mfma_f32_16x16x32_bf16 v[164:167], v[88:91], a[84:87], v[164:167]
buffer_load_dwordx4 v2, s[4:7], s67 offen offset:2048 lds
v_mfma_f32_16x16x32_bf16 v[168:171], v[88:91], a[88:91], v[168:171]
ds_read_b64_tr_b16 v[50:51], v8 offset:41472
ds_read_b64_tr_b16 v[52:53], v9 offset:40960
v_mfma_f32_16x16x32_bf16 v[172:175], v[88:91], a[92:95], v[172:175]
buffer_load_dwordx4 v3, s[4:7], s68 offen offset:3072 lds
v_mfma_f32_16x16x32_bf16 v[188:191], v[92:95], a[92:95], v[188:191]
ds_read_b64_tr_b16 v[54:55], v9 offset:41472
v_mfma_f32_16x16x32_bf16 v[184:187], v[92:95], a[88:91], v[184:187]
v_mfma_f32_16x16x32_bf16 v[180:183], v[92:95], a[84:87], v[180:183]
v_mfma_f32_16x16x32_bf16 v[176:179], v[92:95], a[80:83], v[176:179]
s_waitcnt lgkmcnt(0)
s_waitcnt vmcnt(8)
v_readfirstlane_b32 s63, v227
s_cmp_eq_u32 s63, 0
s_cbranch_scc1 L_nsp
L_nok:
v_mfma_f32_16x16x32_bf16 v[128:131], v[40:43], a[96:99], v[128:131]
ds_read_b64_tr_b16 v[80:81], v8 offset:36864
ds_read_b64_tr_b16 v[82:83], v8 offset:37376
v_mfma_f32_16x16x32_bf16 v[132:135], v[40:43], a[100:103], v[132:135]
s_add_u32 m0, s70, 57344
s_nop 0
buffer_load_dwordx4 v4, s[8:11], s88 offen offset:0 lds
v_mfma_f32_16x16x32_bf16 v[136:139], v[40:43], a[104:107], v[136:139]
ds_read_b128 a[112:115], v7 offset:16384
v_mfma_f32_16x16x32_bf16 v[140:143], v[40:43], a[108:111], v[140:143]
ds_read_b128 a[116:119], v7 offset:18432
v_mfma_f32_16x16x32_bf16 v[156:159], v[44:47], a[108:111], v[156:159]
ds_read_b128 a[120:123], v13 offset:16384
buffer_load_dwordx4 v5, s[8:11], s89 offen offset:1024 lds
v_mfma_f32_16x16x32_bf16 v[152:155], v[44:47], a[104:107], v[152:155]
ds_read_b128 a[124:127], v13 offset:18432
v_mfma_f32_16x16x32_bf16 v[148:151], v[44:47], a[100:103], v[148:151]
ds_read_b64_tr_b16 v[84:85], v9 offset:36864
v_mfma_f32_16x16x32_bf16 v[144:147], v[44:47], a[96:99], v[144:147]
ds_read_b64_tr_b16 v[86:87], v9 offset:37376
v_mfma_f32_16x16x32_bf16 v[160:163], v[48:51], a[96:99], v[160:163]
buffer_load_dwordx4 v4, s[8:11], s90 offen offset:2048 lds
ds_read_b64_tr_b16 v[88:89], v8 offset:45056
v_mfma_f32_16x16x32_bf16 v[164:167], v[48:51], a[100:103], v[164:167]
ds_read_b64_tr_b16 v[90:91], v8 offset:45568
v_mfma_f32_16x16x32_bf16 v[168:171], v[48:51], a[104:107], v[168:171]
ds_read_b64_tr_b16 v[92:93], v9 offset:45056
v_mfma_f32_16x16x32_bf16 v[172:175], v[48:51], a[108:111], v[172:175]
buffer_load_dwordx4 v5, s[8:11], s91 offen offset:3072 lds
v_mfma_f32_16x16x32_bf16 v[188:191], v[52:55], a[108:111], v[188:191]
ds_read_b64_tr_b16 v[94:95], v9 offset:45568
v_mfma_f32_16x16x32_bf16 v[184:187], v[52:55], a[104:107], v[184:187]
v_mov_b32 v226, s63
v_mfma_f32_16x16x32_bf16 v[180:183], v[52:55], a[100:103], v[180:183]
v_mfma_f32_16x16x32_bf16 v[176:179], v[52:55], a[96:99], v[176:179]
s_mov_b32 s60, 63504384
s_waitcnt vmcnt(8) lgkmcnt(0)
s_barrier
v_mfma_f32_16x16x32_bf16 v[128:131], v[80:83], a[112:115], v[128:131]
ds_read_b64_tr_b16 v[40:41], v10 offset:8192
s_cmp_le_u32 s37, 6
s_addc_u32 s69, 0, 6
s_lshl_b32 s38, s69, 7
s_add_u32 s4, s40, s38
s_addc_u32 s5, s41, 0
v_mfma_f32_16x16x32_bf16 v[132:135], v[80:83], a[116:119], v[132:135]
ds_read_b64_tr_b16 v[42:43], v10 offset:8704
v_mfma_f32_16x16x32_bf16 v[136:139], v[80:83], a[120:123], v[136:139]
ds_read_b128 a[128:131], v6 offset:32768
s_mul_i32 s38, s69, 393216
s_add_u32 s8, s42, s38
s_addc_u32 s9, s43, 0
v_mfma_f32_16x16x32_bf16 v[140:143], v[80:83], a[124:127], v[140:143]
ds_read_b128 a[132:135], v6 offset:34816
v_mfma_f32_16x16x32_bf16 v[156:159], v[84:87], a[124:127], v[156:159]
ds_read_b128 a[136:139], v12 offset:32768
v_mfma_f32_16x16x32_bf16 v[152:155], v[84:87], a[120:123], v[152:155]
s_add_u32 m0, s70, 16384
s_nop 0
buffer_load_dwordx4 v2, s[4:7], 0 offen offset:0 lds
ds_read_b128 a[140:143], v12 offset:34816
v_mfma_f32_16x16x32_bf16 v[148:151], v[84:87], a[116:119], v[148:151]
ds_read_b64_tr_b16 v[44:45], v11 offset:8192
v_mfma_f32_16x16x32_bf16 v[144:147], v[84:87], a[112:115], v[144:147]
buffer_load_dwordx4 v3, s[4:7], s66 offen offset:1024 lds
ds_read_b64_tr_b16 v[46:47], v11 offset:8704
v_mfma_f32_16x16x32_bf16 v[160:163], v[88:91], a[112:115], v[160:163]
ds_read_b64_tr_b16 v[48:49], v10 offset:16384
v_mfma_f32_16x16x32_bf16 v[164:167], v[88:91], a[116:119], v[164:167]
buffer_load_dwordx4 v2, s[4:7], s67 offen offset:2048 lds
v_mfma_f32_16x16x32_bf16 v[168:171], v[88:91], a[120:123], v[168:171]
ds_read_b64_tr_b16 v[50:51], v10 offset:16896
ds_read_b64_tr_b16 v[52:53], v11 offset:16384
v_mfma_f32_16x16x32_bf16 v[172:175], v[88:91], a[124:127], v[172:175]
buffer_load_dwordx4 v3, s[4:7], s68 offen offset:3072 lds
v_mfma_f32_16x16x32_bf16 v[188:191], v[92:95], a[124:127], v[188:191]
ds_read_b64_tr_b16 v[54:55], v11 offset:16896
v_mfma_f32_16x16x32_bf16 v[184:187], v[92:95], a[120:123], v[184:187]
v_mfma_f32_16x16x32_bf16 v[180:183], v[92:95], a[116:119], v[180:183]
v_mfma_f32_16x16x32_bf16 v[176:179], v[92:95], a[112:115], v[176:179]
s_cmp_eq_u32 s3, 0
s_cbranch_scc1 L_pf
L_pfr:
s_waitcnt lgkmcnt(0)
v_mfma_f32_16x16x32_bf16 v[128:131], v[40:43], a[128:131], v[128:131]
ds_read_b64_tr_b16 v[80:81], v10 offset:12288
ds_read_b64_tr_b16 v[82:83], v10 offset:12800
v_mfma_f32_16x16x32_bf16 v[132:135], v[40:43], a[132:135], v[132:135]
s_add_u32 m0, s70, 81920
s_nop 0
buffer_load_dwordx4 v4, s[8:11], s88 offen offset:0 lds
v_mfma_f32_16x16x32_bf16 v[136:139], v[40:43], a[136:139], v[136:139]
ds_read_b128 a[144:147], v7 offset:32768
v_mfma_f32_16x16x32_bf16 v[140:143], v[40:43], a[140:143], v[140:143]
ds_read_b128 a[148:151], v7 offset:34816
v_mfma_f32_16x16x32_bf16 v[156:159], v[44:47], a[140:143], v[156:159]
ds_read_b128 a[152:155], v13 offset:32768
buffer_load_dwordx4 v5, s[8:11], s89 offen offset:1024 lds
v_mfma_f32_16x16x32_bf16 v[152:155], v[44:47], a[136:139], v[152:155]
ds_read_b128 a[156:159], v13 offset:34816
v_mfma_f32_16x16x32_bf16 v[148:151], v[44:47], a[132:135], v[148:151]
ds_read_b64_tr_b16 v[84:85], v11 offset:12288
v_mfma_f32_16x16x32_bf16 v[144:147], v[44:47], a[128:131], v[144:147]
ds_read_b64_tr_b16 v[86:87], v11 offset:12800
v_mfma_f32_16x16x32_bf16 v[160:163], v[48:51], a[128:131], v[160:163]
buffer_load_dwordx4 v4, s[8:11], s90 offen offset:2048 lds
ds_read_b64_tr_b16 v[88:89], v10 offset:20480
v_mfma_f32_16x16x32_bf16 v[164:167], v[48:51], a[132:135], v[164:167]
ds_read_b64_tr_b16 v[90:91], v10 offset:20992
v_mfma_f32_16x16x32_bf16 v[168:171], v[48:51], a[136:139], v[168:171]
ds_read_b64_tr_b16 v[92:93], v11 offset:20480
v_mfma_f32_16x16x32_bf16 v[172:175], v[48:51], a[140:143], v[172:175]
buffer_load_dwordx4 v5, s[8:11], s91 offen offset:3072 lds
v_mfma_f32_16x16x32_bf16 v[188:191], v[52:55], a[140:143], v[188:191]
ds_read_b64_tr_b16 v[94:95], v11 offset:20992
v_mfma_f32_16x16x32_bf16 v[184:187], v[52:55], a[136:139], v[184:187]
v_mfma_f32_16x16x32_bf16 v[180:183], v[52:55], a[132:135], v[180:183]
v_mfma_f32_16x16x32_bf16 v[176:179], v[52:55], a[128:131], v[176:179]
s_waitcnt vmcnt(8) lgkmcnt(0)
s_barrier
v_mfma_f32_16x16x32_bf16 v[128:131], v[80:83], a[144:147], v[128:131]
ds_read_b64_tr_b16 v[40:41], v8 offset:8192
s_cmp_le_u32 s37, 7
s_addc_u32 s69, 0, 7
s_lshl_b32 s38, s69, 7
s_add_u32 s4, s40, s38
s_addc_u32 s5, s41, 0
v_mfma_f32_16x16x32_bf16 v[132:135], v[80:83], a[148:151], v[132:135]
ds_read_b64_tr_b16 v[42:43], v8 offset:8704
v_mfma_f32_16x16x32_bf16 v[136:139], v[80:83], a[152:155], v[136:139]
ds_read_b128 a[160:163], v6 offset:0
s_mul_i32 s38, s69, 393216
s_add_u32 s8, s42, s38
s_addc_u32 s9, s43, 0
v_mfma_f32_16x16x32_bf16 v[140:143], v[80:83], a[156:159], v[140:143]
ds_read_b128 a[164:167], v6 offset:2048
v_mfma_f32_16x16x32_bf16 v[156:159], v[84:87], a[156:159], v[156:159]
s_add_u32 m0, s70, 32768
s_nop 0
buffer_load_dwordx4 v2, s[4:7], 0 offen offset:0 lds
ds_read_b128 a[168:171], v12 offset:0
v_mfma_f32_16x16x32_bf16 v[152:155], v[84:87], a[152:155], v[152:155]
ds_read_b128 a[172:175], v12 offset:2048
v_mfma_f32_16x16x32_bf16 v[148:151], v[84:87], a[148:151], v[148:151]
buffer_load_dwordx4 v3, s[4:7], s66 offen offset:1024 lds
ds_read_b64_tr_b16 v[44:45], v9 offset:8192
v_mfma_f32_16x16x32_bf16 v[144:147], v[84:87], a[144:147], v[144:147]
ds_read_b64_tr_b16 v[46:47], v9 offset:8704
v_mfma_f32_16x16x32_bf16 v[160:163], v[88:91], a[144:147], v[160:163]
buffer_load_dwordx4 v2, s[4:7], s67 offen offset:2048 lds
ds_read_b64_tr_b16 v[48:49], v8 offset:16384
v_mfma_f32_16x16x32_bf16 v[164:167], v[88:91], a[148:151], v[164:167]
buffer_load_dwordx4 v3, s[4:7], s68 offen offset:3072 lds
v_mfma_f32_16x16x32_bf16 v[168:171], v[88:91], a[152:155], v[168:171]
ds_read_b64_tr_b16 v[50:51], v8 offset:16896
ds_read_b64_tr_b16 v[52:53], v9 offset:16384
v_mfma_f32_16x16x32_bf16 v[172:175], v[88:91], a[156:159], v[172:175]
s_add_u32 m0, s70, 106496
s_nop 0
buffer_load_dwordx4 v4, s[8:11], s88 offen offset:0 lds
v_mfma_f32_16x16x32_bf16 v[188:191], v[92:95], a[156:159], v[188:191]
ds_read_b64_tr_b16 v[54:55], v9 offset:16896
v_mfma_f32_16x16x32_bf16 v[184:187], v[92:95], a[152:155], v[184:187]
v_mfma_f32_16x16x32_bf16 v[180:183], v[92:95], a[148:151], v[180:183]
v_mfma_f32_16x16x32_bf16 v[176:179], v[92:95], a[144:147], v[176:179]
s_waitcnt lgkmcnt(0)
v_mfma_f32_16x16x32_bf16 v[128:131], v[40:43], a[160:163], v[128:131]
ds_read_b64_tr_b16 v[80:81], v8 offset:12288
buffer_load_dwordx4 v5, s[8:11], s89 offen offset:1024 lds
v_mfma_f32_16x16x32_bf16 v[132:135], v[40:43], a[164:167], v[132:135]
ds_read_b64_tr_b16 v[82:83], v8 offset:12800
v_mfma_f32_16x16x32_bf16 v[136:139], v[40:43], a[168:171], v[136:139]
ds_read_b128 a[176:179], v7 offset:0
v_mfma_f32_16x16x32_bf16 v[140:143], v[40:43], a[172:175], v[140:143]
ds_read_b128 a[180:183], v7 offset:2048
buffer_load_dwordx4 v4, s[8:11], s90 offen offset:2048 lds
v_mfma_f32_16x16x32_bf16 v[156:159], v[44:47], a[172:175], v[156:159]
ds_read_b128 a[184:187], v13 offset:0
v_mfma_f32_16x16x32_bf16 v[152:155], v[44:47], a[168:171], v[152:155]
ds_read_b128 a[188:191], v13 offset:2048
v_mfma_f32_16x16x32_bf16 v[148:151], v[44:47], a[164:167], v[148:151]
buffer_load_dwordx4 v5, s[8:11], s91 offen offset:3072 lds
ds_read_b64_tr_b16 v[84:85], v9 offset:12288
v_mfma_f32_16x16x32_bf16 v[144:147], v[44:47], a[160:163], v[144:147]
ds_read_b64_tr_b16 v[86:87], v9 offset:12800
v_mfma_f32_16x16x32_bf16 v[160:163], v[48:51], a[160:163], v[160:163]
s_add_u32 m0, s71, 98304
s_nop 0
buffer_load_dwordx4 v4, s[8:11], s94 offen lds
v_mfma_f32_16x16x32_bf16 v[164:167], v[48:51], a[164:167], v[164:167]
ds_read_b64_tr_b16 v[88:89], v8 offset:20480
ds_read_b64_tr_b16 v[90:91], v8 offset:20992
v_mfma_f32_16x16x32_bf16 v[168:171], v[48:51], a[168:171], v[168:171]
ds_read_b64_tr_b16 v[92:93], v9 offset:20480
v_mfma_f32_16x16x32_bf16 v[172:175], v[48:51], a[172:175], v[172:175]
buffer_load_dwordx4 v5, s[8:11], s95 offen offset:1024 lds
v_mfma_f32_16x16x32_bf16 v[188:191], v[52:55], a[172:175], v[188:191]
ds_read_b64_tr_b16 v[94:95], v9 offset:20992
v_mfma_f32_16x16x32_bf16 v[184:187], v[52:55], a[168:171], v[184:187]
v_mfma_f32_16x16x32_bf16 v[180:183], v[52:55], a[164:167], v[180:183]
v_mfma_f32_16x16x32_bf16 v[176:179], v[52:55], a[160:163], v[176:179]
s_waitcnt vmcnt(10) lgkmcnt(0)
s_barrier
v_mfma_f32_16x16x32_bf16 v[128:131], v[80:83], a[176:179], v[128:131]
ds_read_b64_tr_b16 v[40:41], v8 offset:32768
s_cmp_le_u32 s37, 8
s_addc_u32 s69, 0, 8
s_lshl_b32 s38, s69, 7
s_add_u32 s4, s40, s38
s_addc_u32 s5, s41, 0
v_mfma_f32_16x16x32_bf16 v[132:135], v[80:83], a[180:183], v[132:135]
ds_read_b64_tr_b16 v[42:43], v8 offset:33280
v_mfma_f32_16x16x32_bf16 v[136:139], v[80:83], a[184:187], v[136:139]
ds_read_b128 a[192:195], v6 offset:16384
s_mul_i32 s38, s69, 393216
s_add_u32 s8, s42, s38
s_addc_u32 s9, s43, 0
v_mfma_f32_16x16x32_bf16 v[140:143], v[80:83], a[188:191], v[140:143]
ds_read_b128 a[196:199], v6 offset:18432
v_mfma_f32_16x16x32_bf16 v[156:159], v[84:87], a[188:191], v[156:159]
s_add_u32 m0, s70, 0
s_nop 0
buffer_load_dwordx4 v2, s[4:7], 0 offen offset:0 lds
ds_read_b128 a[200:203], v12 offset:16384
v_mfma_f32_16x16x32_bf16 v[152:155], v[84:87], a[184:187], v[152:155]
ds_read_b128 a[204:207], v12 offset:18432
v_mfma_f32_16x16x32_bf16 v[148:151], v[84:87], a[180:183], v[148:151]
buffer_load_dwordx4 v3, s[4:7], s66 offen offset:1024 lds
ds_read_b64_tr_b16 v[44:45], v9 offset:32768
v_mfma_f32_16x16x32_bf16 v[144:147], v[84:87], a[176:179], v[144:147]
ds_read_b64_tr_b16 v[46:47], v9 offset:33280
v_mfma_f32_16x16x32_bf16 v[160:163], v[88:91], a[176:179], v[160:163]
buffer_load_dwordx4 v2, s[4:7], s67 offen offset:2048 lds
ds_read_b64_tr_b16 v[48:49], v8 offset:40960
v_mfma_f32_16x16x32_bf16 v[164:167], v[88:91], a[180:183], v[164:167]
buffer_load_dwordx4 v3, s[4:7], s68 offen offset:3072 lds
v_mfma_f32_16x16x32_bf16 v[168:171], v[88:91], a[184:187], v[168:171]
ds_read_b64_tr_b16 v[50:51], v8 offset:41472
ds_read_b64_tr_b16 v[52:53], v9 offset:40960
v_mfma_f32_16x16x32_bf16 v[172:175], v[88:91], a[188:191], v[172:175]
s_add_u32 m0, s70, 57344
s_nop 0
buffer_load_dwordx4 v4, s[8:11], s88 offen offset:0 lds
v_mfma_f32_16x16x32_bf16 v[188:191], v[92:95], a[188:191], v[188:191]
ds_read_b64_tr_b16 v[54:55], v9 offset:41472
v_mfma_f32_16x16x32_bf16 v[184:187], v[92:95], a[184:187], v[184:187]
v_mfma_f32_16x16x32_bf16 v[180:183], v[92:95], a[180:183], v[180:183]
v_mfma_f32_16x16x32_bf16 v[176:179], v[92:95], a[176:179], v[176:179]
s_waitcnt lgkmcnt(0)
v_mfma_f32_16x16x32_bf16 v[128:131], v[40:43], a[192:195], v[128:131]
ds_read_b64_tr_b16 v[80:81], v8 offset:36864
buffer_load_dwordx4 v5, s[8:11], s89 offen offset:1024 lds
v_mfma_f32_16x16x32_bf16 v[132:135], v[40:43], a[196:199], v[132:135]
ds_read_b64_tr_b16 v[82:83], v8 offset:37376
v_mfma_f32_16x16x32_bf16 v[136:139], v[40:43], a[200:203], v[136:139]
ds_read_b128 a[208:211], v7 offset:16384
v_mfma_f32_16x16x32_bf16 v[140:143], v[40:43], a[204:207], v[140:143]
ds_read_b128 a[212:215], v7 offset:18432
buffer_load_dwordx4 v4, s[8:11], s90 offen offset:2048 lds
v_mfma_f32_16x16x32_bf16 v[156:159], v[44:47], a[204:207], v[156:159]
ds_read_b128 a[216:219], v13 offset:16384
v_mfma_f32_16x16x32_bf16 v[152:155], v[44:47], a[200:203], v[152:155]
ds_read_b128 a[220:223], v13 offset:18432
v_mfma_f32_16x16x32_bf16 v[148:151], v[44:47], a[196:199], v[148:151]
buffer_load_dwordx4 v5, s[8:11], s91 offen offset:3072 lds
ds_read_b64_tr_b16 v[84:85], v9 offset:36864
v_mfma_f32_16x16x32_bf16 v[144:147], v[44:47], a[192:195], v[144:147]
ds_read_b64_tr_b16 v[86:87], v9 offset:37376
v_mfma_f32_16x16x32_bf16 v[160:163], v[48:51], a[192:195], v[160:163]
s_add_u32 m0, s71, 49152
s_nop 0
buffer_load_dwordx4 v4, s[8:11], s94 offen lds
v_mfma_f32_16x16x32_bf16 v[164:167], v[48:51], a[196:199], v[164:167]
ds_read_b64_tr_b16 v[88:89], v8 offset:45056
ds_read_b64_tr_b16 v[90:91], v8 offset:45568
v_mfma_f32_16x16x32_bf16 v[168:171], v[48:51], a[200:203], v[168:171]
ds_read_b64_tr_b16 v[92:93], v9 offset:45056
v_mfma_f32_16x16x32_bf16 v[172:175], v[48:51], a[204:207], v[172:175]
buffer_load_dwordx4 v5, s[8:11], s95 offen offset:1024 lds
v_mfma_f32_16x16x32_bf16 v[188:191], v[52:55], a[204:207], v[188:191]
ds_read_b64_tr_b16 v[94:95], v9 offset:45568
v_mfma_f32_16x16x32_bf16 v[184:187], v[52:55], a[200:203], v[184:187]
v_mfma_f32_16x16x32_bf16 v[180:183], v[52:55], a[196:199], v[180:183]
v_mfma_f32_16x16x32_bf16 v[176:179], v[52:55], a[192:195], v[176:179]
s_waitcnt vmcnt(10) lgkmcnt(0)
s_barrier
v_mfma_f32_16x16x32_bf16 v[128:131], v[80:83], a[208:211], v[128:131]
ds_read_b64_tr_b16 v[32:33], v10 offset:0
s_cmp_le_u32 s37, 9
s_addc_u32 s69, 0, 9
s_lshl_b32 s38, s69, 7
s_add_u32 s4, s40, s38
s_addc_u32 s5, s41, 0
v_mfma_f32_16x16x32_bf16 v[132:135], v[80:83], a[212:215], v[132:135]
ds_read_b64_tr_b16 v[34:35], v10 offset:512
ds_read_b128 v[16:19], v6 offset:32768
v_mfma_f32_16x16x32_bf16 v[136:139], v[80:83], a[216:219], v[136:139]
s_mul_i32 s38, s69, 393216
s_add_u32 s8, s42, s38
s_addc_u32 s9, s43, 0
ds_read_b128 v[20:23], v6 offset:34816
v_mfma_f32_16x16x32_bf16 v[140:143], v[80:83], a[220:223], v[140:143]
ds_read_b128 v[24:27], v12 offset:32768
ds_read_b128 v[28:31], v12 offset:34816
v_mfma_f32_16x16x32_bf16 v[156:159], v[84:87], a[220:223], v[156:159]
s_add_u32 m0, s70, 16384
s_nop 0
buffer_load_dwordx4 v2, s[4:7], 0 offen offset:0 lds
v_mfma_f32_16x16x32_bf16 v[152:155], v[84:87], a[216:219], v[152:155]
ds_read_b64_tr_b16 v[36:37], v11 offset:0
ds_read_b64_tr_b16 v[38:39], v11 offset:512
v_mfma_f32_16x16x32_bf16 v[148:151], v[84:87], a[212:215], v[148:151]
buffer_load_dwordx4 v3, s[4:7], s66 offen offset:1024 lds
ds_read_b64_tr_b16 v[40:41], v10 offset:8192
v_mfma_f32_16x16x32_bf16 v[144:147], v[84:87], a[208:211], v[144:147]
ds_read_b64_tr_b16 v[42:43], v10 offset:8704
buffer_load_dwordx4 v2, s[4:7], s67 offen offset:2048 lds
v_mfma_f32_16x16x32_bf16 v[160:163], v[88:91], a[208:211], v[160:163]
ds_read_b64_tr_b16 v[44:45], v11 offset:8192
v_mfma_f32_16x16x32_bf16 v[164:167], v[88:91], a[212:215], v[164:167]
ds_read_b64_tr_b16 v[46:47], v11 offset:8704
ds_read_b64_tr_b16 v[48:49], v10 offset:16384
v_mfma_f32_16x16x32_bf16 v[168:171], v[88:91], a[216:219], v[168:171]
buffer_load_dwordx4 v3, s[4:7], s68 offen offset:3072 lds
ds_read_b64_tr_b16 v[50:51], v10 offset:16896
v_mfma_f32_16x16x32_bf16 v[172:175], v[88:91], a[220:223], v[172:175]
ds_read_b64_tr_b16 v[52:53], v11 offset:16384
s_add_u32 m0, s70, 81920
s_nop 0
buffer_load_dwordx4 v4, s[8:11], s88 offen offset:0 lds
v_mfma_f32_16x16x32_bf16 v[188:191], v[92:95], a[220:223], v[188:191]
ds_read_b64_tr_b16 v[54:55], v11 offset:16896
v_mfma_f32_16x16x32_bf16 v[184:187], v[92:95], a[216:219], v[184:187]
v_mfma_f32_16x16x32_bf16 v[180:183], v[92:95], a[212:215], v[180:183]
v_mfma_f32_16x16x32_bf16 v[176:179], v[92:95], a[208:211], v[176:179]
s_waitcnt lgkmcnt(0)
v_mfma_f32_16x16x32_bf16 v[96:99], v[32:35], v[16:19], v[96:99]
ds_read_b64_tr_b16 v[72:73], v10 offset:4096
ds_read_b64_tr_b16 v[74:75], v10 offset:4608
v_mfma_f32_16x16x32_bf16 v[100:103], v[32:35], v[20:23], v[100:103]
buffer_load_dwordx4 v5, s[8:11], s89 offen offset:1024 lds
v_mfma_f32_16x16x32_bf16 v[104:107], v[32:35], v[24:27], v[104:107]
ds_read_b128 v[56:59], v7 offset:32768
v_mfma_f32_16x16x32_bf16 v[108:111], v[32:35], v[28:31], v[108:111]
ds_read_b128 v[60:63], v7 offset:34816
v_mfma_f32_16x16x32_bf16 v[124:127], v[36:39], v[28:31], v[124:127]
ds_read_b128 v[64:67], v13 offset:32768
v_mfma_f32_16x16x32_bf16 v[120:123], v[36:39], v[24:27], v[120:123]
buffer_load_dwordx4 v4, s[8:11], s90 offen offset:2048 lds
v_mfma_f32_16x16x32_bf16 v[116:119], v[36:39], v[20:23], v[116:119]
ds_read_b128 v[68:71], v13 offset:34816
v_mfma_f32_16x16x32_bf16 v[112:115], v[36:39], v[16:19], v[112:115]
ds_read_b64_tr_b16 v[76:77], v11 offset:4096
v_mfma_f32_16x16x32_bf16 v[128:131], v[40:43], v[16:19], v[128:131]
ds_read_b64_tr_b16 v[78:79], v11 offset:4608
v_mfma_f32_16x16x32_bf16 v[132:135], v[40:43], v[20:23], v[132:135]
buffer_load_dwordx4 v5, s[8:11], s91 offen offset:3072 lds
v_mfma_f32_16x16x32_bf16 v[136:139], v[40:43], v[24:27], v[136:139]
ds_read_b64_tr_b16 v[80:81], v10 offset:12288
v_mfma_f32_16x16x32_bf16 v[140:143], v[40:43], v[28:31], v[140:143]
ds_read_b64_tr_b16 v[82:83], v10 offset:12800
v_mfma_f32_16x16x32_bf16 v[156:159], v[44:47], v[28:31], v[156:159]
ds_read_b64_tr_b16 v[84:85], v11 offset:12288
v_mfma_f32_16x16x32_bf16 v[152:155], v[44:47], v[24:27], v[152:155]
s_add_u32 m0, s71, 73728
s_nop 0
buffer_load_dwordx4 v4, s[8:11], s94 offen lds
v_mfma_f32_16x16x32_bf16 v[148:151], v[44:47], v[20:23], v[148:151]
ds_read_b64_tr_b16 v[86:87], v11 offset:12800
v_mfma_f32_16x16x32_bf16 v[144:147], v[44:47], v[16:19], v[144:147]
ds_read_b64_tr_b16 v[88:89], v10 offset:20480
v_mfma_f32_16x16x32_bf16 v[160:163], v[48:51], v[16:19], v[160:163]
ds_read_b64_tr_b16 v[90:91], v10 offset:20992
v_mfma_f32_16x16x32_bf16 v[164:167], v[48:51], v[20:23], v[164:167]
buffer_load_dwordx4 v5, s[8:11], s95 offen offset:1024 lds
v_mfma_f32_16x16x32_bf16 v[168:171], v[48:51], v[24:27], v[168:171]
ds_read_b64_tr_b16 v[92:93], v11 offset:20480
v_mfma_f32_16x16x32_bf16 v[172:175], v[48:51], v[28:31], v[172:175]
ds_read_b64_tr_b16 v[94:95], v11 offset:20992
v_mfma_f32_16x16x32_bf16 v[188:191], v[52:55], v[28:31], v[188:191]
v_mfma_f32_16x16x32_bf16 v[184:187], v[52:55], v[24:27], v[184:187]
v_mfma_f32_16x16x32_bf16 v[180:183], v[52:55], v[20:23], v[180:183]
v_mfma_f32_16x16x32_bf16 v[176:179], v[52:55], v[16:19], v[176:179]
buffer_load_dword v227, v225, s[12:15], s60 offen sc1
s_waitcnt vmcnt(11) lgkmcnt(0)
s_barrier
v_mfma_f32_16x16x32_bf16 v[96:99], v[72:75], v[56:59], v[96:99]
ds_read_b64_tr_b16 v[32:33], v8 offset:0
s_cmp_le_u32 s37, 10
s_addc_u32 s69, 0, 10
s_lshl_b32 s38, s69, 7
s_add_u32 s4, s40, s38
s_addc_u32 s5, s41, 0
v_mfma_f32_16x16x32_bf16 v[100:103], v[72:75], v[60:63], v[100:103]
ds_read_b64_tr_b16 v[34:35], v8 offset:512
v_mfma_f32_16x16x32_bf16 v[104:107], v[72:75], v[64:67], v[104:107]
ds_read_b128 v[16:19], v6 offset:0
v_mfma_f32_16x16x32_bf16 v[108:111], v[72:75], v[68:71], v[108:111]
s_mul_i32 s38, s69, 393216
s_add_u32 s8, s42, s38
s_addc_u32 s9, s43, 0
v_mfma_f32_16x16x32_bf16 v[124:127], v[76:79], v[68:71], v[124:127]
ds_read_b128 v[20:23], v6 offset:2048
v_mfma_f32_16x16x32_bf16 v[120:123], v[76:79], v[64:67], v[120:123]
ds_read_b128 v[24:27], v12 offset:0
v_mfma_f32_16x16x32_bf16 v[116:119], v[76:79], v[60:63], v[116:119]
ds_read_b128 v[28:31], v12 offset:2048
s_add_u32 m0, s70, 32768
s_nop 0
buffer_load_dwordx4 v2, s[4:7], 0 offen offset:0 lds
v_mfma_f32_16x16x32_bf16 v[112:115], v[76:79], v[56:59], v[112:115]
ds_read_b64_tr_b16 v[36:37], v9 offset:0
v_mfma_f32_16x16x32_bf16 v[128:131], v[80:83], v[56:59], v[128:131]
ds_read_b64_tr_b16 v[38:39], v9 offset:512
v_mfma_f32_16x16x32_bf16 v[132:135], v[80:83], v[60:63], v[132:135]
buffer_load_dwordx4 v3, s[4:7], s66 offen offset:1024 lds
v_mfma_f32_16x16x32_bf16 v[136:139], v[80:83], v[64:67], v[136:139]
ds_read_b64_tr_b16 v[40:41], v8 offset:8192
v_mfma_f32_16x16x32_bf16 v[140:143], v[80:83], v[68:71], v[140:143]
ds_read_b64_tr_b16 v[42:43], v8 offset:8704
v_mfma_f32_16x16x32_bf16 v[156:159], v[84:87], v[68:71], v[156:159]
buffer_load_dwordx4 v2, s[4:7], s67 offen offset:2048 lds
v_mfma_f32_16x16x32_bf16 v[152:155], v[84:87], v[64:67], v[152:155]
ds_read_b64_tr_b16 v[44:45], v9 offset:8192
ds_read_b64_tr_b16 v[46:47], v9 offset:8704
v_mfma_f32_16x16x32_bf16 v[148:151], v[84:87], v[60:63], v[148:151]
ds_read_b64_tr_b16 v[48:49], v8 offset:16384
v_mfma_f32_16x16x32_bf16 v[144:147], v[84:87], v[56:59], v[144:147]
buffer_load_dwordx4 v3, s[4:7], s68 offen offset:3072 lds
v_mfma_f32_16x16x32_bf16 v[160:163], v[88:91], v[56:59], v[160:163]
ds_read_b64_tr_b16 v[50:51], v8 offset:16896
s_lshr_b32 s92, s62, 1
s_add_u32 s92, s92, s34
s_lshl_b32 s92, s92, 12
s_add_u32 s92, s92, 63700992
s_xor_b32 s93, s92, 4096
v_mfma_f32_16x16x32_bf16 v[164:167], v[88:91], v[60:63], v[164:167]
ds_read_b64_tr_b16 v[52:53], v9 offset:16384
v_mfma_f32_16x16x32_bf16 v[168:171], v[88:91], v[64:67], v[168:171]
s_add_u32 m0, s70, 106496
s_nop 0
buffer_load_dwordx4 v4, s[8:11], s88 offen offset:0 lds
v_mfma_f32_16x16x32_bf16 v[172:175], v[88:91], v[68:71], v[172:175]
ds_read_b64_tr_b16 v[54:55], v9 offset:16896
v_mfma_f32_16x16x32_bf16 v[188:191], v[92:95], v[68:71], v[188:191]
v_mfma_f32_16x16x32_bf16 v[184:187], v[92:95], v[64:67], v[184:187]
v_mfma_f32_16x16x32_bf16 v[180:183], v[92:95], v[60:63], v[180:183]
v_mfma_f32_16x16x32_bf16 v[176:179], v[92:95], v[56:59], v[176:179]
s_lshl_b32 s56, s36, 1
s_add_u32 s56, s56, s34
s_mul_i32 s56, s56, 6144
s_add_u32 s56, s56, 63176704
s_add_u32 s57, s56, 4096
s_waitcnt lgkmcnt(0)
v_mfma_f32_16x16x32_bf16 v[96:99], v[32:35], v[16:19], v[96:99]
ds_read_b64_tr_b16 v[72:73], v8 offset:4096
ds_read_b64_tr_b16 v[74:75], v8 offset:4608
v_mfma_f32_16x16x32_bf16 v[100:103], v[32:35], v[20:23], v[100:103]
buffer_load_dwordx4 v5, s[8:11], s89 offen offset:1024 lds
L_wca1:
L_wp1:
s_cbranch_execz L_wp5
v_mfma_f32_16x16x32_bf16 v[104:107], v[32:35], v[24:27], v[104:107]
ds_read_b128 v[56:59], v7 offset:0
v_mfma_f32_16x16x32_bf16 v[108:111], v[32:35], v[28:31], v[108:111]
ds_read_b128 v[60:63], v7 offset:2048
v_mfma_f32_16x16x32_bf16 v[124:127], v[36:39], v[28:31], v[124:127]
ds_read_b128 v[64:67], v13 offset:0
v_mfma_f32_16x16x32_bf16 v[120:123], v[36:39], v[24:27], v[120:123]
buffer_load_dwordx4 v4, s[8:11], s90 offen offset:2048 lds
v_mfma_f32_16x16x32_bf16 v[116:119], v[36:39], v[20:23], v[116:119]
ds_read_b128 v[68:71], v13 offset:2048
v_mfma_f32_16x16x32_bf16 v[112:115], v[36:39], v[16:19], v[112:115]
ds_read_b64_tr_b16 v[76:77], v9 offset:4096
v_mfma_f32_16x16x32_bf16 v[128:131], v[40:43], v[16:19], v[128:131]
ds_read_b64_tr_b16 v[78:79], v9 offset:4608
v_mfma_f32_16x16x32_bf16 v[132:135], v[40:43], v[20:23], v[132:135]
buffer_load_dwordx4 v5, s[8:11], s91 offen offset:3072 lds
v_mfma_f32_16x16x32_bf16 v[136:139], v[40:43], v[24:27], v[136:139]
ds_read_b64_tr_b16 v[80:81], v8 offset:12288
v_mfma_f32_16x16x32_bf16 v[140:143], v[40:43], v[28:31], v[140:143]
ds_read_b64_tr_b16 v[82:83], v8 offset:12800
v_mfma_f32_16x16x32_bf16 v[156:159], v[44:47], v[28:31], v[156:159]
ds_read_b64_tr_b16 v[84:85], v9 offset:12288
v_mfma_f32_16x16x32_bf16 v[152:155], v[44:47], v[24:27], v[152:155]
s_add_u32 m0, s71, 98304
s_nop 0
buffer_load_dwordx4 v4, s[8:11], s94 offen lds
v_mfma_f32_16x16x32_bf16 v[148:151], v[44:47], v[20:23], v[148:151]
ds_read_b64_tr_b16 v[86:87], v9 offset:12800
v_mfma_f32_16x16x32_bf16 v[144:147], v[44:47], v[16:19], v[144:147]
ds_read_b64_tr_b16 v[88:89], v8 offset:20480
v_mfma_f32_16x16x32_bf16 v[160:163], v[48:51], v[16:19], v[160:163]
ds_read_b64_tr_b16 v[90:91], v8 offset:20992
v_mfma_f32_16x16x32_bf16 v[164:167], v[48:51], v[20:23], v[164:167]
buffer_load_dwordx4 v5, s[8:11], s95 offen offset:1024 lds
v_mfma_f32_16x16x32_bf16 v[168:171], v[48:51], v[24:27], v[168:171]
ds_read_b64_tr_b16 v[92:93], v9 offset:20480
v_mfma_f32_16x16x32_bf16 v[172:175], v[48:51], v[28:31], v[172:175]
ds_read_b64_tr_b16 v[94:95], v9 offset:20992
v_mfma_f32_16x16x32_bf16 v[188:191], v[52:55], v[28:31], v[188:191]
v_mfma_f32_16x16x32_bf16 v[184:187], v[52:55], v[24:27], v[184:187]
v_mfma_f32_16x16x32_bf16 v[180:183], v[52:55], v[20:23], v[180:183]
v_mfma_f32_16x16x32_bf16 v[176:179], v[52:55], v[16:19], v[176:179]
s_waitcnt vmcnt(11) lgkmcnt(0)
s_barrier
v_mfma_f32_16x16x32_bf16 v[96:99], v[72:75], v[56:59], v[96:99]
ds_read_b64_tr_b16 v[32:33], v8 offset:24576
s_cmp_le_u32 s37, 11
s_addc_u32 s69, 0, 11
s_lshl_b32 s38, s69, 7
s_add_u32 s4, s40, s38
s_addc_u32 s5, s41, 0
v_mfma_f32_16x16x32_bf16 v[100:103], v[72:75], v[60:63], v[100:103]
ds_read_b64_tr_b16 v[34:35], v8 offset:25088
v_mfma_f32_16x16x32_bf16 v[104:107], v[72:75], v[64:67], v[104:107]
ds_read_b128 v[16:19], v6 offset:16384
v_mfma_f32_16x16x32_bf16 v[108:111], v[72:75], v[68:71], v[108:111]
s_mul_i32 s38, s69, 393216
s_add_u32 s8, s42, s38
s_addc_u32 s9, s43, 0
v_mfma_f32_16x16x32_bf16 v[124:127], v[76:79], v[68:71], v[124:127]
ds_read_b128 v[20:23], v6 offset:18432
v_mfma_f32_16x16x32_bf16 v[120:123], v[76:79], v[64:67], v[120:123]
ds_read_b128 v[24:27], v12 offset:16384
v_mfma_f32_16x16x32_bf16 v[116:119], v[76:79], v[60:63], v[116:119]
ds_read_b128 v[28:31], v12 offset:18432
s_add_u32 m0, s70, 0
s_nop 0
buffer_load_dwordx4 v2, s[4:7], 0 offen offset:0 lds
v_mfma_f32_16x16x32_bf16 v[112:115], v[76:79], v[56:59], v[112:115]
ds_read_b64_tr_b16 v[36:37], v9 offset:24576
v_mfma_f32_16x16x32_bf16 v[128:131], v[80:83], v[56:59], v[128:131]
ds_read_b64_tr_b16 v[38:39], v9 offset:25088
v_mfma_f32_16x16x32_bf16 v[132:135], v[80:83], v[60:63], v[132:135]
buffer_load_dwordx4 v3, s[4:7], s66 offen offset:1024 lds
v_mfma_f32_16x16x32_bf16 v[136:139], v[80:83], v[64:67], v[136:139]
ds_read_b64_tr_b16 v[40:41], v8 offset:32768
v_mfma_f32_16x16x32_bf16 v[140:143], v[80:83], v[68:71], v[140:143]
ds_read_b64_tr_b16 v[42:43], v8 offset:33280
v_mfma_f32_16x16x32_bf16 v[156:159], v[84:87], v[68:71], v[156:159]
buffer_load_dwordx4 v2, s[4:7], s67 offen offset:2048 lds
v_mfma_f32_16x16x32_bf16 v[152:155], v[84:87], v[64:67], v[152:155]
ds_read_b64_tr_b16 v[44:45], v9 offset:32768
ds_read_b64_tr_b16 v[46:47], v9 offset:33280
v_mfma_f32_16x16x32_bf16 v[148:151], v[84:87], v[60:63], v[148:151]
ds_read_b64_tr_b16 v[48:49], v8 offset:40960
v_mfma_f32_16x16x32_bf16 v[144:147], v[84:87], v[56:59], v[144:147]
buffer_load_dwordx4 v3, s[4:7], s68 offen offset:3072 lds
v_mfma_f32_16x16x32_bf16 v[160:163], v[88:91], v[56:59], v[160:163]
ds_read_b64_tr_b16 v[50:51], v8 offset:41472
v_mfma_f32_16x16x32_bf16 v[164:167], v[88:91], v[60:63], v[164:167]
ds_read_b64_tr_b16 v[52:53], v9 offset:40960
v_mfma_f32_16x16x32_bf16 v[168:171], v[88:91], v[64:67], v[168:171]
s_add_u32 m0, s70, 57344
s_nop 0
buffer_load_dwordx4 v4, s[8:11], s88 offen offset:0 lds
v_mfma_f32_16x16x32_bf16 v[172:175], v[88:91], v[68:71], v[172:175]
ds_read_b64_tr_b16 v[54:55], v9 offset:41472
v_mfma_f32_16x16x32_bf16 v[188:191], v[92:95], v[68:71], v[188:191]
v_mfma_f32_16x16x32_bf16 v[184:187], v[92:95], v[64:67], v[184:187]
v_mfma_f32_16x16x32_bf16 v[180:183], v[92:95], v[60:63], v[180:183]
v_mfma_f32_16x16x32_bf16 v[176:179], v[92:95], v[56:59], v[176:179]
s_waitcnt lgkmcnt(0)
s_waitcnt vmcnt(15)
v_cmp_ne_u32 vcc, v227, v226
s_cbranch_vccnz L_fsp
L_fok:
v_mfma_f32_16x16x32_bf16 v[96:99], v[32:35], v[16:19], v[96:99]
ds_read_b64_tr_b16 v[72:73], v8 offset:28672
ds_read_b64_tr_b16 v[74:75], v8 offset:29184
v_mfma_f32_16x16x32_bf16 v[100:103], v[32:35], v[20:23], v[100:103]
buffer_load_dwordx4 v5, s[8:11], s89 offen offset:1024 lds
v_mfma_f32_16x16x32_bf16 v[104:107], v[32:35], v[24:27], v[104:107]
ds_read_b128 v[56:59], v7 offset:16384
v_mfma_f32_16x16x32_bf16 v[108:111], v[32:35], v[28:31], v[108:111]
ds_read_b128 v[60:63], v7 offset:18432
v_mfma_f32_16x16x32_bf16 v[124:127], v[36:39], v[28:31], v[124:127]
ds_read_b128 v[64:67], v13 offset:16384
v_mfma_f32_16x16x32_bf16 v[120:123], v[36:39], v[24:27], v[120:123]
buffer_load_dwordx4 v4, s[8:11], s90 offen offset:2048 lds
v_mfma_f32_16x16x32_bf16 v[116:119], v[36:39], v[20:23], v[116:119]
ds_read_b128 v[68:71], v13 offset:18432
v_mfma_f32_16x16x32_bf16 v[112:115], v[36:39], v[16:19], v[112:115]
ds_read_b64_tr_b16 v[76:77], v9 offset:28672
buffer_load_dwordx4 v[200:203], v1, s[12:15], s92 offen offset:0 sc1
v_mfma_f32_16x16x32_bf16 v[128:131], v[40:43], v[16:19], v[128:131]
ds_read_b64_tr_b16 v[78:79], v9 offset:29184
v_mfma_f32_16x16x32_bf16 v[132:135], v[40:43], v[20:23], v[132:135]
buffer_load_dwordx4 v5, s[8:11], s91 offen offset:3072 lds
v_mfma_f32_16x16x32_bf16 v[136:139], v[40:43], v[24:27], v[136:139]
ds_read_b64_tr_b16 v[80:81], v8 offset:36864
v_mfma_f32_16x16x32_bf16 v[140:143], v[40:43], v[28:31], v[140:143]
ds_read_b64_tr_b16 v[82:83], v8 offset:37376
v_mfma_f32_16x16x32_bf16 v[156:159], v[44:47], v[28:31], v[156:159]
ds_read_b64_tr_b16 v[84:85], v9 offset:36864
v_mfma_f32_16x16x32_bf16 v[152:155], v[44:47], v[24:27], v[152:155]
s_add_u32 m0, s71, 49152
s_nop 0
buffer_load_dwordx4 v4, s[8:11], s94 offen lds
v_mfma_f32_16x16x32_bf16 v[148:151], v[44:47], v[20:23], v[148:151]
ds_read_b64_tr_b16 v[86:87], v9 offset:37376
buffer_load_dwordx4 v[204:207], v1, s[12:15], s92 offen offset:1024 sc1
v_mfma_f32_16x16x32_bf16 v[144:147], v[44:47], v[16:19], v[144:147]
ds_read_b64_tr_b16 v[88:89], v8 offset:45056
v_mfma_f32_16x16x32_bf16 v[160:163], v[48:51], v[16:19], v[160:163]
ds_read_b64_tr_b16 v[90:91], v8 offset:45568
v_mfma_f32_16x16x32_bf16 v[164:167], v[48:51], v[20:23], v[164:167]
buffer_load_dwordx4 v5, s[8:11], s95 offen offset:1024 lds
v_mfma_f32_16x16x32_bf16 v[168:171], v[48:51], v[24:27], v[168:171]
ds_read_b64_tr_b16 v[92:93], v9 offset:45056
v_mfma_f32_16x16x32_bf16 v[172:175], v[48:51], v[28:31], v[172:175]
ds_read_b64_tr_b16 v[94:95], v9 offset:45568
v_mfma_f32_16x16x32_bf16 v[188:191], v[52:55], v[28:31], v[188:191]
buffer_load_dwordx4 v[208:211], v1, s[12:15], s92 offen offset:2048 sc1
v_mfma_f32_16x16x32_bf16 v[184:187], v[52:55], v[24:27], v[184:187]
v_mfma_f32_16x16x32_bf16 v[180:183], v[52:55], v[20:23], v[180:183]
v_mfma_f32_16x16x32_bf16 v[176:179], v[52:55], v[16:19], v[176:179]
buffer_load_dwordx4 v[212:215], v1, s[12:15], s92 offen offset:3072 sc1
s_waitcnt vmcnt(14) lgkmcnt(0)
s_barrier
v_mfma_f32_16x16x32_bf16 v[96:99], v[72:75], v[56:59], v[96:99]
ds_read_b64_tr_b16 v[32:33], v10 offset:0
s_cmp_le_u32 s37, 12
s_addc_u32 s69, 0, 12
s_lshl_b32 s38, s69, 7
s_add_u32 s4, s40, s38
s_addc_u32 s5, s41, 0
v_mfma_f32_16x16x32_bf16 v[100:103], v[72:75], v[60:63], v[100:103]
ds_read_b64_tr_b16 v[34:35], v10 offset:512
v_mfma_f32_16x16x32_bf16 v[104:107], v[72:75], v[64:67], v[104:107]
ds_read_b128 v[16:19], v6 offset:32768
v_mfma_f32_16x16x32_bf16 v[108:111], v[72:75], v[68:71], v[108:111]
s_mul_i32 s38, s69, 393216
s_add_u32 s8, s42, s38
s_addc_u32 s9, s43, 0
v_mfma_f32_16x16x32_bf16 v[124:127], v[76:79], v[68:71], v[124:127]
ds_read_b128 v[20:23], v6 offset:34816
v_mfma_f32_16x16x32_bf16 v[120:123], v[76:79], v[64:67], v[120:123]
ds_read_b128 v[24:27], v12 offset:32768
v_mfma_f32_16x16x32_bf16 v[116:119], v[76:79], v[60:63], v[116:119]
ds_read_b128 v[28:31], v12 offset:34816
s_add_u32 m0, s70, 16384
s_nop 0
buffer_load_dwordx4 v2, s[4:7], 0 offen offset:0 lds
v_mfma_f32_16x16x32_bf16 v[112:115], v[76:79], v[56:59], v[112:115]
ds_read_b64_tr_b16 v[36:37], v11 offset:0
v_mfma_f32_16x16x32_bf16 v[128:131], v[80:83], v[56:59], v[128:131]
ds_read_b64_tr_b16 v[38:39], v11 offset:512
v_mfma_f32_16x16x32_bf16 v[132:135], v[80:83], v[60:63], v[132:135]
buffer_load_dwordx4 v3, s[4:7], s66 offen offset:1024 lds
buffer_load_dwordx4 v[216:219], v1, s[12:15], s93 offen offset:0 sc1
v_mfma_f32_16x16x32_bf16 v[136:139], v[80:83], v[64:67], v[136:139]
ds_read_b64_tr_b16 v[40:41], v10 offset:8192
v_mfma_f32_16x16x32_bf16 v[140:143], v[80:83], v[68:71], v[140:143]
ds_read_b64_tr_b16 v[42:43], v10 offset:8704
v_mfma_f32_16x16x32_bf16 v[156:159], v[84:87], v[68:71], v[156:159]
buffer_load_dwordx4 v2, s[4:7], s67 offen offset:2048 lds
v_mfma_f32_16x16x32_bf16 v[152:155], v[84:87], v[64:67], v[152:155]
ds_read_b64_tr_b16 v[44:45], v11 offset:8192
ds_read_b64_tr_b16 v[46:47], v11 offset:8704
v_mfma_f32_16x16x32_bf16 v[148:151], v[84:87], v[60:63], v[148:151]
ds_read_b64_tr_b16 v[48:49], v10 offset:16384
v_mfma_f32_16x16x32_bf16 v[144:147], v[84:87], v[56:59], v[144:147]
buffer_load_dwordx4 v3, s[4:7], s68 offen offset:3072 lds
v_mfma_f32_16x16x32_bf16 v[160:163], v[88:91], v[56:59], v[160:163]
ds_read_b64_tr_b16 v[50:51], v10 offset:16896
buffer_load_dwordx4 v[220:223], v1, s[12:15], s93 offen offset:1024 sc1
v_mfma_f32_16x16x32_bf16 v[164:167], v[88:91], v[60:63], v[164:167]
ds_read_b64_tr_b16 v[52:53], v11 offset:16384
v_mfma_f32_16x16x32_bf16 v[168:171], v[88:91], v[64:67], v[168:171]
s_add_u32 m0, s70, 81920
s_nop 0
buffer_load_dwordx4 v4, s[8:11], s88 offen offset:0 lds
v_mfma_f32_16x16x32_bf16 v[172:175], v[88:91], v[68:71], v[172:175]
ds_read_b64_tr_b16 v[54:55], v11 offset:16896
v_mfma_f32_16x16x32_bf16 v[188:191], v[92:95], v[68:71], v[188:191]
v_mfma_f32_16x16x32_bf16 v[184:187], v[92:95], v[64:67], v[184:187]
buffer_load_dwordx4 v[224:227], v1, s[12:15], s93 offen offset:2048 sc1
v_mfma_f32_16x16x32_bf16 v[180:183], v[92:95], v[60:63], v[180:183]
v_mfma_f32_16x16x32_bf16 v[176:179], v[92:95], v[56:59], v[176:179]
buffer_load_dwordx4 v[228:231], v1, s[12:15], s93 offen offset:3072 sc1
s_waitcnt lgkmcnt(0)
v_mfma_f32_16x16x32_bf16 v[96:99], v[32:35], v[16:19], v[96:99]
ds_read_b64_tr_b16 v[72:73], v10 offset:4096
ds_read_b64_tr_b16 v[74:75], v10 offset:4608
v_mfma_f32_16x16x32_bf16 v[100:103], v[32:35], v[20:23], v[100:103]
buffer_load_dwordx4 v5, s[8:11], s89 offen offset:1024 lds
v_mfma_f32_16x16x32_bf16 v[104:107], v[32:35], v[24:27], v[104:107]
ds_read_b128 v[56:59], v7 offset:32768
v_mfma_f32_16x16x32_bf16 v[108:111], v[32:35], v[28:31], v[108:111]
ds_read_b128 v[60:63], v7 offset:34816
s_getpc_b64 s[58:59]
L_m_rf1:
s_and_b32 s58, s58, 0xffffff80
v_mfma_f32_16x16x32_bf16 v[124:127], v[36:39], v[28:31], v[124:127]
ds_read_b128 v[64:67], v13 offset:32768
v_mfma_f32_16x16x32_bf16 v[120:123], v[36:39], v[24:27], v[120:123]
buffer_load_dwordx4 v4, s[8:11], s90 offen offset:2048 lds
v_mfma_f32_16x16x32_bf16 v[116:119], v[36:39], v[20:23], v[116:119]
ds_read_b128 v[68:71], v13 offset:34816
v_mfma_f32_16x16x32_bf16 v[112:115], v[36:39], v[16:19], v[112:115]
ds_read_b64_tr_b16 v[76:77], v11 offset:4096
v_mfma_f32_16x16x32_bf16 v[128:131], v[40:43], v[16:19], v[128:131]
ds_read_b64_tr_b16 v[78:79], v11 offset:4608
s_lshr_b32 s60, s2, 3
s_lshl_b32 s60, s60, 2
s_add_u32 s60, s60, s3
s_mul_i32 s60, s60, 2
v_mfma_f32_16x16x32_bf16 v[132:135], v[40:43], v[20:23], v[132:135]
buffer_load_dwordx4 v5, s[8:11], s91 offen offset:3072 lds
v_mfma_f32_16x16x32_bf16 v[136:139], v[40:43], v[24:27], v[136:139]
ds_read_b64_tr_b16 v[80:81], v10 offset:12288
v_min_u32 v14, 1, v0
v_mfma_f32_16x16x32_bf16 v[140:143], v[40:43], v[28:31], v[140:143]
ds_read_b64_tr_b16 v[82:83], v10 offset:12800
v_mfma_f32_16x16x32_bf16 v[156:159], v[44:47], v[28:31], v[156:159]
ds_read_b64_tr_b16 v[84:85], v11 offset:12288
v_mfma_f32_16x16x32_bf16 v[152:155], v[44:47], v[24:27], v[152:155]
s_add_u32 m0, s71, 73728
s_nop 0
buffer_load_dwordx4 v4, s[8:11], s94 offen lds
v_add_lshl_u32 v14, v14, s60, 7
v_mfma_f32_16x16x32_bf16 v[148:151], v[44:47], v[20:23], v[148:151]
ds_read_b64_tr_b16 v[86:87], v11 offset:12800
v_mfma_f32_16x16x32_bf16 v[144:147], v[44:47], v[16:19], v[144:147]
ds_read_b64_tr_b16 v[88:89], v10 offset:20480
v_min_u32 v14, L_p4mid-L_m_rf1-128, v14
v_mfma_f32_16x16x32_bf16 v[160:163], v[48:51], v[16:19], v[160:163]
ds_read_b64_tr_b16 v[90:91], v10 offset:20992
v_mfma_f32_16x16x32_bf16 v[164:167], v[48:51], v[20:23], v[164:167]
buffer_load_dwordx4 v5, s[8:11], s95 offen offset:1024 lds
v_mfma_f32_16x16x32_bf16 v[168:171], v[48:51], v[24:27], v[168:171]
ds_read_b64_tr_b16 v[92:93], v11 offset:20480
global_load_dwordx2 a[254:255], v14, s[58:59] offset:60
v_mfma_f32_16x16x32_bf16 v[172:175], v[48:51], v[28:31], v[172:175]
ds_read_b64_tr_b16 v[94:95], v11 offset:20992
v_mfma_f32_16x16x32_bf16 v[188:191], v[52:55], v[28:31], v[188:191]
buffer_load_dwordx4 v[240:243], v1, s[12:15], s56 offen offset:2048 sc1
v_mfma_f32_16x16x32_bf16 v[184:187], v[52:55], v[24:27], v[184:187]
buffer_load_dwordx4 v[244:247], v1, s[12:15], s56 offen offset:3072 sc1
v_mfma_f32_16x16x32_bf16 v[180:183], v[52:55], v[20:23], v[180:183]
buffer_load_dwordx4 v[248:251], v1, s[12:15], s57 offen offset:0 sc1
v_mfma_f32_16x16x32_bf16 v[176:179], v[52:55], v[16:19], v[176:179]
buffer_load_dwordx4 v[252:255], v1, s[12:15], s57 offen offset:1024 sc1
s_waitcnt vmcnt(21) lgkmcnt(0)
s_barrier
v_mfma_f32_16x16x32_bf16 v[96:99], v[72:75], v[56:59], v[96:99]
ds_read_b64_tr_b16 v[32:33], v8 offset:0
s_cmp_le_u32 s37, 13
s_addc_u32 s69, 0, 13
s_lshl_b32 s38, s69, 7
s_add_u32 s4, s40, s38
s_addc_u32 s5, s41, 0
v_mfma_f32_16x16x32_bf16 v[100:103], v[72:75], v[60:63], v[100:103]
ds_read_b64_tr_b16 v[34:35], v8 offset:512
v_mfma_f32_16x16x32_bf16 v[104:107], v[72:75], v[64:67], v[104:107]
ds_read_b128 v[16:19], v6 offset:0
v_mfma_f32_16x16x32_bf16 v[108:111], v[72:75], v[68:71], v[108:111]
s_mul_i32 s38, s69, 393216
s_add_u32 s8, s42, s38
s_addc_u32 s9, s43, 0
v_mfma_f32_16x16x32_bf16 v[124:127], v[76:79], v[68:71], v[124:127]
ds_read_b128 v[20:23], v6 offset:2048
v_mfma_f32_16x16x32_bf16 v[120:123], v[76:79], v[64:67], v[120:123]
ds_read_b128 v[24:27], v12 offset:0
v_mfma_f32_16x16x32_bf16 v[116:119], v[76:79], v[60:63], v[116:119]
ds_read_b128 v[28:31], v12 offset:2048
s_add_u32 m0, s70, 32768
s_nop 0
buffer_load_dwordx4 v2, s[4:7], 0 offen offset:0 lds
v_mfma_f32_16x16x32_bf16 v[112:115], v[76:79], v[56:59], v[112:115]
ds_read_b64_tr_b16 v[36:37], v9 offset:0
v_mfma_f32_16x16x32_bf16 v[128:131], v[80:83], v[56:59], v[128:131]
ds_read_b64_tr_b16 v[38:39], v9 offset:512
v_mfma_f32_16x16x32_bf16 v[132:135], v[80:83], v[60:63], v[132:135]
buffer_load_dwordx4 v3, s[4:7], s66 offen offset:1024 lds
v_mfma_f32_16x16x32_bf16 v[136:139], v[80:83], v[64:67], v[136:139]
ds_read_b64_tr_b16 v[40:41], v8 offset:8192
v_mfma_f32_16x16x32_bf16 v[140:143], v[80:83], v[68:71], v[140:143]
ds_read_b64_tr_b16 v[42:43], v8 offset:8704
v_mfma_f32_16x16x32_bf16 v[156:159], v[84:87], v[68:71], v[156:159]
buffer_load_dwordx4 v2, s[4:7], s67 offen offset:2048 lds
v_mfma_f32_16x16x32_bf16 v[152:155], v[84:87], v[64:67], v[152:155]
ds_read_b64_tr_b16 v[44:45], v9 offset:8192
ds_read_b64_tr_b16 v[46:47], v9 offset:8704
v_mfma_f32_16x16x32_bf16 v[148:151], v[84:87], v[60:63], v[148:151]
ds_read_b64_tr_b16 v[48:49], v8 offset:16384
v_mfma_f32_16x16x32_bf16 v[144:147], v[84:87], v[56:59], v[144:147]
buffer_load_dwordx4 v3, s[4:7], s68 offen offset:3072 lds
v_mfma_f32_16x16x32_bf16 v[160:163], v[88:91], v[56:59], v[160:163]
ds_read_b64_tr_b16 v[50:51], v8 offset:16896
v_mfma_f32_16x16x32_bf16 v[164:167], v[88:91], v[60:63], v[164:167]
ds_read_b64_tr_b16 v[52:53], v9 offset:16384
v_mfma_f32_16x16x32_bf16 v[168:171], v[88:91], v[64:67], v[168:171]
s_add_u32 m0, s70, 106496
s_nop 0
buffer_load_dwordx4 v4, s[8:11], s88 offen offset:0 lds
v_mfma_f32_16x16x32_bf16 v[172:175], v[88:91], v[68:71], v[172:175]
ds_read_b64_tr_b16 v[54:55], v9 offset:16896
v_mfma_f32_16x16x32_bf16 v[188:191], v[92:95], v[68:71], v[188:191]
v_mfma_f32_16x16x32_bf16 v[184:187], v[92:95], v[64:67], v[184:187]
v_mfma_f32_16x16x32_bf16 v[180:183], v[92:95], v[60:63], v[180:183]
v_mfma_f32_16x16x32_bf16 v[176:179], v[92:95], v[56:59], v[176:179]
s_waitcnt lgkmcnt(0)
v_mfma_f32_16x16x32_bf16 v[96:99], v[32:35], v[16:19], v[96:99]
ds_read_b64_tr_b16 v[72:73], v8 offset:4096
ds_read_b64_tr_b16 v[74:75], v8 offset:4608
v_mfma_f32_16x16x32_bf16 v[100:103], v[32:35], v[20:23], v[100:103]
buffer_load_dwordx4 v5, s[8:11], s89 offen offset:1024 lds
v_mfma_f32_16x16x32_bf16 v[104:107], v[32:35], v[24:27], v[104:107]
ds_read_b128 v[56:59], v7 offset:0
s_waitcnt vmcnt(16)
s_mov_b32 s48, 0
s_mov_b32 s49, -1
v_mfma_f32_16x16x32_bf16 v[108:111], v[32:35], v[28:31], v[108:111]
ds_read_b128 v[60:63], v7 offset:2048
v_add_f32 v200, v200, v204
v_mfma_f32_16x16x32_bf16 v[124:127], v[36:39], v[28:31], v[124:127]
ds_read_b128 v[64:67], v13 offset:0
v_mfma_f32_16x16x32_bf16 v[120:123], v[36:39], v[24:27], v[120:123]
buffer_load_dwordx4 v4, s[8:11], s90 offen offset:2048 lds
v_add_f32 v216, v216, v220
v_mfma_f32_16x16x32_bf16 v[116:119], v[36:39], v[20:23], v[116:119]
ds_read_b128 v[68:71], v13 offset:2048
v_add_f32 v201, v201, v205
v_mfma_f32_16x16x32_bf16 v[112:115], v[36:39], v[16:19], v[112:115]
ds_read_b64_tr_b16 v[76:77], v9 offset:4096
v_add_f32 v217, v217, v221
v_mfma_f32_16x16x32_bf16 v[128:131], v[40:43], v[16:19], v[128:131]
ds_read_b64_tr_b16 v[78:79], v9 offset:4608
v_add_f32 v202, v202, v206
v_mfma_f32_16x16x32_bf16 v[132:135], v[40:43], v[20:23], v[132:135]
buffer_load_dwordx4 v5, s[8:11], s91 offen offset:3072 lds
v_add_f32 v218, v218, v222
v_mfma_f32_16x16x32_bf16 v[136:139], v[40:43], v[24:27], v[136:139]
ds_read_b64_tr_b16 v[80:81], v8 offset:12288
v_mfma_f32_16x16x32_bf16 v[140:143], v[40:43], v[28:31], v[140:143]
ds_read_b64_tr_b16 v[82:83], v8 offset:12800
v_add_f32 v203, v203, v207
v_mfma_f32_16x16x32_bf16 v[156:159], v[44:47], v[28:31], v[156:159]
ds_read_b64_tr_b16 v[84:85], v9 offset:12288
v_add_f32 v219, v219, v223
v_mfma_f32_16x16x32_bf16 v[152:155], v[44:47], v[24:27], v[152:155]
s_add_u32 m0, s71, 98304
s_nop 0
buffer_load_dwordx4 v4, s[8:11], s94 offen lds
v_add_f32 v208, v208, v212
v_mfma_f32_16x16x32_bf16 v[148:151], v[44:47], v[20:23], v[148:151]
ds_read_b64_tr_b16 v[86:87], v9 offset:12800
v_mfma_f32_16x16x32_bf16 v[144:147], v[44:47], v[16:19], v[144:147]
ds_read_b64_tr_b16 v[88:89], v8 offset:20480
v_add_f32 v224, v224, v228
v_mfma_f32_16x16x32_bf16 v[160:163], v[48:51], v[16:19], v[160:163]
ds_read_b64_tr_b16 v[90:91], v8 offset:20992
v_add_f32 v209, v209, v213
v_mfma_f32_16x16x32_bf16 v[164:167], v[48:51], v[20:23], v[164:167]
buffer_load_dwordx4 v5, s[8:11], s95 offen offset:1024 lds
v_add_f32 v225, v225, v229
v_mfma_f32_16x16x32_bf16 v[168:171], v[48:51], v[24:27], v[168:171]
ds_read_b64_tr_b16 v[92:93], v9 offset:20480
v_add_f32 v210, v210, v214
v_mfma_f32_16x16x32_bf16 v[172:175], v[48:51], v[28:31], v[172:175]
ds_read_b64_tr_b16 v[94:95], v9 offset:20992
v_add_f32 v226, v226, v230
v_mfma_f32_16x16x32_bf16 v[188:191], v[52:55], v[28:31], v[188:191]
v_add_f32 v211, v211, v215
v_mfma_f32_16x16x32_bf16 v[184:187], v[52:55], v[24:27], v[184:187]
v_add_f32 v227, v227, v231
v_add_f32 v200, v200, v208
v_mfma_f32_16x16x32_bf16 v[180:183], v[52:55], v[20:23], v[180:183]
v_add_f32 v216, v216, v224
v_add_f32 v201, v201, v209
v_mfma_f32_16x16x32_bf16 v[176:179], v[52:55], v[16:19], v[176:179]
v_add_f32 v217, v217, v225
v_add_f32 v202, v202, v210
s_waitcnt vmcnt(15) lgkmcnt(0)
s_barrier
v_mfma_f32_16x16x32_bf16 v[96:99], v[72:75], v[56:59], v[96:99]
ds_read_b64_tr_b16 v[32:33], v8 offset:24576
s_cmp_le_u32 s37, 14
s_addc_u32 s69, 0, 14
s_lshl_b32 s38, s69, 7
s_add_u32 s4, s40, s38
s_addc_u32 s5, s41, 0
v_mfma_f32_16x16x32_bf16 v[100:103], v[72:75], v[60:63], v[100:103]
ds_read_b64_tr_b16 v[34:35], v8 offset:25088
v_mfma_f32_16x16x32_bf16 v[104:107], v[72:75], v[64:67], v[104:107]
ds_read_b128 v[16:19], v6 offset:16384
v_mfma_f32_16x16x32_bf16 v[108:111], v[72:75], v[68:71], v[108:111]
s_mul_i32 s38, s69, 393216
s_add_u32 s8, s42, s38
s_addc_u32 s9, s43, 0
v_add_f32 v218, v218, v226
v_mfma_f32_16x16x32_bf16 v[124:127], v[76:79], v[68:71], v[124:127]
ds_read_b128 v[20:23], v6 offset:18432
v_add_f32 v203, v203, v211
v_mfma_f32_16x16x32_bf16 v[120:123], v[76:79], v[64:67], v[120:123]
ds_read_b128 v[24:27], v12 offset:16384
v_add_f32 v219, v219, v227
v_mfma_f32_16x16x32_bf16 v[116:119], v[76:79], v[60:63], v[116:119]
ds_read_b128 v[28:31], v12 offset:18432
s_add_u32 m0, s70, 0
s_nop 0
buffer_load_dwordx4 v2, s[4:7], 0 offen offset:0 lds
v_mfma_f32_16x16x32_bf16 v[112:115], v[76:79], v[56:59], v[112:115]
ds_read_b64_tr_b16 v[36:37], v9 offset:24576
v_mfma_f32_16x16x32_bf16 v[128:131], v[80:83], v[56:59], v[128:131]
ds_read_b64_tr_b16 v[38:39], v9 offset:25088
v_mfma_f32_16x16x32_bf16 v[132:135], v[80:83], v[60:63], v[132:135]
buffer_load_dwordx4 v3, s[4:7], s66 offen offset:1024 lds
v_permlane16_swap_b32 v200, v201
v_mfma_f32_16x16x32_bf16 v[136:139], v[80:83], v[64:67], v[136:139]
ds_read_b64_tr_b16 v[40:41], v8 offset:32768
v_mfma_f32_16x16x32_bf16 v[140:143], v[80:83], v[68:71], v[140:143]
ds_read_b64_tr_b16 v[42:43], v8 offset:33280
v_permlane16_swap_b32 v216, v217
v_mfma_f32_16x16x32_bf16 v[156:159], v[84:87], v[68:71], v[156:159]
buffer_load_dwordx4 v2, s[4:7], s67 offen offset:2048 lds
v_permlane16_swap_b32 v202, v203
v_mfma_f32_16x16x32_bf16 v[152:155], v[84:87], v[64:67], v[152:155]
ds_read_b64_tr_b16 v[44:45], v9 offset:32768
ds_read_b64_tr_b16 v[46:47], v9 offset:33280
v_mfma_f32_16x16x32_bf16 v[148:151], v[84:87], v[60:63], v[148:151]
ds_read_b64_tr_b16 v[48:49], v8 offset:40960
v_mfma_f32_16x16x32_bf16 v[144:147], v[84:87], v[56:59], v[144:147]
buffer_load_dwordx4 v3, s[4:7], s68 offen offset:3072 lds
v_permlane16_swap_b32 v218, v219
v_mfma_f32_16x16x32_bf16 v[160:163], v[88:91], v[56:59], v[160:163]
ds_read_b64_tr_b16 v[50:51], v8 offset:41472
v_add_f32 v201, v200, v201
v_mfma_f32_16x16x32_bf16 v[164:167], v[88:91], v[60:63], v[164:167]
ds_read_b64_tr_b16 v[52:53], v9 offset:40960
v_add_f32 v217, v216, v217
v_mfma_f32_16x16x32_bf16 v[168:171], v[88:91], v[64:67], v[168:171]
s_add_u32 m0, s70, 57344
s_nop 0
buffer_load_dwordx4 v4, s[8:11], s88 offen offset:0 lds
v_mfma_f32_16x16x32_bf16 v[172:175], v[88:91], v[68:71], v[172:175]
ds_read_b64_tr_b16 v[54:55], v9 offset:41472
v_add_f32 v203, v202, v203
v_mfma_f32_16x16x32_bf16 v[188:191], v[92:95], v[68:71], v[188:191]
v_add_f32 v219, v218, v219
v_mfma_f32_16x16x32_bf16 v[184:187], v[92:95], v[64:67], v[184:187]
v_permlane32_swap_b32 v201, v203
v_mfma_f32_16x16x32_bf16 v[180:183], v[92:95], v[60:63], v[180:183]
v_permlane32_swap_b32 v217, v219
v_add_f32 v201, v201, v203
v_mfma_f32_16x16x32_bf16 v[176:179], v[92:95], v[56:59], v[176:179]
v_add_f32 v217, v217, v219
v_mov_b32 v203, v201
v_mov_b32 v219, v217
s_waitcnt lgkmcnt(0)
v_mfma_f32_16x16x32_bf16 v[96:99], v[32:35], v[16:19], v[96:99]
ds_read_b64_tr_b16 v[72:73], v8 offset:28672
ds_read_b64_tr_b16 v[74:75], v8 offset:29184
v_mfma_f32_16x16x32_bf16 v[100:103], v[32:35], v[20:23], v[100:103]
buffer_load_dwordx4 v5, s[8:11], s89 offen offset:1024 lds
v_mfma_f32_16x16x32_bf16 v[104:107], v[32:35], v[24:27], v[104:107]
ds_read_b128 v[56:59], v7 offset:16384
v_mfma_f32_16x16x32_bf16 v[108:111], v[32:35], v[28:31], v[108:111]
ds_read_b128 v[60:63], v7 offset:18432
v_permlane32_swap_b32 v201, v203
v_mfma_f32_16x16x32_bf16 v[124:127], v[36:39], v[28:31], v[124:127]
ds_read_b128 v[64:67], v13 offset:16384
v_mfma_f32_16x16x32_bf16 v[120:123], v[36:39], v[24:27], v[120:123]
buffer_load_dwordx4 v4, s[8:11], s90 offen offset:2048 lds
v_permlane32_swap_b32 v217, v219
v_mfma_f32_16x16x32_bf16 v[116:119], v[36:39], v[20:23], v[116:119]
ds_read_b128 v[68:71], v13 offset:18432
v_mov_b32 v200, v201
v_mfma_f32_16x16x32_bf16 v[112:115], v[36:39], v[16:19], v[112:115]
ds_read_b64_tr_b16 v[76:77], v9 offset:28672
v_mov_b32 v216, v217
v_mfma_f32_16x16x32_bf16 v[128:131], v[40:43], v[16:19], v[128:131]
ds_read_b64_tr_b16 v[78:79], v9 offset:29184
v_mfma_f32_16x16x32_bf16 v[132:135], v[40:43], v[20:23], v[132:135]
buffer_load_dwordx4 v5, s[8:11], s91 offen offset:3072 lds
v_mov_b32 v202, v203
v_mfma_f32_16x16x32_bf16 v[136:139], v[40:43], v[24:27], v[136:139]
ds_read_b64_tr_b16 v[80:81], v8 offset:36864
v_mov_b32 v218, v219
v_mfma_f32_16x16x32_bf16 v[140:143], v[40:43], v[28:31], v[140:143]
ds_read_b64_tr_b16 v[82:83], v8 offset:37376
v_mfma_f32_16x16x32_bf16 v[156:159], v[44:47], v[28:31], v[156:159]
ds_read_b64_tr_b16 v[84:85], v9 offset:36864
v_permlane16_swap_b32 v200, v201
v_mfma_f32_16x16x32_bf16 v[152:155], v[44:47], v[24:27], v[152:155]
s_add_u32 m0, s71, 49152
s_nop 0
buffer_load_dwordx4 v4, s[8:11], s94 offen lds
v_mfma_f32_16x16x32_bf16 v[148:151], v[44:47], v[20:23], v[148:151]
ds_read_b64_tr_b16 v[86:87], v9 offset:37376
v_mfma_f32_16x16x32_bf16 v[144:147], v[44:47], v[16:19], v[144:147]
ds_read_b64_tr_b16 v[88:89], v8 offset:45056
v_permlane16_swap_b32 v216, v217
v_mfma_f32_16x16x32_bf16 v[160:163], v[48:51], v[16:19], v[160:163]
ds_read_b64_tr_b16 v[90:91], v8 offset:45568
v_mfma_f32_16x16x32_bf16 v[164:167], v[48:51], v[20:23], v[164:167]
buffer_load_dwordx4 v5, s[8:11], s95 offen offset:1024 lds
v_permlane16_swap_b32 v202, v203
v_mfma_f32_16x16x32_bf16 v[168:171], v[48:51], v[24:27], v[168:171]
ds_read_b64_tr_b16 v[92:93], v9 offset:45056
v_mfma_f32_16x16x32_bf16 v[172:175], v[48:51], v[28:31], v[172:175]
ds_read_b64_tr_b16 v[94:95], v9 offset:45568
v_permlane16_swap_b32 v218, v219
v_mfma_f32_16x16x32_bf16 v[188:191], v[52:55], v[28:31], v[188:191]
v_mul_f32 v204, 0xba800000, v200
v_mfma_f32_16x16x32_bf16 v[184:187], v[52:55], v[24:27], v[184:187]
v_mul_f32 v220, 0xba800000, v216
v_mul_f32 v206, 0xba800000, v202
v_mfma_f32_16x16x32_bf16 v[180:183], v[52:55], v[20:23], v[180:183]
v_mul_f32 v222, 0xba800000, v218
v_mul_f32 v201, 0x3a800000, v201
v_mfma_f32_16x16x32_bf16 v[176:179], v[52:55], v[16:19], v[176:179]
v_mul_f32 v217, 0x3a800000, v217
v_mul_f32 v203, 0x3a800000, v203
s_waitcnt vmcnt(10) lgkmcnt(0)
s_barrier
v_mfma_f32_16x16x32_bf16 v[96:99], v[72:75], v[56:59], v[96:99]
ds_read_b64_tr_b16 v[32:33], v10 offset:0
s_cmp_le_u32 s37, 0
s_addc_u32 s69, 0, 0
s_mul_i32 s38, s69, 393216
s_add_u32 s8, s42, s38
s_addc_u32 s9, s43, 0
v_mfma_f32_16x16x32_bf16 v[100:103], v[72:75], v[60:63], v[100:103]
ds_read_b64_tr_b16 v[34:35], v10 offset:512
v_mfma_f32_16x16x32_bf16 v[104:107], v[72:75], v[64:67], v[104:107]
ds_read_b128 v[16:19], v6 offset:32768
v_mul_f32 v219, 0x3a800000, v219
v_mfma_f32_16x16x32_bf16 v[108:111], v[72:75], v[68:71], v[108:111]
s_add_u32 m0, s71, 131072
s_nop 0
buffer_load_dwordx4 v4, s[8:11], s94 offen lds
v_mfma_f32_16x16x32_bf16 v[124:127], v[76:79], v[68:71], v[124:127]
ds_read_b128 v[20:23], v6 offset:34816
L_wca2:
L_wp2:
s_cbranch_execz L_wp7
buffer_load_dwordx4 v5, s[8:11], s95 offen offset:1024 lds
v_fma_f32 v201, -v204, v204, v201
v_mfma_f32_16x16x32_bf16 v[120:123], v[76:79], v[64:67], v[120:123]
ds_read_b128 v[24:27], v12 offset:32768
v_fma_f32 v217, -v220, v220, v217
v_mfma_f32_16x16x32_bf16 v[116:119], v[76:79], v[60:63], v[116:119]
ds_read_b128 v[28:31], v12 offset:34816
v_fma_f32 v203, -v206, v206, v203
v_mfma_f32_16x16x32_bf16 v[112:115], v[76:79], v[56:59], v[112:115]
s_cmp_le_u32 s37, 1
s_addc_u32 s69, 0, 1
s_mul_i32 s38, s69, 393216
s_add_u32 s8, s42, s38
s_addc_u32 s9, s43, 0
v_mfma_f32_16x16x32_bf16 v[128:131], v[80:83], v[56:59], v[128:131]
ds_read_b64_tr_b16 v[36:37], v11 offset:0
ds_read_b64_tr_b16 v[38:39], v11 offset:512
v_mfma_f32_16x16x32_bf16 v[132:135], v[80:83], v[60:63], v[132:135]
s_add_u32 m0, s71, 139264
s_nop 0
buffer_load_dwordx4 v4, s[8:11], s94 offen lds
v_fma_f32 v219, -v222, v222, v219
v_mfma_f32_16x16x32_bf16 v[136:139], v[80:83], v[64:67], v[136:139]
ds_read_b64_tr_b16 v[40:41], v10 offset:8192
v_max_f32 v201, 0, v201
v_mfma_f32_16x16x32_bf16 v[140:143], v[80:83], v[68:71], v[140:143]
ds_read_b64_tr_b16 v[42:43], v10 offset:8704
v_max_f32 v217, 0, v217
v_mfma_f32_16x16x32_bf16 v[156:159], v[84:87], v[68:71], v[156:159]
buffer_load_dwordx4 v5, s[8:11], s95 offen offset:1024 lds
ds_read_b64_tr_b16 v[44:45], v11 offset:8192
v_mfma_f32_16x16x32_bf16 v[152:155], v[84:87], v[64:67], v[152:155]
ds_read_b64_tr_b16 v[46:47], v11 offset:8704
v_max_f32 v203, 0, v203
v_mfma_f32_16x16x32_bf16 v[148:151], v[84:87], v[60:63], v[148:151]
s_cmp_le_u32 s37, 2
s_addc_u32 s69, 0, 2
s_mul_i32 s38, s69, 393216
s_add_u32 s8, s42, s38
s_addc_u32 s9, s43, 0
v_max_f32 v219, 0, v219
v_mfma_f32_16x16x32_bf16 v[144:147], v[84:87], v[56:59], v[144:147]
ds_read_b64_tr_b16 v[48:49], v10 offset:16384
v_mfma_f32_16x16x32_bf16 v[160:163], v[88:91], v[56:59], v[160:163]
s_add_u32 m0, s71, 147456
s_nop 0
buffer_load_dwordx4 v4, s[8:11], s94 offen lds
ds_read_b64_tr_b16 v[50:51], v10 offset:16896
v_add_f32 v201, 0x3727c5ac, v201
v_mfma_f32_16x16x32_bf16 v[164:167], v[88:91], v[60:63], v[164:167]
ds_read_b64_tr_b16 v[52:53], v11 offset:16384
v_mfma_f32_16x16x32_bf16 v[168:171], v[88:91], v[64:67], v[168:171]
buffer_load_dwordx4 v5, s[8:11], s95 offen offset:1024 lds
v_add_f32 v217, 0x3727c5ac, v217
v_mfma_f32_16x16x32_bf16 v[172:175], v[88:91], v[68:71], v[172:175]
ds_read_b64_tr_b16 v[54:55], v11 offset:16896
v_add_f32 v203, 0x3727c5ac, v203
v_add_f32 v219, 0x3727c5ac, v219
v_mfma_f32_16x16x32_bf16 v[188:191], v[92:95], v[68:71], v[188:191]
v_rsq_f32 v205, v201
v_mfma_f32_16x16x32_bf16 v[184:187], v[92:95], v[64:67], v[184:187]
v_rsq_f32 v221, v217
v_mfma_f32_16x16x32_bf16 v[180:183], v[92:95], v[60:63], v[180:183]
v_rsq_f32 v207, v203
v_mfma_f32_16x16x32_bf16 v[176:179], v[92:95], v[56:59], v[176:179]
v_rsq_f32 v223, v219
v_mul_f32 v208, 0x3fb8aa3b, v205
s_waitcnt lgkmcnt(0)
v_mfma_f32_16x16x32_bf16 v[96:99], v[32:35], v[16:19], v[96:99]
ds_read_b64_tr_b16 v[72:73], v10 offset:4096
s_cmp_le_u32 s37, 3
s_addc_u32 s69, 0, 3
s_mul_i32 s38, s69, 393216
s_add_u32 s8, s42, s38
s_addc_u32 s9, s43, 0
v_mfma_f32_16x16x32_bf16 v[100:103], v[32:35], v[20:23], v[100:103]
ds_read_b64_tr_b16 v[74:75], v10 offset:4608
v_mfma_f32_16x16x32_bf16 v[104:107], v[32:35], v[24:27], v[104:107]
ds_read_b128 v[56:59], v7 offset:32768
v_mul_f32 v224, 0x3fb8aa3b, v221
v_mfma_f32_16x16x32_bf16 v[108:111], v[32:35], v[28:31], v[108:111]
s_add_u32 m0, s71, 155648
s_nop 0
buffer_load_dwordx4 v4, s[8:11], s94 offen lds
v_mul_f32 v209, 0x3fb8aa3b, v207
v_mfma_f32_16x16x32_bf16 v[124:127], v[36:39], v[28:31], v[124:127]
ds_read_b128 v[60:63], v7 offset:34816
buffer_load_dwordx4 v5, s[8:11], s95 offen offset:1024 lds
v_mfma_f32_16x16x32_bf16 v[120:123], v[36:39], v[24:27], v[120:123]
ds_read_b128 v[64:67], v13 offset:32768
v_mul_f32 v225, 0x3fb8aa3b, v223
v_mfma_f32_16x16x32_bf16 v[116:119], v[36:39], v[20:23], v[116:119]
ds_read_b128 v[68:71], v13 offset:34816
v_cndmask_b32 v210, v208, v209, s[48:49]
v_mfma_f32_16x16x32_bf16 v[112:115], v[36:39], v[16:19], v[112:115]
s_cmp_le_u32 s37, 4
s_addc_u32 s69, 0, 4
s_mul_i32 s38, s69, 393216
s_add_u32 s8, s42, s38
s_addc_u32 s9, s43, 0
v_cndmask_b32 v226, v224, v225, s[48:49]
v_mfma_f32_16x16x32_bf16 v[128:131], v[40:43], v[16:19], v[128:131]
ds_read_b64_tr_b16 v[76:77], v11 offset:4096
ds_read_b64_tr_b16 v[78:79], v11 offset:4608
v_mfma_f32_16x16x32_bf16 v[132:135], v[40:43], v[20:23], v[132:135]
s_add_u32 m0, s71, 81920
s_nop 0
buffer_load_dwordx4 v4, s[8:11], s94 offen lds
v_mfma_f32_16x16x32_bf16 v[136:139], v[40:43], v[24:27], v[136:139]
ds_read_b64_tr_b16 v[80:81], v10 offset:12288
s_waitcnt vmcnt(29)
v_add_f32_dpp v240, v240, v240 row_ror:8 row_mask:0xf bank_mask:0xf
v_mfma_f32_16x16x32_bf16 v[140:143], v[40:43], v[28:31], v[140:143]
ds_read_b64_tr_b16 v[82:83], v10 offset:12800
v_add_f32_dpp v241, v241, v241 row_ror:8 row_mask:0xf bank_mask:0xf
v_mfma_f32_16x16x32_bf16 v[156:159], v[44:47], v[28:31], v[156:159]
buffer_load_dwordx4 v5, s[8:11], s95 offen offset:1024 lds
ds_read_b64_tr_b16 v[84:85], v11 offset:12288
v_add_f32_dpp v242, v242, v242 row_ror:8 row_mask:0xf bank_mask:0xf
v_mfma_f32_16x16x32_bf16 v[152:155], v[44:47], v[24:27], v[152:155]
ds_read_b64_tr_b16 v[86:87], v11 offset:12800
v_add_f32_dpp v243, v243, v243 row_ror:8 row_mask:0xf bank_mask:0xf
v_mfma_f32_16x16x32_bf16 v[148:151], v[44:47], v[20:23], v[148:151]
s_cmp_le_u32 s37, 5
s_addc_u32 s69, 0, 5
s_mul_i32 s38, s69, 393216
s_add_u32 s8, s42, s38
s_addc_u32 s9, s43, 0
v_mfma_f32_16x16x32_bf16 v[144:147], v[44:47], v[16:19], v[144:147]
ds_read_b64_tr_b16 v[88:89], v10 offset:20480
v_add_f32_dpp v244, v244, v244 row_ror:8 row_mask:0xf bank_mask:0xf
v_mfma_f32_16x16x32_bf16 v[160:163], v[48:51], v[16:19], v[160:163]
s_add_u32 m0, s71, 90112
s_nop 0
buffer_load_dwordx4 v4, s[8:11], s94 offen lds
ds_read_b64_tr_b16 v[90:91], v10 offset:20992
v_mfma_f32_16x16x32_bf16 v[164:167], v[48:51], v[20:23], v[164:167]
ds_read_b64_tr_b16 v[92:93], v11 offset:20480
v_add_f32_dpp v245, v245, v245 row_ror:8 row_mask:0xf bank_mask:0xf
v_mfma_f32_16x16x32_bf16 v[168:171], v[48:51], v[24:27], v[168:171]
buffer_load_dwordx4 v5, s[8:11], s95 offen offset:1024 lds
v_add_f32_dpp v246, v246, v246 row_ror:8 row_mask:0xf bank_mask:0xf
v_mfma_f32_16x16x32_bf16 v[172:175], v[48:51], v[28:31], v[172:175]
ds_read_b64_tr_b16 v[94:95], v11 offset:20992
v_add_f32_dpp v247, v247, v247 row_ror:8 row_mask:0xf bank_mask:0xf
v_mfma_f32_16x16x32_bf16 v[188:191], v[52:55], v[28:31], v[188:191]
v_add_f32_dpp v248, v248, v248 row_ror:8 row_mask:0xf bank_mask:0xf
v_add_f32_dpp v249, v249, v249 row_ror:8 row_mask:0xf bank_mask:0xf
v_add_f32_dpp v250, v250, v250 row_ror:8 row_mask:0xf bank_mask:0xf
v_mfma_f32_16x16x32_bf16 v[184:187], v[52:55], v[24:27], v[184:187]
v_add_f32_dpp v251, v251, v251 row_ror:8 row_mask:0xf bank_mask:0xf
v_add_f32_dpp v252, v252, v252 row_ror:8 row_mask:0xf bank_mask:0xf
v_mfma_f32_16x16x32_bf16 v[180:183], v[52:55], v[20:23], v[180:183]
v_add_f32_dpp v253, v253, v253 row_ror:8 row_mask:0xf bank_mask:0xf
v_add_f32_dpp v254, v254, v254 row_ror:8 row_mask:0xf bank_mask:0xf
v_mfma_f32_16x16x32_bf16 v[176:179], v[52:55], v[16:19], v[176:179]
v_add_f32_dpp v255, v255, v255 row_ror:8 row_mask:0xf bank_mask:0xf
v_add_f32_dpp v240, v240, v240 row_ror:4 row_mask:0xf bank_mask:0xf
v_add_f32_dpp v241, v241, v241 row_ror:4 row_mask:0xf bank_mask:0xf
s_waitcnt vmcnt(12) lgkmcnt(0)
s_barrier
v_mfma_f32_16x16x32_bf16 v[96:99], v[72:75], v[56:59], v[96:99]
ds_read_b64_tr_b16 v[32:33], v8 offset:0
s_cmp_le_u32 s37, 6
s_addc_u32 s69, 0, 6
s_mul_i32 s38, s69, 393216
s_add_u32 s8, s42, s38
s_addc_u32 s9, s43, 0
v_mfma_f32_16x16x32_bf16 v[100:103], v[72:75], v[60:63], v[100:103]
ds_read_b64_tr_b16 v[34:35], v8 offset:512
v_mfma_f32_16x16x32_bf16 v[104:107], v[72:75], v[64:67], v[104:107]
s_add_u32 m0, s71, 98304
s_nop 0
buffer_load_dwordx4 v4, s[8:11], s94 offen lds
ds_read_b128 v[16:19], v6 offset:0
v_add_f32_dpp v242, v242, v242 row_ror:4 row_mask:0xf bank_mask:0xf
v_mfma_f32_16x16x32_bf16 v[108:111], v[72:75], v[68:71], v[108:111]
ds_read_b128 v[20:23], v6 offset:2048
v_mfma_f32_16x16x32_bf16 v[124:127], v[76:79], v[68:71], v[124:127]
buffer_load_dwordx4 v5, s[8:11], s95 offen offset:1024 lds
v_add_f32_dpp v243, v243, v243 row_ror:4 row_mask:0xf bank_mask:0xf
v_add_f32_dpp v244, v244, v244 row_ror:4 row_mask:0xf bank_mask:0xf
v_mfma_f32_16x16x32_bf16 v[120:123], v[76:79], v[64:67], v[120:123]
ds_read_b128 v[24:27], v12 offset:0
v_and_b32 v3, 15, v0
v_lshlrev_b32 v3, 11, v3
v_and_b32 v2, 16, v0
v_lshl_add_u32 v3, v2, 1, v3
v_mfma_f32_16x16x32_bf16 v[116:119], v[76:79], v[60:63], v[116:119]
ds_read_b128 v[28:31], v12 offset:2048
v_add_f32_dpp v245, v245, v245 row_ror:4 row_mask:0xf bank_mask:0xf
v_mfma_f32_16x16x32_bf16 v[112:115], v[76:79], v[56:59], v[112:115]
ds_read_b64_tr_b16 v[36:37], v9 offset:0
v_mfma_f32_16x16x32_bf16 v[128:131], v[80:83], v[56:59], v[128:131]
v_and_b32 v2, 32, v0
v_lshrrev_b32 v2, 1, v2
v_add_u32 v2, v2, v3
ds_read_b64_tr_b16 v[38:39], v9 offset:512
v_mfma_f32_16x16x32_bf16 v[132:135], v[80:83], v[60:63], v[132:135]
s_mov_b32 s4, s40
s_mov_b32 s5, s41
s_mov_b32 s6, 4194304
v_add_f32_dpp v246, v246, v246 row_ror:4 row_mask:0xf bank_mask:0xf
v_mfma_f32_16x16x32_bf16 v[136:139], v[80:83], v[64:67], v[136:139]
ds_read_b64_tr_b16 v[40:41], v8 offset:8192
v_mfma_f32_16x16x32_bf16 v[140:143], v[80:83], v[68:71], v[140:143]
s_lshl_b32 s38, s64, 15
s_lshl_b32 s69, s55, 7
s_add_u32 s38, s38, s69
s_add_u32 s69, s38, 32768
ds_read_b64_tr_b16 v[42:43], v8 offset:8704
v_add_f32_dpp v247, v247, v247 row_ror:4 row_mask:0xf bank_mask:0xf
v_mfma_f32_16x16x32_bf16 v[156:159], v[84:87], v[68:71], v[156:159]
ds_read_b64_tr_b16 v[44:45], v9 offset:8192
v_mfma_f32_16x16x32_bf16 v[152:155], v[84:87], v[64:67], v[152:155]
buffer_load_dwordx4 a[232:235], v2, s[4:7], s38 offen offset:0
v_add_f32_dpp v248, v248, v248 row_ror:4 row_mask:0xf bank_mask:0xf
v_mfma_f32_16x16x32_bf16 v[148:151], v[84:87], v[60:63], v[148:151]
ds_read_b64_tr_b16 v[46:47], v9 offset:8704
buffer_load_dwordx4 a[236:239], v2, s[4:7], s38 offen offset:64
v_mfma_f32_16x16x32_bf16 v[144:147], v[84:87], v[56:59], v[144:147]
ds_read_b64_tr_b16 v[48:49], v8 offset:16384
v_add_f32_dpp v249, v249, v249 row_ror:4 row_mask:0xf bank_mask:0xf
v_mfma_f32_16x16x32_bf16 v[160:163], v[88:91], v[56:59], v[160:163]
ds_read_b64_tr_b16 v[50:51], v8 offset:16896
v_add_f32_dpp v250, v250, v250 row_ror:4 row_mask:0xf bank_mask:0xf
v_mfma_f32_16x16x32_bf16 v[164:167], v[88:91], v[60:63], v[164:167]
buffer_load_dwordx4 a[240:243], v2, s[4:7], s69 offen offset:0
ds_read_b64_tr_b16 v[52:53], v9 offset:16384
v_add_f32_dpp v251, v251, v251 row_ror:4 row_mask:0xf bank_mask:0xf
v_mfma_f32_16x16x32_bf16 v[168:171], v[88:91], v[64:67], v[168:171]
buffer_load_dwordx4 a[244:247], v2, s[4:7], s69 offen offset:64
v_add_f32_dpp v252, v252, v252 row_ror:4 row_mask:0xf bank_mask:0xf
v_mfma_f32_16x16x32_bf16 v[172:175], v[88:91], v[68:71], v[172:175]
ds_read_b64_tr_b16 v[54:55], v9 offset:16896
v_add_f32_dpp v253, v253, v253 row_ror:4 row_mask:0xf bank_mask:0xf
v_add_f32_dpp v254, v254, v254 row_ror:4 row_mask:0xf bank_mask:0xf
v_mfma_f32_16x16x32_bf16 v[188:191], v[92:95], v[68:71], v[188:191]
v_add_f32_dpp v255, v255, v255 row_ror:4 row_mask:0xf bank_mask:0xf
v_add_f32_dpp v240, v240, v240 row_ror:2 row_mask:0xf bank_mask:0xf
v_mfma_f32_16x16x32_bf16 v[184:187], v[92:95], v[64:67], v[184:187]
v_add_f32_dpp v241, v241, v241 row_ror:2 row_mask:0xf bank_mask:0xf
v_add_f32_dpp v242, v242, v242 row_ror:2 row_mask:0xf bank_mask:0xf
v_add_f32_dpp v243, v243, v243 row_ror:2 row_mask:0xf bank_mask:0xf
v_mfma_f32_16x16x32_bf16 v[180:183], v[92:95], v[60:63], v[180:183]
v_add_f32_dpp v244, v244, v244 row_ror:2 row_mask:0xf bank_mask:0xf
v_add_f32_dpp v245, v245, v245 row_ror:2 row_mask:0xf bank_mask:0xf
v_mfma_f32_16x16x32_bf16 v[176:179], v[92:95], v[56:59], v[176:179]
v_add_f32_dpp v246, v246, v246 row_ror:2 row_mask:0xf bank_mask:0xf
v_add_f32_dpp v247, v247, v247 row_ror:2 row_mask:0xf bank_mask:0xf
v_add_f32_dpp v248, v248, v248 row_ror:2 row_mask:0xf bank_mask:0xf
s_waitcnt lgkmcnt(0)
v_mfma_f32_16x16x32_bf16 v[96:99], v[32:35], v[16:19], v[96:99]
ds_read_b64_tr_b16 v[72:73], v8 offset:4096
v_accvgpr_read_b32 v215, a253
s_lshl_b32 s32, s3, 16
s_mul_i32 s20, s55, 131200
s_xor_b32 s32, s32, s20
s_mov_b32 s22, 63616
v_mfma_f32_16x16x32_bf16 v[100:103], v[32:35], v[20:23], v[100:103]
ds_read_b64_tr_b16 v[74:75], v8 offset:4608
v_mfma_f32_16x16x32_bf16 v[104:107], v[32:35], v[24:27], v[104:107]
ds_read_b128 v[56:59], v7 offset:0
v_mfma_f32_16x16x32_bf16 v[108:111], v[32:35], v[28:31], v[108:111]
ds_read_b128 v[60:63], v7 offset:2048
buffer_load_dwordx4 v[232:235], v1, s[12:15], s56 offen offset:0 sc1
v_mfma_f32_16x16x32_bf16 v[124:127], v[36:39], v[28:31], v[124:127]
s_add_u32 m0, s70, 114688
s_xor_b32 s20, s32, 0
s_add_u32 s20, s28, s20
s_addc_u32 s21, s29, 0
v_mfma_f32_16x16x32_bf16 v[120:123], v[36:39], v[24:27], v[120:123]
ds_read_b128 v[64:67], v13 offset:0
buffer_load_dwordx4 v[236:239], v1, s[12:15], s56 offen offset:1024 sc1
v_mfma_f32_16x16x32_bf16 v[116:119], v[36:39], v[20:23], v[116:119]
ds_read_b128 v[68:71], v13 offset:2048
v_add_f32_dpp v249, v249, v249 row_ror:2 row_mask:0xf bank_mask:0xf
v_mfma_f32_16x16x32_bf16 v[112:115], v[36:39], v[16:19], v[112:115]
ds_read_b64_tr_b16 v[76:77], v9 offset:4096
v_add_f32_dpp v250, v250, v250 row_ror:2 row_mask:0xf bank_mask:0xf
v_mfma_f32_16x16x32_bf16 v[128:131], v[40:43], v[16:19], v[128:131]
buffer_load_dwordx4 v215, s[20:23], 0 offen offset:0 lds
v_add_f32_dpp v251, v251, v251 row_ror:2 row_mask:0xf bank_mask:0xf
v_mfma_f32_16x16x32_bf16 v[132:135], v[40:43], v[20:23], v[132:135]
ds_read_b64_tr_b16 v[78:79], v9 offset:4608
v_add_f32_dpp v252, v252, v252 row_ror:2 row_mask:0xf bank_mask:0xf
v_mfma_f32_16x16x32_bf16 v[136:139], v[40:43], v[24:27], v[136:139]
ds_read_b64_tr_b16 v[80:81], v8 offset:12288
buffer_load_dwordx4 v215, s[20:23], s66 offen offset:1024 lds
v_mfma_f32_16x16x32_bf16 v[140:143], v[40:43], v[28:31], v[140:143]
ds_read_b64_tr_b16 v[82:83], v8 offset:12800
v_add_f32_dpp v253, v253, v253 row_ror:2 row_mask:0xf bank_mask:0xf
v_add_f32_dpp v254, v254, v254 row_ror:2 row_mask:0xf bank_mask:0xf
v_mfma_f32_16x16x32_bf16 v[156:159], v[44:47], v[28:31], v[156:159]
ds_read_b64_tr_b16 v[84:85], v9 offset:12288
v_add_f32_dpp v255, v255, v255 row_ror:2 row_mask:0xf bank_mask:0xf
v_mfma_f32_16x16x32_bf16 v[152:155], v[44:47], v[24:27], v[152:155]
ds_read_b64_tr_b16 v[86:87], v9 offset:12800
v_add_f32_dpp v240, v240, v240 row_ror:1 row_mask:0xf bank_mask:0xf
v_mfma_f32_16x16x32_bf16 v[148:151], v[44:47], v[20:23], v[148:151]
buffer_load_dwordx4 v215, s[20:23], s67 offen offset:2048 lds
v_add_f32_dpp v241, v241, v241 row_ror:1 row_mask:0xf bank_mask:0xf
v_mfma_f32_16x16x32_bf16 v[144:147], v[44:47], v[16:19], v[144:147]
ds_read_b64_tr_b16 v[88:89], v8 offset:20480
v_add_f32_dpp v242, v242, v242 row_ror:1 row_mask:0xf bank_mask:0xf
v_mfma_f32_16x16x32_bf16 v[160:163], v[48:51], v[16:19], v[160:163]
ds_read_b64_tr_b16 v[90:91], v8 offset:20992
v_add_f32_dpp v243, v243, v243 row_ror:1 row_mask:0xf bank_mask:0xf
v_mfma_f32_16x16x32_bf16 v[164:167], v[48:51], v[20:23], v[164:167]
ds_read_b64_tr_b16 v[92:93], v9 offset:20480
v_add_f32_dpp v244, v244, v244 row_ror:1 row_mask:0xf bank_mask:0xf
v_mfma_f32_16x16x32_bf16 v[168:171], v[48:51], v[24:27], v[168:171]
buffer_load_dwordx4 v215, s[20:23], s68 offen offset:3072 lds
v_add_f32_dpp v245, v245, v245 row_ror:1 row_mask:0xf bank_mask:0xf
v_mfma_f32_16x16x32_bf16 v[172:175], v[48:51], v[28:31], v[172:175]
ds_read_b64_tr_b16 v[94:95], v9 offset:20992
v_add_f32_dpp v246, v246, v246 row_ror:1 row_mask:0xf bank_mask:0xf
v_mfma_f32_16x16x32_bf16 v[188:191], v[52:55], v[28:31], v[188:191]
v_add_f32_dpp v247, v247, v247 row_ror:1 row_mask:0xf bank_mask:0xf
v_add_f32_dpp v248, v248, v248 row_ror:1 row_mask:0xf bank_mask:0xf
v_mfma_f32_16x16x32_bf16 v[184:187], v[52:55], v[24:27], v[184:187]
v_add_f32_dpp v249, v249, v249 row_ror:1 row_mask:0xf bank_mask:0xf
v_add_f32_dpp v250, v250, v250 row_ror:1 row_mask:0xf bank_mask:0xf
v_mfma_f32_16x16x32_bf16 v[180:183], v[52:55], v[20:23], v[180:183]
v_add_f32_dpp v251, v251, v251 row_ror:1 row_mask:0xf bank_mask:0xf
v_add_f32_dpp v252, v252, v252 row_ror:1 row_mask:0xf bank_mask:0xf
v_mfma_f32_16x16x32_bf16 v[176:179], v[52:55], v[16:19], v[176:179]
v_add_f32_dpp v253, v253, v253 row_ror:1 row_mask:0xf bank_mask:0xf
v_add_f32_dpp v254, v254, v254 row_ror:1 row_mask:0xf bank_mask:0xf
v_add_f32_dpp v255, v255, v255 row_ror:1 row_mask:0xf bank_mask:0xf
s_waitcnt lgkmcnt(0)
s_barrier
v_mfma_f32_16x16x32_bf16 v[96:99], v[72:75], v[56:59], v[96:99]
s_and_b32 s39, s2, 63
s_lshl_b32 s39, s39, 2
s_add_u32 s39, s39, s3
s_mul_i32 s39, s39, 5376
s_bfe_u32 s61, s2, 0x10006
s_mul_i32 s61, s61, 3670016
s_add_u32 s39, s39, s61
s_add_u32 s39, s39, 0
v_min_u32 v200, 41, v0
v_lshlrev_b32 v200, 7, v200
buffer_load_dwordx2 a[254:255], v200, s[24:27], s39 offen offset:60
v_mfma_f32_16x16x32_bf16 v[100:103], v[72:75], v[60:63], v[100:103]
v_mfma_f32_16x16x32_bf16 v[104:107], v[72:75], v[64:67], v[104:107]
v_mfma_f32_16x16x32_bf16 v[108:111], v[72:75], v[68:71], v[108:111]
v_mfma_f32_16x16x32_bf16 v[124:127], v[76:79], v[68:71], v[124:127]
v_mfma_f32_16x16x32_bf16 v[120:123], v[76:79], v[64:67], v[120:123]
v_mfma_f32_16x16x32_bf16 v[116:119], v[76:79], v[60:63], v[116:119]
s_lshl_b32 s39, s2, 2
s_add_u32 s39, s39, s3
s_mul_i32 s39, s39, 2048
s_add_u32 s39, s39, 0
v_min_u32 v14, 15, v0
v_lshlrev_b32 v14, 7, v14
buffer_load_dwordx2 a[254:255], v14, s[28:31], s39 offen offset:60
v_mfma_f32_16x16x32_bf16 v[112:115], v[76:79], v[56:59], v[112:115]
v_and_b32 v14, 15, v0
v_mfma_f32_16x16x32_bf16 v[128:131], v[80:83], v[56:59], v[128:131]
s_lshl_b32 s39, s33, 6
v_add_u32 v14, s39, v14
v_mul_u32_u24 v14, 608, v14
v_mfma_f32_16x16x32_bf16 v[132:135], v[80:83], v[60:63], v[132:135]
v_and_b32 v213, 48, v0
v_mfma_f32_16x16x32_bf16 v[136:139], v[80:83], v[64:67], v[136:139]
v_and_b32 v200, 7, v0
v_lshlrev_b32 v200, 11, v200
v_and_b32 v201, 8, v0
v_lshl_add_u32 v200, v201, 7, v200
s_lshr_b32 s39, s2, 3
s_lshl_b32 s39, s39, 2
s_add_u32 s39, s39, s3
s_lshl_b32 s39, s39, 14
s_mov_b64 exec, 0xffff
buffer_load_dwordx2 a[254:255], v200, s[28:31], s39 offen offset:444
s_mov_b64 exec, -1
v_mfma_f32_16x16x32_bf16 v[140:143], v[80:83], v[68:71], v[140:143]
v_mfma_f32_16x16x32_bf16 v[156:159], v[84:87], v[68:71], v[156:159]
v_mfma_f32_16x16x32_bf16 v[152:155], v[84:87], v[64:67], v[152:155]
v_mfma_f32_16x16x32_bf16 v[148:151], v[84:87], v[60:63], v[148:151]
s_lshl_b32 s39, s34, 7
v_add3_u32 v212, v14, v213, s39
v_mfma_f32_16x16x32_bf16 v[144:147], v[84:87], v[56:59], v[144:147]
v_lshrrev_b32 v214, 2, v213
v_mfma_f32_16x16x32_bf16 v[160:163], v[88:91], v[56:59], v[160:163]
s_lshl_b32 s39, s34, 5
s_add_u32 s39, s39, 512
v_add3_u32 v214, v14, v214, s39
v_mfma_f32_16x16x32_bf16 v[164:167], v[88:91], v[60:63], v[164:167]
v_and_b32 v14, 1, v0
v_cmp_eq_u32 vcc, 0, v14
v_mfma_f32_16x16x32_bf16 v[168:171], v[88:91], v[64:67], v[168:171]
v_mov_b32 v14, 0x3f803f80
v_cndmask_b32 v228, 0, v14, vcc
v_mfma_f32_16x16x32_bf16 v[172:175], v[88:91], v[68:71], v[172:175]
v_cndmask_b32 v216, v14, 0, vcc
v_mfma_f32_16x16x32_bf16 v[188:191], v[92:95], v[68:71], v[188:191]
v_mov_b32 v229, v228
v_mov_b32 v230, v228
v_mfma_f32_16x16x32_bf16 v[184:187], v[92:95], v[64:67], v[184:187]
v_mov_b32 v231, v228
v_mfma_f32_16x16x32_bf16 v[180:183], v[92:95], v[60:63], v[180:183]
v_mov_b32 v217, v216
v_mov_b32 v218, v216
v_mfma_f32_16x16x32_bf16 v[176:179], v[92:95], v[56:59], v[176:179]
v_mov_b32 v219, v216
v_mov_b32 v15, s63
v_pk_fma_f32 v[128:129], v[240:241], v[204:205], v[128:129] op_sel:[0,0,0] op_sel_hi:[1,0,1]
v_pk_fma_f32 v[130:131], v[242:243], v[204:205], v[130:131] op_sel:[0,0,0] op_sel_hi:[1,0,1]
v_pk_fma_f32 v[144:145], v[244:245], v[204:205], v[144:145] op_sel:[0,0,0] op_sel_hi:[1,0,1]
v_pk_fma_f32 v[146:147], v[246:247], v[204:205], v[146:147] op_sel:[0,0,0] op_sel_hi:[1,0,1]
v_cvt_pk_bf16_f32 v128, v128, v129
v_cvt_pk_bf16_f32 v129, v130, v131
v_cvt_pk_bf16_f32 v130, v144, v145
v_cvt_pk_bf16_f32 v131, v146, v147
s_nop 1
v_mfma_f32_16x16x32_bf16 v[16:19], v[192:195], v[128:131], 0
v_mfma_f32_16x16x32_bf16 v[20:23], v[196:199], v[128:131], 0
v_pk_fma_f32 v[132:133], v[240:241], v[206:207], v[132:133] op_sel:[0,0,0] op_sel_hi:[1,0,1]
v_pk_fma_f32 v[134:135], v[242:243], v[206:207], v[134:135] op_sel:[0,0,0] op_sel_hi:[1,0,1]
v_pk_fma_f32 v[148:149], v[244:245], v[206:207], v[148:149] op_sel:[0,0,0] op_sel_hi:[1,0,1]
v_pk_fma_f32 v[150:151], v[246:247], v[206:207], v[150:151] op_sel:[0,0,0] op_sel_hi:[1,0,1]
v_cvt_pk_bf16_f32 v132, v132, v133
v_cvt_pk_bf16_f32 v133, v134, v135
v_cvt_pk_bf16_f32 v134, v148, v149
v_cvt_pk_bf16_f32 v135, v150, v151
s_nop 1
v_mfma_f32_16x16x32_bf16 v[24:27], v[192:195], v[132:135], 0
v_mfma_f32_16x16x32_bf16 v[28:31], v[196:199], v[132:135], 0
v_pk_fma_f32 v[136:137], v[240:241], v[220:221], v[136:137] op_sel:[0,0,0] op_sel_hi:[1,0,1]
v_pk_fma_f32 v[138:139], v[242:243], v[220:221], v[138:139] op_sel:[0,0,0] op_sel_hi:[1,0,1]
v_pk_fma_f32 v[152:153], v[244:245], v[220:221], v[152:153] op_sel:[0,0,0] op_sel_hi:[1,0,1]
v_pk_fma_f32 v[154:155], v[246:247], v[220:221], v[154:155] op_sel:[0,0,0] op_sel_hi:[1,0,1]
v_cvt_pk_bf16_f32 v136, v136, v137
v_cvt_pk_bf16_f32 v137, v138, v139
v_cvt_pk_bf16_f32 v138, v152, v153
v_cvt_pk_bf16_f32 v139, v154, v155
s_nop 1
v_mfma_f32_16x16x32_bf16 v[32:35], v[192:195], v[136:139], 0
v_mfma_f32_16x16x32_bf16 v[36:39], v[196:199], v[136:139], 0
v_pk_fma_f32 v[140:141], v[240:241], v[222:223], v[140:141] op_sel:[0,0,0] op_sel_hi:[1,0,1]
v_pk_fma_f32 v[142:143], v[242:243], v[222:223], v[142:143] op_sel:[0,0,0] op_sel_hi:[1,0,1]
v_pk_fma_f32 v[156:157], v[244:245], v[222:223], v[156:157] op_sel:[0,0,0] op_sel_hi:[1,0,1]
v_pk_fma_f32 v[158:159], v[246:247], v[222:223], v[158:159] op_sel:[0,0,0] op_sel_hi:[1,0,1]
v_cvt_pk_bf16_f32 v140, v140, v141
v_cvt_pk_bf16_f32 v141, v142, v143
v_cvt_pk_bf16_f32 v142, v156, v157
v_cvt_pk_bf16_f32 v143, v158, v159
s_nop 1
v_mfma_f32_16x16x32_bf16 v[40:43], v[192:195], v[140:143], 0
v_mfma_f32_16x16x32_bf16 v[44:47], v[196:199], v[140:143], 0
v_pk_fma_f32 v[160:161], v[248:249], v[204:205], v[160:161] op_sel:[0,0,0] op_sel_hi:[1,0,1]
v_pk_fma_f32 v[164:165], v[248:249], v[206:207], v[164:165] op_sel:[0,0,0] op_sel_hi:[1,0,1]
v_pk_fma_f32 v[162:163], v[250:251], v[204:205], v[162:163] op_sel:[0,0,0] op_sel_hi:[1,0,1]
v_pk_fma_f32 v[166:167], v[250:251], v[206:207], v[166:167] op_sel:[0,0,0] op_sel_hi:[1,0,1]
v_pk_fma_f32 v[176:177], v[252:253], v[204:205], v[176:177] op_sel:[0,0,0] op_sel_hi:[1,0,1]
v_pk_fma_f32 v[180:181], v[252:253], v[206:207], v[180:181] op_sel:[0,0,0] op_sel_hi:[1,0,1]
v_pk_fma_f32 v[178:179], v[254:255], v[204:205], v[178:179] op_sel:[0,0,0] op_sel_hi:[1,0,1]
v_pk_fma_f32 v[182:183], v[254:255], v[206:207], v[182:183] op_sel:[0,0,0] op_sel_hi:[1,0,1]
v_max3_f32 v64, v16, v17, v18
v_max3_f32 v66, v24, v25, v26
v_max3_f32 v65, -v16, -v17, -v18
v_max3_f32 v67, -v24, -v25, -v26
v_max3_f32 v64, v64, v19, v20
v_max3_f32 v66, v66, v27, v28
v_max3_f32 v65, v65, -v19, -v20
v_max3_f32 v67, v67, -v27, -v28
v_max3_f32 v64, v64, v21, v22
v_max3_f32 v66, v66, v29, v30
v_max3_f32 v65, v65, -v21, -v22
v_max3_f32 v67, v67, -v29, -v30
v_max_f32 v64, v64, v23
v_max_f32 v66, v66, v31
v_max_f32 v65, v65, -v23
v_max_f32 v67, v67, -v31
v_max3_f32 v68, v32, v33, v34
v_max3_f32 v70, v40, v41, v42
v_max3_f32 v69, -v32, -v33, -v34
v_max3_f32 v71, -v40, -v41, -v42
v_max3_f32 v68, v68, v35, v36
v_max3_f32 v70, v70, v43, v44
v_max3_f32 v69, v69, -v35, -v36
v_max3_f32 v71, v71, -v43, -v44
v_max3_f32 v68, v68, v37, v38
v_max3_f32 v70, v70, v45, v46
v_max3_f32 v69, v69, -v37, -v38
v_max3_f32 v71, v71, -v45, -v46
v_max_f32 v68, v68, v39
v_max_f32 v70, v70, v47
v_max_f32 v69, v69, -v39
v_max_f32 v71, v71, -v47
v_permlane16_swap_b32 v64, v65
v_permlane16_swap_b32 v68, v69
v_pk_fma_f32 v[168:169], v[248:249], v[220:221], v[168:169] op_sel:[0,0,0] op_sel_hi:[1,0,1]
v_permlane16_swap_b32 v66, v67
v_permlane16_swap_b32 v70, v71
v_pk_fma_f32 v[170:171], v[250:251], v[220:221], v[170:171] op_sel:[0,0,0] op_sel_hi:[1,0,1]
v_max_f32 v64, v64, v65
v_max_f32 v68, v68, v69
v_pk_fma_f32 v[184:185], v[252:253], v[220:221], v[184:185] op_sel:[0,0,0] op_sel_hi:[1,0,1]
v_max_f32 v66, v66, v67
v_max_f32 v70, v70, v71
v_pk_fma_f32 v[186:187], v[254:255], v[220:221], v[186:187] op_sel:[0,0,0] op_sel_hi:[1,0,1]
v_permlane32_swap_b32 v64, v66
v_permlane32_swap_b32 v68, v70
v_pk_fma_f32 v[172:173], v[248:249], v[222:223], v[172:173] op_sel:[0,0,0] op_sel_hi:[1,0,1]
v_max_f32 v64, v64, v66
v_max_f32 v68, v68, v70
v_pk_fma_f32 v[174:175], v[250:251], v[222:223], v[174:175] op_sel:[0,0,0] op_sel_hi:[1,0,1]
v_mul_f32 v65, -v64, v210
v_mul_f32 v69, -v68, v226
v_pk_fma_f32 v[188:189], v[252:253], v[222:223], v[188:189] op_sel:[0,0,0] op_sel_hi:[1,0,1]
v_mul_f32 v67, -v64, v210
v_mul_f32 v71, -v68, v226
v_pk_fma_f32 v[190:191], v[254:255], v[222:223], v[190:191] op_sel:[0,0,0] op_sel_hi:[1,0,1]
v_permlane32_swap_b32 v65, v67
v_permlane32_swap_b32 v69, v71
v_mov_b32 v64, v65
v_mov_b32 v68, v69
v_mov_b32 v66, v67
v_mov_b32 v70, v71
v_permlane16_swap_b32 v64, v65
v_permlane16_swap_b32 v68, v69
v_permlane16_swap_b32 v66, v67
v_permlane16_swap_b32 v70, v71
v_pk_fma_f32 v[48:49], v[16:17], v[208:209], v[64:65] op_sel:[0,0,1] op_sel_hi:[1,0,1] neg_lo:[1,0,0] neg_hi:[1,0,0]
v_pk_fma_f32 v[50:51], v[18:19], v[208:209], v[64:65] op_sel:[0,0,1] op_sel_hi:[1,0,1] neg_lo:[1,0,0] neg_hi:[1,0,0]
v_pk_fma_f32 v[52:53], v[20:21], v[208:209], v[64:65] op_sel:[0,0,1] op_sel_hi:[1,0,1] neg_lo:[1,0,0] neg_hi:[1,0,0]
v_pk_fma_f32 v[54:55], v[22:23], v[208:209], v[64:65] op_sel:[0,0,1] op_sel_hi:[1,0,1] neg_lo:[1,0,0] neg_hi:[1,0,0]
v_pk_fma_f32 v[16:17], v[16:17], v[208:209], v[64:65] op_sel:[0,0,0] op_sel_hi:[1,0,0]
v_pk_fma_f32 v[18:19], v[18:19], v[208:209], v[64:65] op_sel:[0,0,0] op_sel_hi:[1,0,0]
v_pk_fma_f32 v[20:21], v[20:21], v[208:209], v[64:65] op_sel:[0,0,0] op_sel_hi:[1,0,0]
v_pk_fma_f32 v[22:23], v[22:23], v[208:209], v[64:65] op_sel:[0,0,0] op_sel_hi:[1,0,0]
v_exp_f32 v16, v16
v_exp_f32 v17, v17
v_exp_f32 v18, v18
v_exp_f32 v19, v19
v_exp_f32 v20, v20
v_exp_f32 v21, v21
v_exp_f32 v22, v22
v_exp_f32 v23, v23
v_exp_f32 v48, v48
v_exp_f32 v49, v49
v_exp_f32 v50, v50
v_exp_f32 v51, v51
v_exp_f32 v52, v52
v_exp_f32 v53, v53
v_exp_f32 v54, v54
v_exp_f32 v55, v55
v_cvt_pk_bf16_f32 v128, v16, v17
v_cvt_pk_bf16_f32 v129, v18, v19
v_cvt_pk_bf16_f32 v130, v20, v21
v_cvt_pk_bf16_f32 v131, v22, v23
v_cvt_pk_bf16_f32 v144, v48, v49
v_cvt_pk_bf16_f32 v145, v50, v51
v_cvt_pk_bf16_f32 v146, v52, v53
v_cvt_pk_bf16_f32 v147, v54, v55
v_mfma_f32_16x16x32_bf16 v[72:75], v[228:231], v[128:131], 0
s_nop 0
v_mfma_f32_16x16x32_bf16 v[72:75], v[216:219], v[144:147], v[72:75]
ds_write_b128 v212, v[128:131] offset:0
ds_write_b128 v212, v[144:147] offset:64
v_pk_fma_f32 v[56:57], v[24:25], v[208:209], v[66:67] op_sel:[0,1,1] op_sel_hi:[1,1,1] neg_lo:[1,0,0] neg_hi:[1,0,0]
v_pk_fma_f32 v[58:59], v[26:27], v[208:209], v[66:67] op_sel:[0,1,1] op_sel_hi:[1,1,1] neg_lo:[1,0,0] neg_hi:[1,0,0]
v_pk_fma_f32 v[60:61], v[28:29], v[208:209], v[66:67] op_sel:[0,1,1] op_sel_hi:[1,1,1] neg_lo:[1,0,0] neg_hi:[1,0,0]
v_pk_fma_f32 v[62:63], v[30:31], v[208:209], v[66:67] op_sel:[0,1,1] op_sel_hi:[1,1,1] neg_lo:[1,0,0] neg_hi:[1,0,0]
v_pk_fma_f32 v[24:25], v[24:25], v[208:209], v[66:67] op_sel:[0,1,0] op_sel_hi:[1,1,0]
v_pk_fma_f32 v[26:27], v[26:27], v[208:209], v[66:67] op_sel:[0,1,0] op_sel_hi:[1,1,0]
v_pk_fma_f32 v[28:29], v[28:29], v[208:209], v[66:67] op_sel:[0,1,0] op_sel_hi:[1,1,0]
v_pk_fma_f32 v[30:31], v[30:31], v[208:209], v[66:67] op_sel:[0,1,0] op_sel_hi:[1,1,0]
v_exp_f32 v24, v24
v_exp_f32 v25, v25
v_exp_f32 v26, v26
v_exp_f32 v27, v27
v_exp_f32 v28, v28
v_exp_f32 v29, v29
v_exp_f32 v30, v30
v_exp_f32 v31, v31
v_exp_f32 v56, v56
v_exp_f32 v57, v57
v_exp_f32 v58, v58
v_exp_f32 v59, v59
v_exp_f32 v60, v60
v_exp_f32 v61, v61
v_exp_f32 v62, v62
v_exp_f32_e64 v63, v63
v_cvt_pk_bf16_f32 v132, v24, v25
v_cvt_pk_bf16_f32 v133, v26, v27
v_cvt_pk_bf16_f32 v134, v28, v29
v_cvt_pk_bf16_f32 v135, v30, v31
L_wca3:
L_wp3:
s_cbranch_execz L_wra
v_cvt_pk_bf16_f32 v148, v56, v57
v_cvt_pk_bf16_f32 v149, v58, v59
v_cvt_pk_bf16_f32 v150, v60, v61
v_cvt_pk_bf16_f32 v151, v62, v63
v_mfma_f32_16x16x32_bf16 v[76:79], v[228:231], v[132:135], 0
s_nop 0
v_mfma_f32_16x16x32_bf16 v[76:79], v[216:219], v[148:151], v[76:79]
ds_write_b128 v212, v[132:135] offset:9728
ds_write_b128 v212, v[148:151] offset:9792
v_rcp_f32 v72, v72
v_rcp_f32 v73, v73
s_nop 0
v_pk_mul_f32 v[74:75], v[72:73], v[204:205] op_sel:[0,1] op_sel_hi:[1,1]
v_cvt_pk_bf16_f32 v72, v72, v73
ds_write_b32 v214, v72 offset:0
v_pk_mul_f32 v[48:49], v[160:161], v[74:75] op_sel:[0,0] op_sel_hi:[1,0]
v_pk_mul_f32 v[50:51], v[162:163], v[74:75] op_sel:[0,0] op_sel_hi:[1,0]
v_pk_mul_f32 v[52:53], v[176:177], v[74:75] op_sel:[0,0] op_sel_hi:[1,0]
v_pk_mul_f32 v[54:55], v[178:179], v[74:75] op_sel:[0,0] op_sel_hi:[1,0]
v_pk_mul_f32 v[160:161], v[160:161], v[74:75] op_sel:[0,1] op_sel_hi:[1,1]
v_pk_mul_f32 v[162:163], v[162:163], v[74:75] op_sel:[0,1] op_sel_hi:[1,1]
v_pk_mul_f32 v[176:177], v[176:177], v[74:75] op_sel:[0,1] op_sel_hi:[1,1]
v_pk_mul_f32 v[178:179], v[178:179], v[74:75] op_sel:[0,1] op_sel_hi:[1,1]
v_cvt_pk_bf16_f32 v48, v48, v49
v_cvt_pk_bf16_f32 v49, v50, v51
v_cvt_pk_bf16_f32 v50, v52, v53
v_cvt_pk_bf16_f32 v51, v54, v55
ds_write_b128 v212, v[48:51] offset:256
v_cvt_pk_bf16_f32 v160, v160, v161
v_cvt_pk_bf16_f32 v161, v162, v163
v_cvt_pk_bf16_f32 v162, v176, v177
v_cvt_pk_bf16_f32 v163, v178, v179
ds_write_b128 v212, v[160:163] offset:320
v_pk_fma_f32 v[48:49], v[32:33], v[224:225], v[68:69] op_sel:[0,0,1] op_sel_hi:[1,0,1] neg_lo:[1,0,0] neg_hi:[1,0,0]
v_pk_fma_f32 v[50:51], v[34:35], v[224:225], v[68:69] op_sel:[0,0,1] op_sel_hi:[1,0,1] neg_lo:[1,0,0] neg_hi:[1,0,0]
v_pk_fma_f32 v[52:53], v[36:37], v[224:225], v[68:69] op_sel:[0,0,1] op_sel_hi:[1,0,1] neg_lo:[1,0,0] neg_hi:[1,0,0]
v_pk_fma_f32 v[54:55], v[38:39], v[224:225], v[68:69] op_sel:[0,0,1] op_sel_hi:[1,0,1] neg_lo:[1,0,0] neg_hi:[1,0,0]
v_pk_fma_f32 v[32:33], v[32:33], v[224:225], v[68:69] op_sel:[0,0,0] op_sel_hi:[1,0,0]
v_pk_fma_f32 v[34:35], v[34:35], v[224:225], v[68:69] op_sel:[0,0,0] op_sel_hi:[1,0,0]
v_pk_fma_f32 v[36:37], v[36:37], v[224:225], v[68:69] op_sel:[0,0,0] op_sel_hi:[1,0,0]
v_pk_fma_f32 v[38:39], v[38:39], v[224:225], v[68:69] op_sel:[0,0,0] op_sel_hi:[1,0,0]
v_exp_f32 v32, v32
v_exp_f32 v33, v33
v_exp_f32 v34, v34
v_exp_f32 v35, v35
v_exp_f32 v36, v36
v_exp_f32 v37, v37
v_exp_f32 v38, v38
v_exp_f32 v39, v39
v_exp_f32 v48, v48
v_exp_f32 v49, v49
v_exp_f32 v50, v50
v_exp_f32 v51, v51
v_exp_f32 v52, v52
v_exp_f32 v53, v53
v_exp_f32 v54, v54
v_exp_f32_e64 v55, v55
v_cvt_pk_bf16_f32 v136, v32, v33
v_cvt_pk_bf16_f32 v137, v34, v35
v_cvt_pk_bf16_f32 v138, v36, v37
v_cvt_pk_bf16_f32 v139, v38, v39
v_cvt_pk_bf16_f32 v152, v48, v49
v_cvt_pk_bf16_f32 v153, v50, v51
v_cvt_pk_bf16_f32 v154, v52, v53
v_cvt_pk_bf16_f32 v155, v54, v55
v_mfma_f32_16x16x32_bf16 v[80:83], v[228:231], v[136:139], 0
s_nop 0
v_mfma_f32_16x16x32_bf16 v[80:83], v[216:219], v[152:155], v[80:83]
ds_write_b128 v212, v[136:139] offset:19456
ds_write_b128 v212, v[152:155] offset:19520
v_rcp_f32 v76, v76
v_rcp_f32 v77, v77
s_nop 0
v_pk_mul_f32 v[78:79], v[76:77], v[206:207] op_sel:[0,1] op_sel_hi:[1,1]
v_cvt_pk_bf16_f32 v76, v76, v77
ds_write_b32 v214, v76 offset:9728
v_pk_mul_f32 v[56:57], v[164:165], v[78:79] op_sel:[0,0] op_sel_hi:[1,0]
v_pk_mul_f32 v[58:59], v[166:167], v[78:79] op_sel:[0,0] op_sel_hi:[1,0]
v_pk_mul_f32 v[60:61], v[180:181], v[78:79] op_sel:[0,0] op_sel_hi:[1,0]
v_pk_mul_f32 v[62:63], v[182:183], v[78:79] op_sel:[0,0] op_sel_hi:[1,0]
v_pk_mul_f32 v[164:165], v[164:165], v[78:79] op_sel:[0,1] op_sel_hi:[1,1]
v_pk_mul_f32 v[166:167], v[166:167], v[78:79] op_sel:[0,1] op_sel_hi:[1,1]
v_pk_mul_f32 v[180:181], v[180:181], v[78:79] op_sel:[0,1] op_sel_hi:[1,1]
v_pk_mul_f32 v[182:183], v[182:183], v[78:79] op_sel:[0,1] op_sel_hi:[1,1]
v_cvt_pk_bf16_f32 v56, v56, v57
v_cvt_pk_bf16_f32 v57, v58, v59
v_cvt_pk_bf16_f32 v58, v60, v61
v_cvt_pk_bf16_f32 v59, v62, v63
ds_write_b128 v212, v[56:59] offset:9984
v_cvt_pk_bf16_f32 v164, v164, v165
v_cvt_pk_bf16_f32 v165, v166, v167
v_cvt_pk_bf16_f32 v166, v180, v181
v_cvt_pk_bf16_f32 v167, v182, v183
ds_write_b128 v212, v[164:167] offset:10048
v_pk_fma_f32 v[56:57], v[40:41], v[224:225], v[70:71] op_sel:[0,1,1] op_sel_hi:[1,1,1] neg_lo:[1,0,0] neg_hi:[1,0,0]
v_pk_fma_f32 v[58:59], v[42:43], v[224:225], v[70:71] op_sel:[0,1,1] op_sel_hi:[1,1,1] neg_lo:[1,0,0] neg_hi:[1,0,0]
v_pk_fma_f32 v[60:61], v[44:45], v[224:225], v[70:71] op_sel:[0,1,1] op_sel_hi:[1,1,1] neg_lo:[1,0,0] neg_hi:[1,0,0]
v_pk_fma_f32 v[62:63], v[46:47], v[224:225], v[70:71] op_sel:[0,1,1] op_sel_hi:[1,1,1] neg_lo:[1,0,0] neg_hi:[1,0,0]
v_pk_fma_f32 v[40:41], v[40:41], v[224:225], v[70:71] op_sel:[0,1,0] op_sel_hi:[1,1,0]
v_pk_fma_f32 v[42:43], v[42:43], v[224:225], v[70:71] op_sel:[0,1,0] op_sel_hi:[1,1,0]
v_pk_fma_f32 v[44:45], v[44:45], v[224:225], v[70:71] op_sel:[0,1,0] op_sel_hi:[1,1,0]
v_pk_fma_f32 v[46:47], v[46:47], v[224:225], v[70:71] op_sel:[0,1,0] op_sel_hi:[1,1,0]
v_exp_f32 v40, v40
v_exp_f32 v41, v41
v_exp_f32 v42, v42
v_exp_f32 v43, v43
v_exp_f32 v44, v44
v_exp_f32 v45, v45
v_exp_f32 v46, v46
v_exp_f32 v47, v47
v_exp_f32 v56, v56
v_exp_f32 v57, v57
v_exp_f32 v58, v58
v_exp_f32 v59, v59
v_exp_f32 v60, v60
v_exp_f32 v61, v61
v_exp_f32 v62, v62
v_exp_f32 v63, v63
v_cvt_pk_bf16_f32 v140, v40, v41
v_cvt_pk_bf16_f32 v141, v42, v43
v_cvt_pk_bf16_f32 v142, v44, v45
v_cvt_pk_bf16_f32 v143, v46, v47
v_cvt_pk_bf16_f32 v156, v56, v57
v_cvt_pk_bf16_f32 v157, v58, v59
v_cvt_pk_bf16_f32 v158, v60, v61
v_cvt_pk_bf16_f32 v159, v62, v63
v_mfma_f32_16x16x32_bf16 v[84:87], v[228:231], v[140:143], 0
s_nop 0
v_mfma_f32_16x16x32_bf16 v[84:87], v[216:219], v[156:159], v[84:87]
ds_write_b128 v212, v[140:143] offset:29184
ds_write_b128 v212, v[156:159] offset:29248
v_rcp_f32 v80, v80
v_rcp_f32 v81, v81
s_nop 0
v_pk_mul_f32 v[82:83], v[80:81], v[220:221] op_sel:[0,1] op_sel_hi:[1,1]
v_cvt_pk_bf16_f32 v80, v80, v81
ds_write_b32 v214, v80 offset:19456
v_pk_mul_f32 v[48:49], v[168:169], v[82:83] op_sel:[0,0] op_sel_hi:[1,0]
v_pk_mul_f32 v[50:51], v[170:171], v[82:83] op_sel:[0,0] op_sel_hi:[1,0]
v_pk_mul_f32 v[52:53], v[184:185], v[82:83] op_sel:[0,0] op_sel_hi:[1,0]
v_pk_mul_f32 v[54:55], v[186:187], v[82:83] op_sel:[0,0] op_sel_hi:[1,0]
v_pk_mul_f32 v[168:169], v[168:169], v[82:83] op_sel:[0,1] op_sel_hi:[1,1]
v_pk_mul_f32 v[170:171], v[170:171], v[82:83] op_sel:[0,1] op_sel_hi:[1,1]
v_pk_mul_f32 v[184:185], v[184:185], v[82:83] op_sel:[0,1] op_sel_hi:[1,1]
v_pk_mul_f32 v[186:187], v[186:187], v[82:83] op_sel:[0,1] op_sel_hi:[1,1]
v_cvt_pk_bf16_f32 v48, v48, v49
v_cvt_pk_bf16_f32 v49, v50, v51
v_cvt_pk_bf16_f32 v50, v52, v53
v_cvt_pk_bf16_f32 v51, v54, v55
ds_write_b128 v212, v[48:51] offset:19712
v_cvt_pk_bf16_f32 v168, v168, v169
v_cvt_pk_bf16_f32 v169, v170, v171
v_cvt_pk_bf16_f32 v170, v184, v185
v_cvt_pk_bf16_f32 v171, v186, v187
ds_write_b128 v212, v[168:171] offset:19776
v_lshrrev_b32 v200, 2, v0
v_mul_u32_u24 v200, 608, v200
v_and_b32 v201, 3, v0
v_lshl_add_u32 v200, v201, 3, v200
s_lshl_b32 s38, s33, 5
v_add_u32 v201, s38, v200
s_lshl_b32 s38, s3, 6
v_add_u32 v200, s38, v200
v_add_u32 v202, 38912, v200
v_add_u32 v203, 38912, v201
v_rcp_f32 v84, v84
v_rcp_f32 v85, v85
s_nop 0
v_pk_mul_f32 v[86:87], v[84:85], v[222:223] op_sel:[0,1] op_sel_hi:[1,1]
v_cvt_pk_bf16_f32 v84, v84, v85
ds_write_b32 v214, v84 offset:29184
v_pk_mul_f32 v[56:57], v[172:173], v[86:87] op_sel:[0,0] op_sel_hi:[1,0]
v_pk_mul_f32 v[58:59], v[174:175], v[86:87] op_sel:[0,0] op_sel_hi:[1,0]
v_pk_mul_f32 v[60:61], v[188:189], v[86:87] op_sel:[0,0] op_sel_hi:[1,0]
v_pk_mul_f32 v[62:63], v[190:191], v[86:87] op_sel:[0,0] op_sel_hi:[1,0]
v_pk_mul_f32 v[172:173], v[172:173], v[86:87] op_sel:[0,1] op_sel_hi:[1,1]
v_pk_mul_f32 v[174:175], v[174:175], v[86:87] op_sel:[0,1] op_sel_hi:[1,1]
v_pk_mul_f32 v[188:189], v[188:189], v[86:87] op_sel:[0,1] op_sel_hi:[1,1]
v_pk_mul_f32 v[190:191], v[190:191], v[86:87] op_sel:[0,1] op_sel_hi:[1,1]
v_cvt_pk_bf16_f32 v56, v56, v57
v_cvt_pk_bf16_f32 v57, v58, v59
v_cvt_pk_bf16_f32 v58, v60, v61
v_cvt_pk_bf16_f32 v59, v62, v63
ds_write_b128 v212, v[56:59] offset:29440
v_cvt_pk_bf16_f32 v172, v172, v173
v_cvt_pk_bf16_f32 v173, v174, v175
v_cvt_pk_bf16_f32 v174, v188, v189
v_cvt_pk_bf16_f32 v175, v190, v191
ds_write_b128 v212, v[172:175] offset:29504
s_lshl_b32 s38, s36, 4
s_lshl_b32 s39, s3, 2
s_add_u32 s38, s38, s39
s_lshl_b32 s38, s38, 4
s_add_u32 s38, s38, s35
s_lshl_b32 s38, s38, 10
s_add_u32 s38, s38, 58720256
s_add_u32 s89, s38, 16384
s_add_u32 s90, s38, 32768
s_add_u32 s91, s38, 49152
s_lshl_b32 s61, s36, 1
s_add_u32 s61, s61, s33
s_lshl_b32 s61, s61, 4
s_add_u32 s61, s61, s35
s_lshl_b32 s61, s61, 1
s_add_u32 s61, s61, s34
s_lshl_b32 s61, s61, 7
s_add_u32 s61, s61, 63373312
s_lshl_b32 s39, 0x00010001, s34
v_and_b32 v211, 48, v0
s_waitcnt vmcnt(13) lgkmcnt(0)
s_barrier
ds_read_b64_tr_b16 v[16:17], v200 offset:0
ds_read_b64_tr_b16 v[18:19], v200 offset:9728
ds_read_b64_tr_b16 v[24:25], v200 offset:256
ds_read_b64_tr_b16 v[26:27], v200 offset:9984
ds_read_b64_tr_b16 v[20:21], v200 offset:32
ds_read_b64_tr_b16 v[22:23], v200 offset:9760
ds_read_b64_tr_b16 v[28:29], v200 offset:288
ds_read_b64_tr_b16 v[30:31], v200 offset:10016
ds_read_b64_tr_b16 v[32:33], v201 offset:512
ds_read_b64_tr_b16 v[34:35], v201 offset:10240
ds_read_b64_tr_b16 v[36:37], v200 offset:19456
ds_read_b64_tr_b16 v[38:39], v200 offset:29184
ds_read_b64_tr_b16 v[44:45], v200 offset:19712
ds_read_b64_tr_b16 v[46:47], v200 offset:29440
s_waitcnt lgkmcnt(4)
v_mfma_f32_16x16x32_bf16 v[128:131], v[16:19], v[24:27], 0
ds_read_b64_tr_b16 v[40:41], v200 offset:19488
ds_read_b64_tr_b16 v[42:43], v200 offset:29216
v_mfma_f32_16x16x32_bf16 v[136:139], v[16:19], v[28:31], 0
ds_read_b64_tr_b16 v[48:49], v200 offset:19744
ds_read_b64_tr_b16 v[50:51], v200 offset:29472
v_mfma_f32_16x16x32_bf16 v[132:135], v[20:23], v[24:27], 0
ds_read_b64_tr_b16 v[52:53], v201 offset:19968
ds_read_b64_tr_b16 v[54:55], v201 offset:29696
v_mfma_f32_16x16x32_bf16 v[140:143], v[20:23], v[28:31], 0
ds_read_b64_tr_b16 v[56:57], v202 offset:0
ds_read_b64_tr_b16 v[58:59], v202 offset:9728
v_mfma_f32_16x16x32_bf16 v[144:147], v[16:19], v[32:35], 0
ds_read_b64_tr_b16 v[64:65], v202 offset:256
ds_read_b64_tr_b16 v[66:67], v202 offset:9984
v_mfma_f32_16x16x32_bf16 v[148:151], v[20:23], v[32:35], 0
ds_read_b64_tr_b16 v[60:61], v202 offset:32
ds_read_b64_tr_b16 v[62:63], v202 offset:9760
s_waitcnt lgkmcnt(6)
v_mfma_f32_16x16x32_bf16 v[128:131], v[36:39], v[44:47], v[128:131]
ds_read_b64_tr_b16 v[68:69], v202 offset:288
ds_read_b64_tr_b16 v[70:71], v202 offset:10016
v_mfma_f32_16x16x32_bf16 v[136:139], v[36:39], v[48:51], v[136:139]
ds_read_b64_tr_b16 v[72:73], v203 offset:512
ds_read_b64_tr_b16 v[74:75], v203 offset:10240
v_mfma_f32_16x16x32_bf16 v[132:135], v[40:43], v[44:47], v[132:135]
ds_read_b64_tr_b16 v[76:77], v202 offset:19456
ds_read_b64_tr_b16 v[78:79], v202 offset:29184
v_mfma_f32_16x16x32_bf16 v[140:143], v[40:43], v[48:51], v[140:143]
ds_read_b64_tr_b16 v[84:85], v202 offset:19712
ds_read_b64_tr_b16 v[86:87], v202 offset:29440
v_mfma_f32_16x16x32_bf16 v[144:147], v[36:39], v[52:55], v[144:147]
ds_read_b64_tr_b16 v[80:81], v202 offset:19488
ds_read_b64_tr_b16 v[82:83], v202 offset:29216
v_mfma_f32_16x16x32_bf16 v[148:151], v[40:43], v[52:55], v[148:151]
ds_read_b64_tr_b16 v[88:89], v202 offset:19744
ds_read_b64_tr_b16 v[90:91], v202 offset:29472
s_waitcnt lgkmcnt(8)
v_mfma_f32_16x16x32_bf16 v[128:131], v[56:59], v[64:67], v[128:131]
ds_read_b64_tr_b16 v[92:93], v203 offset:19968
ds_read_b64_tr_b16 v[94:95], v203 offset:29696
v_mfma_f32_16x16x32_bf16 v[136:139], v[56:59], v[68:71], v[136:139]
ds_read_b64_tr_b16 v[160:161], v10 offset:32768
ds_read_b64_tr_b16 v[162:163], v10 offset:33280
v_mfma_f32_16x16x32_bf16 v[132:135], v[60:63], v[64:67], v[132:135]
ds_read_b64_tr_b16 v[164:165], v11 offset:32768
ds_read_b64_tr_b16 v[166:167], v11 offset:33280
v_mfma_f32_16x16x32_bf16 v[140:143], v[60:63], v[68:71], v[140:143]
ds_read_b64_tr_b16 v[168:169], v10 offset:36864
ds_read_b64_tr_b16 v[170:171], v10 offset:37376
v_mfma_f32_16x16x32_bf16 v[144:147], v[56:59], v[72:75], v[144:147]
ds_read_b64_tr_b16 v[172:173], v11 offset:36864
ds_read_b64_tr_b16 v[174:175], v11 offset:37376
v_mfma_f32_16x16x32_bf16 v[148:151], v[60:63], v[72:75], v[148:151]
s_waitcnt lgkmcnt(8)
v_mfma_f32_16x16x32_bf16 v[128:131], v[76:79], v[84:87], v[128:131]
v_mfma_f32_16x16x32_bf16 v[136:139], v[76:79], v[88:91], v[136:139]
v_mfma_f32_16x16x32_bf16 v[132:135], v[80:83], v[84:87], v[132:135]
s_nop 5
v_perm_b32 v128, v128, v15, s44
v_perm_b32 v129, v129, v15, s45
v_perm_b32 v130, v130, v15, s46
v_perm_b32 v131, v131, v15, s47
buffer_store_dwordx4 v[128:131], v1, s[12:15], s38 offen sc1
v_mfma_f32_16x16x32_bf16 v[140:143], v[80:83], v[88:91], v[140:143]
v_perm_b32 v136, v136, v15, s44
v_perm_b32 v137, v137, v15, s45
v_perm_b32 v138, v138, v15, s46
v_perm_b32 v139, v139, v15, s47
buffer_store_dwordx4 v[136:139], v1, s[12:15], s90 offen sc1
v_mfma_f32_16x16x32_bf16 v[144:147], v[76:79], v[92:95], v[144:147]
v_perm_b32 v132, v132, v15, s44
v_perm_b32 v133, v133, v15, s45
v_perm_b32 v134, v134, v15, s46
v_perm_b32 v135, v135, v15, s47
buffer_store_dwordx4 v[132:135], v1, s[12:15], s89 offen sc1
v_mfma_f32_16x16x32_bf16 v[148:151], v[80:83], v[92:95], v[148:151]
v_perm_b32 v140, v140, v15, s44
v_perm_b32 v141, v141, v15, s45
v_perm_b32 v142, v142, v15, s46
v_perm_b32 v143, v143, v15, s47
buffer_store_dwordx4 v[140:143], v1, s[12:15], s91 offen sc1
v_perm_b32 v144, v144, v15, s44
v_perm_b32 v145, v145, v15, s45
v_perm_b32 v146, v146, v15, s46
v_perm_b32 v147, v147, v15, s47
v_perm_b32 v148, v148, v15, s44
v_perm_b32 v149, v149, v15, s45
v_perm_b32 v150, v150, v15, s46
v_perm_b32 v151, v151, v15, s47
s_mov_b32 exec_lo, s39
s_mov_b32 exec_hi, s39
buffer_store_dwordx4 v[144:147], v211, s[12:15], s61 offen offset:0 sc1
buffer_store_dwordx4 v[148:151], v211, s[12:15], s61 offen offset:64 sc1
s_mov_b64 exec, -1
s_barrier
s_waitcnt lgkmcnt(0)
v_mfma_f32_16x16x32_bf16 v[96:99], v[160:163], a[0:3], v[96:99]
ds_read_b64_tr_b16 v[176:177], v10 offset:40960
v_mfma_f32_16x16x32_bf16 v[96:99], v[168:171], a[16:19], v[96:99]
ds_read_b64_tr_b16 v[178:179], v10 offset:41472
s_mov_b32 s50, 0x0c0c0400
s_mov_b32 s51, 0x04000c0c
v_mfma_f32_16x16x32_bf16 v[100:103], v[168:171], a[20:23], v[100:103]
s_add_u32 m0, s70, 0
s_xor_b32 s20, s32, 1048576
s_add_u32 s20, s28, s20
s_addc_u32 s21, s29, 0
v_mfma_f32_16x16x32_bf16 v[100:103], v[160:163], a[4:7], v[100:103]
ds_read_b64_tr_b16 v[180:181], v11 offset:40960
v_mfma_f32_16x16x32_bf16 v[104:107], v[160:163], a[8:11], v[104:107]
ds_read_b64_tr_b16 v[182:183], v11 offset:41472
v_lshrrev_b32 v200, 4, v0
v_mfma_f32_16x16x32_bf16 v[104:107], v[168:171], a[24:27], v[104:107]
v_lshlrev_b32 v200, 10, v200
v_mfma_f32_16x16x32_bf16 v[108:111], v[168:171], a[28:31], v[108:111]
ds_read_b64_tr_b16 v[184:185], v10 offset:45056
v_and_b32 v201, 15, v0
v_mfma_f32_16x16x32_bf16 v[108:111], v[160:163], a[12:15], v[108:111]
ds_read_b64_tr_b16 v[186:187], v10 offset:45568
v_lshl_add_u32 v200, v201, 4, v200
v_mfma_f32_16x16x32_bf16 v[124:127], v[164:167], a[12:15], v[124:127]
buffer_load_dwordx4 v215, s[20:23], 0 offen offset:0 lds
v_mfma_f32_16x16x32_bf16 v[124:127], v[172:175], a[28:31], v[124:127]
ds_read_b64_tr_b16 v[188:189], v11 offset:45056
v_mfma_f32_16x16x32_bf16 v[120:123], v[172:175], a[24:27], v[120:123]
ds_read_b64_tr_b16 v[190:191], v11 offset:45568
s_lshl_b32 s61, s36, 4
s_add_u32 s61, s61, s35
s_lshl_b32 s88, s61, 14
s_lshl_b32 s39, s3, 8
v_mfma_f32_16x16x32_bf16 v[120:123], v[164:167], a[8:11], v[120:123]
s_add_u32 s88, s88, s39
s_add_u32 s88, s88, 58720256
v_mfma_f32_16x16x32_bf16 v[116:119], v[164:167], a[4:7], v[116:119]
s_add_u32 s89, s88, 4096
s_add_u32 s90, s88, 8192
s_add_u32 s91, s88, 12288
v_mfma_f32_16x16x32_bf16 v[116:119], v[172:175], a[20:23], v[116:119]
v_mfma_f32_16x16x32_bf16 v[112:115], v[172:175], a[16:19], v[112:115]
s_lshl_b32 s61, s61, 10
s_add_u32 s61, s61, s39
s_add_u32 s56, s61, 62914560
v_mfma_f32_16x16x32_bf16 v[112:115], v[164:167], a[0:3], v[112:115]
s_lshl_b32 s93, s36, 1
s_add_u32 s93, s93, s34
s_xor_b32 s93, s93, 0
s_lshl_b32 s92, s93, 12
s_add_u32 s92, s92, 63373312
s_waitcnt lgkmcnt(0)
v_mfma_f32_16x16x32_bf16 v[96:99], v[176:179], a[32:35], v[96:99]
ds_read_b64_tr_b16 v[160:161], v10 offset:49152
v_mfma_f32_16x16x32_bf16 v[96:99], v[184:187], a[48:51], v[96:99]
buffer_load_dwordx4 v215, s[20:23], s66 offen offset:1024 lds
v_mfma_f32_16x16x32_bf16 v[100:103], v[184:187], a[52:55], v[100:103]
ds_read_b64_tr_b16 v[162:163], v10 offset:49664
s_waitcnt vmcnt(15)
v_add_f32_dpp v232, v232, v232 row_ror:8 row_mask:0xf bank_mask:0xf
v_mfma_f32_16x16x32_bf16 v[100:103], v[176:179], a[36:39], v[100:103]
ds_read_b64_tr_b16 v[164:165], v11 offset:49152
v_mfma_f32_16x16x32_bf16 v[104:107], v[176:179], a[40:43], v[104:107]
ds_read_b64_tr_b16 v[166:167], v11 offset:49664
v_add_f32_dpp v233, v233, v233 row_ror:8 row_mask:0xf bank_mask:0xf
v_mfma_f32_16x16x32_bf16 v[104:107], v[184:187], a[56:59], v[104:107]
buffer_load_dwordx4 v215, s[20:23], s67 offen offset:2048 lds
v_mfma_f32_16x16x32_bf16 v[108:111], v[184:187], a[60:63], v[108:111]
ds_read_b64_tr_b16 v[168:169], v10 offset:53248
v_add_f32_dpp v234, v234, v234 row_ror:8 row_mask:0xf bank_mask:0xf
v_mfma_f32_16x16x32_bf16 v[108:111], v[176:179], a[44:47], v[108:111]
ds_read_b64_tr_b16 v[170:171], v10 offset:53760
v_mfma_f32_16x16x32_bf16 v[124:127], v[180:183], a[44:47], v[124:127]
ds_read_b64_tr_b16 v[172:173], v11 offset:53248
v_add_f32_dpp v235, v235, v235 row_ror:8 row_mask:0xf bank_mask:0xf
v_mfma_f32_16x16x32_bf16 v[124:127], v[188:191], a[60:63], v[124:127]
buffer_load_dwordx4 v215, s[20:23], s68 offen offset:3072 lds
v_mfma_f32_16x16x32_bf16 v[120:123], v[188:191], a[56:59], v[120:123]
ds_read_b64_tr_b16 v[174:175], v11 offset:53760
v_add_f32_dpp v236, v236, v236 row_ror:8 row_mask:0xf bank_mask:0xf
v_mfma_f32_16x16x32_bf16 v[120:123], v[180:183], a[40:43], v[120:123]
v_add_f32_dpp v237, v237, v237 row_ror:8 row_mask:0xf bank_mask:0xf
v_mfma_f32_16x16x32_bf16 v[116:119], v[180:183], a[36:39], v[116:119]
v_add_f32_dpp v238, v238, v238 row_ror:8 row_mask:0xf bank_mask:0xf
v_mfma_f32_16x16x32_bf16 v[116:119], v[188:191], a[52:55], v[116:119]
v_add_f32_dpp v239, v239, v239 row_ror:8 row_mask:0xf bank_mask:0xf
v_mfma_f32_16x16x32_bf16 v[112:115], v[188:191], a[48:51], v[112:115]
v_add_f32_dpp v232, v232, v232 row_ror:4 row_mask:0xf bank_mask:0xf
v_mfma_f32_16x16x32_bf16 v[112:115], v[180:183], a[32:35], v[112:115]
v_add_f32_dpp v233, v233, v233 row_ror:4 row_mask:0xf bank_mask:0xf
s_waitcnt lgkmcnt(0)
v_mfma_f32_16x16x32_bf16 v[96:99], v[160:163], a[64:67], v[96:99]
ds_read_b64_tr_b16 v[176:177], v10 offset:57344
v_mfma_f32_16x16x32_bf16 v[96:99], v[168:171], a[80:83], v[96:99]
ds_read_b64_tr_b16 v[178:179], v10 offset:57856
v_add_f32_dpp v234, v234, v234 row_ror:4 row_mask:0xf bank_mask:0xf
v_mfma_f32_16x16x32_bf16 v[100:103], v[168:171], a[84:87], v[100:103]
s_add_u32 m0, s70, 16384
s_xor_b32 s20, s32, 1310720
s_add_u32 s20, s28, s20
s_addc_u32 s21, s29, 0
v_mfma_f32_16x16x32_bf16 v[100:103], v[160:163], a[68:71], v[100:103]
ds_read_b64_tr_b16 v[180:181], v11 offset:57344
v_mfma_f32_16x16x32_bf16 v[104:107], v[160:163], a[72:75], v[104:107]
ds_read_b64_tr_b16 v[182:183], v11 offset:57856
v_add_f32_dpp v235, v235, v235 row_ror:4 row_mask:0xf bank_mask:0xf
v_mfma_f32_16x16x32_bf16 v[104:107], v[168:171], a[88:91], v[104:107]
v_add_f32_dpp v236, v236, v236 row_ror:4 row_mask:0xf bank_mask:0xf
v_mfma_f32_16x16x32_bf16 v[108:111], v[168:171], a[92:95], v[108:111]
ds_read_b64_tr_b16 v[184:185], v10 offset:61440
v_mfma_f32_16x16x32_bf16 v[108:111], v[160:163], a[76:79], v[108:111]
ds_read_b64_tr_b16 v[186:187], v10 offset:61952
v_add_f32_dpp v237, v237, v237 row_ror:4 row_mask:0xf bank_mask:0xf
v_mfma_f32_16x16x32_bf16 v[124:127], v[164:167], a[76:79], v[124:127]
buffer_load_dwordx4 v215, s[20:23], 0 offen offset:0 lds
v_mfma_f32_16x16x32_bf16 v[124:127], v[172:175], a[92:95], v[124:127]
ds_read_b64_tr_b16 v[188:189], v11 offset:61440
v_add_f32_dpp v238, v238, v238 row_ror:4 row_mask:0xf bank_mask:0xf
v_mfma_f32_16x16x32_bf16 v[120:123], v[172:175], a[88:91], v[120:123]
ds_read_b64_tr_b16 v[190:191], v11 offset:61952
v_mfma_f32_16x16x32_bf16 v[120:123], v[164:167], a[72:75], v[120:123]
v_add_f32_dpp v239, v239, v239 row_ror:4 row_mask:0xf bank_mask:0xf
v_mfma_f32_16x16x32_bf16 v[116:119], v[164:167], a[68:71], v[116:119]
v_add_f32_dpp v232, v232, v232 row_ror:2 row_mask:0xf bank_mask:0xf
v_mfma_f32_16x16x32_bf16 v[116:119], v[172:175], a[84:87], v[116:119]
v_add_f32_dpp v233, v233, v233 row_ror:2 row_mask:0xf bank_mask:0xf
v_mfma_f32_16x16x32_bf16 v[112:115], v[172:175], a[80:83], v[112:115]
v_add_f32_dpp v234, v234, v234 row_ror:2 row_mask:0xf bank_mask:0xf
v_mfma_f32_16x16x32_bf16 v[112:115], v[164:167], a[64:67], v[112:115]
v_add_f32_dpp v235, v235, v235 row_ror:2 row_mask:0xf bank_mask:0xf
v_add_f32_dpp v236, v236, v236 row_ror:2 row_mask:0xf bank_mask:0xf
s_waitcnt lgkmcnt(0)
v_mfma_f32_16x16x32_bf16 v[96:99], v[176:179], a[96:99], v[96:99]
ds_read_b64_tr_b16 v[160:161], v8 offset:32768
v_mfma_f32_16x16x32_bf16 v[96:99], v[184:187], a[112:115], v[96:99]
buffer_load_dwordx4 v215, s[20:23], s66 offen offset:1024 lds
v_add_f32_dpp v237, v237, v237 row_ror:2 row_mask:0xf bank_mask:0xf
v_mfma_f32_16x16x32_bf16 v[100:103], v[184:187], a[116:119], v[100:103]
ds_read_b64_tr_b16 v[162:163], v8 offset:33280
v_mfma_f32_16x16x32_bf16 v[100:103], v[176:179], a[100:103], v[100:103]
ds_read_b64_tr_b16 v[164:165], v9 offset:32768
v_add_f32_dpp v238, v238, v238 row_ror:2 row_mask:0xf bank_mask:0xf
v_mfma_f32_16x16x32_bf16 v[104:107], v[176:179], a[104:107], v[104:107]
ds_read_b64_tr_b16 v[166:167], v9 offset:33280
v_mfma_f32_16x16x32_bf16 v[104:107], v[184:187], a[120:123], v[104:107]
buffer_load_dwordx4 v215, s[20:23], s67 offen offset:2048 lds
v_add_f32_dpp v239, v239, v239 row_ror:2 row_mask:0xf bank_mask:0xf
v_mfma_f32_16x16x32_bf16 v[108:111], v[184:187], a[124:127], v[108:111]
ds_read_b64_tr_b16 v[168:169], v8 offset:36864
v_mfma_f32_16x16x32_bf16 v[108:111], v[176:179], a[108:111], v[108:111]
ds_read_b64_tr_b16 v[170:171], v8 offset:37376
v_add_f32_dpp v232, v232, v232 row_ror:1 row_mask:0xf bank_mask:0xf
v_mfma_f32_16x16x32_bf16 v[124:127], v[180:183], a[108:111], v[124:127]
ds_read_b64_tr_b16 v[172:173], v9 offset:36864
v_mfma_f32_16x16x32_bf16 v[124:127], v[188:191], a[124:127], v[124:127]
buffer_load_dwordx4 v215, s[20:23], s68 offen offset:3072 lds
v_add_f32_dpp v233, v233, v233 row_ror:1 row_mask:0xf bank_mask:0xf
v_mfma_f32_16x16x32_bf16 v[120:123], v[188:191], a[120:123], v[120:123]
ds_read_b64_tr_b16 v[174:175], v9 offset:37376
v_mfma_f32_16x16x32_bf16 v[120:123], v[180:183], a[104:107], v[120:123]
v_add_f32_dpp v234, v234, v234 row_ror:1 row_mask:0xf bank_mask:0xf
v_mfma_f32_16x16x32_bf16 v[116:119], v[180:183], a[100:103], v[116:119]
v_add_f32_dpp v235, v235, v235 row_ror:1 row_mask:0xf bank_mask:0xf
v_mfma_f32_16x16x32_bf16 v[116:119], v[188:191], a[116:119], v[116:119]
v_add_f32_dpp v236, v236, v236 row_ror:1 row_mask:0xf bank_mask:0xf
v_mfma_f32_16x16x32_bf16 v[112:115], v[188:191], a[112:115], v[112:115]
v_add_f32_dpp v237, v237, v237 row_ror:1 row_mask:0xf bank_mask:0xf
v_mfma_f32_16x16x32_bf16 v[112:115], v[180:183], a[96:99], v[112:115]
v_add_f32_dpp v238, v238, v238 row_ror:1 row_mask:0xf bank_mask:0xf
v_add_f32_dpp v239, v239, v239 row_ror:1 row_mask:0xf bank_mask:0xf
s_waitcnt lgkmcnt(0)
v_mfma_f32_16x16x32_bf16 v[96:99], v[160:163], a[128:131], v[96:99]
ds_read_b64_tr_b16 v[176:177], v8 offset:40960
v_mfma_f32_16x16x32_bf16 v[96:99], v[168:171], a[144:147], v[96:99]
ds_read_b64_tr_b16 v[178:179], v8 offset:41472
v_mfma_f32_16x16x32_bf16 v[100:103], v[168:171], a[148:151], v[100:103]
v_mfma_f32_16x16x32_bf16 v[100:103], v[160:163], a[132:135], v[100:103]
ds_read_b64_tr_b16 v[180:181], v9 offset:40960
v_mfma_f32_16x16x32_bf16 v[104:107], v[160:163], a[136:139], v[104:107]
ds_read_b64_tr_b16 v[182:183], v9 offset:41472
v_mfma_f32_16x16x32_bf16 v[104:107], v[168:171], a[152:155], v[104:107]
v_mfma_f32_16x16x32_bf16 v[108:111], v[168:171], a[156:159], v[108:111]
ds_read_b64_tr_b16 v[184:185], v8 offset:45056
v_mfma_f32_16x16x32_bf16 v[108:111], v[160:163], a[140:143], v[108:111]
ds_read_b64_tr_b16 v[186:187], v8 offset:45568
v_mfma_f32_16x16x32_bf16 v[124:127], v[164:167], a[140:143], v[124:127]
v_mfma_f32_16x16x32_bf16 v[124:127], v[172:175], a[156:159], v[124:127]
ds_read_b64_tr_b16 v[188:189], v9 offset:45056
v_mfma_f32_16x16x32_bf16 v[120:123], v[172:175], a[152:155], v[120:123]
ds_read_b64_tr_b16 v[190:191], v9 offset:45568
v_mfma_f32_16x16x32_bf16 v[120:123], v[164:167], a[136:139], v[120:123]
v_mfma_f32_16x16x32_bf16 v[116:119], v[164:167], a[132:135], v[116:119]
v_mfma_f32_16x16x32_bf16 v[116:119], v[172:175], a[148:151], v[116:119]
v_mfma_f32_16x16x32_bf16 v[112:115], v[172:175], a[144:147], v[112:115]
v_mfma_f32_16x16x32_bf16 v[112:115], v[164:167], a[128:131], v[112:115]
s_waitcnt lgkmcnt(0)
v_mfma_f32_16x16x32_bf16 v[96:99], v[176:179], a[160:163], v[96:99]
ds_read_b64_tr_b16 v[160:161], v10 offset:0
v_mfma_f32_16x16x32_bf16 v[96:99], v[184:187], a[176:179], v[96:99]
buffer_load_dwordx4 v[240:243], v200, s[12:15], s88 offen sc1
v_mfma_f32_16x16x32_bf16 v[100:103], v[184:187], a[180:183], v[100:103]
ds_read_b64_tr_b16 v[162:163], v10 offset:512
v_mfma_f32_16x16x32_bf16 v[100:103], v[176:179], a[164:167], v[100:103]
ds_read_b64_tr_b16 v[164:165], v11 offset:0
v_mfma_f32_16x16x32_bf16 v[104:107], v[176:179], a[168:171], v[104:107]
buffer_load_dwordx4 v[244:247], v200, s[12:15], s89 offen sc1
v_mfma_f32_16x16x32_bf16 v[104:107], v[184:187], a[184:187], v[104:107]
ds_read_b64_tr_b16 v[166:167], v11 offset:512
v_mfma_f32_16x16x32_bf16 v[108:111], v[184:187], a[188:191], v[108:111]
ds_read_b64_tr_b16 v[168:169], v10 offset:4096
v_mfma_f32_16x16x32_bf16 v[108:111], v[176:179], a[172:175], v[108:111]
buffer_load_dwordx4 v[248:251], v200, s[12:15], s90 offen sc1
v_mfma_f32_16x16x32_bf16 v[124:127], v[180:183], a[172:175], v[124:127]
ds_read_b64_tr_b16 v[170:171], v10 offset:4608
v_mfma_f32_16x16x32_bf16 v[124:127], v[188:191], a[188:191], v[124:127]
ds_read_b64_tr_b16 v[172:173], v11 offset:4096
v_mfma_f32_16x16x32_bf16 v[120:123], v[188:191], a[184:187], v[120:123]
buffer_load_dwordx4 v[252:255], v200, s[12:15], s91 offen sc1
v_mfma_f32_16x16x32_bf16 v[120:123], v[180:183], a[168:171], v[120:123]
ds_read_b64_tr_b16 v[174:175], v11 offset:4608
v_mfma_f32_16x16x32_bf16 v[116:119], v[180:183], a[164:167], v[116:119]
v_mfma_f32_16x16x32_bf16 v[116:119], v[188:191], a[180:183], v[116:119]
v_mfma_f32_16x16x32_bf16 v[112:115], v[188:191], a[176:179], v[112:115]
v_mfma_f32_16x16x32_bf16 v[112:115], v[180:183], a[160:163], v[112:115]
s_waitcnt lgkmcnt(0)
v_mfma_f32_16x16x32_bf16 v[96:99], v[160:163], a[192:195], v[96:99]
v_mfma_f32_16x16x32_bf16 v[96:99], v[168:171], a[208:211], v[96:99]
v_mfma_f32_16x16x32_bf16 v[100:103], v[168:171], a[212:215], v[100:103]
v_mfma_f32_16x16x32_bf16 v[100:103], v[160:163], a[196:199], v[100:103]
v_mfma_f32_16x16x32_bf16 v[104:107], v[160:163], a[200:203], v[104:107]
v_mfma_f32_16x16x32_bf16 v[104:107], v[168:171], a[216:219], v[104:107]
v_mfma_f32_16x16x32_bf16 v[108:111], v[168:171], a[220:223], v[108:111]
v_mfma_f32_16x16x32_bf16 v[108:111], v[160:163], a[204:207], v[108:111]
v_mfma_f32_16x16x32_bf16 v[124:127], v[164:167], a[204:207], v[124:127]
v_mfma_f32_16x16x32_bf16 v[124:127], v[172:175], a[220:223], v[124:127]
v_mfma_f32_16x16x32_bf16 v[120:123], v[172:175], a[216:219], v[120:123]
v_mfma_f32_16x16x32_bf16 v[120:123], v[164:167], a[200:203], v[120:123]
v_mfma_f32_16x16x32_bf16 v[116:119], v[164:167], a[196:199], v[116:119]
v_mfma_f32_16x16x32_bf16 v[116:119], v[172:175], a[212:215], v[116:119]
v_mfma_f32_16x16x32_bf16 v[112:115], v[172:175], a[208:211], v[112:115]
L_wp4:
s_cbranch_execz L_wra
v_mfma_f32_16x16x32_bf16 v[112:115], v[164:167], a[192:195], v[112:115]
v_pk_fma_f32 v[96:97], v[232:233], v[204:205], v[96:97] op_sel:[0,0,0] op_sel_hi:[1,0,1]
v_pk_fma_f32 v[98:99], v[234:235], v[204:205], v[98:99] op_sel:[0,0,0] op_sel_hi:[1,0,1]
s_nop 5
s_nop 0
v_pk_fma_f32 v[112:113], v[236:237], v[204:205], v[112:113] op_sel:[0,0,0] op_sel_hi:[1,0,1]
v_pk_fma_f32 v[114:115], v[238:239], v[204:205], v[114:115] op_sel:[0,0,0] op_sel_hi:[1,0,1]
v_pk_fma_f32 v[100:101], v[232:233], v[206:207], v[100:101] op_sel:[0,0,0] op_sel_hi:[1,0,1]
v_pk_fma_f32 v[102:103], v[234:235], v[206:207], v[102:103] op_sel:[0,0,0] op_sel_hi:[1,0,1]
v_pk_fma_f32 v[116:117], v[236:237], v[206:207], v[116:117] op_sel:[0,0,0] op_sel_hi:[1,0,1]
v_pk_fma_f32 v[118:119], v[238:239], v[206:207], v[118:119] op_sel:[0,0,0] op_sel_hi:[1,0,1]
v_pk_fma_f32 v[104:105], v[232:233], v[220:221], v[104:105] op_sel:[0,0,0] op_sel_hi:[1,0,1]
v_pk_fma_f32 v[106:107], v[234:235], v[220:221], v[106:107] op_sel:[0,0,0] op_sel_hi:[1,0,1]
v_pk_fma_f32 v[120:121], v[236:237], v[220:221], v[120:121] op_sel:[0,0,0] op_sel_hi:[1,0,1]
v_pk_fma_f32 v[122:123], v[238:239], v[220:221], v[122:123] op_sel:[0,0,0] op_sel_hi:[1,0,1]
v_pk_fma_f32 v[108:109], v[232:233], v[222:223], v[108:109] op_sel:[0,0,0] op_sel_hi:[1,0,1]
v_pk_fma_f32 v[110:111], v[234:235], v[222:223], v[110:111] op_sel:[0,0,0] op_sel_hi:[1,0,1]
v_pk_fma_f32 v[124:125], v[236:237], v[222:223], v[124:125] op_sel:[0,0,0] op_sel_hi:[1,0,1]
v_pk_fma_f32 v[126:127], v[238:239], v[222:223], v[126:127] op_sel:[0,0,0] op_sel_hi:[1,0,1]
v_cvt_pk_bf16_f32 v96, v96, v97
v_cvt_pk_bf16_f32 v97, v98, v99
v_cvt_pk_bf16_f32 v98, v112, v113
v_cvt_pk_bf16_f32 v99, v114, v115
s_nop 1
v_mfma_f32_16x16x32_bf16 v[16:19], v[192:195], v[96:99], 0
v_mfma_f32_16x16x32_bf16 v[20:23], v[196:199], v[96:99], 0
v_cvt_pk_bf16_f32 v100, v100, v101
v_cvt_pk_bf16_f32 v101, v102, v103
v_cvt_pk_bf16_f32 v102, v116, v117
v_cvt_pk_bf16_f32 v103, v118, v119
s_nop 1
v_mfma_f32_16x16x32_bf16 v[24:27], v[192:195], v[100:103], 0
v_mfma_f32_16x16x32_bf16 v[28:31], v[196:199], v[100:103], 0
v_cvt_pk_bf16_f32 v104, v104, v105
v_cvt_pk_bf16_f32 v105, v106, v107
v_cvt_pk_bf16_f32 v106, v120, v121
v_cvt_pk_bf16_f32 v107, v122, v123
s_nop 1
v_mfma_f32_16x16x32_bf16 v[32:35], v[192:195], v[104:107], 0
v_mfma_f32_16x16x32_bf16 v[36:39], v[196:199], v[104:107], 0
v_cvt_pk_bf16_f32 v108, v108, v109
v_cvt_pk_bf16_f32 v109, v110, v111
v_cvt_pk_bf16_f32 v110, v124, v125
v_cvt_pk_bf16_f32 v111, v126, v127
s_nop 1
v_mfma_f32_16x16x32_bf16 v[40:43], v[192:195], v[108:111], 0
v_mfma_f32_16x16x32_bf16 v[44:47], v[196:199], v[108:111], 0
s_mov_b32 s60, 0
s_waitcnt vmcnt(0)
L_h1:
v_perm_b32 v201, v241, v240, s50
v_perm_b32 v202, v243, v242, s51
v_or_b32 v201, v201, v202
v_xor_b32 v203, v201, v15
v_perm_b32 v201, v245, v244, s50
v_perm_b32 v202, v247, v246, s51
v_or_b32 v201, v201, v202
v_xor_b32 v201, v201, v15
v_or_b32 v203, v203, v201
v_perm_b32 v201, v249, v248, s50
v_perm_b32 v202, v251, v250, s51
v_or_b32 v201, v201, v202
v_xor_b32 v201, v201, v15
v_or_b32 v203, v203, v201
v_perm_b32 v201, v253, v252, s50
v_perm_b32 v202, v255, v254, s51
v_or_b32 v201, v201, v202
v_xor_b32 v201, v201, v15
v_or_b32 v203, v203, v201
v_cmp_ne_u32 vcc, 0, v203
s_cbranch_vccz L_h1x
s_mov_b64 exec, vcc
buffer_load_dwordx4 v[240:243], v200, s[12:15], s88 offen sc1
buffer_load_dwordx4 v[244:247], v200, s[12:15], s89 offen sc1
buffer_load_dwordx4 v[248:251], v200, s[12:15], s90 offen sc1
buffer_load_dwordx4 v[252:255], v200, s[12:15], s91 offen sc1
s_mov_b64 exec, -1
s_add_u32 s60, s60, 1
s_cmp_lt_u32 s60, 20000
s_waitcnt vmcnt(0)
s_cbranch_scc1 L_h1
L_h1x:
v_and_b32 v240, 0xffffff00, v240
v_and_b32 v241, 0xffffff00, v241
v_and_b32 v242, 0xffffff00, v242
v_and_b32 v243, 0xffffff00, v243
v_and_b32 v244, 0xffffff00, v244
v_and_b32 v245, 0xffffff00, v245
v_and_b32 v246, 0xffffff00, v246
v_and_b32 v247, 0xffffff00, v247
v_and_b32 v248, 0xffffff00, v248
v_and_b32 v249, 0xffffff00, v249
v_and_b32 v250, 0xffffff00, v250
v_and_b32 v251, 0xffffff00, v251
v_and_b32 v252, 0xffffff00, v252
v_and_b32 v253, 0xffffff00, v253
v_and_b32 v254, 0xffffff00, v254
v_and_b32 v255, 0xffffff00, v255
v_pk_add_f32 v[240:241], v[240:241], v[244:245]
v_pk_add_f32 v[248:249], v[248:249], v[252:253]
v_pk_add_f32 v[242:243], v[242:243], v[246:247]
v_pk_add_f32 v[250:251], v[250:251], v[254:255]
v_pk_add_f32 v[240:241], v[240:241], v[248:249]
v_pk_add_f32 v[242:243], v[242:243], v[250:251]
s_nop 0
v_permlane16_swap_b32 v240, v241
v_permlane16_swap_b32 v242, v243
v_add_f32 v241, v240, v241
v_add_f32 v243, v242, v243
s_nop 1
v_permlane32_swap_b32 v241, v243
v_add_f32 v241, v241, v243
v_mov_b32 v243, v241
s_nop 1
v_permlane32_swap_b32 v241, v243
v_mov_b32 v240, v241
v_mov_b32 v242, v243
s_nop 0
v_permlane16_swap_b32 v240, v241
v_permlane16_swap_b32 v242, v243
v_perm_b32 v240, v240, v15, s44
v_perm_b32 v241, v241, v15, s45
v_perm_b32 v242, v242, v15, s46
v_perm_b32 v243, v243, v15, s47
s_mov_b64 exec, 0xffff
buffer_store_dwordx4 v[240:243], v1, s[12:15], s56 offen sc1
s_mov_b64 exec, -1
buffer_load_dwordx4 v[80:83], v1, s[12:15], s92 offen offset:0 sc1
buffer_load_dwordx4 v[84:87], v1, s[12:15], s92 offen offset:1024 sc1
buffer_load_dwordx4 v[88:91], v1, s[12:15], s92 offen offset:2048 sc1
buffer_load_dwordx4 v[92:95], v1, s[12:15], s92 offen offset:3072 sc1
s_barrier
s_add_u32 m0, s70, 98304
s_xor_b32 s20, s32, 262144
s_add_u32 s20, s28, s20
s_addc_u32 s21, s29, 0
buffer_load_dwordx4 v215, s[20:23], 0 offen offset:0 lds
buffer_load_dwordx4 v215, s[20:23], s66 offen offset:1024 lds
v_and_b32 v6, 3, v0
v_lshlrev_b32 v6, 4, v6
v_and_b32 v8, 4, v0
v_lshl_add_u32 v6, v8, 5, v6
v_and_b32 v8, 8, v0
v_lshl_add_u32 v6, v8, 8, v6
v_and_b32 v8, 48, v0
v_lshl_add_u32 v6, v8, 5, v6
s_lshl_b32 s88, s93, 13
s_add_u32 s88, s88, 62914560
s_add_u32 s89, s88, 4096
v_max3_f32 v64, v16, v17, v18
v_max3_f32 v66, v24, v25, v26
v_max3_f32 v65, -v16, -v17, -v18
v_max3_f32 v67, -v24, -v25, -v26
v_max3_f32 v64, v64, v19, v20
v_max3_f32 v66, v66, v27, v28
v_max3_f32 v65, v65, -v19, -v20
v_max3_f32 v67, v67, -v27, -v28
v_max3_f32 v64, v64, v21, v22
v_max3_f32 v66, v66, v29, v30
v_max3_f32 v65, v65, -v21, -v22
v_max3_f32 v67, v67, -v29, -v30
v_max_f32 v64, v64, v23
v_max_f32 v66, v66, v31
v_max_f32 v65, v65, -v23
v_max_f32 v67, v67, -v31
v_max3_f32 v68, v32, v33, v34
v_max3_f32 v70, v40, v41, v42
v_max3_f32 v69, -v32, -v33, -v34
v_max3_f32 v71, -v40, -v41, -v42
v_max3_f32 v68, v68, v35, v36
v_max3_f32 v70, v70, v43, v44
v_max3_f32 v69, v69, -v35, -v36
v_max3_f32 v71, v71, -v43, -v44
v_max3_f32 v68, v68, v37, v38
v_max3_f32 v70, v70, v45, v46
v_max3_f32 v69, v69, -v37, -v38
v_max3_f32 v71, v71, -v45, -v46
v_max_f32 v68, v68, v39
v_max_f32 v70, v70, v47
v_max_f32 v69, v69, -v39
v_max_f32 v71, v71, -v47
v_permlane16_swap_b32 v64, v65
v_permlane16_swap_b32 v68, v69
v_permlane16_swap_b32 v66, v67
v_permlane16_swap_b32 v70, v71
v_max_f32 v64, v64, v65
v_max_f32 v68, v68, v69
v_max_f32 v66, v66, v67
v_max_f32 v70, v70, v71
s_nop 0
v_permlane32_swap_b32 v64, v66
v_permlane32_swap_b32 v68, v70
v_max_f32 v64, v64, v66
v_max_f32_e64 v68, v68, v70
v_mul_f32 v65, -v64, v210
v_mul_f32 v69, -v68, v226
v_mul_f32 v67, -v64, v210
v_mul_f32 v71, -v68, v226
s_nop 0
v_permlane32_swap_b32 v65, v67
v_permlane32_swap_b32 v69, v71
v_mov_b32 v64, v65
v_mov_b32 v68, v69
v_mov_b32 v66, v67
v_mov_b32 v70, v71
v_permlane16_swap_b32 v64, v65
v_permlane16_swap_b32 v68, v69
v_permlane16_swap_b32 v66, v67
v_permlane16_swap_b32 v70, v71
buffer_load_dwordx4 v215, s[20:23], s67 offen offset:2048 lds
buffer_load_dwordx4 v215, s[20:23], s68 offen offset:3072 lds
s_add_u32 m0, s70, 131072
s_xor_b32 s20, s32, 524288
s_add_u32 s20, s28, s20
s_addc_u32 s21, s29, 0
buffer_load_dwordx4 v215, s[20:23], 0 offen offset:0 lds
v_pk_fma_f32 v[48:49], v[16:17], v[208:209], v[64:65] op_sel:[0,0,1] op_sel_hi:[1,0,1] neg_lo:[1,0,0] neg_hi:[1,0,0]
v_pk_fma_f32 v[50:51], v[18:19], v[208:209], v[64:65] op_sel:[0,0,1] op_sel_hi:[1,0,1] neg_lo:[1,0,0] neg_hi:[1,0,0]
v_pk_fma_f32 v[52:53], v[20:21], v[208:209], v[64:65] op_sel:[0,0,1] op_sel_hi:[1,0,1] neg_lo:[1,0,0] neg_hi:[1,0,0]
v_pk_fma_f32 v[54:55], v[22:23], v[208:209], v[64:65] op_sel:[0,0,1] op_sel_hi:[1,0,1] neg_lo:[1,0,0] neg_hi:[1,0,0]
v_pk_fma_f32 v[16:17], v[16:17], v[208:209], v[64:65] op_sel:[0,0,0] op_sel_hi:[1,0,0]
v_pk_fma_f32 v[18:19], v[18:19], v[208:209], v[64:65] op_sel:[0,0,0] op_sel_hi:[1,0,0]
v_pk_fma_f32 v[20:21], v[20:21], v[208:209], v[64:65] op_sel:[0,0,0] op_sel_hi:[1,0,0]
v_pk_fma_f32 v[22:23], v[22:23], v[208:209], v[64:65] op_sel:[0,0,0] op_sel_hi:[1,0,0]
v_exp_f32 v16, v16
v_exp_f32 v17, v17
v_exp_f32 v18, v18
v_exp_f32 v19, v19
v_exp_f32 v20, v20
v_exp_f32 v21, v21
v_exp_f32 v22, v22
v_exp_f32 v23, v23
v_exp_f32 v48, v48
v_exp_f32 v49, v49
v_exp_f32 v50, v50
v_exp_f32 v51, v51
v_exp_f32 v52, v52
v_exp_f32 v53, v53
v_exp_f32 v54, v54
v_exp_f32_e64 v55, v55
v_cvt_pk_bf16_f32 v160, v16, v17
v_cvt_pk_bf16_f32 v161, v18, v19
v_cvt_pk_bf16_f32 v162, v20, v21
v_cvt_pk_bf16_f32 v163, v22, v23
v_cvt_pk_bf16_f32 v164, v48, v49
v_cvt_pk_bf16_f32 v165, v50, v51
v_cvt_pk_bf16_f32 v166, v52, v53
v_cvt_pk_bf16_f32 v167, v54, v55
buffer_load_dwordx4 v215, s[20:23], s66 offen offset:1024 lds
buffer_load_dwordx4 v215, s[20:23], s67 offen offset:2048 lds
buffer_load_dwordx4 v215, s[20:23], s68 offen offset:3072 lds
s_add_u32 m0, s70, 147456
s_xor_b32 s20, s32, 786432
s_add_u32 s20, s28, s20
s_addc_u32 s21, s29, 0
v_pk_fma_f32 v[56:57], v[24:25], v[208:209], v[66:67] op_sel:[0,1,1] op_sel_hi:[1,1,1] neg_lo:[1,0,0] neg_hi:[1,0,0]
v_pk_fma_f32 v[58:59], v[26:27], v[208:209], v[66:67] op_sel:[0,1,1] op_sel_hi:[1,1,1] neg_lo:[1,0,0] neg_hi:[1,0,0]
v_pk_fma_f32 v[60:61], v[28:29], v[208:209], v[66:67] op_sel:[0,1,1] op_sel_hi:[1,1,1] neg_lo:[1,0,0] neg_hi:[1,0,0]
v_pk_fma_f32 v[62:63], v[30:31], v[208:209], v[66:67] op_sel:[0,1,1] op_sel_hi:[1,1,1] neg_lo:[1,0,0] neg_hi:[1,0,0]
v_pk_fma_f32 v[24:25], v[24:25], v[208:209], v[66:67] op_sel:[0,1,0] op_sel_hi:[1,1,0]
v_pk_fma_f32 v[26:27], v[26:27], v[208:209], v[66:67] op_sel:[0,1,0] op_sel_hi:[1,1,0]
v_pk_fma_f32 v[28:29], v[28:29], v[208:209], v[66:67] op_sel:[0,1,0] op_sel_hi:[1,1,0]
v_pk_fma_f32 v[30:31], v[30:31], v[208:209], v[66:67] op_sel:[0,1,0] op_sel_hi:[1,1,0]
v_exp_f32 v24, v24
v_exp_f32 v25, v25
v_exp_f32 v26, v26
v_exp_f32 v27, v27
v_exp_f32 v28, v28
v_exp_f32 v29, v29
v_exp_f32 v30, v30
v_exp_f32 v31, v31
v_exp_f32 v56, v56
v_exp_f32 v57, v57
v_exp_f32 v58, v58
v_exp_f32 v59, v59
v_exp_f32 v60, v60
v_exp_f32 v61, v61
v_exp_f32 v62, v62
v_exp_f32 v63, v63
v_cvt_pk_bf16_f32 v168, v24, v25
v_cvt_pk_bf16_f32 v169, v26, v27
v_cvt_pk_bf16_f32 v170, v28, v29
v_cvt_pk_bf16_f32 v171, v30, v31
v_cvt_pk_bf16_f32 v172, v56, v57
v_cvt_pk_bf16_f32 v173, v58, v59
v_cvt_pk_bf16_f32 v174, v60, v61
v_cvt_pk_bf16_f32 v175, v62, v63
buffer_load_dwordx4 v215, s[20:23], 0 offen offset:0 lds
buffer_load_dwordx4 v215, s[20:23], s66 offen offset:1024 lds
buffer_load_dwordx4 v215, s[20:23], s67 offen offset:2048 lds
buffer_load_dwordx4 v215, s[20:23], s68 offen offset:3072 lds
v_pk_fma_f32 v[48:49], v[32:33], v[224:225], v[68:69] op_sel:[0,0,1] op_sel_hi:[1,0,1] neg_lo:[1,0,0] neg_hi:[1,0,0]
v_pk_fma_f32 v[50:51], v[34:35], v[224:225], v[68:69] op_sel:[0,0,1] op_sel_hi:[1,0,1] neg_lo:[1,0,0] neg_hi:[1,0,0]
v_pk_fma_f32 v[52:53], v[36:37], v[224:225], v[68:69] op_sel:[0,0,1] op_sel_hi:[1,0,1] neg_lo:[1,0,0] neg_hi:[1,0,0]
v_pk_fma_f32 v[54:55], v[38:39], v[224:225], v[68:69] op_sel:[0,0,1] op_sel_hi:[1,0,1] neg_lo:[1,0,0] neg_hi:[1,0,0]
v_pk_fma_f32 v[32:33], v[32:33], v[224:225], v[68:69] op_sel:[0,0,0] op_sel_hi:[1,0,0]
v_pk_fma_f32 v[34:35], v[34:35], v[224:225], v[68:69] op_sel:[0,0,0] op_sel_hi:[1,0,0]
v_pk_fma_f32 v[36:37], v[36:37], v[224:225], v[68:69] op_sel:[0,0,0] op_sel_hi:[1,0,0]
v_pk_fma_f32 v[38:39], v[38:39], v[224:225], v[68:69] op_sel:[0,0,0] op_sel_hi:[1,0,0]
v_exp_f32 v32, v32
v_exp_f32 v33, v33
v_exp_f32 v34, v34
v_exp_f32 v35, v35
v_exp_f32 v36, v36
v_exp_f32 v37, v37
v_exp_f32 v38, v38
v_exp_f32 v39, v39
v_exp_f32 v48, v48
v_exp_f32 v49, v49
v_exp_f32 v50, v50
v_exp_f32 v51, v51
v_exp_f32 v52, v52
v_exp_f32 v53, v53
v_exp_f32 v54, v54
v_exp_f32 v55, v55
v_cvt_pk_bf16_f32 v176, v32, v33
v_cvt_pk_bf16_f32 v177, v34, v35
v_cvt_pk_bf16_f32 v178, v36, v37
v_cvt_pk_bf16_f32 v179, v38, v39
v_cvt_pk_bf16_f32 v180, v48, v49
v_cvt_pk_bf16_f32 v181, v50, v51
v_cvt_pk_bf16_f32 v182, v52, v53
v_cvt_pk_bf16_f32 v183, v54, v55
v_pk_fma_f32 v[56:57], v[40:41], v[224:225], v[70:71] op_sel:[0,1,1] op_sel_hi:[1,1,1] neg_lo:[1,0,0] neg_hi:[1,0,0]
v_pk_fma_f32 v[58:59], v[42:43], v[224:225], v[70:71] op_sel:[0,1,1] op_sel_hi:[1,1,1] neg_lo:[1,0,0] neg_hi:[1,0,0]
v_pk_fma_f32 v[60:61], v[44:45], v[224:225], v[70:71] op_sel:[0,1,1] op_sel_hi:[1,1,1] neg_lo:[1,0,0] neg_hi:[1,0,0]
v_pk_fma_f32 v[62:63], v[46:47], v[224:225], v[70:71] op_sel:[0,1,1] op_sel_hi:[1,1,1] neg_lo:[1,0,0] neg_hi:[1,0,0]
v_pk_fma_f32 v[40:41], v[40:41], v[224:225], v[70:71] op_sel:[0,1,0] op_sel_hi:[1,1,0]
v_pk_fma_f32 v[42:43], v[42:43], v[224:225], v[70:71] op_sel:[0,1,0] op_sel_hi:[1,1,0]
v_pk_fma_f32 v[44:45], v[44:45], v[224:225], v[70:71] op_sel:[0,1,0] op_sel_hi:[1,1,0]
v_pk_fma_f32 v[46:47], v[46:47], v[224:225], v[70:71] op_sel:[0,1,0] op_sel_hi:[1,1,0]
v_exp_f32 v40, v40
v_exp_f32 v41, v41
v_exp_f32 v42, v42
v_exp_f32 v43, v43
v_exp_f32 v44, v44
v_exp_f32 v45, v45
v_exp_f32 v46, v46
v_exp_f32 v47, v47
v_exp_f32 v56, v56
v_exp_f32 v57, v57
v_exp_f32 v58, v58
v_exp_f32 v59, v59
v_exp_f32 v60, v60
v_exp_f32 v61, v61
v_exp_f32 v62, v62
v_exp_f32 v63, v63
v_cvt_pk_bf16_f32 v184, v40, v41
v_cvt_pk_bf16_f32 v185, v42, v43
v_cvt_pk_bf16_f32 v186, v44, v45
v_cvt_pk_bf16_f32 v187, v46, v47
v_cvt_pk_bf16_f32 v188, v56, v57
v_cvt_pk_bf16_f32 v189, v58, v59
v_cvt_pk_bf16_f32 v190, v60, v61
v_cvt_pk_bf16_f32 v191, v62, v63
buffer_load_dwordx4 v[128:131], v6, s[12:15], s88 offen offset:0 sc1
buffer_load_dwordx4 v[132:135], v6, s[12:15], s88 offen offset:256 sc1
buffer_load_dwordx4 v[136:139], v6, s[12:15], s88 offen offset:64 sc1
buffer_load_dwordx4 v[140:143], v6, s[12:15], s88 offen offset:320 sc1
buffer_load_dwordx4 v[144:147], v6, s[12:15], s89 offen offset:0 sc1
buffer_load_dwordx4 v[148:151], v6, s[12:15], s89 offen offset:256 sc1
buffer_load_dwordx4 v[152:155], v6, s[12:15], s89 offen offset:64 sc1
buffer_load_dwordx4 v[156:159], v6, s[12:15], s89 offen offset:320 sc1
s_mov_b32 s60, 0
s_waitcnt vmcnt(20)
L_hz:
v_perm_b32 v12, v81, v80, s50
v_perm_b32 v13, v83, v82, s51
v_or_b32 v12, v12, v13
v_xor_b32 v14, v12, v15
v_perm_b32 v12, v85, v84, s50
v_perm_b32 v13, v87, v86, s51
v_or_b32 v12, v12, v13
v_xor_b32 v12, v12, v15
v_or_b32 v14, v14, v12
v_perm_b32 v12, v89, v88, s50
v_perm_b32 v13, v91, v90, s51
v_or_b32 v12, v12, v13
v_xor_b32 v12, v12, v15
v_or_b32 v14, v14, v12
v_perm_b32 v12, v93, v92, s50
v_perm_b32 v13, v95, v94, s51
v_or_b32 v12, v12, v13
v_xor_b32 v12, v12, v15
v_or_b32 v14, v14, v12
v_cmp_ne_u32 vcc, 0, v14
s_cbranch_vccz L_hzx
s_mov_b64 exec, vcc
buffer_load_dwordx4 v[80:83], v1, s[12:15], s92 offen offset:0 sc1
buffer_load_dwordx4 v[84:87], v1, s[12:15], s92 offen offset:1024 sc1
buffer_load_dwordx4 v[88:91], v1, s[12:15], s92 offen offset:2048 sc1
buffer_load_dwordx4 v[92:95], v1, s[12:15], s92 offen offset:3072 sc1
s_mov_b64 exec, -1
s_add_u32 s60, s60, 1
s_cmp_lt_u32 s60, 20000
s_waitcnt vmcnt(0)
s_cbranch_scc1 L_hz
L_hzx:
s_lshl_b32 s38, s3, 9
s_add_u32 s38, s38, 77824
v_lshl_add_u32 v9, v0, 3, s38
v_add_u32 v8, s38, v8
v_and_b32 v80, 0xffffff00, v80
v_and_b32 v81, 0xffffff00, v81
v_and_b32 v82, 0xffffff00, v82
v_and_b32 v83, 0xffffff00, v83
v_and_b32 v84, 0xffffff00, v84
v_and_b32 v85, 0xffffff00, v85
v_and_b32 v86, 0xffffff00, v86
v_and_b32 v87, 0xffffff00, v87
v_and_b32 v88, 0xffffff00, v88
v_and_b32 v89, 0xffffff00, v89
v_and_b32 v90, 0xffffff00, v90
v_and_b32 v91, 0xffffff00, v91
v_and_b32 v92, 0xffffff00, v92
v_and_b32 v93, 0xffffff00, v93
v_and_b32 v94, 0xffffff00, v94
v_and_b32 v95, 0xffffff00, v95
v_pk_add_f32 v[80:81], v[80:81], v[84:85]
v_pk_add_f32 v[88:89], v[88:89], v[92:93]
v_pk_add_f32 v[82:83], v[82:83], v[86:87]
v_pk_add_f32 v[90:91], v[90:91], v[94:95]
v_pk_add_f32 v[80:81], v[80:81], v[88:89]
v_pk_add_f32 v[82:83], v[82:83], v[90:91]
s_nop 0
v_permlane16_swap_b32 v80, v81
v_permlane16_swap_b32 v82, v83
v_add_f32 v81, v80, v81
v_add_f32 v83, v82, v83
s_nop 1
v_permlane32_swap_b32 v81, v83
v_add_f32 v81, v81, v83
v_mov_b32 v83, v81
s_nop 1
v_permlane32_swap_b32 v81, v83
v_mov_b32 v80, v81
v_mov_b32 v82, v83
s_nop 0
v_permlane16_swap_b32 v80, v81
v_permlane16_swap_b32 v82, v83
v_cvt_pk_bf16_f32 v80, v80, v81
v_cvt_pk_bf16_f32 v81, v82, v83
ds_write_b64 v9, v[80:81]
ds_read_b128 v[88:91], v8 offset:0
ds_read_b128 v[92:95], v8 offset:64
v_and_b32 v9, 1, v0
v_cmp_eq_u32 vcc, 0, v9
s_waitcnt lgkmcnt(0)
s_nop 0
v_cndmask_b32 v88, v216, v88, vcc
v_cndmask_b32 v89, v216, v89, vcc
v_cndmask_b32 v90, v216, v90, vcc
v_cndmask_b32 v91, v216, v91, vcc
v_cndmask_b32 v92, v216, v92, vcc
v_cndmask_b32 v93, v216, v93, vcc
v_cndmask_b32 v94, v216, v94, vcc
v_cndmask_b32 v95, v216, v95, vcc
v_mfma_f32_16x16x32_bf16 v[16:19], v[88:91], v[160:163], 0
s_nop 0
v_mfma_f32_16x16x32_bf16 v[20:23], v[92:95], v[164:167], 0
v_mfma_f32_16x16x32_bf16 v[24:27], v[88:91], v[168:171], 0
v_mfma_f32_16x16x32_bf16 v[28:31], v[92:95], v[172:175], 0
v_mfma_f32_16x16x32_bf16 v[32:35], v[88:91], v[176:179], 0
v_mfma_f32_16x16x32_bf16 v[36:39], v[92:95], v[180:183], 0
v_mfma_f32_16x16x32_bf16 v[40:43], v[88:91], v[184:187], 0
v_mfma_f32_16x16x32_bf16 v[44:47], v[92:95], v[188:191], 0
s_lshl_b32 s38, s62, 5
s_add_u32 s38, s38, s93
s_lshl_b32 s38, s38, 10
s_add_u32 s38, s38, 25165824
s_lshl_b32 s39, s34, 16
s_xor_b32 s90, s39, 0
s_add_u32 s90, s90, s38
s_xor_b32 s91, s39, 32768
s_add_u32 s91, s91, s38
s_xor_b32 s92, s39, 65536
s_add_u32 s92, s92, s38
s_xor_b32 s93, s39, 98304
s_add_u32 s93, s93, s38
v_lshlrev_b32 v1, 4, v0
s_mov_b32 exec_lo, 0xff000000
s_mov_b32 exec_hi, 0
v_add_u32 v1, 29360256, v1
s_mov_b64 exec, -1
v_rcp_f32 v17, v17
v_rcp_f32 v25, v25
v_rcp_f32 v33, v33
v_rcp_f32 v41, v41
v_rcp_f32 v21, v21
v_rcp_f32 v29, v29
v_rcp_f32 v37, v37
v_rcp_f32 v45, v45
v_mul_f32 v16, v16, v17
v_mul_f32 v24, v24, v25
v_mul_f32 v32, v32, v33
v_mul_f32 v40, v40, v41
v_fmac_f32 v16, v20, v21
v_fmac_f32 v24, v28, v29
v_fmac_f32 v32, v36, v37
v_fmac_f32 v40, v44, v45
v_add_f32 v16, 0x358637bd, v16
v_add_f32 v24, 0x358637bd, v24
v_add_f32 v32, 0x358637bd, v32
v_add_f32 v40, 0x358637bd, v40
v_rcp_f32 v16, v16
v_rcp_f32 v24, v24
v_rcp_f32 v32, v32
v_rcp_f32 v40, v40
v_mul_f32 v48, v17, v16
v_mul_f32 v50, v25, v24
v_mul_f32 v52, v33, v32
v_mul_f32 v54, v41, v40
v_mul_f32 v49, v21, v16
v_mul_f32 v51, v29, v24
v_mul_f32 v53, v37, v32
v_mul_f32 v55, v45, v40
s_lshl_b32 s56, s35, 5
s_add_u32 s56, s56, s36
s_lshl_b32 s56, s56, 2
s_add_u32 s56, s56, 63508480
s_lshl_b32 s57, s54, 7
s_add_u32 s57, s57, 63508480
s_mov_b32 s60, 0
s_waitcnt vmcnt(0)
L_h2:
v_perm_b32 v12, v129, v128, s50
v_perm_b32 v13, v131, v130, s51
v_or_b32 v12, v12, v13
v_xor_b32 v14, v12, v15
v_perm_b32 v12, v133, v132, s50
v_perm_b32 v13, v135, v134, s51
v_or_b32 v12, v12, v13
v_xor_b32 v12, v12, v15
v_or_b32 v14, v14, v12
v_perm_b32 v12, v137, v136, s50
v_perm_b32 v13, v139, v138, s51
v_or_b32 v12, v12, v13
v_xor_b32 v12, v12, v15
v_or_b32 v14, v14, v12
v_perm_b32 v12, v141, v140, s50
v_perm_b32 v13, v143, v142, s51
v_or_b32 v12, v12, v13
v_xor_b32 v12, v12, v15
v_or_b32 v14, v14, v12
v_perm_b32 v12, v145, v144, s50
v_perm_b32 v13, v147, v146, s51
v_or_b32 v12, v12, v13
v_xor_b32 v12, v12, v15
v_or_b32 v14, v14, v12
v_perm_b32 v12, v149, v148, s50
v_perm_b32 v13, v151, v150, s51
v_or_b32 v12, v12, v13
v_xor_b32 v12, v12, v15
v_or_b32 v14, v14, v12
v_perm_b32 v12, v153, v152, s50
v_perm_b32 v13, v155, v154, s51
v_or_b32 v12, v12, v13
v_xor_b32 v12, v12, v15
v_or_b32 v14, v14, v12
v_perm_b32 v12, v157, v156, s50
v_perm_b32 v13, v159, v158, s51
v_or_b32 v12, v12, v13
v_xor_b32 v12, v12, v15
v_or_b32 v14, v14, v12
v_cmp_ne_u32 vcc, 0, v14
s_cbranch_vccz L_h2x
s_mov_b64 exec, vcc
buffer_load_dwordx4 v[128:131], v6, s[12:15], s88 offen offset:0 sc1
buffer_load_dwordx4 v[132:135], v6, s[12:15], s88 offen offset:256 sc1
buffer_load_dwordx4 v[136:139], v6, s[12:15], s88 offen offset:64 sc1
buffer_load_dwordx4 v[140:143], v6, s[12:15], s88 offen offset:320 sc1
buffer_load_dwordx4 v[144:147], v6, s[12:15], s89 offen offset:0 sc1
buffer_load_dwordx4 v[148:151], v6, s[12:15], s89 offen offset:256 sc1
buffer_load_dwordx4 v[152:155], v6, s[12:15], s89 offen offset:64 sc1
buffer_load_dwordx4 v[156:159], v6, s[12:15], s89 offen offset:320 sc1
s_mov_b64 exec, -1
s_add_u32 s60, s60, 1
s_cmp_lt_u32 s60, 20000
s_waitcnt vmcnt(0)
s_cbranch_scc1 L_h2
L_h2x:
v_cvt_pk_bf16_f32 v16, v128, v129
v_cvt_pk_bf16_f32 v17, v130, v131
v_cvt_pk_bf16_f32 v18, v132, v133
v_cvt_pk_bf16_f32 v19, v134, v135
v_cvt_pk_bf16_f32 v20, v136, v137
v_cvt_pk_bf16_f32 v21, v138, v139
v_cvt_pk_bf16_f32 v22, v140, v141
v_cvt_pk_bf16_f32 v23, v142, v143
v_cvt_pk_bf16_f32 v24, v144, v145
v_cvt_pk_bf16_f32 v25, v146, v147
v_cvt_pk_bf16_f32 v26, v148, v149
v_cvt_pk_bf16_f32 v27, v150, v151
v_cvt_pk_bf16_f32 v28, v152, v153
v_cvt_pk_bf16_f32 v29, v154, v155
v_cvt_pk_bf16_f32 v30, v156, v157
v_cvt_pk_bf16_f32 v31, v158, v159
v_mfma_f32_16x16x32_bf16 v[96:99], v[16:19], v[160:163], 0
v_mfma_f32_16x16x32_bf16 v[100:103], v[20:23], v[160:163], 0
v_mfma_f32_16x16x32_bf16 v[104:107], v[24:27], v[164:167], 0
v_mfma_f32_16x16x32_bf16 v[108:111], v[28:31], v[164:167], 0
v_mfma_f32_16x16x32_bf16 v[112:115], v[16:19], v[168:171], 0
v_mfma_f32_16x16x32_bf16 v[116:119], v[20:23], v[168:171], 0
v_mfma_f32_16x16x32_bf16 v[120:123], v[24:27], v[172:175], 0
v_mfma_f32_16x16x32_bf16 v[124:127], v[28:31], v[172:175], 0
v_mfma_f32_16x16x32_bf16 v[128:131], v[16:19], v[176:179], 0
v_mfma_f32_16x16x32_bf16 v[132:135], v[20:23], v[176:179], 0
v_mfma_f32_16x16x32_bf16 v[136:139], v[24:27], v[180:183], 0
v_mfma_f32_16x16x32_bf16 v[140:143], v[28:31], v[180:183], 0
v_mfma_f32_16x16x32_bf16 v[144:147], v[16:19], v[184:187], 0
v_mfma_f32_16x16x32_bf16 v[148:151], v[20:23], v[184:187], 0
v_mfma_f32_16x16x32_bf16 v[152:155], v[24:27], v[188:191], 0
v_mfma_f32_16x16x32_bf16 v[156:159], v[28:31], v[188:191], 0
v_pk_mul_f32 v[96:97], v[96:97], v[48:49] op_sel:[0,0] op_sel_hi:[1,0]
v_pk_mul_f32 v[98:99], v[98:99], v[48:49] op_sel:[0,0] op_sel_hi:[1,0]
v_pk_mul_f32 v[100:101], v[100:101], v[48:49] op_sel:[0,0] op_sel_hi:[1,0]
v_pk_mul_f32 v[102:103], v[102:103], v[48:49] op_sel:[0,0] op_sel_hi:[1,0]
v_pk_fma_f32 v[96:97], v[104:105], v[48:49], v[96:97] op_sel:[0,1,0] op_sel_hi:[1,1,1]
v_pk_fma_f32 v[98:99], v[106:107], v[48:49], v[98:99] op_sel:[0,1,0] op_sel_hi:[1,1,1]
v_pk_fma_f32 v[100:101], v[108:109], v[48:49], v[100:101] op_sel:[0,1,0] op_sel_hi:[1,1,1]
v_pk_fma_f32 v[102:103], v[110:111], v[48:49], v[102:103] op_sel:[0,1,0] op_sel_hi:[1,1,1]
v_cvt_pk_bf16_f32 v104, v96, v97
v_cvt_pk_bf16_f32 v105, v98, v99
v_cvt_pk_bf16_f32 v106, v100, v101
v_cvt_pk_bf16_f32 v107, v102, v103
buffer_store_dwordx4 v[104:107], v1, s[12:15], s90 offen sc1
v_pk_mul_f32 v[112:113], v[112:113], v[50:51] op_sel:[0,0] op_sel_hi:[1,0]
v_pk_mul_f32 v[114:115], v[114:115], v[50:51] op_sel:[0,0] op_sel_hi:[1,0]
v_pk_mul_f32 v[116:117], v[116:117], v[50:51] op_sel:[0,0] op_sel_hi:[1,0]
v_pk_mul_f32 v[118:119], v[118:119], v[50:51] op_sel:[0,0] op_sel_hi:[1,0]
v_pk_fma_f32 v[112:113], v[120:121], v[50:51], v[112:113] op_sel:[0,1,0] op_sel_hi:[1,1,1]
v_pk_fma_f32 v[114:115], v[122:123], v[50:51], v[114:115] op_sel:[0,1,0] op_sel_hi:[1,1,1]
v_pk_fma_f32 v[116:117], v[124:125], v[50:51], v[116:117] op_sel:[0,1,0] op_sel_hi:[1,1,1]
v_pk_fma_f32 v[118:119], v[126:127], v[50:51], v[118:119] op_sel:[0,1,0] op_sel_hi:[1,1,1]
v_cvt_pk_bf16_f32 v120, v112, v113
v_cvt_pk_bf16_f32 v121, v114, v115
v_cvt_pk_bf16_f32 v122, v116, v117
v_cvt_pk_bf16_f32 v123, v118, v119
buffer_store_dwordx4 v[120:123], v1, s[12:15], s91 offen sc1
v_pk_mul_f32 v[128:129], v[128:129], v[52:53] op_sel:[0,0] op_sel_hi:[1,0]
v_pk_mul_f32 v[130:131], v[130:131], v[52:53] op_sel:[0,0] op_sel_hi:[1,0]
v_pk_mul_f32 v[132:133], v[132:133], v[52:53] op_sel:[0,0] op_sel_hi:[1,0]
v_pk_mul_f32 v[134:135], v[134:135], v[52:53] op_sel:[0,0] op_sel_hi:[1,0]
v_pk_fma_f32 v[128:129], v[136:137], v[52:53], v[128:129] op_sel:[0,1,0] op_sel_hi:[1,1,1]
v_pk_fma_f32 v[130:131], v[138:139], v[52:53], v[130:131] op_sel:[0,1,0] op_sel_hi:[1,1,1]
v_pk_fma_f32 v[132:133], v[140:141], v[52:53], v[132:133] op_sel:[0,1,0] op_sel_hi:[1,1,1]
v_pk_fma_f32 v[134:135], v[142:143], v[52:53], v[134:135] op_sel:[0,1,0] op_sel_hi:[1,1,1]
v_cvt_pk_bf16_f32 v136, v128, v129
v_cvt_pk_bf16_f32 v137, v130, v131
v_cvt_pk_bf16_f32 v138, v132, v133
v_cvt_pk_bf16_f32 v139, v134, v135
buffer_store_dwordx4 v[136:139], v1, s[12:15], s92 offen sc1
v_pk_mul_f32 v[144:145], v[144:145], v[54:55] op_sel:[0,0] op_sel_hi:[1,0]
v_pk_mul_f32 v[146:147], v[146:147], v[54:55] op_sel:[0,0] op_sel_hi:[1,0]
L_wp5:
s_cbranch_execz L_wra
v_pk_mul_f32 v[148:149], v[148:149], v[54:55] op_sel:[0,0] op_sel_hi:[1,0]
v_pk_mul_f32 v[150:151], v[150:151], v[54:55] op_sel:[0,0] op_sel_hi:[1,0]
v_pk_fma_f32 v[144:145], v[152:153], v[54:55], v[144:145] op_sel:[0,1,0] op_sel_hi:[1,1,1]
v_pk_fma_f32 v[146:147], v[154:155], v[54:55], v[146:147] op_sel:[0,1,0] op_sel_hi:[1,1,1]
v_pk_fma_f32 v[148:149], v[156:157], v[54:55], v[148:149] op_sel:[0,1,0] op_sel_hi:[1,1,1]
v_pk_fma_f32 v[150:151], v[158:159], v[54:55], v[150:151] op_sel:[0,1,0] op_sel_hi:[1,1,1]
v_cvt_pk_bf16_f32 v152, v144, v145
v_cvt_pk_bf16_f32 v153, v146, v147
v_cvt_pk_bf16_f32 v154, v148, v149
v_cvt_pk_bf16_f32 v155, v150, v151
buffer_store_dwordx4 v[152:155], v1, s[12:15], s93 offen sc1
s_waitcnt vmcnt(0)
s_barrier
s_cmp_lg_u32 s3, 0
s_cbranch_scc1 L_hs3
v_mov_b32 v14, 0
v_mov_b32 v15, s63
s_mov_b64 exec, 1
buffer_store_dword v15, v14, s[12:15], s56 offen sc1
s_mov_b64 exec, -1
L_hs3:
s_add_u32 m0, s70, 32768
s_xor_b32 s20, s32, 1572864
s_add_u32 s20, s28, s20
s_addc_u32 s21, s29, 0
buffer_load_dwordx4 v215, s[20:23], 0 offen offset:0 lds
buffer_load_dwordx4 v215, s[20:23], s66 offen offset:1024 lds
buffer_load_dwordx4 v215, s[20:23], s67 offen offset:2048 lds
buffer_load_dwordx4 v215, s[20:23], s68 offen offset:3072 lds
s_add_u32 m0, s70, 49152
s_xor_b32 s20, s32, 1835008
s_add_u32 s20, s28, s20
s_addc_u32 s21, s29, 0
buffer_load_dwordx4 v215, s[20:23], 0 offen offset:0 lds
buffer_load_dwordx4 v215, s[20:23], s66 offen offset:1024 lds
buffer_load_dwordx4 v215, s[20:23], s67 offen offset:2048 lds
buffer_load_dwordx4 v215, s[20:23], s68 offen offset:3072 lds
s_load_dwordx4 s[48:51], s[0:1], 40
s_load_dwordx2 s[28:29], s[0:1], 56
s_and_b32 s38, s2, 7
s_lshr_b32 s39, s2, 3
s_and_b32 s36, s38, 3
s_lshl_b32 s36, s36, 1
s_and_b32 s61, s39, 1
s_add_u32 s36, s36, s61
s_lshr_b32 s37, s38, 2
s_lshl_b32 s37, s37, 4
s_lshr_b32 s61, s39, 1
s_add_u32 s37, s37, s61
s_and_b32 s71, s36, 4
s_lshl_b32 s71, s71, 1
s_and_b32 s38, s3, 1
s_mul_i32 s38, s38, 229376
s_mul_i32 s39, s37, 224
s_add_u32 s38, s38, s39
s_and_b32 s39, s37, 1
s_lshl_b32 s39, s39, 1
v_add_u32 v11, 0, v0
v_mul_u32_u24 v12, 4682, v11
v_lshrrev_b32 v12, 16, v12
v_mul_u32_u24 v13, 14, v12
v_sub_u32 v13, v11, v13
v_add_u32 v13, s39, v13
v_subrev_u32 v14, 14, v13
v_min_u32 v13, v13, v14
v_mul_u32_u24 v12, 7168, v12
v_lshlrev_b32 v13, 4, v13
v_add3_u32 v4, v12, v13, s38
v_add_u32 v11, 64, v0
v_mul_u32_u24 v12, 4682, v11
v_lshrrev_b32 v12, 16, v12
v_mul_u32_u24 v13, 14, v12
v_sub_u32 v13, v11, v13
v_add_u32 v13, s39, v13
v_subrev_u32 v14, 14, v13
v_min_u32 v13, v13, v14
v_mul_u32_u24 v12, 7168, v12
v_lshlrev_b32 v13, 4, v13
v_add3_u32 v5, v12, v13, s38
v_subrev_u32 v5, 1024, v5
v_add_u32 v11, 128, v0
v_mul_u32_u24 v12, 4682, v11
v_lshrrev_b32 v12, 16, v12
v_mul_u32_u24 v13, 14, v12
v_sub_u32 v13, v11, v13
v_add_u32 v13, s39, v13
v_subrev_u32 v14, 14, v13
v_min_u32 v13, v13, v14
v_mul_u32_u24 v12, 7168, v12
v_lshlrev_b32_e64 v13, 4, v13
v_add3_u32 v6, v12, v13, s38
v_subrev_u32 v6, 2048, v6
v_add_u32 v11, 192, v0
v_mul_u32_u24 v12, 4682, v11
v_lshrrev_b32 v12, 16, v12
v_mul_u32_u24 v13, 14, v12
v_sub_u32 v13, v11, v13
v_add_u32 v13, s39, v13
v_subrev_u32 v14, 14, v13
v_min_u32 v13, v13, v14
v_mul_u32_u24 v12, 7168, v12
v_lshlrev_b32_e64 v13, 4, v13
v_add3_u32 v7, v12, v13, s38
v_subrev_u32 v7, 3072, v7
v_add_u32 v11, 256, v0
v_mul_u32_u24 v12, 4682, v11
v_lshrrev_b32 v12, 16, v12
v_mul_u32_u24 v13, 14, v12
v_sub_u32 v13, v11, v13
v_add_u32 v13, s39, v13
v_subrev_u32 v14, 14, v13
v_min_u32 v13, v13, v14
v_mul_u32_u24 v12, 7168, v12
v_lshlrev_b32_e64 v13, 4, v13
v_add3_u32 v8, v12, v13, s38
v_add_u32 v11, 320, v0
v_mul_u32_u24 v12, 4682, v11
v_lshrrev_b32 v12, 16, v12
v_mul_u32_u24 v13, 14, v12
v_sub_u32 v13, v11, v13
v_add_u32 v13, s39, v13
v_subrev_u32 v14, 14, v13
v_min_u32 v13, v13, v14
v_mul_u32_u24 v12, 7168, v12
v_lshlrev_b32_e64 v13, 4, v13
v_add3_u32 v9, v12, v13, s38
v_subrev_u32 v9, 1024, v9
v_add_u32 v11, 384, v0
v_mul_u32_u24 v12, 4682, v11
v_lshrrev_b32 v12, 16, v12
v_mul_u32_u24 v13, 14, v12
v_sub_u32 v13, v11, v13
v_add_u32 v13, s39, v13
v_subrev_u32 v14, 14, v13
v_min_u32 v13, v13, v14
v_mul_u32_u24 v12, 7168, v12
v_lshlrev_b32 v13, 4, v13
v_add3_u32 v10, v12, v13, s38
v_subrev_u32 v10, 2048, v10
s_mov_b32 s32, 32768
s_mov_b32 s33, 65536
s_mov_b32 s34, 98304
s_lshr_b32 s38, s3, 1
s_mul_i32 s35, s38, 14336
s_and_b32 s38, s3, 1
s_mul_i32 s38, s38, 7168
s_add_u32 s35, s35, s38
s_lshl_b32 s69, s36, 4
s_lshl_b32 s39, s3, 2
s_add_u32 s69, s69, s39
s_lshl_b32 s38, s69, 15
s_add_u32 s38, s38, 4194304
s_add_u32 s42, s12, s38
s_addc_u32 s43, s13, 0
s_mov_b32 s6, 458752
s_mov_b32 s10, 29491200
s_mov_b32 s30, 7340032
v_lshrrev_b32 v11, 2, v0
v_mul_u32_u24 v11, 224, v11
v_and_b32 v12, 3, v0
v_lshl_add_u32 v3, v12, 3, v11
v_add_u32 v2, 0x10000, v3
s_cmp_ge_u32 s3, 2
s_waitcnt lgkmcnt(0)
s_cselect_b32 s40, s50, s48
s_cselect_b32 s41, s51, s49
v_lshrrev_b32 v11, 2, v0
v_lshrrev_b32 v12, 1, v11
v_and_b32 v12, 3, v12
v_lshlrev_b32 v11, 7, v11
v_and_b32 v13, 3, v0
v_lshl_add_u32 v11, v13, 3, v11
v_xor_b32 v13, 0, v12
v_lshl_add_u32 v128, v13, 5, v11
v_xor_b32 v13, 1, v12
v_lshl_add_u32 v129, v13, 5, v11
v_xor_b32 v13, 2, v12
v_lshl_add_u32 v130, v13, 5, v11
v_xor_b32_e64 v13, 3, v12
v_lshl_add_u32 v131, v13, 5, v11
v_add_u32 v132, 0x10000, v128
v_add_u32 v133, 0x10000, v129
v_add_u32 v134, 0x10000, v130
v_add_u32 v135, 0x10000, v131
v_add_u32 v136, 0x20000, v128
v_add_u32 v137, 0x20000, v129
v_add_u32 v138, 0x20000, v130
v_add_u32 v139, 0x20000, v131
s_lshl_b32 s38, s64, 15
s_add_u32 s38, s38, 25165824
s_add_u32 s16, s12, s38
s_addc_u32 s17, s13, 0
s_mov_b32 s18, 29425664
s_mul_i32 s53, s55, 2048
v_add_u32 v140, 32768, v1
ds_read_b64_tr_b16 v[16:17], v132 offset:49152
ds_read_b64_tr_b16 v[18:19], v132 offset:51200
ds_read_b64_tr_b16 v[20:21], v133 offset:49152
ds_read_b64_tr_b16 v[22:23], v133 offset:51200
ds_read_b64_tr_b16 v[24:25], v134 offset:49152
ds_read_b64_tr_b16 v[26:27], v134 offset:51200
ds_read_b64_tr_b16 v[28:29], v135 offset:49152
ds_read_b64_tr_b16 v[30:31], v135 offset:51200
ds_read_b64_tr_b16 v[32:33], v132 offset:53248
ds_read_b64_tr_b16 v[34:35], v132 offset:55296
ds_read_b64_tr_b16 v[36:37], v133 offset:53248
ds_read_b64_tr_b16 v[38:39], v133 offset:55296
ds_read_b64_tr_b16 v[40:41], v134 offset:53248
ds_read_b64_tr_b16 v[42:43], v134 offset:55296
ds_read_b64_tr_b16 v[44:45], v135 offset:53248
ds_read_b64_tr_b16 v[46:47], v135 offset:55296
s_cmp_eq_u32 s3, 0
s_cbranch_scc1 L_hq3
s_mov_b64 exec, 0
s_cmp_eq_u32 s3, 1
s_cbranch_scc1 L_wc31
s_cmp_eq_u32 s3, 2
s_cbranch_scc1 L_wc32
s_branch L_wc33
L_wr3:
s_mov_b64 exec, -1
s_branch L_hd3
L_hq3:
v_and_b32 v14, 15, v0
v_lshlrev_b32 v14, 2, v14
s_mov_b32 s65, 0
L_hp3:
buffer_load_dword v15, v14, s[12:15], s57 offen sc1
s_waitcnt vmcnt(0)
v_cmp_ne_u32 vcc, s63, v15
s_add_u32 s65, s65, 1
s_cmp_ge_u32 s65, 20000
s_cbranch_scc1 L_hd3
s_cbranch_vccnz L_hp3
L_hd3:
s_barrier
s_xor_b32 s52, s53, 0
buffer_load_dwordx4 a[0:3], v1, s[16:19], s52 offen offset:0 sc1
buffer_load_dwordx4 a[4:7], v140, s[16:19], s52 offen offset:0 sc1
buffer_load_dwordx4 a[8:11], v1, s[16:19], s52 offen offset:1024 sc1
buffer_load_dwordx4 a[12:15], v140, s[16:19], s52 offen offset:1024 sc1
s_xor_b32 s52, s53, 2048
buffer_load_dwordx4 a[16:19], v1, s[16:19], s52 offen offset:0 sc1
buffer_load_dwordx4 a[20:23], v140, s[16:19], s52 offen offset:0 sc1
buffer_load_dwordx4 a[24:27], v1, s[16:19], s52 offen offset:1024 sc1
buffer_load_dwordx4 a[28:31], v140, s[16:19], s52 offen offset:1024 sc1
s_xor_b32 s52, s53, 4096
buffer_load_dwordx4 a[32:35], v1, s[16:19], s52 offen offset:0 sc1
buffer_load_dwordx4 a[36:39], v140, s[16:19], s52 offen offset:0 sc1
buffer_load_dwordx4 a[40:43], v1, s[16:19], s52 offen offset:1024 sc1
buffer_load_dwordx4 a[44:47], v140, s[16:19], s52 offen offset:1024 sc1
s_xor_b32 s52, s53, 6144
buffer_load_dwordx4 a[48:51], v1, s[16:19], s52 offen offset:0 sc1
buffer_load_dwordx4 a[52:55], v140, s[16:19], s52 offen offset:0 sc1
buffer_load_dwordx4 a[56:59], v1, s[16:19], s52 offen offset:1024 sc1
buffer_load_dwordx4 a[60:63], v140, s[16:19], s52 offen offset:1024 sc1
s_xor_b32 s52, s53, 8192
buffer_load_dwordx4 a[64:67], v1, s[16:19], s52 offen offset:0 sc1
buffer_load_dwordx4 a[68:71], v140, s[16:19], s52 offen offset:0 sc1
buffer_load_dwordx4 a[72:75], v1, s[16:19], s52 offen offset:1024 sc1
buffer_load_dwordx4 a[76:79], v140, s[16:19], s52 offen offset:1024 sc1
s_xor_b32 s52, s53, 10240
buffer_load_dwordx4 a[80:83], v1, s[16:19], s52 offen offset:0 sc1
buffer_load_dwordx4 a[84:87], v140, s[16:19], s52 offen offset:0 sc1
buffer_load_dwordx4 a[88:91], v1, s[16:19], s52 offen offset:1024 sc1
buffer_load_dwordx4 a[92:95], v140, s[16:19], s52 offen offset:1024 sc1
s_waitcnt vmcnt(20) lgkmcnt(0)
v_mfma_f32_16x16x32_bf16 v[96:99], v[16:19], a[0:3], 0
ds_read_b64_tr_b16 v[48:49], v132 offset:57344
ds_read_b64_tr_b16 v[50:51], v132 offset:59392
v_mfma_f32_16x16x32_bf16 v[96:99], v[32:35], a[8:11], v[96:99]
s_xor_b32 s52, s53, 12288
buffer_load_dwordx4 a[96:99], v1, s[16:19], s52 offen offset:0 sc1
v_mfma_f32_16x16x32_bf16 v[100:103], v[32:35], a[12:15], 0
ds_read_b64_tr_b16 v[52:53], v133 offset:57344
ds_read_b64_tr_b16 v[54:55], v133 offset:59392
v_mfma_f32_16x16x32_bf16 v[100:103], v[16:19], a[4:7], v[100:103]
ds_read_b64_tr_b16 v[56:57], v134 offset:57344
v_mfma_f32_16x16x32_bf16 v[108:111], v[20:23], a[4:7], 0
ds_read_b64_tr_b16 v[58:59], v134 offset:59392
buffer_load_dwordx4 a[100:103], v140, s[16:19], s52 offen offset:0 sc1
v_mfma_f32_16x16x32_bf16 v[108:111], v[36:39], a[12:15], v[108:111]
ds_read_b64_tr_b16 v[60:61], v135 offset:57344
v_mfma_f32_16x16x32_bf16 v[104:107], v[36:39], a[8:11], 0
ds_read_b64_tr_b16 v[62:63], v135 offset:59392
v_mfma_f32_16x16x32_bf16 v[104:107], v[20:23], a[0:3], v[104:107]
ds_read_b64_tr_b16 v[64:65], v132 offset:61440
ds_read_b64_tr_b16 v[66:67], v132 offset:63488
v_mfma_f32_16x16x32_bf16 v[112:115], v[24:27], a[0:3], 0
buffer_load_dwordx4 a[104:107], v1, s[16:19], s52 offen offset:1024 sc1
v_mfma_f32_16x16x32_bf16 v[112:115], v[40:43], a[8:11], v[112:115]
ds_read_b64_tr_b16 v[68:69], v133 offset:61440
ds_read_b64_tr_b16 v[70:71], v133 offset:63488
v_mfma_f32_16x16x32_bf16 v[116:119], v[40:43], a[12:15], 0
ds_read_b64_tr_b16 v[72:73], v134 offset:61440
v_mfma_f32_16x16x32_bf16 v[116:119], v[24:27], a[4:7], v[116:119]
ds_read_b64_tr_b16 v[74:75], v134 offset:63488
buffer_load_dwordx4 a[108:111], v140, s[16:19], s52 offen offset:1024 sc1
v_mfma_f32_16x16x32_bf16 v[124:127], v[28:31], a[4:7], 0
ds_read_b64_tr_b16 v[76:77], v135 offset:61440
v_mfma_f32_16x16x32_bf16 v[124:127], v[44:47], a[12:15], v[124:127]
ds_read_b64_tr_b16 v[78:79], v135 offset:63488
v_mfma_f32_16x16x32_bf16 v[120:123], v[44:47], a[8:11], 0
v_mfma_f32_16x16x32_bf16 v[120:123], v[28:31], a[0:3], v[120:123]
s_waitcnt vmcnt(20) lgkmcnt(0)
v_mfma_f32_16x16x32_bf16 v[96:99], v[48:51], a[16:19], v[96:99]
ds_read_b64_tr_b16 v[16:17], v132 offset:32768
s_xor_b32 s52, s53, 14336
buffer_load_dwordx4 a[112:115], v1, s[16:19], s52 offen offset:0 sc1
v_mfma_f32_16x16x32_bf16 v[96:99], v[64:67], a[24:27], v[96:99]
ds_read_b64_tr_b16 v[18:19], v132 offset:34816
ds_read_b64_tr_b16 v[20:21], v133 offset:32768
v_mfma_f32_16x16x32_bf16 v[100:103], v[64:67], a[28:31], v[100:103]
buffer_load_dwordx4 a[116:119], v140, s[16:19], s52 offen offset:0 sc1
ds_read_b64_tr_b16 v[22:23], v133 offset:34816
v_mfma_f32_16x16x32_bf16 v[100:103], v[48:51], a[20:23], v[100:103]
ds_read_b64_tr_b16 v[24:25], v134 offset:32768
v_mfma_f32_16x16x32_bf16 v[108:111], v[52:55], a[20:23], v[108:111]
buffer_load_dwordx4 a[120:123], v1, s[16:19], s52 offen offset:1024 sc1
ds_read_b64_tr_b16 v[26:27], v134 offset:34816
v_mfma_f32_16x16x32_bf16 v[108:111], v[68:71], a[28:31], v[108:111]
ds_read_b64_tr_b16 v[28:29], v135 offset:32768
buffer_load_dwordx4 a[124:127], v140, s[16:19], s52 offen offset:1024 sc1
v_mfma_f32_16x16x32_bf16 v[104:107], v[68:71], a[24:27], v[104:107]
ds_read_b64_tr_b16 v[30:31], v135 offset:34816
v_mfma_f32_16x16x32_bf16 v[104:107], v[52:55], a[16:19], v[104:107]
ds_read_b64_tr_b16 v[32:33], v132 offset:36864
v_accvgpr_mov_b32 a224, a0
v_mfma_f32_16x16x32_bf16 v[112:115], v[56:59], a[16:19], v[112:115]
ds_read_b64_tr_b16 v[34:35], v132 offset:38912
ds_read_b64_tr_b16 v[36:37], v133 offset:36864
v_mfma_f32_16x16x32_bf16 v[112:115], v[72:75], a[24:27], v[112:115]
v_accvgpr_mov_b32 a225, a8
ds_read_b64_tr_b16 v[38:39], v133 offset:38912
v_mfma_f32_16x16x32_bf16 v[116:119], v[72:75], a[28:31], v[116:119]
ds_read_b64_tr_b16 v[40:41], v134 offset:36864
v_mfma_f32_16x16x32_bf16 v[116:119], v[56:59], a[20:23], v[116:119]
v_accvgpr_mov_b32 a226, a4
ds_read_b64_tr_b16 v[42:43], v134 offset:38912
v_mfma_f32_16x16x32_bf16 v[124:127], v[60:63], a[20:23], v[124:127]
ds_read_b64_tr_b16 v[44:45], v135 offset:36864
v_accvgpr_mov_b32 a227, a12
v_mfma_f32_16x16x32_bf16 v[124:127], v[76:79], a[28:31], v[124:127]
ds_read_b64_tr_b16 v[46:47], v135 offset:38912
v_mfma_f32_16x16x32_bf16 v[120:123], v[76:79], a[24:27], v[120:123]
v_mfma_f32_16x16x32_bf16 v[120:123], v[60:63], a[16:19], v[120:123]
s_waitcnt vmcnt(20) lgkmcnt(0)
v_mfma_f32_16x16x32_bf16 v[96:99], v[16:19], a[32:35], v[96:99]
ds_read_b64_tr_b16 v[48:49], v132 offset:40960
ds_read_b64_tr_b16 v[50:51], v132 offset:43008
v_mfma_f32_16x16x32_bf16 v[96:99], v[32:35], a[40:43], v[96:99]
s_xor_b32 s52, s53, 16384
buffer_load_dwordx4 a[128:131], v1, s[16:19], s52 offen offset:0 sc1
v_mfma_f32_16x16x32_bf16 v[100:103], v[32:35], a[44:47], v[100:103]
ds_read_b64_tr_b16 v[52:53], v133 offset:40960
ds_read_b64_tr_b16 v[54:55], v133 offset:43008
v_mfma_f32_16x16x32_bf16 v[100:103], v[16:19], a[36:39], v[100:103]
ds_read_b64_tr_b16 v[56:57], v134 offset:40960
v_mfma_f32_16x16x32_bf16 v[108:111], v[20:23], a[36:39], v[108:111]
ds_read_b64_tr_b16 v[58:59], v134 offset:43008
buffer_load_dwordx4 a[132:135], v140, s[16:19], s52 offen offset:0 sc1
v_mfma_f32_16x16x32_bf16 v[108:111], v[36:39], a[44:47], v[108:111]
ds_read_b64_tr_b16 v[60:61], v135 offset:40960
v_mfma_f32_16x16x32_bf16 v[104:107], v[36:39], a[40:43], v[104:107]
ds_read_b64_tr_b16 v[62:63], v135 offset:43008
v_mfma_f32_16x16x32_bf16 v[104:107], v[20:23], a[32:35], v[104:107]
ds_read_b64_tr_b16 v[64:65], v132 offset:45056
ds_read_b64_tr_b16 v[66:67], v132 offset:47104
v_mfma_f32_16x16x32_bf16 v[112:115], v[24:27], a[32:35], v[112:115]
buffer_load_dwordx4 a[136:139], v1, s[16:19], s52 offen offset:1024 sc1
v_mfma_f32_16x16x32_bf16 v[112:115], v[40:43], a[40:43], v[112:115]
ds_read_b64_tr_b16 v[68:69], v133 offset:45056
ds_read_b64_tr_b16 v[70:71], v133 offset:47104
v_mfma_f32_16x16x32_bf16 v[116:119], v[40:43], a[44:47], v[116:119]
ds_read_b64_tr_b16 v[72:73], v134 offset:45056
v_mfma_f32_16x16x32_bf16 v[116:119], v[24:27], a[36:39], v[116:119]
ds_read_b64_tr_b16 v[74:75], v134 offset:47104
buffer_load_dwordx4 a[140:143], v140, s[16:19], s52 offen offset:1024 sc1
v_mfma_f32_16x16x32_bf16 v[124:127], v[28:31], a[36:39], v[124:127]
ds_read_b64_tr_b16 v[76:77], v135 offset:45056
v_mfma_f32_16x16x32_bf16 v[124:127], v[44:47], a[44:47], v[124:127]
ds_read_b64_tr_b16 v[78:79], v135 offset:47104
v_mfma_f32_16x16x32_bf16 v[120:123], v[44:47], a[40:43], v[120:123]
v_mfma_f32_16x16x32_bf16 v[120:123], v[28:31], a[32:35], v[120:123]
s_waitcnt vmcnt(20) lgkmcnt(0)
v_mfma_f32_16x16x32_bf16 v[96:99], v[48:51], a[48:51], v[96:99]
ds_read_b64_tr_b16 v[16:17], v136 offset:0
ds_read_b64_tr_b16 v[18:19], v136 offset:2048
v_mfma_f32_16x16x32_bf16 v[96:99], v[64:67], a[56:59], v[96:99]
s_xor_b32 s52, s53, 18432
buffer_load_dwordx4 a[144:147], v1, s[16:19], s52 offen offset:0 sc1
v_mfma_f32_16x16x32_bf16 v[100:103], v[64:67], a[60:63], v[100:103]
ds_read_b64_tr_b16 v[20:21], v137 offset:0
ds_read_b64_tr_b16 v[22:23], v137 offset:2048
v_mfma_f32_16x16x32_bf16 v[100:103], v[48:51], a[52:55], v[100:103]
ds_read_b64_tr_b16 v[24:25], v138 offset:0
v_mfma_f32_16x16x32_bf16 v[108:111], v[52:55], a[52:55], v[108:111]
ds_read_b64_tr_b16 v[26:27], v138 offset:2048
buffer_load_dwordx4 a[148:151], v140, s[16:19], s52 offen offset:0 sc1
v_mfma_f32_16x16x32_bf16 v[108:111], v[68:71], a[60:63], v[108:111]
ds_read_b64_tr_b16 v[28:29], v139 offset:0
v_mfma_f32_16x16x32_bf16 v[104:107], v[68:71], a[56:59], v[104:107]
ds_read_b64_tr_b16 v[30:31], v139 offset:2048
v_mfma_f32_16x16x32_bf16 v[104:107], v[52:55], a[48:51], v[104:107]
ds_read_b64_tr_b16 v[32:33], v136 offset:4096
ds_read_b64_tr_b16 v[34:35], v136 offset:6144
v_mfma_f32_16x16x32_bf16 v[112:115], v[56:59], a[48:51], v[112:115]
buffer_load_dwordx4 a[152:155], v1, s[16:19], s52 offen offset:1024 sc1
v_mfma_f32_16x16x32_bf16 v[112:115], v[72:75], a[56:59], v[112:115]
ds_read_b64_tr_b16 v[36:37], v137 offset:4096
ds_read_b64_tr_b16 v[38:39], v137 offset:6144
v_mfma_f32_16x16x32_bf16 v[116:119], v[72:75], a[60:63], v[116:119]
ds_read_b64_tr_b16 v[40:41], v138 offset:4096
v_mfma_f32_16x16x32_bf16 v[116:119], v[56:59], a[52:55], v[116:119]
ds_read_b64_tr_b16 v[42:43], v138 offset:6144
buffer_load_dwordx4 a[156:159], v140, s[16:19], s52 offen offset:1024 sc1
v_mfma_f32_16x16x32_bf16 v[124:127], v[60:63], a[52:55], v[124:127]
ds_read_b64_tr_b16 v[44:45], v139 offset:4096
v_mfma_f32_16x16x32_bf16 v[124:127], v[76:79], a[60:63], v[124:127]
ds_read_b64_tr_b16 v[46:47], v139 offset:6144
v_mfma_f32_16x16x32_bf16 v[120:123], v[76:79], a[56:59], v[120:123]
v_mfma_f32_16x16x32_bf16 v[120:123], v[60:63], a[48:51], v[120:123]
s_waitcnt vmcnt(20) lgkmcnt(0)
v_mfma_f32_16x16x32_bf16 v[96:99], v[16:19], a[64:67], v[96:99]
ds_read_b64_tr_b16 v[48:49], v136 offset:8192
ds_read_b64_tr_b16 v[50:51], v136 offset:10240
v_mfma_f32_16x16x32_bf16 v[96:99], v[32:35], a[72:75], v[96:99]
s_xor_b32 s52, s53, 20480
buffer_load_dwordx4 a[160:163], v1, s[16:19], s52 offen offset:0 sc1
v_mfma_f32_16x16x32_bf16 v[100:103], v[32:35], a[76:79], v[100:103]
ds_read_b64_tr_b16 v[52:53], v137 offset:8192
ds_read_b64_tr_b16 v[54:55], v137 offset:10240
v_mfma_f32_16x16x32_bf16 v[100:103], v[16:19], a[68:71], v[100:103]
ds_read_b64_tr_b16 v[56:57], v138 offset:8192
v_mfma_f32_16x16x32_bf16 v[108:111], v[20:23], a[68:71], v[108:111]
ds_read_b64_tr_b16 v[58:59], v138 offset:10240
buffer_load_dwordx4 a[164:167], v140, s[16:19], s52 offen offset:0 sc1
v_mfma_f32_16x16x32_bf16 v[108:111], v[36:39], a[76:79], v[108:111]
ds_read_b64_tr_b16 v[60:61], v139 offset:8192
v_mfma_f32_16x16x32_bf16 v[104:107], v[36:39], a[72:75], v[104:107]
ds_read_b64_tr_b16 v[62:63], v139 offset:10240
v_mfma_f32_16x16x32_bf16 v[104:107], v[20:23], a[64:67], v[104:107]
ds_read_b64_tr_b16 v[64:65], v136 offset:12288
ds_read_b64_tr_b16 v[66:67], v136 offset:14336
v_mfma_f32_16x16x32_bf16 v[112:115], v[24:27], a[64:67], v[112:115]
buffer_load_dwordx4 a[168:171], v1, s[16:19], s52 offen offset:1024 sc1
v_mfma_f32_16x16x32_bf16 v[112:115], v[40:43], a[72:75], v[112:115]
ds_read_b64_tr_b16 v[68:69], v137 offset:12288
ds_read_b64_tr_b16 v[70:71], v137 offset:14336
v_mfma_f32_16x16x32_bf16 v[116:119], v[40:43], a[76:79], v[116:119]
ds_read_b64_tr_b16 v[72:73], v138 offset:12288
v_mfma_f32_16x16x32_bf16 v[116:119], v[24:27], a[68:71], v[116:119]
ds_read_b64_tr_b16 v[74:75], v138 offset:14336
buffer_load_dwordx4 a[172:175], v140, s[16:19], s52 offen offset:1024 sc1
v_mfma_f32_16x16x32_bf16 v[124:127], v[28:31], a[68:71], v[124:127]
ds_read_b64_tr_b16 v[76:77], v139 offset:12288
v_mfma_f32_16x16x32_bf16 v[124:127], v[44:47], a[76:79], v[124:127]
ds_read_b64_tr_b16 v[78:79], v139 offset:14336
v_mfma_f32_16x16x32_bf16 v[120:123], v[44:47], a[72:75], v[120:123]
v_mfma_f32_16x16x32_bf16 v[120:123], v[28:31], a[64:67], v[120:123]
s_waitcnt vmcnt(20) lgkmcnt(0)
v_mfma_f32_16x16x32_bf16 v[96:99], v[48:51], a[80:83], v[96:99]
ds_read_b64_tr_b16 v[16:17], v136 offset:16384
ds_read_b64_tr_b16 v[18:19], v136 offset:18432
v_mfma_f32_16x16x32_bf16 v[96:99], v[64:67], a[88:91], v[96:99]
s_xor_b32 s52, s53, 22528
buffer_load_dwordx4 a[176:179], v1, s[16:19], s52 offen offset:0 sc1
v_mfma_f32_16x16x32_bf16 v[100:103], v[64:67], a[92:95], v[100:103]
ds_read_b64_tr_b16 v[20:21], v137 offset:16384
ds_read_b64_tr_b16 v[22:23], v137 offset:18432
v_mfma_f32_16x16x32_bf16 v[100:103], v[48:51], a[84:87], v[100:103]
ds_read_b64_tr_b16 v[24:25], v138 offset:16384
v_mfma_f32_16x16x32_bf16 v[108:111], v[52:55], a[84:87], v[108:111]
ds_read_b64_tr_b16 v[26:27], v138 offset:18432
buffer_load_dwordx4 a[180:183], v140, s[16:19], s52 offen offset:0 sc1
v_mfma_f32_16x16x32_bf16 v[108:111], v[68:71], a[92:95], v[108:111]
ds_read_b64_tr_b16 v[28:29], v139 offset:16384
v_mfma_f32_16x16x32_bf16 v[104:107], v[68:71], a[88:91], v[104:107]
ds_read_b64_tr_b16 v[30:31], v139 offset:18432
v_mfma_f32_16x16x32_bf16 v[104:107], v[52:55], a[80:83], v[104:107]
ds_read_b64_tr_b16 v[32:33], v136 offset:20480
ds_read_b64_tr_b16 v[34:35], v136 offset:22528
v_mfma_f32_16x16x32_bf16 v[112:115], v[56:59], a[80:83], v[112:115]
buffer_load_dwordx4 a[184:187], v1, s[16:19], s52 offen offset:1024 sc1
v_mfma_f32_16x16x32_bf16 v[112:115], v[72:75], a[88:91], v[112:115]
ds_read_b64_tr_b16 v[36:37], v137 offset:20480
ds_read_b64_tr_b16 v[38:39], v137 offset:22528
v_mfma_f32_16x16x32_bf16 v[116:119], v[72:75], a[92:95], v[116:119]
ds_read_b64_tr_b16 v[40:41], v138 offset:20480
v_mfma_f32_16x16x32_bf16 v[116:119], v[56:59], a[84:87], v[116:119]
ds_read_b64_tr_b16 v[42:43], v138 offset:22528
buffer_load_dwordx4 a[188:191], v140, s[16:19], s52 offen offset:1024 sc1
v_mfma_f32_16x16x32_bf16 v[124:127], v[60:63], a[84:87], v[124:127]
ds_read_b64_tr_b16 v[44:45], v139 offset:20480
v_mfma_f32_16x16x32_bf16 v[124:127], v[76:79], a[92:95], v[124:127]
ds_read_b64_tr_b16 v[46:47], v139 offset:22528
v_mfma_f32_16x16x32_bf16 v[120:123], v[76:79], a[88:91], v[120:123]
v_mfma_f32_16x16x32_bf16 v[120:123], v[60:63], a[80:83], v[120:123]
s_waitcnt vmcnt(20) lgkmcnt(0)
v_mfma_f32_16x16x32_bf16 v[96:99], v[16:19], a[96:99], v[96:99]
ds_read_b64_tr_b16 v[48:49], v136 offset:24576
ds_read_b64_tr_b16 v[50:51], v136 offset:26624
v_mfma_f32_16x16x32_bf16 v[96:99], v[32:35], a[104:107], v[96:99]
s_xor_b32 s52, s53, 24576
buffer_load_dwordx4 a[192:195], v1, s[16:19], s52 offen offset:0 sc1
v_mfma_f32_16x16x32_bf16 v[100:103], v[32:35], a[108:111], v[100:103]
ds_read_b64_tr_b16 v[52:53], v137 offset:24576
ds_read_b64_tr_b16 v[54:55], v137 offset:26624
v_mfma_f32_16x16x32_bf16 v[100:103], v[16:19], a[100:103], v[100:103]
ds_read_b64_tr_b16 v[56:57], v138 offset:24576
v_mfma_f32_16x16x32_bf16 v[108:111], v[20:23], a[100:103], v[108:111]
ds_read_b64_tr_b16 v[58:59], v138 offset:26624
buffer_load_dwordx4 a[196:199], v140, s[16:19], s52 offen offset:0 sc1
v_mfma_f32_16x16x32_bf16 v[108:111], v[36:39], a[108:111], v[108:111]
ds_read_b64_tr_b16 v[60:61], v139 offset:24576
v_mfma_f32_16x16x32_bf16 v[104:107], v[36:39], a[104:107], v[104:107]
ds_read_b64_tr_b16 v[62:63], v139 offset:26624
v_mfma_f32_16x16x32_bf16 v[104:107], v[20:23], a[96:99], v[104:107]
ds_read_b64_tr_b16 v[64:65], v136 offset:28672
ds_read_b64_tr_b16 v[66:67], v136 offset:30720
v_mfma_f32_16x16x32_bf16 v[112:115], v[24:27], a[96:99], v[112:115]
buffer_load_dwordx4 a[200:203], v1, s[16:19], s52 offen offset:1024 sc1
v_mfma_f32_16x16x32_bf16 v[112:115], v[40:43], a[104:107], v[112:115]
ds_read_b64_tr_b16 v[68:69], v137 offset:28672
ds_read_b64_tr_b16 v[70:71], v137 offset:30720
v_mfma_f32_16x16x32_bf16 v[116:119], v[40:43], a[108:111], v[116:119]
ds_read_b64_tr_b16 v[72:73], v138 offset:28672
v_mfma_f32_16x16x32_bf16 v[116:119], v[24:27], a[100:103], v[116:119]
ds_read_b64_tr_b16 v[74:75], v138 offset:30720
buffer_load_dwordx4 a[204:207], v140, s[16:19], s52 offen offset:1024 sc1
v_mfma_f32_16x16x32_bf16 v[124:127], v[28:31], a[100:103], v[124:127]
ds_read_b64_tr_b16 v[76:77], v139 offset:28672
v_mfma_f32_16x16x32_bf16 v[124:127], v[44:47], a[108:111], v[124:127]
ds_read_b64_tr_b16 v[78:79], v139 offset:30720
v_mfma_f32_16x16x32_bf16 v[120:123], v[44:47], a[104:107], v[120:123]
v_mfma_f32_16x16x32_bf16 v[120:123], v[28:31], a[96:99], v[120:123]
s_waitcnt vmcnt(20) lgkmcnt(0)
v_mfma_f32_16x16x32_bf16 v[96:99], v[48:51], a[112:115], v[96:99]
ds_read_b64_tr_b16 v[16:17], v128 offset:0
ds_read_b64_tr_b16 v[18:19], v128 offset:2048
v_mfma_f32_16x16x32_bf16 v[96:99], v[64:67], a[120:123], v[96:99]
s_xor_b32 s52, s53, 26624
buffer_load_dwordx4 a[208:211], v1, s[16:19], s52 offen offset:0 sc1
v_mfma_f32_16x16x32_bf16 v[100:103], v[64:67], a[124:127], v[100:103]
ds_read_b64_tr_b16 v[20:21], v129 offset:0
ds_read_b64_tr_b16 v[22:23], v129 offset:2048
v_mfma_f32_16x16x32_bf16 v[100:103], v[48:51], a[116:119], v[100:103]
ds_read_b64_tr_b16 v[24:25], v130 offset:0
v_mfma_f32_16x16x32_bf16 v[108:111], v[52:55], a[116:119], v[108:111]
ds_read_b64_tr_b16 v[26:27], v130 offset:2048
buffer_load_dwordx4 a[212:215], v140, s[16:19], s52 offen offset:0 sc1
v_mfma_f32_16x16x32_bf16 v[108:111], v[68:71], a[124:127], v[108:111]
ds_read_b64_tr_b16 v[28:29], v131 offset:0
v_mfma_f32_16x16x32_bf16 v[104:107], v[68:71], a[120:123], v[104:107]
ds_read_b64_tr_b16 v[30:31], v131 offset:2048
v_mfma_f32_16x16x32_bf16 v[104:107], v[52:55], a[112:115], v[104:107]
ds_read_b64_tr_b16 v[32:33], v128 offset:4096
ds_read_b64_tr_b16 v[34:35], v128 offset:6144
v_mfma_f32_16x16x32_bf16 v[112:115], v[56:59], a[112:115], v[112:115]
buffer_load_dwordx4 a[216:219], v1, s[16:19], s52 offen offset:1024 sc1
v_mfma_f32_16x16x32_bf16 v[112:115], v[72:75], a[120:123], v[112:115]
ds_read_b64_tr_b16 v[36:37], v129 offset:4096
ds_read_b64_tr_b16 v[38:39], v129 offset:6144
v_mfma_f32_16x16x32_bf16 v[116:119], v[72:75], a[124:127], v[116:119]
ds_read_b64_tr_b16 v[40:41], v130 offset:4096
v_mfma_f32_16x16x32_bf16 v[116:119], v[56:59], a[116:119], v[116:119]
ds_read_b64_tr_b16 v[42:43], v130 offset:6144
buffer_load_dwordx4 a[220:223], v140, s[16:19], s52 offen offset:1024 sc1
v_mfma_f32_16x16x32_bf16 v[124:127], v[60:63], a[116:119], v[124:127]
ds_read_b64_tr_b16 v[44:45], v131 offset:4096
v_mfma_f32_16x16x32_bf16 v[124:127], v[76:79], a[124:127], v[124:127]
ds_read_b64_tr_b16 v[46:47], v131 offset:6144
v_mfma_f32_16x16x32_bf16 v[120:123], v[76:79], a[120:123], v[120:123]
v_mfma_f32_16x16x32_bf16 v[120:123], v[60:63], a[112:115], v[120:123]
s_waitcnt vmcnt(20) lgkmcnt(0)
s_barrier
v_mfma_f32_16x16x32_bf16 v[96:99], v[16:19], a[128:131], v[96:99]
ds_read_b64_tr_b16 v[48:49], v128 offset:8192
ds_read_b64_tr_b16 v[50:51], v128 offset:10240
v_mfma_f32_16x16x32_bf16 v[96:99], v[32:35], a[136:139], v[96:99]
s_xor_b32 s52, s53, 28672
buffer_load_dwordx4 a[0:3], v1, s[16:19], s52 offen offset:0 sc1
v_mfma_f32_16x16x32_bf16 v[100:103], v[32:35], a[140:143], v[100:103]
ds_read_b64_tr_b16 v[52:53], v129 offset:8192
L_wc31:
L_wp6:
s_cbranch_execz L_wp10
ds_read_b64_tr_b16 v[54:55], v129 offset:10240
v_mfma_f32_16x16x32_bf16 v[100:103], v[16:19], a[132:135], v[100:103]
ds_read_b64_tr_b16 v[56:57], v130 offset:8192
v_mfma_f32_16x16x32_bf16 v[108:111], v[20:23], a[132:135], v[108:111]
ds_read_b64_tr_b16 v[58:59], v130 offset:10240
buffer_load_dwordx4 a[4:7], v140, s[16:19], s52 offen offset:0 sc1
v_mfma_f32_16x16x32_bf16 v[108:111], v[36:39], a[140:143], v[108:111]
ds_read_b64_tr_b16 v[60:61], v131 offset:8192
v_mfma_f32_16x16x32_bf16 v[104:107], v[36:39], a[136:139], v[104:107]
ds_read_b64_tr_b16 v[62:63], v131 offset:10240
v_mfma_f32_16x16x32_bf16 v[104:107], v[20:23], a[128:131], v[104:107]
ds_read_b64_tr_b16 v[64:65], v128 offset:12288
ds_read_b64_tr_b16 v[66:67], v128 offset:14336
v_mfma_f32_16x16x32_bf16 v[112:115], v[24:27], a[128:131], v[112:115]
buffer_load_dwordx4 a[8:11], v1, s[16:19], s52 offen offset:1024 sc1
v_mfma_f32_16x16x32_bf16 v[112:115], v[40:43], a[136:139], v[112:115]
ds_read_b64_tr_b16 v[68:69], v129 offset:12288
ds_read_b64_tr_b16 v[70:71], v129 offset:14336
v_mfma_f32_16x16x32_bf16 v[116:119], v[40:43], a[140:143], v[116:119]
ds_read_b64_tr_b16 v[72:73], v130 offset:12288
v_mfma_f32_16x16x32_bf16 v[116:119], v[24:27], a[132:135], v[116:119]
ds_read_b64_tr_b16 v[74:75], v130 offset:14336
buffer_load_dwordx4 a[12:15], v140, s[16:19], s52 offen offset:1024 sc1
v_mfma_f32_16x16x32_bf16 v[124:127], v[28:31], a[132:135], v[124:127]
ds_read_b64_tr_b16 v[76:77], v131 offset:12288
v_mfma_f32_16x16x32_bf16 v[124:127], v[44:47], a[140:143], v[124:127]
ds_read_b64_tr_b16 v[78:79], v131 offset:14336
v_mfma_f32_16x16x32_bf16 v[120:123], v[44:47], a[136:139], v[120:123]
v_mfma_f32_16x16x32_bf16 v[120:123], v[28:31], a[128:131], v[120:123]
s_waitcnt vmcnt(20) lgkmcnt(0)
v_mfma_f32_16x16x32_bf16 v[96:99], v[48:51], a[144:147], v[96:99]
ds_read_b64_tr_b16 v[16:17], v128 offset:16384
ds_read_b64_tr_b16 v[18:19], v128 offset:18432
v_mfma_f32_16x16x32_bf16 v[96:99], v[64:67], a[152:155], v[96:99]
s_xor_b32 s52, s53, 30720
buffer_load_dwordx4 a[16:19], v1, s[16:19], s52 offen offset:0 sc1
v_mfma_f32_16x16x32_bf16 v[100:103], v[64:67], a[156:159], v[100:103]
ds_read_b64_tr_b16 v[20:21], v129 offset:16384
ds_read_b64_tr_b16 v[22:23], v129 offset:18432
v_mfma_f32_16x16x32_bf16 v[100:103], v[48:51], a[148:151], v[100:103]
ds_read_b64_tr_b16 v[24:25], v130 offset:16384
v_mfma_f32_16x16x32_bf16 v[108:111], v[52:55], a[148:151], v[108:111]
ds_read_b64_tr_b16 v[26:27], v130 offset:18432
buffer_load_dwordx4 a[20:23], v140, s[16:19], s52 offen offset:0 sc1
v_mfma_f32_16x16x32_bf16 v[108:111], v[68:71], a[156:159], v[108:111]
ds_read_b64_tr_b16 v[28:29], v131 offset:16384
v_mfma_f32_16x16x32_bf16 v[104:107], v[68:71], a[152:155], v[104:107]
ds_read_b64_tr_b16 v[30:31], v131 offset:18432
v_mfma_f32_16x16x32_bf16 v[104:107], v[52:55], a[144:147], v[104:107]
ds_read_b64_tr_b16 v[32:33], v128 offset:20480
ds_read_b64_tr_b16 v[34:35], v128 offset:22528
v_mfma_f32_16x16x32_bf16 v[112:115], v[56:59], a[144:147], v[112:115]
buffer_load_dwordx4 a[24:27], v1, s[16:19], s52 offen offset:1024 sc1
v_mfma_f32_16x16x32_bf16 v[112:115], v[72:75], a[152:155], v[112:115]
ds_read_b64_tr_b16 v[36:37], v129 offset:20480
ds_read_b64_tr_b16 v[38:39], v129 offset:22528
v_mfma_f32_16x16x32_bf16 v[116:119], v[72:75], a[156:159], v[116:119]
ds_read_b64_tr_b16 v[40:41], v130 offset:20480
v_mfma_f32_16x16x32_bf16 v[116:119], v[56:59], a[148:151], v[116:119]
ds_read_b64_tr_b16 v[42:43], v130 offset:22528
buffer_load_dwordx4 a[28:31], v140, s[16:19], s52 offen offset:1024 sc1
v_mfma_f32_16x16x32_bf16 v[124:127], v[60:63], a[148:151], v[124:127]
ds_read_b64_tr_b16 v[44:45], v131 offset:20480
v_mfma_f32_16x16x32_bf16 v[124:127], v[76:79], a[156:159], v[124:127]
ds_read_b64_tr_b16 v[46:47], v131 offset:22528
v_mfma_f32_16x16x32_bf16 v[120:123], v[76:79], a[152:155], v[120:123]
v_mfma_f32_16x16x32_bf16 v[120:123], v[60:63], a[144:147], v[120:123]
s_waitcnt vmcnt(20) lgkmcnt(0)
v_mfma_f32_16x16x32_bf16 v[96:99], v[16:19], a[160:163], v[96:99]
ds_read_b64_tr_b16 v[48:49], v128 offset:24576
ds_read_b64_tr_b16 v[50:51], v128 offset:26624
v_mfma_f32_16x16x32_bf16 v[96:99], v[32:35], a[168:171], v[96:99]
s_xor_b32 s38, s71, 0
s_mul_i32 s38, s38, 458752
s_add_u32 s4, s40, s38
s_addc_u32 s5, s41, 0
v_mfma_f32_16x16x32_bf16 v[100:103], v[32:35], a[172:175], v[100:103]
ds_read_b64_tr_b16 v[52:53], v129 offset:24576
ds_read_b64_tr_b16 v[54:55], v129 offset:26624
v_mfma_f32_16x16x32_bf16 v[100:103], v[16:19], a[164:167], v[100:103]
ds_read_b64_tr_b16 v[56:57], v130 offset:24576
v_mfma_f32_16x16x32_bf16 v[108:111], v[20:23], a[164:167], v[108:111]
ds_read_b64_tr_b16 v[58:59], v130 offset:26624
s_add_u32 m0, s35, 65536
s_nop 0
buffer_load_dwordx4 v4, s[4:7], 0 offen offset:0 lds
v_mfma_f32_16x16x32_bf16 v[108:111], v[36:39], a[172:175], v[108:111]
ds_read_b64_tr_b16 v[60:61], v131 offset:24576
v_mfma_f32_16x16x32_bf16 v[104:107], v[36:39], a[168:171], v[104:107]
ds_read_b64_tr_b16 v[62:63], v131 offset:26624
v_mfma_f32_16x16x32_bf16 v[104:107], v[20:23], a[160:163], v[104:107]
ds_read_b64_tr_b16 v[64:65], v128 offset:28672
ds_read_b64_tr_b16 v[66:67], v128 offset:30720
v_mfma_f32_16x16x32_bf16 v[112:115], v[24:27], a[160:163], v[112:115]
buffer_load_dwordx4 v5, s[4:7], 0 offen offset:1024 lds
v_mfma_f32_16x16x32_bf16 v[112:115], v[40:43], a[168:171], v[112:115]
ds_read_b64_tr_b16 v[68:69], v129 offset:28672
ds_read_b64_tr_b16 v[70:71], v129 offset:30720
v_mfma_f32_16x16x32_bf16 v[116:119], v[40:43], a[172:175], v[116:119]
ds_read_b64_tr_b16 v[72:73], v130 offset:28672
v_mfma_f32_16x16x32_bf16 v[116:119], v[24:27], a[164:167], v[116:119]
ds_read_b64_tr_b16 v[74:75], v130 offset:30720
buffer_load_dwordx4 v6, s[4:7], 0 offen offset:2048 lds
v_mfma_f32_16x16x32_bf16 v[124:127], v[28:31], a[164:167], v[124:127]
ds_read_b64_tr_b16 v[76:77], v131 offset:28672
v_mfma_f32_16x16x32_bf16 v[124:127], v[44:47], a[172:175], v[124:127]
ds_read_b64_tr_b16 v[78:79], v131 offset:30720
v_mfma_f32_16x16x32_bf16 v[120:123], v[44:47], a[168:171], v[120:123]
v_mfma_f32_16x16x32_bf16 v[120:123], v[28:31], a[160:163], v[120:123]
s_waitcnt vmcnt(19) lgkmcnt(0)
v_mfma_f32_16x16x32_bf16 v[96:99], v[48:51], a[176:179], v[96:99]
ds_read_b64_tr_b16 v[16:17], v128 offset:32768
ds_read_b64_tr_b16 v[18:19], v128 offset:34816
v_mfma_f32_16x16x32_bf16 v[96:99], v[64:67], a[184:187], v[96:99]
buffer_load_dwordx4 v7, s[4:7], 0 offen offset:3072 lds
v_mfma_f32_16x16x32_bf16 v[100:103], v[64:67], a[188:191], v[100:103]
ds_read_b64_tr_b16 v[20:21], v129 offset:32768
ds_read_b64_tr_b16 v[22:23], v129 offset:34816
v_mfma_f32_16x16x32_bf16 v[100:103], v[48:51], a[180:183], v[100:103]
ds_read_b64_tr_b16 v[24:25], v130 offset:32768
v_mfma_f32_16x16x32_bf16 v[108:111], v[52:55], a[180:183], v[108:111]
ds_read_b64_tr_b16 v[26:27], v130 offset:34816
s_add_u32 m0, s35, 69632
s_nop 0
buffer_load_dwordx4 v8, s[4:7], 0 offen offset:0 lds
v_mfma_f32_16x16x32_bf16 v[108:111], v[68:71], a[188:191], v[108:111]
ds_read_b64_tr_b16 v[28:29], v131 offset:32768
v_mfma_f32_16x16x32_bf16 v[104:107], v[68:71], a[184:187], v[104:107]
ds_read_b64_tr_b16 v[30:31], v131 offset:34816
v_mfma_f32_16x16x32_bf16 v[104:107], v[52:55], a[176:179], v[104:107]
ds_read_b64_tr_b16 v[32:33], v128 offset:36864
ds_read_b64_tr_b16 v[34:35], v128 offset:38912
v_mfma_f32_16x16x32_bf16 v[112:115], v[56:59], a[176:179], v[112:115]
buffer_load_dwordx4 v9, s[4:7], 0 offen offset:1024 lds
v_mfma_f32_16x16x32_bf16 v[112:115], v[72:75], a[184:187], v[112:115]
ds_read_b64_tr_b16 v[36:37], v129 offset:36864
ds_read_b64_tr_b16 v[38:39], v129 offset:38912
v_mfma_f32_16x16x32_bf16 v[116:119], v[72:75], a[188:191], v[116:119]
ds_read_b64_tr_b16 v[40:41], v130 offset:36864
v_mfma_f32_16x16x32_bf16 v[116:119], v[56:59], a[180:183], v[116:119]
ds_read_b64_tr_b16 v[42:43], v130 offset:38912
buffer_load_dwordx4 v10, s[4:7], 0 offen offset:2048 lds
v_mfma_f32_16x16x32_bf16 v[124:127], v[60:63], a[180:183], v[124:127]
ds_read_b64_tr_b16 v[44:45], v131 offset:36864
v_mfma_f32_16x16x32_bf16 v[124:127], v[76:79], a[188:191], v[124:127]
ds_read_b64_tr_b16 v[46:47], v131 offset:38912
v_mfma_f32_16x16x32_bf16 v[120:123], v[76:79], a[184:187], v[120:123]
v_mfma_f32_16x16x32_bf16 v[120:123], v[60:63], a[176:179], v[120:123]
s_waitcnt vmcnt(19) lgkmcnt(0)
v_mfma_f32_16x16x32_bf16 v[96:99], v[16:19], a[192:195], v[96:99]
ds_read_b64_tr_b16 v[48:49], v128 offset:40960
ds_read_b64_tr_b16 v[50:51], v128 offset:43008
v_mfma_f32_16x16x32_bf16 v[96:99], v[32:35], a[200:203], v[96:99]
s_xor_b32 s38, s71, 1
s_mul_i32 s38, s38, 458752
s_add_u32 s4, s40, s38
s_addc_u32 s5, s41, 0
v_mfma_f32_16x16x32_bf16 v[100:103], v[32:35], a[204:207], v[100:103]
ds_read_b64_tr_b16 v[52:53], v129 offset:40960
ds_read_b64_tr_b16 v[54:55], v129 offset:43008
v_mfma_f32_16x16x32_bf16 v[100:103], v[16:19], a[196:199], v[100:103]
ds_read_b64_tr_b16 v[56:57], v130 offset:40960
v_mfma_f32_16x16x32_bf16 v[108:111], v[20:23], a[196:199], v[108:111]
ds_read_b64_tr_b16 v[58:59], v130 offset:43008
s_add_u32 m0, s35, 98304
s_nop 0
buffer_load_dwordx4 v4, s[4:7], 0 offen offset:0 lds
v_mfma_f32_16x16x32_bf16 v[108:111], v[36:39], a[204:207], v[108:111]
ds_read_b64_tr_b16 v[60:61], v131 offset:40960
v_mfma_f32_16x16x32_bf16 v[104:107], v[36:39], a[200:203], v[104:107]
ds_read_b64_tr_b16 v[62:63], v131 offset:43008
v_mfma_f32_16x16x32_bf16 v[104:107], v[20:23], a[192:195], v[104:107]
ds_read_b64_tr_b16 v[64:65], v128 offset:45056
ds_read_b64_tr_b16 v[66:67], v128 offset:47104
v_mfma_f32_16x16x32_bf16 v[112:115], v[24:27], a[192:195], v[112:115]
buffer_load_dwordx4 v5, s[4:7], 0 offen offset:1024 lds
v_mfma_f32_16x16x32_bf16 v[112:115], v[40:43], a[200:203], v[112:115]
ds_read_b64_tr_b16 v[68:69], v129 offset:45056
ds_read_b64_tr_b16 v[70:71], v129 offset:47104
v_mfma_f32_16x16x32_bf16 v[116:119], v[40:43], a[204:207], v[116:119]
ds_read_b64_tr_b16 v[72:73], v130 offset:45056
v_mfma_f32_16x16x32_bf16 v[116:119], v[24:27], a[196:199], v[116:119]
ds_read_b64_tr_b16 v[74:75], v130 offset:47104
buffer_load_dwordx4 v6, s[4:7], 0 offen offset:2048 lds
v_mfma_f32_16x16x32_bf16 v[124:127], v[28:31], a[196:199], v[124:127]
ds_read_b64_tr_b16 v[76:77], v131 offset:45056
v_mfma_f32_16x16x32_bf16 v[124:127], v[44:47], a[204:207], v[124:127]
ds_read_b64_tr_b16 v[78:79], v131 offset:47104
v_mfma_f32_16x16x32_bf16 v[120:123], v[44:47], a[200:203], v[120:123]
v_mfma_f32_16x16x32_bf16 v[120:123], v[28:31], a[192:195], v[120:123]
s_waitcnt vmcnt(18) lgkmcnt(0)
v_mfma_f32_16x16x32_bf16 v[96:99], v[48:51], a[208:211], v[96:99]
ds_read_b64_tr_b16 v[16:17], v128 offset:49152
ds_read_b64_tr_b16 v[18:19], v128 offset:51200
v_mfma_f32_16x16x32_bf16 v[96:99], v[64:67], a[216:219], v[96:99]
buffer_load_dwordx4 v7, s[4:7], 0 offen offset:3072 lds
v_mfma_f32_16x16x32_bf16 v[100:103], v[64:67], a[220:223], v[100:103]
ds_read_b64_tr_b16 v[20:21], v129 offset:49152
ds_read_b64_tr_b16 v[22:23], v129 offset:51200
v_mfma_f32_16x16x32_bf16 v[100:103], v[48:51], a[212:215], v[100:103]
ds_read_b64_tr_b16 v[24:25], v130 offset:49152
v_mfma_f32_16x16x32_bf16 v[108:111], v[52:55], a[212:215], v[108:111]
ds_read_b64_tr_b16 v[26:27], v130 offset:51200
s_add_u32 m0, s35, 102400
s_nop 0
buffer_load_dwordx4 v8, s[4:7], 0 offen offset:0 lds
v_mfma_f32_16x16x32_bf16 v[108:111], v[68:71], a[220:223], v[108:111]
ds_read_b64_tr_b16 v[28:29], v131 offset:49152
v_mfma_f32_16x16x32_bf16 v[104:107], v[68:71], a[216:219], v[104:107]
ds_read_b64_tr_b16 v[30:31], v131 offset:51200
v_mfma_f32_16x16x32_bf16 v[104:107], v[52:55], a[208:211], v[104:107]
ds_read_b64_tr_b16 v[32:33], v128 offset:53248
ds_read_b64_tr_b16 v[34:35], v128 offset:55296
v_mfma_f32_16x16x32_bf16 v[112:115], v[56:59], a[208:211], v[112:115]
buffer_load_dwordx4 v9, s[4:7], 0 offen offset:1024 lds
v_mfma_f32_16x16x32_bf16 v[112:115], v[72:75], a[216:219], v[112:115]
ds_read_b64_tr_b16 v[36:37], v129 offset:53248
ds_read_b64_tr_b16 v[38:39], v129 offset:55296
v_mfma_f32_16x16x32_bf16 v[116:119], v[72:75], a[220:223], v[116:119]
ds_read_b64_tr_b16 v[40:41], v130 offset:53248
v_mfma_f32_16x16x32_bf16 v[116:119], v[56:59], a[212:215], v[116:119]
ds_read_b64_tr_b16 v[42:43], v130 offset:55296
buffer_load_dwordx4 v10, s[4:7], 0 offen offset:2048 lds
v_mfma_f32_16x16x32_bf16 v[124:127], v[60:63], a[212:215], v[124:127]
ds_read_b64_tr_b16 v[44:45], v131 offset:53248
v_mfma_f32_16x16x32_bf16 v[124:127], v[76:79], a[220:223], v[124:127]
ds_read_b64_tr_b16 v[46:47], v131 offset:55296
v_mfma_f32_16x16x32_bf16 v[120:123], v[76:79], a[216:219], v[120:123]
v_mfma_f32_16x16x32_bf16 v[120:123], v[60:63], a[208:211], v[120:123]
s_waitcnt vmcnt(18) lgkmcnt(0)
v_mfma_f32_16x16x32_bf16 v[96:99], v[16:19], a[0:3], v[96:99]
ds_read_b64_tr_b16 v[48:49], v128 offset:57344
ds_read_b64_tr_b16 v[50:51], v128 offset:59392
v_mfma_f32_16x16x32_bf16 v[96:99], v[32:35], a[8:11], v[96:99]
ds_read_b64_tr_b16 v[52:53], v129 offset:57344
v_mfma_f32_16x16x32_bf16 v[100:103], v[32:35], a[12:15], v[100:103]
ds_read_b64_tr_b16 v[54:55], v129 offset:59392
v_accvgpr_read_b32 v236, a232
v_mfma_f32_16x16x32_bf16 v[100:103], v[16:19], a[4:7], v[100:103]
ds_read_b64_tr_b16 v[56:57], v130 offset:57344
v_mfma_f32_16x16x32_bf16 v[108:111], v[20:23], a[4:7], v[108:111]
ds_read_b64_tr_b16 v[58:59], v130 offset:59392
v_accvgpr_read_b32 v237, a233
v_mfma_f32_16x16x32_bf16 v[108:111], v[36:39], a[12:15], v[108:111]
ds_read_b64_tr_b16 v[60:61], v131 offset:57344
v_mfma_f32_16x16x32_bf16 v[104:107], v[36:39], a[8:11], v[104:107]
ds_read_b64_tr_b16 v[62:63], v131 offset:59392
v_accvgpr_read_b32 v238, a234
v_mfma_f32_16x16x32_bf16 v[104:107], v[20:23], a[0:3], v[104:107]
ds_read_b64_tr_b16 v[64:65], v128 offset:61440
ds_read_b64_tr_b16 v[66:67], v128 offset:63488
v_mfma_f32_16x16x32_bf16 v[112:115], v[24:27], a[0:3], v[112:115]
ds_read_b64_tr_b16 v[68:69], v129 offset:61440
v_mfma_f32_16x16x32_bf16 v[112:115], v[40:43], a[8:11], v[112:115]
ds_read_b64_tr_b16 v[70:71], v129 offset:63488
v_accvgpr_read_b32 v239, a235
v_mfma_f32_16x16x32_bf16 v[116:119], v[40:43], a[12:15], v[116:119]
ds_read_b64_tr_b16 v[72:73], v130 offset:61440
v_mfma_f32_16x16x32_bf16 v[116:119], v[24:27], a[4:7], v[116:119]
ds_read_b64_tr_b16 v[74:75], v130 offset:63488
v_accvgpr_read_b32 v240, a236
v_mfma_f32_16x16x32_bf16 v[124:127], v[28:31], a[4:7], v[124:127]
ds_read_b64_tr_b16 v[76:77], v131 offset:61440
v_mfma_f32_16x16x32_bf16 v[124:127], v[44:47], a[12:15], v[124:127]
ds_read_b64_tr_b16 v[78:79], v131 offset:63488
v_accvgpr_read_b32 v241, a237
v_mfma_f32_16x16x32_bf16 v[120:123], v[44:47], a[8:11], v[120:123]
v_accvgpr_read_b32 v242, a238
v_mfma_f32_16x16x32_bf16 v[120:123], v[28:31], a[0:3], v[120:123]
v_accvgpr_read_b32 v243, a239
s_waitcnt vmcnt(14) lgkmcnt(0)
v_mfma_f32_16x16x32_bf16 v[96:99], v[48:51], a[16:19], v[96:99]
s_getpc_b64 s[58:59]
L_m_rf3:
s_and_b32 s58, s58, 0xffffff80
v_mfma_f32_16x16x32_bf16 v[96:99], v[64:67], a[24:27], v[96:99]
v_mfma_f32_16x16x32_bf16 v[100:103], v[64:67], a[28:31], v[100:103]
s_lshr_b32 s60, s2, 3
s_lshl_b32 s60, s60, 2
s_add_u32 s60, s60, s3
s_mul_i32 s60, s60, 4
v_mfma_f32_16x16x32_bf16 v[100:103], v[48:51], a[20:23], v[100:103]
v_accvgpr_read_b32 v244, a240
v_mfma_f32_16x16x32_bf16 v[108:111], v[52:55], a[20:23], v[108:111]
v_min_u32 v11, 3, v0
v_mfma_f32_16x16x32_bf16 v[108:111], v[68:71], a[28:31], v[108:111]
v_accvgpr_read_b32 v245, a241
v_mfma_f32_16x16x32_bf16 v[104:107], v[68:71], a[24:27], v[104:107]
v_accvgpr_read_b32 v246, a242
v_mfma_f32_16x16x32_bf16 v[104:107], v[52:55], a[16:19], v[104:107]
v_add_lshl_u32 v11, v11, s60, 7
v_mfma_f32_16x16x32_bf16 v[112:115], v[56:59], a[16:19], v[112:115]
v_accvgpr_read_b32 v247, a243
v_mfma_f32_16x16x32_bf16 v[112:115], v[72:75], a[24:27], v[112:115]
v_min_u32 v11, L_fin-L_m_rf3-128, v11
v_mfma_f32_16x16x32_bf16 v[116:119], v[72:75], a[28:31], v[116:119]
v_accvgpr_read_b32 v248, a244
v_mfma_f32_16x16x32_bf16 v[116:119], v[56:59], a[20:23], v[116:119]
global_load_dwordx2 a[254:255], v11, s[58:59] offset:60
v_mfma_f32_16x16x32_bf16 v[124:127], v[60:63], a[20:23], v[124:127]
v_accvgpr_read_b32 v249, a245
v_mfma_f32_16x16x32_bf16 v[124:127], v[76:79], a[28:31], v[124:127]
v_mfma_f32_16x16x32_bf16 v[120:123], v[76:79], a[24:27], v[120:123]
v_accvgpr_read_b32 v250, a246
v_mfma_f32_16x16x32_bf16 v[120:123], v[60:63], a[16:19], v[120:123]
v_accvgpr_read_b32 v251, a247
s_lshl_b32 s38, s64, 15
s_lshl_b32 s39, s55, 11
s_add_u32 s38, s38, s39
s_add_u32 s38, s38, 4194304
s_add_u32 s39, s38, 32768
s_mov_b32 s61, 0x3f803f80
v_permlane16_swap_b32 v236, v238
v_permlane16_swap_b32 v237, v239
v_permlane16_swap_b32 v240, v242
v_permlane16_swap_b32 v241, v243
v_permlane16_swap_b32 v244, v246
v_permlane16_swap_b32 v245, v247
v_permlane16_swap_b32 v248, v250
v_permlane16_swap_b32 v249, v251
v_mov_b32 v16, 0
v_mov_b32 v17, 0
v_mov_b32 v18, 0
v_mov_b32 v19, 0
v_lshlrev_b32_e64 v12, 16, v236
v_and_b32 v13, 0xffff0000, v236
v_pk_add_f32 v[96:97], v[96:97], v[12:13]
v_cvt_pk_bf16_f32 v236, v96, v97
v_lshlrev_b32_e64 v12, 16, v237
v_and_b32 v13, 0xffff0000, v237
v_pk_add_f32 v[98:99], v[98:99], v[12:13]
v_cvt_pk_bf16_f32 v237, v98, v99
v_lshlrev_b32_e64 v12, 16, v238
v_and_b32 v13, 0xffff0000, v238
v_pk_add_f32 v[104:105], v[104:105], v[12:13]
v_cvt_pk_bf16_f32 v238, v104, v105
v_lshlrev_b32_e64 v12, 16, v239
v_and_b32 v13, 0xffff0000, v239
v_pk_add_f32 v[106:107], v[106:107], v[12:13]
v_cvt_pk_bf16_f32 v239, v106, v107
buffer_store_dwordx4 v[236:239], v1, s[12:15], s38 offen offset:0 sc1
v_lshlrev_b32_e64 v12, 16, v240
v_and_b32 v13, 0xffff0000, v240
v_pk_add_f32 v[112:113], v[112:113], v[12:13]
v_cvt_pk_bf16_f32 v240, v112, v113
v_lshlrev_b32_e64 v12, 16, v241
v_and_b32 v13, 0xffff0000, v241
v_pk_add_f32 v[114:115], v[114:115], v[12:13]
v_cvt_pk_bf16_f32 v241, v114, v115
v_lshlrev_b32_e64 v12, 16, v242
v_and_b32 v13, 0xffff0000, v242
v_pk_add_f32 v[120:121], v[120:121], v[12:13]
v_cvt_pk_bf16_f32 v242, v120, v121
v_lshlrev_b32_e64 v12, 16, v243
v_and_b32 v13, 0xffff0000, v243
v_pk_add_f32 v[122:123], v[122:123], v[12:13]
v_cvt_pk_bf16_f32 v243, v122, v123
buffer_store_dwordx4 v[240:243], v1, s[12:15], s38 offen offset:1024 sc1
v_lshlrev_b32_e64 v12, 16, v244
v_and_b32 v13, 0xffff0000, v244
v_pk_add_f32 v[100:101], v[100:101], v[12:13]
v_cvt_pk_bf16_f32 v244, v100, v101
v_lshlrev_b32_e64 v12, 16, v245
v_and_b32 v13, 0xffff0000, v245
v_pk_add_f32 v[102:103], v[102:103], v[12:13]
v_cvt_pk_bf16_f32 v245, v102, v103
v_lshlrev_b32_e64 v12, 16, v246
v_and_b32 v13, 0xffff0000, v246
v_pk_add_f32 v[108:109], v[108:109], v[12:13]
v_cvt_pk_bf16_f32 v246, v108, v109
v_lshlrev_b32_e64 v12, 16, v247
v_and_b32 v13, 0xffff0000, v247
v_pk_add_f32 v[110:111], v[110:111], v[12:13]
v_cvt_pk_bf16_f32 v247, v110, v111
buffer_store_dwordx4 v[244:247], v1, s[12:15], s39 offen offset:0 sc1
v_lshlrev_b32_e64 v12, 16, v248
v_and_b32 v13, 0xffff0000, v248
v_pk_add_f32 v[116:117], v[116:117], v[12:13]
v_cvt_pk_bf16_f32 v248, v116, v117
v_lshlrev_b32_e64 v12, 16, v249
v_and_b32 v13, 0xffff0000, v249
v_pk_add_f32 v[118:119], v[118:119], v[12:13]
v_cvt_pk_bf16_f32 v249, v118, v119
v_lshlrev_b32_e64 v12, 16, v250
v_and_b32 v13, 0xffff0000, v250
v_pk_add_f32 v[124:125], v[124:125], v[12:13]
v_cvt_pk_bf16_f32 v250, v124, v125
v_lshlrev_b32_e64 v12, 16, v251
v_and_b32 v13, 0xffff0000, v251
v_pk_add_f32 v[126:127], v[126:127], v[12:13]
v_cvt_pk_bf16_f32 v251, v126, v127
buffer_store_dwordx4 v[248:251], v1, s[12:15], s39 offen offset:1024 sc1
v_dot2c_f32_bf16 v16, s61, v236
v_dot2c_f32_bf16 v17, v236, v236
v_dot2c_f32_bf16 v16, s61, v237
v_dot2c_f32_bf16 v17, v237, v237
v_dot2c_f32_bf16 v16, s61, v238
v_dot2c_f32_bf16 v17, v238, v238
v_dot2c_f32_bf16 v16, s61, v239
v_dot2c_f32_bf16 v17, v239, v239
v_dot2c_f32_bf16 v16, s61, v240
v_dot2c_f32_bf16 v17, v240, v240
v_dot2c_f32_bf16 v16, s61, v241
v_dot2c_f32_bf16 v17, v241, v241
v_dot2c_f32_bf16 v16, s61, v242
v_dot2c_f32_bf16 v17, v242, v242
v_dot2c_f32_bf16 v16, s61, v243
v_dot2c_f32_bf16 v17, v243, v243
v_dot2c_f32_bf16 v18, s61, v244
v_dot2c_f32_bf16 v19, v244, v244
v_dot2c_f32_bf16 v18, s61, v245
v_dot2c_f32_bf16 v19, v245, v245
v_dot2c_f32_bf16 v18, s61, v246
v_dot2c_f32_bf16 v19, v246, v246
v_dot2c_f32_bf16 v18, s61, v247
v_dot2c_f32_bf16 v19, v247, v247
v_dot2c_f32_bf16 v18, s61, v248
v_dot2c_f32_bf16 v19, v248, v248
v_dot2c_f32_bf16 v18, s61, v249
v_dot2c_f32_bf16 v19, v249, v249
v_dot2c_f32_bf16 v18, s61, v250
v_dot2c_f32_bf16 v19, v250, v250
v_dot2c_f32_bf16 v18, s61, v251
v_dot2c_f32_bf16 v19, v251, v251
v_permlane16_swap_b32 v16, v17
s_nop 1
v_permlane16_swap_b32 v18, v19
v_add_f32 v17, v16, v17
v_add_f32 v19, v18, v19
s_nop 1
v_permlane32_swap_b32 v17, v19
v_add_f32 v17, v17, v19
v_mov_b32 v19, v17
s_nop 1
v_permlane32_swap_b32 v17, v19
v_mov_b32 v16, v17
v_mov_b32 v18, v19
s_nop 0
v_permlane16_swap_b32 v16, v17
v_permlane16_swap_b32 v18, v19
s_lshl_b32 s38, s64, 11
s_lshl_b32 s39, s55, 8
s_add_u32 s38, s38, s39
s_add_u32 s38, s38, 63963136
s_mov_b64 exec, 0xffff
buffer_store_dwordx4 v[16:19], v1, s[12:15], s38 offen sc1
s_mov_b64 exec, -1
s_lshl_b32 s56, s54, 4
s_add_u32 s56, s56, s55
s_lshl_b32 s56, s56, 2
s_add_u32 s56, s56, 63510528
s_lshl_b32 s57, s36, 7
s_add_u32 s57, s57, 63510528
s_lshl_b32 s64, s64, 15
s_lshl_b32 s39, s55, 11
s_add_u32 s64, s64, s39
s_add_u32 s64, s64, 25165824
s_branch L_p3end
L_wp7:
s_branch L_wra
L_pf:
s_mov_b64 exec, 3
buffer_store_dword v226, v224, s[12:15], s60 offen sc1
s_getreg_b32 s39, hwreg(HW_REG_XCC_ID, 0, 4)
s_lshl_b32 s39, s39, 1
s_xor_b32 s39, s39, s63
v_mov_b32 v200, s39
s_and_b32 s39, s2, 7
s_lshl_b32 s39, s39, 5
s_lshr_b32 s61, s2, 3
s_add_u32 s39, s39, s61
s_lshl_b32 s39, s39, 2
s_add_u32 s39, s39, 63533056
s_mov_b64 exec, 1
buffer_store_dword v200, off, s[12:15], s39 sc1
s_mov_b64 exec, -1
s_branch L_pfr
L_wc32:
L_wp8:
s_branch L_wp11
L_st00:
v_mfma_f32_16x16x32_bf16 a[148:151], a[64:67], a[120:123], 0
v_mfma_f32_16x16x32_bf16 a[148:151], a[68:71], a[124:127], a[148:151]
v_mfma_f32_16x16x32_bf16 a[148:151], a[72:75], a[128:131], a[148:151]
v_mfma_f32_16x16x32_bf16 a[148:151], a[76:79], a[132:135], a[148:151]
v_mfma_f32_16x16x32_bf16 a[148:151], a[80:83], a[136:139], a[148:151]
v_mfma_f32_16x16x32_bf16 a[148:151], a[84:87], a[140:143], a[148:151]
v_mfma_f32_16x16x32_bf16 a[148:151], a[88:91], a[144:147], a[148:151]
s_branch L_st00r
L_st01:
s_nop 6
v_mfma_f32_16x16x32_bf16 a[148:151], a[92:95], a[120:123], 0
v_mfma_f32_16x16x32_bf16 a[148:151], a[96:99], a[124:127], a[148:151]
v_mfma_f32_16x16x32_bf16 a[148:151], a[100:103], a[128:131], a[148:151]
v_mfma_f32_16x16x32_bf16 a[148:151], a[104:107], a[132:135], a[148:151]
v_mfma_f32_16x16x32_bf16 a[148:151], a[108:111], a[136:139], a[148:151]
v_mfma_f32_16x16x32_bf16 a[148:151], a[112:115], a[140:143], a[148:151]
v_mfma_f32_16x16x32_bf16 a[148:151], a[116:119], a[144:147], a[148:151]
s_branch L_st01r
L_st02:
s_nop 6
v_mfma_f32_16x16x32_bf16 a[148:151], a[64:67], a[120:123], 0
v_mfma_f32_16x16x32_bf16 a[148:151], a[68:71], a[124:127], a[148:151]
v_mfma_f32_16x16x32_bf16 a[148:151], a[72:75], a[128:131], a[148:151]
v_mfma_f32_16x16x32_bf16 a[148:151], a[76:79], a[132:135], a[148:151]
v_mfma_f32_16x16x32_bf16 a[148:151], a[80:83], a[136:139], a[148:151]
v_mfma_f32_16x16x32_bf16 a[148:151], a[84:87], a[140:143], a[148:151]
v_mfma_f32_16x16x32_bf16 a[148:151], a[88:91], a[144:147], a[148:151]
s_branch L_st02r
L_st03:
s_nop 6
v_mfma_f32_16x16x32_bf16 a[148:151], a[92:95], a[120:123], 0
v_mfma_f32_16x16x32_bf16 a[148:151], a[96:99], a[124:127], a[148:151]
v_mfma_f32_16x16x32_bf16 a[148:151], a[100:103], a[128:131], a[148:151]
v_mfma_f32_16x16x32_bf16 a[148:151], a[104:107], a[132:135], a[148:151]
v_mfma_f32_16x16x32_bf16 a[148:151], a[108:111], a[136:139], a[148:151]
v_mfma_f32_16x16x32_bf16 a[148:151], a[112:115], a[140:143], a[148:151]
v_mfma_f32_16x16x32_bf16 a[148:151], a[116:119], a[144:147], a[148:151]
s_branch L_st03r
L_st10:
v_mfma_f32_16x16x32_bf16 a[148:151], a[64:67], a[120:123], a[148:151]
v_mfma_f32_16x16x32_bf16 a[148:151], a[68:71], a[120:123], a[148:151]
v_mfma_f32_16x16x32_bf16 a[148:151], a[72:75], a[124:127], a[148:151]
v_mfma_f32_16x16x32_bf16 a[148:151], a[76:79], a[124:127], a[148:151]
v_mfma_f32_16x16x32_bf16 a[148:151], a[80:83], a[128:131], a[148:151]
v_mfma_f32_16x16x32_bf16 a[148:151], a[84:87], a[128:131], a[148:151]
v_mfma_f32_16x16x32_bf16 a[148:151], a[88:91], a[132:135], a[148:151]
s_branch L_st10r
L_st11:
v_mfma_f32_16x16x32_bf16 a[148:151], a[92:95], a[132:135], a[148:151]
v_mfma_f32_16x16x32_bf16 a[148:151], a[96:99], a[136:139], a[148:151]
v_mfma_f32_16x16x32_bf16 a[148:151], a[100:103], a[136:139], a[148:151]
v_mfma_f32_16x16x32_bf16 a[148:151], a[104:107], a[140:143], a[148:151]
v_mfma_f32_16x16x32_bf16 a[148:151], a[108:111], a[140:143], a[148:151]
v_mfma_f32_16x16x32_bf16 a[148:151], a[112:115], a[144:147], a[148:151]
v_mfma_f32_16x16x32_bf16 a[148:151], a[116:119], a[144:147], a[148:151]
s_branch L_st11r
L_st12:
v_mfma_f32_16x16x32_bf16 a[148:151], a[64:67], a[120:123], a[148:151]
v_mfma_f32_16x16x32_bf16 a[148:151], a[68:71], a[120:123], a[148:151]
v_mfma_f32_16x16x32_bf16 a[148:151], a[72:75], a[124:127], a[148:151]
v_mfma_f32_16x16x32_bf16 a[148:151], a[76:79], a[124:127], a[148:151]
v_mfma_f32_16x16x32_bf16 a[148:151], a[80:83], a[128:131], a[148:151]
v_mfma_f32_16x16x32_bf16 a[148:151], a[84:87], a[128:131], a[148:151]
v_mfma_f32_16x16x32_bf16 a[148:151], a[88:91], a[132:135], a[148:151]
s_branch L_st12r
L_st13:
v_mfma_f32_16x16x32_bf16 a[148:151], a[92:95], a[132:135], a[148:151]
v_mfma_f32_16x16x32_bf16 a[148:151], a[96:99], a[136:139], a[148:151]
v_mfma_f32_16x16x32_bf16 a[148:151], a[100:103], a[136:139], a[148:151]
v_mfma_f32_16x16x32_bf16 a[148:151], a[104:107], a[140:143], a[148:151]
v_mfma_f32_16x16x32_bf16 a[148:151], a[108:111], a[140:143], a[148:151]
v_mfma_f32_16x16x32_bf16 a[148:151], a[112:115], a[144:147], a[148:151]
v_mfma_f32_16x16x32_bf16 a[148:151], a[116:119], a[144:147], a[148:151]
s_branch L_st13r
L_wc33:
L_wp9:
s_branch L_wp12
L_st20:
s_nop 6
v_mfma_f32_16x16x32_bf16 a[148:151], a[64:67], a[120:123], 0
v_mfma_f32_16x16x32_bf16 a[148:151], a[68:71], a[120:123], a[148:151]
v_mfma_f32_16x16x32_bf16 a[148:151], a[72:75], a[124:127], a[148:151]
v_mfma_f32_16x16x32_bf16 a[148:151], a[76:79], a[124:127], a[148:151]
v_mfma_f32_16x16x32_bf16 a[148:151], a[80:83], a[128:131], a[148:151]
v_mfma_f32_16x16x32_bf16 a[148:151], a[84:87], a[128:131], a[148:151]
v_mfma_f32_16x16x32_bf16 a[148:151], a[88:91], a[132:135], a[148:151]
s_branch L_st20r
L_st21:
s_nop 6
v_mfma_f32_16x16x32_bf16 a[148:151], a[92:95], a[132:135], 0
v_mfma_f32_16x16x32_bf16 a[148:151], a[96:99], a[136:139], a[148:151]
v_mfma_f32_16x16x32_bf16 a[148:151], a[100:103], a[136:139], a[148:151]
v_mfma_f32_16x16x32_bf16 a[148:151], a[104:107], a[140:143], a[148:151]
v_mfma_f32_16x16x32_bf16 a[148:151], a[108:111], a[140:143], a[148:151]
v_mfma_f32_16x16x32_bf16 a[148:151], a[112:115], a[144:147], a[148:151]
v_mfma_f32_16x16x32_bf16 a[148:151], a[116:119], a[144:147], a[148:151]
s_branch L_st21r
L_st22:
s_nop 6
v_mfma_f32_16x16x32_bf16 a[148:151], a[64:67], a[120:123], 0
v_mfma_f32_16x16x32_bf16 a[148:151], a[68:71], a[120:123], a[148:151]
v_mfma_f32_16x16x32_bf16 a[148:151], a[72:75], a[124:127], a[148:151]
v_mfma_f32_16x16x32_bf16 a[148:151], a[76:79], a[124:127], a[148:151]
v_mfma_f32_16x16x32_bf16 a[148:151], a[80:83], a[128:131], a[148:151]
v_mfma_f32_16x16x32_bf16 a[148:151], a[84:87], a[128:131], a[148:151]
v_mfma_f32_16x16x32_bf16 a[148:151], a[88:91], a[132:135], a[148:151]
s_branch L_st22r
L_st23:
s_nop 6
v_mfma_f32_16x16x32_bf16 a[148:151], a[92:95], a[132:135], 0
v_mfma_f32_16x16x32_bf16 a[148:151], a[96:99], a[136:139], a[148:151]
v_mfma_f32_16x16x32_bf16 a[148:151], a[100:103], a[136:139], a[148:151]
v_mfma_f32_16x16x32_bf16 a[148:151], a[104:107], a[140:143], a[148:151]
v_mfma_f32_16x16x32_bf16 a[148:151], a[108:111], a[140:143], a[148:151]
v_mfma_f32_16x16x32_bf16 a[148:151], a[112:115], a[144:147], a[148:151]
L_wp10:
s_cbranch_execz L_wp13
v_mfma_f32_16x16x32_bf16 a[148:151], a[116:119], a[144:147], a[148:151]
s_branch L_st23r
L_st30:
v_mfma_f32_16x16x32_bf16 a[148:151], a[64:67], a[120:123], a[148:151]
v_mfma_f32_16x16x32_bf16 a[148:151], a[68:71], a[120:123], a[148:151]
v_mfma_f32_16x16x32_bf16 a[148:151], a[72:75], a[124:127], a[148:151]
v_mfma_f32_16x16x32_bf16 a[148:151], a[76:79], a[124:127], a[148:151]
v_mfma_f32_16x16x32_bf16 a[148:151], a[80:83], a[128:131], a[148:151]
v_mfma_f32_16x16x32_bf16 a[148:151], a[84:87], a[128:131], a[148:151]
v_mfma_f32_16x16x32_bf16 a[148:151], a[88:91], a[132:135], a[148:151]
s_branch L_st30r
L_st31:
v_mfma_f32_16x16x32_bf16 a[148:151], a[92:95], a[132:135], a[148:151]
v_mfma_f32_16x16x32_bf16 a[148:151], a[96:99], a[136:139], a[148:151]
v_mfma_f32_16x16x32_bf16 a[148:151], a[100:103], a[136:139], a[148:151]
v_mfma_f32_16x16x32_bf16 a[148:151], a[104:107], a[140:143], a[148:151]
v_mfma_f32_16x16x32_bf16 a[148:151], a[108:111], a[140:143], a[148:151]
v_mfma_f32_16x16x32_bf16 a[148:151], a[112:115], a[144:147], a[148:151]
v_mfma_f32_16x16x32_bf16 a[148:151], a[116:119], a[144:147], a[148:151]
s_branch L_st31r
L_st32:
v_mfma_f32_16x16x32_bf16 a[148:151], a[64:67], a[120:123], a[148:151]
v_mfma_f32_16x16x32_bf16 a[148:151], a[68:71], a[120:123], a[148:151]
v_mfma_f32_16x16x32_bf16 a[148:151], a[72:75], a[124:127], a[148:151]
v_mfma_f32_16x16x32_bf16 a[148:151], a[76:79], a[124:127], a[148:151]
v_mfma_f32_16x16x32_bf16 a[148:151], a[80:83], a[128:131], a[148:151]
v_mfma_f32_16x16x32_bf16 a[148:151], a[84:87], a[128:131], a[148:151]
v_mfma_f32_16x16x32_bf16 a[148:151], a[88:91], a[132:135], a[148:151]
s_branch L_st32r
L_st33:
v_mfma_f32_16x16x32_bf16 a[148:151], a[92:95], a[132:135], a[148:151]
v_mfma_f32_16x16x32_bf16 a[148:151], a[96:99], a[136:139], a[148:151]
v_mfma_f32_16x16x32_bf16 a[148:151], a[100:103], a[136:139], a[148:151]
v_mfma_f32_16x16x32_bf16 a[148:151], a[104:107], a[140:143], a[148:151]
v_mfma_f32_16x16x32_bf16 a[148:151], a[108:111], a[140:143], a[148:151]
v_mfma_f32_16x16x32_bf16 a[148:151], a[112:115], a[144:147], a[148:151]
v_mfma_f32_16x16x32_bf16 a[148:151], a[116:119], a[144:147], a[148:151]
s_branch L_st33r
L_wp11:
s_branch L_wp14
L_st40:
s_nop 6
v_mfma_f32_16x16x32_bf16 a[148:151], a[64:67], a[120:123], 0
v_mfma_f32_16x16x32_bf16 a[148:151], a[68:71], a[120:123], a[148:151]
v_mfma_f32_16x16x32_bf16 a[148:151], a[72:75], a[124:127], a[148:151]
v_mfma_f32_16x16x32_bf16 a[148:151], a[76:79], a[124:127], a[148:151]
v_mfma_f32_16x16x32_bf16 a[148:151], a[80:83], a[128:131], a[148:151]
v_mfma_f32_16x16x32_bf16 a[148:151], a[84:87], a[128:131], a[148:151]
v_mfma_f32_16x16x32_bf16 a[148:151], a[88:91], a[132:135], a[148:151]
s_branch L_st40r
L_st41:
s_nop 6
v_mfma_f32_16x16x32_bf16 a[148:151], a[92:95], a[132:135], 0
v_mfma_f32_16x16x32_bf16 a[148:151], a[96:99], a[136:139], a[148:151]
v_mfma_f32_16x16x32_bf16 a[148:151], a[100:103], a[136:139], a[148:151]
v_mfma_f32_16x16x32_bf16 a[148:151], a[104:107], a[140:143], a[148:151]
v_mfma_f32_16x16x32_bf16 a[148:151], a[108:111], a[140:143], a[148:151]
v_mfma_f32_16x16x32_bf16 a[148:151], a[112:115], a[144:147], a[148:151]
v_mfma_f32_16x16x32_bf16 a[148:151], a[116:119], a[144:147], a[148:151]
s_branch L_st41r
L_st42:
s_nop 6
v_mfma_f32_16x16x32_bf16 a[148:151], a[64:67], a[120:123], 0
v_mfma_f32_16x16x32_bf16 a[148:151], a[68:71], a[120:123], a[148:151]
v_mfma_f32_16x16x32_bf16 a[148:151], a[72:75], a[124:127], a[148:151]
v_mfma_f32_16x16x32_bf16 a[148:151], a[76:79], a[124:127], a[148:151]
v_mfma_f32_16x16x32_bf16 a[148:151], a[80:83], a[128:131], a[148:151]
v_mfma_f32_16x16x32_bf16 a[148:151], a[84:87], a[128:131], a[148:151]
v_mfma_f32_16x16x32_bf16 a[148:151], a[88:91], a[132:135], a[148:151]
s_branch L_st42r
L_st43:
s_nop 6
v_mfma_f32_16x16x32_bf16 a[148:151], a[92:95], a[132:135], 0
v_mfma_f32_16x16x32_bf16 a[148:151], a[96:99], a[136:139], a[148:151]
v_mfma_f32_16x16x32_bf16 a[148:151], a[100:103], a[136:139], a[148:151]
v_mfma_f32_16x16x32_bf16 a[148:151], a[104:107], a[140:143], a[148:151]
v_mfma_f32_16x16x32_bf16 a[148:151], a[108:111], a[140:143], a[148:151]
v_mfma_f32_16x16x32_bf16 a[148:151], a[112:115], a[144:147], a[148:151]
v_mfma_f32_16x16x32_bf16 a[148:151], a[116:119], a[144:147], a[148:151]
s_branch L_st43r
L_st50:
v_mfma_f32_16x16x32_bf16 a[148:151], a[64:67], a[120:123], a[148:151]
v_mfma_f32_16x16x32_bf16 a[148:151], a[68:71], a[120:123], a[148:151]
v_mfma_f32_16x16x32_bf16 a[148:151], a[72:75], a[124:127], a[148:151]
v_mfma_f32_16x16x32_bf16 a[148:151], a[76:79], a[124:127], a[148:151]
v_mfma_f32_16x16x32_bf16 a[148:151], a[80:83], a[128:131], a[148:151]
v_mfma_f32_16x16x32_bf16 a[148:151], a[84:87], a[128:131], a[148:151]
v_mfma_f32_16x16x32_bf16 a[148:151], a[88:91], a[132:135], a[148:151]
s_branch L_st50r
L_st51:
v_mfma_f32_16x16x32_bf16 a[148:151], a[92:95], a[132:135], a[148:151]
v_mfma_f32_16x16x32_bf16 a[148:151], a[96:99], a[136:139], a[148:151]
v_mfma_f32_16x16x32_bf16 a[148:151], a[100:103], a[136:139], a[148:151]
v_mfma_f32_16x16x32_bf16 a[148:151], a[104:107], a[140:143], a[148:151]
v_mfma_f32_16x16x32_bf16 a[148:151], a[108:111], a[140:143], a[148:151]
v_mfma_f32_16x16x32_bf16 a[148:151], a[112:115], a[144:147], a[148:151]
v_mfma_f32_16x16x32_bf16 a[148:151], a[116:119], a[144:147], a[148:151]
s_branch L_st51r
L_st52:
v_mfma_f32_16x16x32_bf16 a[148:151], a[64:67], a[120:123], a[148:151]
v_mfma_f32_16x16x32_bf16 a[148:151], a[68:71], a[120:123], a[148:151]
v_mfma_f32_16x16x32_bf16 a[148:151], a[72:75], a[124:127], a[148:151]
v_mfma_f32_16x16x32_bf16 a[148:151], a[76:79], a[124:127], a[148:151]
v_mfma_f32_16x16x32_bf16 a[148:151], a[80:83], a[128:131], a[148:151]
v_mfma_f32_16x16x32_bf16 a[148:151], a[84:87], a[128:131], a[148:151]
v_mfma_f32_16x16x32_bf16 a[148:151], a[88:91], a[132:135], a[148:151]
s_branch L_st52r
L_st53:
v_mfma_f32_16x16x32_bf16 a[148:151], a[92:95], a[132:135], a[148:151]
v_mfma_f32_16x16x32_bf16 a[148:151], a[96:99], a[136:139], a[148:151]
v_mfma_f32_16x16x32_bf16 a[148:151], a[100:103], a[136:139], a[148:151]
v_mfma_f32_16x16x32_bf16 a[148:151], a[104:107], a[140:143], a[148:151]
v_mfma_f32_16x16x32_bf16 a[148:151], a[108:111], a[140:143], a[148:151]
v_mfma_f32_16x16x32_bf16 a[148:151], a[112:115], a[144:147], a[148:151]
v_mfma_f32_16x16x32_bf16 a[148:151], a[116:119], a[144:147], a[148:151]
s_branch L_st53r
L_wp12:
s_branch L_wr3
L_st60:
s_nop 6
v_mfma_f32_16x16x32_bf16 a[148:151], a[64:67], a[120:123], 0
v_mfma_f32_16x16x32_bf16 a[148:151], a[68:71], a[120:123], a[148:151]
v_mfma_f32_16x16x32_bf16 a[148:151], a[72:75], a[124:127], a[148:151]
v_mfma_f32_16x16x32_bf16 a[148:151], a[76:79], a[124:127], a[148:151]
v_mfma_f32_16x16x32_bf16 a[148:151], a[80:83], a[128:131], a[148:151]
v_mfma_f32_16x16x32_bf16 a[148:151], a[84:87], a[128:131], a[148:151]
v_mfma_f32_16x16x32_bf16 a[148:151], a[88:91], a[132:135], a[148:151]
s_branch L_st60r
L_st61:
s_nop 6
v_mfma_f32_16x16x32_bf16 a[148:151], a[92:95], a[132:135], 0
v_mfma_f32_16x16x32_bf16 a[148:151], a[96:99], a[136:139], a[148:151]
v_mfma_f32_16x16x32_bf16 a[148:151], a[100:103], a[136:139], a[148:151]
v_mfma_f32_16x16x32_bf16 a[148:151], a[104:107], a[140:143], a[148:151]
v_mfma_f32_16x16x32_bf16 a[148:151], a[108:111], a[140:143], a[148:151]
v_mfma_f32_16x16x32_bf16 a[148:151], a[112:115], a[144:147], a[148:151]
v_mfma_f32_16x16x32_bf16 a[148:151], a[116:119], a[144:147], a[148:151]
s_branch L_st61r
L_st62:
s_nop 6
v_mfma_f32_16x16x32_bf16 a[148:151], a[64:67], a[120:123], 0
v_mfma_f32_16x16x32_bf16 a[148:151], a[68:71], a[120:123], a[148:151]
v_mfma_f32_16x16x32_bf16 a[148:151], a[72:75], a[124:127], a[148:151]
v_mfma_f32_16x16x32_bf16 a[148:151], a[76:79], a[124:127], a[148:151]
v_mfma_f32_16x16x32_bf16 a[148:151], a[80:83], a[128:131], a[148:151]
v_mfma_f32_16x16x32_bf16 a[148:151], a[84:87], a[128:131], a[148:151]
v_mfma_f32_16x16x32_bf16 a[148:151], a[88:91], a[132:135], a[148:151]
s_branch L_st62r
L_st63:
s_nop 6
v_mfma_f32_16x16x32_bf16 a[148:151], a[92:95], a[132:135], 0
v_mfma_f32_16x16x32_bf16 a[148:151], a[96:99], a[136:139], a[148:151]
v_mfma_f32_16x16x32_bf16 a[148:151], a[100:103], a[136:139], a[148:151]
v_mfma_f32_16x16x32_bf16 a[148:151], a[104:107], a[140:143], a[148:151]
v_mfma_f32_16x16x32_bf16 a[148:151], a[108:111], a[140:143], a[148:151]
v_mfma_f32_16x16x32_bf16 a[148:151], a[112:115], a[144:147], a[148:151]
v_mfma_f32_16x16x32_bf16 a[148:151], a[116:119], a[144:147], a[148:151]
s_branch L_st63r
L_st70:
v_mfma_f32_16x16x32_bf16 a[148:151], a[64:67], a[120:123], a[148:151]
v_mfma_f32_16x16x32_bf16 a[148:151], a[68:71], a[120:123], a[148:151]
v_mfma_f32_16x16x32_bf16 a[148:151], a[72:75], a[124:127], a[148:151]
v_mfma_f32_16x16x32_bf16 a[148:151], a[76:79], a[124:127], a[148:151]
v_mfma_f32_16x16x32_bf16 a[148:151], a[80:83], a[128:131], a[148:151]
v_mfma_f32_16x16x32_bf16 a[148:151], a[84:87], a[128:131], a[148:151]
v_mfma_f32_16x16x32_bf16 a[148:151], a[88:91], a[132:135], a[148:151]
s_branch L_st70r
L_st71:
v_mfma_f32_16x16x32_bf16 a[148:151], a[92:95], a[132:135], a[148:151]
v_mfma_f32_16x16x32_bf16 a[148:151], a[96:99], a[136:139], a[148:151]
v_mfma_f32_16x16x32_bf16 a[148:151], a[100:103], a[136:139], a[148:151]
v_mfma_f32_16x16x32_bf16 a[148:151], a[104:107], a[140:143], a[148:151]
v_mfma_f32_16x16x32_bf16 a[148:151], a[108:111], a[140:143], a[148:151]
v_mfma_f32_16x16x32_bf16 a[148:151], a[112:115], a[144:147], a[148:151]
v_mfma_f32_16x16x32_bf16 a[148:151], a[116:119], a[144:147], a[148:151]
s_branch L_st71r
L_st72:
v_mfma_f32_16x16x32_bf16 a[148:151], a[64:67], a[120:123], a[148:151]
v_mfma_f32_16x16x32_bf16 a[148:151], a[68:71], a[120:123], a[148:151]
v_mfma_f32_16x16x32_bf16 a[148:151], a[72:75], a[124:127], a[148:151]
v_mfma_f32_16x16x32_bf16 a[148:151], a[76:79], a[124:127], a[148:151]
v_mfma_f32_16x16x32_bf16 a[148:151], a[80:83], a[128:131], a[148:151]
v_mfma_f32_16x16x32_bf16 a[148:151], a[84:87], a[128:131], a[148:151]
v_mfma_f32_16x16x32_bf16 a[148:151], a[88:91], a[132:135], a[148:151]
s_branch L_st72r
L_st73:
v_mfma_f32_16x16x32_bf16 a[148:151], a[92:95], a[132:135], a[148:151]
v_mfma_f32_16x16x32_bf16 a[148:151], a[96:99], a[136:139], a[148:151]
v_mfma_f32_16x16x32_bf16 a[148:151], a[100:103], a[136:139], a[148:151]
v_mfma_f32_16x16x32_bf16 a[148:151], a[104:107], a[140:143], a[148:151]
v_mfma_f32_16x16x32_bf16 a[148:151], a[108:111], a[140:143], a[148:151]
v_mfma_f32_16x16x32_bf16 a[148:151], a[112:115], a[144:147], a[148:151]
v_mfma_f32_16x16x32_bf16 a[148:151], a[116:119], a[144:147], a[148:151]
s_branch L_st73r
L_wp13:
s_branch L_wr3
L_p3end:
s_waitcnt vmcnt(0)
s_barrier
s_cmp_lg_u32 s3, 0
s_cbranch_scc1 L_hs4
v_mov_b32 v14, 0
v_mov_b32 v15, s63
s_mov_b64 exec, 1
buffer_store_dword v15, v14, s[12:15], s56 offen sc1
s_mov_b64 exec, -1
L_hs4:
v_and_b32 v11, 15, v0
v_mov_b32 v12, 0x3f803f80
v_cmp_eq_u32 vcc, 0, v11
s_nop 1
v_cndmask_b32_e64 v13, 0, v12, vcc
v_accvgpr_write_b32 a120, v13
v_accvgpr_write_b32 a121, v13
v_accvgpr_write_b32 a122, v13
v_accvgpr_write_b32 a123, v13
v_cmp_eq_u32 vcc, 1, v11
s_nop 1
v_cndmask_b32_e64 v13, 0, v12, vcc
v_accvgpr_write_b32 a124, v13
v_accvgpr_write_b32 a125, v13
v_accvgpr_write_b32 a126, v13
v_accvgpr_write_b32 a127, v13
v_cmp_eq_u32 vcc, 2, v11
s_nop 1
v_cndmask_b32_e64 v13, 0, v12, vcc
v_accvgpr_write_b32 a128, v13
v_accvgpr_write_b32 a129, v13
v_accvgpr_write_b32 a130, v13
v_accvgpr_write_b32 a131, v13
v_cmp_eq_u32 vcc, 3, v11
s_nop 1
v_cndmask_b32_e64 v13, 0, v12, vcc
v_accvgpr_write_b32 a132, v13
v_accvgpr_write_b32 a133, v13
v_accvgpr_write_b32 a134, v13
v_accvgpr_write_b32 a135, v13
v_cmp_eq_u32 vcc, 4, v11
s_nop 1
v_cndmask_b32_e64 v13, 0, v12, vcc
v_accvgpr_write_b32 a136, v13
v_accvgpr_write_b32 a137, v13
v_accvgpr_write_b32 a138, v13
v_accvgpr_write_b32 a139, v13
v_cmp_eq_u32 vcc, 5, v11
s_nop 1
v_cndmask_b32_e64 v13, 0, v12, vcc
v_accvgpr_write_b32 a140, v13
v_accvgpr_write_b32 a141, v13
v_accvgpr_write_b32 a142, v13
v_accvgpr_write_b32 a143, v13
v_cmp_eq_u32 vcc, 6, v11
s_nop 1
v_cndmask_b32_e64 v13, 0, v12, vcc
v_accvgpr_write_b32 a144, v13
v_accvgpr_write_b32 a145, v13
v_accvgpr_write_b32 a146, v13
v_accvgpr_write_b32 a147, v13
s_and_b32 s38, s36, 3
s_cmp_eq_u32 s3, 0
s_cselect_b32 s88, s38, 99
s_cmp_eq_u32 s3, 2
s_cselect_b32 s89, s38, 99
s_cmp_eq_u32 s3, 1
s_cselect_b32 s90, s38, 99
s_cmp_eq_u32 s3, 3
s_cselect_b32 s91, s38, 99
s_mov_b32 s92, 0x0c0c0400
s_mov_b32 s93, 0x0c040100
s_mov_b32 s94, 0x04020100
s_bitcmp1_b32 s3, 0
s_cselect_b32 s24, s50, s48
s_cselect_b32 s25, s51, s49
s_bfm_b32 s38, s37, 0
s_and_b32 s38, s38, 2559119769
s_bcnt1_i32_b32 s38, s38
s_lshl_b32 s38, s38, 3
s_add_u32 s38, s38, s36
s_mul_i32 s38, s38, 4864
s_lshr_b32 s39, s3, 1
s_mul_i32 s39, s39, 3670016
s_add_u32 s38, s38, s39
s_add_u32 s24, s24, s38
s_addc_u32 s25, s25, 0
s_sub_u32 s38, 7340032, s38
s_bitcmp1_b32 2559119769, s37
s_cselect_b32 s26, s38, 0
s_lshr_b32 s39, s37, 3
s_mul_i32 s39, s39, 1835008
s_and_b32 s61, s37, 7
s_lshl_b32 s61, s61, 8
s_add_u32 s39, s39, s61
s_and_b32 s61, s37, 16
s_lshl_b32 s61, s61, 3
s_add_u32 s39, s39, s61
s_add_u32 s16, s28, s39
s_addc_u32 s17, s29, 0
s_xor_b32 s39, s39, 128
s_add_u32 s20, s28, s39
s_addc_u32 s21, s29, 0
s_sub_u32 s20, s20, 1024
s_subb_u32 s21, s21, 0
s_mov_b32 s18, 1833088
s_mov_b32 s22, 1834112
s_lshl_b32 s70, s3, 11
v_accvgpr_read_b32 v12, a253
s_lshl_b32 s39, s3, 14
v_add_u32 v12, s39, v12
s_and_b32 s39, s37, 8
s_lshl_b32 s39, s39, 3
v_xor_b32 v12, s39, v12
v_accvgpr_write_b32 a253, v12
s_add_u32 s39, s37, 0
s_and_b32 s39, s39, 7
s_mul_i32 s61, s39, 7
s_and_b32 s39, s39, 1
s_add_u32 s39, s39, s61
s_lshl_b32 s48, s39, 9
s_add_u32 s39, s37, 1
s_and_b32 s39, s39, 7
s_mul_i32 s61, s39, 7
s_and_b32 s39, s39, 1
s_add_u32 s39, s39, s61
s_lshl_b32 s49, s39, 9
s_add_u32 s39, s37, 2
s_and_b32 s39, s39, 7
s_mul_i32 s61, s39, 7
s_and_b32 s39, s39, 1
s_add_u32 s39, s39, s61
s_lshl_b32 s50, s39, 9
s_add_u32 s39, s37, 3
s_and_b32 s39, s39, 7
s_mul_i32 s61, s39, 7
s_and_b32 s39, s39, 1
s_add_u32 s39, s39, s61
s_lshl_b32 s51, s39, 9
s_add_u32 s39, s37, 4
s_and_b32 s39, s39, 7
s_mul_i32 s61, s39, 7
s_and_b32 s39, s39, 1
s_add_u32 s39, s39, s61
s_lshl_b32 s52, s39, 9
s_add_u32 s39, s37, 5
s_and_b32 s39, s39, 7
s_mul_i32 s61, s39, 7
s_and_b32 s39, s39, 1
s_add_u32 s39, s39, s61
s_lshl_b32 s53, s39, 9
s_add_u32 s39, s37, 6
s_and_b32 s39, s39, 7
s_mul_i32 s61, s39, 7
s_and_b32 s39, s39, 1
s_add_u32 s39, s39, s61
s_lshl_b32 s66, s39, 9
s_add_u32 s39, s37, 7
s_and_b32 s39, s39, 7
s_mul_i32 s61, s39, 7
s_and_b32 s39, s39, 1
s_add_u32 s39, s39, s61
s_lshl_b32 s67, s39, 9
s_lshr_b32 s39, s37, 3
s_lshl_b32 s62, s36, 2
s_add_u32 s62, s62, s39
s_lshl_b32 s62, s62, 2
s_add_u32 s62, s62, s3
s_lshl_b32 s62, s62, 7
s_add_u32 s62, s62, 63512576
s_lshl_b32 s98, s36, 2
s_add_u32 s98, s98, s3
s_lshl_b32 s98, s98, 7
s_add_u32 s98, s98, 63528960
v_and_b32 v12, 31, v0
v_lshlrev_b32 v12, 2, v12
v_add_u32 v13, s62, v12
v_accvgpr_write_b32 a252, v13
v_add_u32 v13, s98, v12
v_accvgpr_write_b32 a247, v13
s_and_b32 s39, s37, 7
s_lshl_b32 s54, 1, s39
s_xor_b32 s54, s54, 0xff
s_lshl_b32 s39, s39, 2
s_add_u32 s62, s62, s39
s_lshl_b32 s39, s37, 2
s_add_u32 s98, s98, s39
s_lshl_b32 s95, s36, 5
s_add_u32 s95, s95, s37
s_lshl_b32 s95, s95, 2
s_add_u32 s95, s95, s3
s_lshl_b32 s95, s95, 12
s_add_u32 s95, s95, 58720256
v_lshrrev_b32 v16, 2, v0
v_lshrrev_b32 v17, 1, v16
v_and_b32 v17, 3, v17
v_lshlrev_b32 v16, 7, v16
v_and_b32 v18, 3, v0
v_lshl_add_u32 v16, v18, 3, v16
v_xor_b32 v18, 0, v17
v_lshl_add_u32 v12, v18, 5, v16
v_xor_b32 v18, 1, v17
v_lshl_add_u32 v13, v18, 5, v16
v_xor_b32 v18, 2, v17
v_lshl_add_u32 v14, v18, 5, v16
v_xor_b32 v18, 3, v17
v_lshl_add_u32 v15, v18, 5, v16
v_and_b32_e64 v16, 32, v0
v_or_b32 v16, 0x800, v16
v_lshl_add_u32 v12, v16, 5, v12
v_lshl_add_u32 v13, v16, 5, v13
v_lshl_add_u32 v14, v16, 5, v14
v_lshl_add_u32 v15, v16, 5, v15
v_accvgpr_write_b32 a248, v12
v_accvgpr_write_b32 a249, v13
v_accvgpr_write_b32 a250, v14
v_accvgpr_write_b32 a251, v15
s_lshl_b32 s56, s69, 3
s_and_b32 s61, s37, 7
s_add_u32 s56, s56, s61
s_lshl_b32 s56, s56, 2
s_lshr_b32 s39, s37, 3
s_add_u32 s56, s56, s39
s_lshl_b32 s56, s56, 10
s_add_u32 s56, s56, 4194304
ds_read_b64_tr_b16 a[64:65], v2 offset:0
ds_read_b64_tr_b16 a[66:67], v2 offset:3584
ds_read_b64_tr_b16 a[68:69], v2 offset:32
ds_read_b64_tr_b16 a[70:71], v2 offset:3616
ds_read_b64_tr_b16 a[72:73], v2 offset:64
ds_read_b64_tr_b16 a[74:75], v2 offset:3648
ds_read_b64_tr_b16 a[76:77], v2 offset:96
ds_read_b64_tr_b16 a[78:79], v2 offset:3680
ds_read_b64_tr_b16 a[80:81], v2 offset:128
ds_read_b64_tr_b16 a[82:83], v2 offset:3712
ds_read_b64_tr_b16 a[84:85], v2 offset:160
ds_read_b64_tr_b16 a[86:87], v2 offset:3744
ds_read_b64_tr_b16 a[88:89], v2 offset:192
ds_read_b64_tr_b16 a[90:91], v2 offset:3776
s_xor_b32 s38, s71, 0
s_lshl_b32 s38, s38, 11
s_add_u32 s8, s42, s38
s_addc_u32 s9, s43, 0
s_cmp_eq_u32 s3, 0
s_cbranch_scc1 L_hq4
s_mov_b64 exec, 0
s_cmp_eq_u32 s3, 1
s_cbranch_scc1 L_wc41
s_cmp_eq_u32 s3, 2
s_cbranch_scc1 L_wc42
s_branch L_wc43
L_wr4:
s_mov_b64 exec, -1
s_branch L_hd4
L_hq4:
v_and_b32 v14, 31, v0
v_lshlrev_b32 v14, 2, v14
s_mov_b32 s65, 0
L_hp4:
buffer_load_dword v15, v14, s[12:15], s57 offen sc1
s_waitcnt vmcnt(0)
v_cmp_ne_u32 vcc, s63, v15
s_add_u32 s65, s65, 1
s_cmp_ge_u32 s65, 20000
s_cbranch_scc1 L_hd4
s_cbranch_vccnz L_hp4
L_hd4:
s_barrier
buffer_load_dwordx4 a[0:3], v1, s[8:11], 0 offen offset:0 sc1
buffer_load_dwordx4 a[4:7], v1, s[8:11], s32 offen offset:0 sc1
buffer_load_dwordx4 a[8:11], v1, s[8:11], s33 offen offset:0 sc1
buffer_load_dwordx4 a[12:15], v1, s[8:11], s34 offen offset:0 sc1
buffer_load_dwordx4 a[16:19], v1, s[8:11], 0 offen offset:1024 sc1
buffer_load_dwordx4 a[20:23], v1, s[8:11], s32 offen offset:1024 sc1
buffer_load_dwordx4 a[24:27], v1, s[8:11], s33 offen offset:1024 sc1
buffer_load_dwordx4 a[28:31], v1, s[8:11], s34 offen offset:1024 sc1
s_xor_b32 s38, s71, 1
s_lshl_b32 s38, s38, 11
s_add_u32 s8, s42, s38
s_addc_u32 s9, s43, 0
buffer_load_dwordx4 a[32:35], v1, s[8:11], 0 offen offset:0 sc1
buffer_load_dwordx4 a[36:39], v1, s[8:11], s32 offen offset:0 sc1
buffer_load_dwordx4 a[40:43], v1, s[8:11], s33 offen offset:0 sc1
buffer_load_dwordx4 a[44:47], v1, s[8:11], s34 offen offset:0 sc1
s_waitcnt vmcnt(8) lgkmcnt(0)
v_mfma_f32_16x16x32_bf16 v[32:35], a[64:67], a[0:3], 0
ds_read_b64_tr_b16 a[92:93], v2 offset:7168
v_mfma_f32_16x16x32_bf16 v[36:39], a[64:67], a[4:7], 0
buffer_load_dwordx4 a[48:51], v1, s[8:11], 0 offen offset:1024 sc1
v_mfma_f32_16x16x32_bf16 v[40:43], a[64:67], a[8:11], 0
ds_read_b64_tr_b16 a[94:95], v2 offset:10752
v_mfma_f32_16x16x32_bf16 v[44:47], a[64:67], a[12:15], 0
ds_read_b64_tr_b16 a[96:97], v2 offset:7200
v_mfma_f32_16x16x32_bf16 v[60:63], a[68:71], a[12:15], 0
ds_read_b64_tr_b16 a[98:99], v2 offset:10784
v_mfma_f32_16x16x32_bf16 v[56:59], a[68:71], a[8:11], 0
v_mfma_f32_16x16x32_bf16 v[52:55], a[68:71], a[4:7], 0
buffer_load_dwordx4 a[52:55], v1, s[8:11], s32 offen offset:1024 sc1
v_mfma_f32_16x16x32_bf16 v[48:51], a[68:71], a[0:3], 0
ds_read_b64_tr_b16 a[100:101], v2 offset:7232
v_mfma_f32_16x16x32_bf16 v[64:67], a[72:75], a[0:3], 0
ds_read_b64_tr_b16 a[102:103], v2 offset:10816
v_mfma_f32_16x16x32_bf16 v[68:71], a[72:75], a[4:7], 0
ds_read_b64_tr_b16 a[104:105], v2 offset:7264
v_mfma_f32_16x16x32_bf16 v[72:75], a[72:75], a[8:11], 0
buffer_load_dwordx4 a[56:59], v1, s[8:11], s33 offen offset:1024 sc1
v_mfma_f32_16x16x32_bf16 v[76:79], a[72:75], a[12:15], 0
v_mfma_f32_16x16x32_bf16 v[92:95], a[76:79], a[12:15], 0
ds_read_b64_tr_b16 a[106:107], v2 offset:10848
v_mfma_f32_16x16x32_bf16 v[88:91], a[76:79], a[8:11], 0
ds_read_b64_tr_b16 a[108:109], v2 offset:7296
v_mfma_f32_16x16x32_bf16 v[84:87], a[76:79], a[4:7], 0
ds_read_b64_tr_b16 a[110:111], v2 offset:10880
v_mfma_f32_16x16x32_bf16 v[80:83], a[76:79], a[0:3], 0
buffer_load_dwordx4 a[60:63], v1, s[8:11], s34 offen offset:1024 sc1
v_mfma_f32_16x16x32_bf16 v[96:99], a[80:83], a[0:3], 0
ds_read_b64_tr_b16 a[112:113], v2 offset:7328
v_mfma_f32_16x16x32_bf16 v[100:103], a[80:83], a[4:7], 0
v_mfma_f32_16x16x32_bf16 v[104:107], a[80:83], a[8:11], 0
ds_read_b64_tr_b16 a[114:115], v2 offset:10912
v_mfma_f32_16x16x32_bf16 v[108:111], a[80:83], a[12:15], 0
ds_read_b64_tr_b16 a[116:117], v2 offset:7360
v_mfma_f32_16x16x32_bf16 v[124:127], a[84:87], a[12:15], 0
s_cmp_eq_u32 s88, 0
s_cbranch_scc1 L_st00
L_st00r:
v_mfma_f32_16x16x32_bf16 v[120:123], a[84:87], a[8:11], 0
ds_read_b64_tr_b16 a[118:119], v2 offset:10944
v_mfma_f32_16x16x32_bf16 v[116:119], a[84:87], a[4:7], 0
v_mfma_f32_16x16x32_bf16 v[112:115], a[84:87], a[0:3], 0
v_mfma_f32_16x16x32_bf16 v[128:131], a[88:91], a[0:3], 0
v_mfma_f32_16x16x32_bf16 v[132:135], a[88:91], a[4:7], 0
v_mfma_f32_16x16x32_bf16 v[136:139], a[88:91], a[8:11], 0
v_mfma_f32_16x16x32_bf16 v[140:143], a[88:91], a[12:15], 0
s_waitcnt vmcnt(8) lgkmcnt(0)
v_mfma_f32_16x16x32_bf16 v[32:35], a[92:95], a[16:19], v[32:35]
ds_read_b64_tr_b16 a[64:65], v2 offset:14336
v_mfma_f32_16x16x32_bf16 v[36:39], a[92:95], a[20:23], v[36:39]
s_xor_b32 s38, s71, 2
s_mul_i32 s38, s38, 458752
s_add_u32 s4, s40, s38
s_addc_u32 s5, s41, 0
v_mfma_f32_16x16x32_bf16 v[40:43], a[92:95], a[24:27], v[40:43]
ds_read_b64_tr_b16 a[66:67], v2 offset:17920
v_mfma_f32_16x16x32_bf16 v[44:47], a[92:95], a[28:31], v[44:47]
ds_read_b64_tr_b16 a[68:69], v2 offset:14368
v_mfma_f32_16x16x32_bf16 v[60:63], a[96:99], a[28:31], v[60:63]
ds_read_b64_tr_b16 a[70:71], v2 offset:17952
v_mfma_f32_16x16x32_bf16 v[56:59], a[96:99], a[24:27], v[56:59]
s_add_u32 m0, s35, 0
s_nop 0
buffer_load_dwordx4 v4, s[4:7], 0 offen offset:0 lds
v_mfma_f32_16x16x32_bf16 v[52:55], a[96:99], a[20:23], v[52:55]
ds_read_b64_tr_b16 a[72:73], v2 offset:14400
v_mfma_f32_16x16x32_bf16 v[48:51], a[96:99], a[16:19], v[48:51]
v_mfma_f32_16x16x32_bf16 v[64:67], a[100:103], a[16:19], v[64:67]
ds_read_b64_tr_b16 a[74:75], v2 offset:17984
v_mfma_f32_16x16x32_bf16 v[68:71], a[100:103], a[20:23], v[68:71]
buffer_load_dwordx4 v5, s[4:7], 0 offen offset:1024 lds
v_mfma_f32_16x16x32_bf16 v[72:75], a[100:103], a[24:27], v[72:75]
ds_read_b64_tr_b16 a[76:77], v2 offset:14432
v_mfma_f32_16x16x32_bf16 v[76:79], a[100:103], a[28:31], v[76:79]
ds_read_b64_tr_b16 a[78:79], v2 offset:18016
v_mfma_f32_16x16x32_bf16 v[92:95], a[104:107], a[28:31], v[92:95]
buffer_load_dwordx4 v6, s[4:7], 0 offen offset:2048 lds
v_mfma_f32_16x16x32_bf16 v[88:91], a[104:107], a[24:27], v[88:91]
ds_read_b64_tr_b16 a[80:81], v2 offset:14464
v_mfma_f32_16x16x32_bf16 v[84:87], a[104:107], a[20:23], v[84:87]
ds_read_b64_tr_b16 a[82:83], v2 offset:18048
v_mfma_f32_16x16x32_bf16 v[80:83], a[104:107], a[16:19], v[80:83]
v_mfma_f32_16x16x32_bf16 v[96:99], a[108:111], a[16:19], v[96:99]
ds_read_b64_tr_b16 a[84:85], v2 offset:14496
v_mfma_f32_16x16x32_bf16 v[100:103], a[108:111], a[20:23], v[100:103]
buffer_load_dwordx4 v7, s[4:7], 0 offen offset:3072 lds
v_mfma_f32_16x16x32_bf16 v[104:107], a[108:111], a[24:27], v[104:107]
ds_read_b64_tr_b16 a[86:87], v2 offset:18080
v_mfma_f32_16x16x32_bf16 v[108:111], a[108:111], a[28:31], v[108:111]
ds_read_b64_tr_b16 a[88:89], v2 offset:14528
v_mfma_f32_16x16x32_bf16 v[124:127], a[112:115], a[28:31], v[124:127]
s_cmp_eq_u32 s89, 0
s_cbranch_scc1 L_st01
L_st01r:
v_mfma_f32_16x16x32_bf16 v[120:123], a[112:115], a[24:27], v[120:123]
ds_read_b64_tr_b16 a[90:91], v2 offset:18112
v_mfma_f32_16x16x32_bf16 v[116:119], a[112:115], a[20:23], v[116:119]
v_mfma_f32_16x16x32_bf16 v[112:115], a[112:115], a[16:19], v[112:115]
v_mfma_f32_16x16x32_bf16 v[128:131], a[116:119], a[16:19], v[128:131]
v_mfma_f32_16x16x32_bf16 v[132:135], a[116:119], a[20:23], v[132:135]
v_mfma_f32_16x16x32_bf16 v[136:139], a[116:119], a[24:27], v[136:139]
v_mfma_f32_16x16x32_bf16 v[140:143], a[116:119], a[28:31], v[140:143]
v_min_u32 v11, 37, v0
v_lshlrev_b32 v11, 7, v11
v_add_u32 v11, 1376256, v11
buffer_load_dwordx2 a[254:255], v11, s[24:27], 0 offen offset:60
s_waitcnt lgkmcnt(0)
v_mfma_f32_16x16x32_bf16 v[144:147], a[64:67], a[0:3], 0
ds_read_b64_tr_b16 a[92:93], v2 offset:21504
v_mfma_f32_16x16x32_bf16 v[148:151], a[64:67], a[4:7], 0
s_xor_b32 s38, s71, 2
s_lshl_b32 s38, s38, 11
s_add_u32 s8, s42, s38
s_addc_u32 s9, s43, 0
v_mfma_f32_16x16x32_bf16 v[152:155], a[64:67], a[8:11], 0
ds_read_b64_tr_b16 a[94:95], v2 offset:25088
v_mfma_f32_16x16x32_bf16 v[156:159], a[64:67], a[12:15], 0
ds_read_b64_tr_b16 a[96:97], v2 offset:21536
v_mfma_f32_16x16x32_bf16 v[172:175], a[68:71], a[12:15], 0
ds_read_b64_tr_b16 a[98:99], v2 offset:25120
v_mfma_f32_16x16x32_bf16 v[168:171], a[68:71], a[8:11], 0
buffer_load_dwordx4 a[184:187], v1, s[8:11], 0 offen offset:0 sc1
v_mfma_f32_16x16x32_bf16 v[164:167], a[68:71], a[4:7], 0
ds_read_b64_tr_b16 a[100:101], v2 offset:21568
v_mfma_f32_16x16x32_bf16 v[160:163], a[68:71], a[0:3], 0
v_mfma_f32_16x16x32_bf16 v[176:179], a[72:75], a[0:3], 0
ds_read_b64_tr_b16 a[102:103], v2 offset:25152
v_mfma_f32_16x16x32_bf16 v[180:183], a[72:75], a[4:7], 0
buffer_load_dwordx4 a[188:191], v1, s[8:11], s32 offen offset:0 sc1
v_mfma_f32_16x16x32_bf16 v[184:187], a[72:75], a[8:11], 0
ds_read_b64_tr_b16 a[104:105], v2 offset:21600
v_mfma_f32_16x16x32_bf16 v[188:191], a[72:75], a[12:15], 0
ds_read_b64_tr_b16 a[106:107], v2 offset:25184
v_mfma_f32_16x16x32_bf16 v[204:207], a[76:79], a[12:15], 0
buffer_load_dwordx4 a[192:195], v1, s[8:11], s33 offen offset:0 sc1
v_mfma_f32_16x16x32_bf16 v[200:203], a[76:79], a[8:11], 0
ds_read_b64_tr_b16 a[108:109], v2 offset:21632
v_mfma_f32_16x16x32_bf16 v[196:199], a[76:79], a[4:7], 0
ds_read_b64_tr_b16 a[110:111], v2 offset:25216
v_mfma_f32_16x16x32_bf16 v[192:195], a[76:79], a[0:3], 0
v_mfma_f32_16x16x32_bf16 v[208:211], a[80:83], a[0:3], 0
ds_read_b64_tr_b16 a[112:113], v2 offset:21664
v_mfma_f32_16x16x32_bf16 v[212:215], a[80:83], a[4:7], 0
buffer_load_dwordx4 a[196:199], v1, s[8:11], s34 offen offset:0 sc1
v_mfma_f32_16x16x32_bf16 v[216:219], a[80:83], a[8:11], 0
ds_read_b64_tr_b16 a[114:115], v2 offset:25248
v_mfma_f32_16x16x32_bf16 v[220:223], a[80:83], a[12:15], 0
ds_read_b64_tr_b16 a[116:117], v2 offset:21696
v_mfma_f32_16x16x32_bf16 v[236:239], a[84:87], a[12:15], 0
s_cmp_eq_u32 s90, 0
s_cbranch_scc1 L_st02
L_st02r:
v_mfma_f32_16x16x32_bf16 v[232:235], a[84:87], a[8:11], 0
ds_read_b64_tr_b16 a[118:119], v2 offset:25280
v_mfma_f32_16x16x32_bf16 v[228:231], a[84:87], a[4:7], 0
v_mfma_f32_16x16x32_bf16 v[224:227], a[84:87], a[0:3], 0
v_mfma_f32_16x16x32_bf16 v[240:243], a[88:91], a[0:3], 0
v_mfma_f32_16x16x32_bf16 v[244:247], a[88:91], a[4:7], 0
v_mfma_f32_16x16x32_bf16 v[248:251], a[88:91], a[8:11], 0
v_mfma_f32_16x16x32_bf16 v[252:255], a[88:91], a[12:15], 0
s_waitcnt vmcnt(30) lgkmcnt(0)
s_barrier
v_mfma_f32_16x16x32_bf16 v[144:147], a[92:95], a[16:19], v[144:147]
ds_read_b64_tr_b16 a[64:65], v2 offset:32768
v_mfma_f32_16x16x32_bf16 v[148:151], a[92:95], a[20:23], v[148:151]
ds_read_b64_tr_b16 a[66:67], v2 offset:36352
v_mfma_f32_16x16x32_bf16 v[152:155], a[92:95], a[24:27], v[152:155]
s_add_u32 m0, s35, 4096
s_nop 0
buffer_load_dwordx4 v8, s[4:7], 0 offen offset:0 lds
v_mfma_f32_16x16x32_bf16 v[156:159], a[92:95], a[28:31], v[156:159]
ds_read_b64_tr_b16 a[68:69], v2 offset:39936
v_mfma_f32_16x16x32_bf16 v[172:175], a[96:99], a[28:31], v[172:175]
L_wp14:
s_cbranch_execz L_wr3
v_mfma_f32_16x16x32_bf16 v[168:171], a[96:99], a[24:27], v[168:171]
ds_read_b64_tr_b16 a[70:71], v2 offset:43520
v_mfma_f32_16x16x32_bf16 v[164:167], a[96:99], a[20:23], v[164:167]
ds_read_b64_tr_b16 a[72:73], v2 offset:32800
v_mfma_f32_16x16x32_bf16 v[160:163], a[96:99], a[16:19], v[160:163]
buffer_load_dwordx4 v9, s[4:7], 0 offen offset:1024 lds
v_mfma_f32_16x16x32_bf16 v[176:179], a[100:103], a[16:19], v[176:179]
ds_read_b64_tr_b16 a[74:75], v2 offset:36384
v_mfma_f32_16x16x32_bf16 v[180:183], a[100:103], a[20:23], v[180:183]
v_mfma_f32_16x16x32_bf16 v[184:187], a[100:103], a[24:27], v[184:187]
ds_read_b64_tr_b16 a[76:77], v2 offset:39968
v_mfma_f32_16x16x32_bf16 v[188:191], a[100:103], a[28:31], v[188:191]
ds_read_b64_tr_b16 a[78:79], v2 offset:43552
v_mfma_f32_16x16x32_bf16 v[204:207], a[104:107], a[28:31], v[204:207]
ds_read_b64_tr_b16 a[80:81], v2 offset:32832
v_mfma_f32_16x16x32_bf16 v[200:203], a[104:107], a[24:27], v[200:203]
v_mfma_f32_16x16x32_bf16 v[196:199], a[104:107], a[20:23], v[196:199]
buffer_load_dwordx4 v10, s[4:7], 0 offen offset:2048 lds
v_mfma_f32_16x16x32_bf16 v[192:195], a[104:107], a[16:19], v[192:195]
ds_read_b64_tr_b16 a[82:83], v2 offset:36416
v_mfma_f32_16x16x32_bf16 v[208:211], a[108:111], a[16:19], v[208:211]
ds_read_b64_tr_b16 a[84:85], v2 offset:40000
v_mfma_f32_16x16x32_bf16 v[212:215], a[108:111], a[20:23], v[212:215]
ds_read_b64_tr_b16 a[86:87], v2 offset:43584
v_mfma_f32_16x16x32_bf16 v[216:219], a[108:111], a[24:27], v[216:219]
v_mfma_f32_16x16x32_bf16 v[220:223], a[108:111], a[28:31], v[220:223]
s_cmp_eq_u32 s91, 0
s_cbranch_scc1 L_st03
L_st03r:
v_mfma_f32_16x16x32_bf16 v[236:239], a[112:115], a[28:31], v[236:239]
ds_read_b64_tr_b16 a[88:89], v2 offset:32864
v_mfma_f32_16x16x32_bf16 v[232:235], a[112:115], a[24:27], v[232:235]
ds_read_b64_tr_b16 a[90:91], v2 offset:36448
v_mfma_f32_16x16x32_bf16 v[228:231], a[112:115], a[20:23], v[228:231]
v_mfma_f32_16x16x32_bf16 v[224:227], a[112:115], a[16:19], v[224:227]
v_mfma_f32_16x16x32_bf16 v[240:243], a[116:119], a[16:19], v[240:243]
v_mfma_f32_16x16x32_bf16 v[244:247], a[116:119], a[20:23], v[244:247]
v_mfma_f32_16x16x32_bf16 v[248:251], a[116:119], a[24:27], v[248:251]
v_mfma_f32_16x16x32_bf16 v[252:255], a[116:119], a[28:31], v[252:255]
s_waitcnt vmcnt(12) lgkmcnt(0)
v_mfma_f32_16x16x32_bf16 v[32:35], a[64:67], a[32:35], v[32:35]
ds_read_b64_tr_b16 a[92:93], v2 offset:40032
v_mfma_f32_16x16x32_bf16 v[32:35], a[68:71], a[48:51], v[32:35]
buffer_load_dwordx4 a[200:203], v1, s[8:11], 0 offen offset:1024 sc1
v_mfma_f32_16x16x32_bf16 v[36:39], a[68:71], a[52:55], v[36:39]
ds_read_b64_tr_b16 a[94:95], v2 offset:43616
v_mfma_f32_16x16x32_bf16 v[36:39], a[64:67], a[36:39], v[36:39]
ds_read_b64_tr_b16 a[96:97], v2 offset:32896
v_mfma_f32_16x16x32_bf16 v[40:43], a[64:67], a[40:43], v[40:43]
ds_read_b64_tr_b16 a[98:99], v2 offset:36480
v_mfma_f32_16x16x32_bf16 v[40:43], a[68:71], a[56:59], v[40:43]
v_mfma_f32_16x16x32_bf16 v[44:47], a[68:71], a[60:63], v[44:47]
buffer_load_dwordx4 a[204:207], v1, s[8:11], s32 offen offset:1024 sc1
v_mfma_f32_16x16x32_bf16 v[44:47], a[64:67], a[44:47], v[44:47]
ds_read_b64_tr_b16 a[100:101], v2 offset:40064
v_mfma_f32_16x16x32_bf16 v[60:63], a[72:75], a[44:47], v[60:63]
ds_read_b64_tr_b16 a[102:103], v2 offset:43648
v_mfma_f32_16x16x32_bf16 v[60:63], a[76:79], a[60:63], v[60:63]
ds_read_b64_tr_b16 a[104:105], v2 offset:32928
v_mfma_f32_16x16x32_bf16 v[56:59], a[76:79], a[56:59], v[56:59]
buffer_load_dwordx4 a[208:211], v1, s[8:11], s33 offen offset:1024 sc1
v_mfma_f32_16x16x32_bf16 v[56:59], a[72:75], a[40:43], v[56:59]
v_mfma_f32_16x16x32_bf16 v[52:55], a[72:75], a[36:39], v[52:55]
ds_read_b64_tr_b16 a[106:107], v2 offset:36512
v_mfma_f32_16x16x32_bf16 v[52:55], a[76:79], a[52:55], v[52:55]
ds_read_b64_tr_b16 a[108:109], v2 offset:40096
v_mfma_f32_16x16x32_bf16 v[48:51], a[76:79], a[48:51], v[48:51]
ds_read_b64_tr_b16 a[110:111], v2 offset:43680
v_mfma_f32_16x16x32_bf16 v[48:51], a[72:75], a[32:35], v[48:51]
buffer_load_dwordx4 a[212:215], v1, s[8:11], s34 offen offset:1024 sc1
v_mfma_f32_16x16x32_bf16 v[64:67], a[80:83], a[32:35], v[64:67]
ds_read_b64_tr_b16 a[112:113], v2 offset:32960
v_mfma_f32_16x16x32_bf16 v[64:67], a[84:87], a[48:51], v[64:67]
v_mfma_f32_16x16x32_bf16 v[68:71], a[84:87], a[52:55], v[68:71]
ds_read_b64_tr_b16 a[114:115], v2 offset:36544
v_mfma_f32_16x16x32_bf16 v[68:71], a[80:83], a[36:39], v[68:71]
ds_read_b64_tr_b16 a[116:117], v2 offset:40128
v_mfma_f32_16x16x32_bf16 v[72:75], a[80:83], a[40:43], v[72:75]
s_cmp_eq_u32 s88, 0
s_cbranch_scc1 L_st10
L_st10r:
v_mfma_f32_16x16x32_bf16 v[72:75], a[84:87], a[56:59], v[72:75]
ds_read_b64_tr_b16 a[118:119], v2 offset:43712
v_mfma_f32_16x16x32_bf16 v[76:79], a[84:87], a[60:63], v[76:79]
v_mfma_f32_16x16x32_bf16 v[76:79], a[80:83], a[44:47], v[76:79]
v_mfma_f32_16x16x32_bf16 v[92:95], a[88:91], a[44:47], v[92:95]
v_mfma_f32_16x16x32_bf16 v[88:91], a[88:91], a[40:43], v[88:91]
v_mfma_f32_16x16x32_bf16 v[84:87], a[88:91], a[36:39], v[84:87]
v_mfma_f32_16x16x32_bf16 v[80:83], a[88:91], a[32:35], v[80:83]
s_waitcnt vmcnt(16) lgkmcnt(0)
v_mfma_f32_16x16x32_bf16 v[80:83], a[92:95], a[48:51], v[80:83]
ds_read_b64_tr_b16 a[64:65], v2 offset:47104
v_mfma_f32_16x16x32_bf16 v[84:87], a[92:95], a[52:55], v[84:87]
s_xor_b32 s38, s71, 3
s_mul_i32 s38, s38, 458752
s_add_u32 s4, s40, s38
s_addc_u32 s5, s41, 0
v_mfma_f32_16x16x32_bf16 v[88:91], a[92:95], a[56:59], v[88:91]
ds_read_b64_tr_b16 a[66:67], v2 offset:50688
v_mfma_f32_16x16x32_bf16 v[92:95], a[92:95], a[60:63], v[92:95]
ds_read_b64_tr_b16 a[68:69], v2 offset:54272
v_mfma_f32_16x16x32_bf16 v[108:111], a[100:103], a[60:63], v[108:111]
ds_read_b64_tr_b16 a[70:71], v2 offset:57856
v_mfma_f32_16x16x32_bf16 v[108:111], a[96:99], a[44:47], v[108:111]
s_add_u32 m0, s35, 32768
s_nop 0
buffer_load_dwordx4 v4, s[4:7], 0 offen offset:0 lds
v_mfma_f32_16x16x32_bf16 v[104:107], a[96:99], a[40:43], v[104:107]
ds_read_b64_tr_b16 a[72:73], v2 offset:47136
v_mfma_f32_16x16x32_bf16 v[104:107], a[100:103], a[56:59], v[104:107]
v_mfma_f32_16x16x32_bf16 v[100:103], a[100:103], a[52:55], v[100:103]
ds_read_b64_tr_b16 a[74:75], v2 offset:50720
v_mfma_f32_16x16x32_bf16 v[100:103], a[96:99], a[36:39], v[100:103]
buffer_load_dwordx4 v5, s[4:7], 0 offen offset:1024 lds
v_mfma_f32_16x16x32_bf16 v[96:99], a[96:99], a[32:35], v[96:99]
ds_read_b64_tr_b16 a[76:77], v2 offset:54304
v_mfma_f32_16x16x32_bf16 v[96:99], a[100:103], a[48:51], v[96:99]
ds_read_b64_tr_b16 a[78:79], v2 offset:57888
v_mfma_f32_16x16x32_bf16 v[112:115], a[108:111], a[48:51], v[112:115]
buffer_load_dwordx4 v6, s[4:7], 0 offen offset:2048 lds
v_mfma_f32_16x16x32_bf16 v[112:115], a[104:107], a[32:35], v[112:115]
ds_read_b64_tr_b16 a[80:81], v2 offset:47168
v_mfma_f32_16x16x32_bf16 v[116:119], a[104:107], a[36:39], v[116:119]
ds_read_b64_tr_b16 a[82:83], v2 offset:50752
v_mfma_f32_16x16x32_bf16 v[116:119], a[108:111], a[52:55], v[116:119]
v_mfma_f32_16x16x32_bf16 v[120:123], a[108:111], a[56:59], v[120:123]
ds_read_b64_tr_b16 a[84:85], v2 offset:54336
v_mfma_f32_16x16x32_bf16 v[120:123], a[104:107], a[40:43], v[120:123]
buffer_load_dwordx4 v7, s[4:7], 0 offen offset:3072 lds
v_mfma_f32_16x16x32_bf16 v[124:127], a[104:107], a[44:47], v[124:127]
ds_read_b64_tr_b16 a[86:87], v2 offset:57920
v_mfma_f32_16x16x32_bf16 v[124:127], a[108:111], a[60:63], v[124:127]
ds_read_b64_tr_b16 a[88:89], v2 offset:47200
v_mfma_f32_16x16x32_bf16 v[140:143], a[116:119], a[60:63], v[140:143]
s_cmp_eq_u32 s89, 0
s_cbranch_scc1 L_st11
L_st11r:
v_mfma_f32_16x16x32_bf16 v[140:143], a[112:115], a[44:47], v[140:143]
ds_read_b64_tr_b16 a[90:91], v2 offset:50784
v_mfma_f32_16x16x32_bf16 v[136:139], a[112:115], a[40:43], v[136:139]
v_mfma_f32_16x16x32_bf16 v[136:139], a[116:119], a[56:59], v[136:139]
v_mfma_f32_16x16x32_bf16 v[132:135], a[116:119], a[52:55], v[132:135]
v_mfma_f32_16x16x32_bf16 v[132:135], a[112:115], a[36:39], v[132:135]
v_mfma_f32_16x16x32_bf16 v[128:131], a[112:115], a[32:35], v[128:131]
v_mfma_f32_16x16x32_bf16 v[128:131], a[116:119], a[48:51], v[128:131]
v_min_u32 v11, 37, v0
v_lshlrev_b32 v11, 7, v11
v_add_u32 v11, 1835008, v11
buffer_load_dwordx2 a[254:255], v11, s[24:27], 0 offen offset:60
s_waitcnt lgkmcnt(0)
v_mfma_f32_16x16x32_bf16 v[144:147], a[64:67], a[32:35], v[144:147]
ds_read_b64_tr_b16 a[92:93], v2 offset:54368
v_mfma_f32_16x16x32_bf16 v[144:147], a[68:71], a[48:51], v[144:147]
s_xor_b32 s38, s71, 3
s_lshl_b32 s38, s38, 11
s_add_u32 s8, s42, s38
s_addc_u32 s9, s43, 0
v_mfma_f32_16x16x32_bf16 v[148:151], a[68:71], a[52:55], v[148:151]
ds_read_b64_tr_b16 a[94:95], v2 offset:57952
v_mfma_f32_16x16x32_bf16 v[148:151], a[64:67], a[36:39], v[148:151]
ds_read_b64_tr_b16 a[96:97], v2 offset:47232
v_mfma_f32_16x16x32_bf16 v[152:155], a[64:67], a[40:43], v[152:155]
ds_read_b64_tr_b16 a[98:99], v2 offset:50816
v_mfma_f32_16x16x32_bf16 v[152:155], a[68:71], a[56:59], v[152:155]
buffer_load_dwordx4 a[0:3], v1, s[8:11], 0 offen offset:0 sc1
v_mfma_f32_16x16x32_bf16 v[156:159], a[68:71], a[60:63], v[156:159]
ds_read_b64_tr_b16 a[100:101], v2 offset:54400
v_mfma_f32_16x16x32_bf16 v[156:159], a[64:67], a[44:47], v[156:159]
v_mfma_f32_16x16x32_bf16 v[172:175], a[72:75], a[44:47], v[172:175]
ds_read_b64_tr_b16 a[102:103], v2 offset:57984
v_mfma_f32_16x16x32_bf16 v[172:175], a[76:79], a[60:63], v[172:175]
buffer_load_dwordx4 a[4:7], v1, s[8:11], s32 offen offset:0 sc1
v_mfma_f32_16x16x32_bf16 v[168:171], a[76:79], a[56:59], v[168:171]
ds_read_b64_tr_b16 a[104:105], v2 offset:47264
v_mfma_f32_16x16x32_bf16 v[168:171], a[72:75], a[40:43], v[168:171]
ds_read_b64_tr_b16 a[106:107], v2 offset:50848
v_mfma_f32_16x16x32_bf16 v[164:167], a[72:75], a[36:39], v[164:167]
buffer_load_dwordx4 a[8:11], v1, s[8:11], s33 offen offset:0 sc1
v_mfma_f32_16x16x32_bf16 v[164:167], a[76:79], a[52:55], v[164:167]
ds_read_b64_tr_b16 a[108:109], v2 offset:54432
v_mfma_f32_16x16x32_bf16 v[160:163], a[76:79], a[48:51], v[160:163]
ds_read_b64_tr_b16 a[110:111], v2 offset:58016
v_mfma_f32_16x16x32_bf16 v[160:163], a[72:75], a[32:35], v[160:163]
v_mfma_f32_16x16x32_bf16 v[176:179], a[80:83], a[32:35], v[176:179]
ds_read_b64_tr_b16 a[112:113], v2 offset:47296
v_mfma_f32_16x16x32_bf16 v[176:179], a[84:87], a[48:51], v[176:179]
buffer_load_dwordx4 a[12:15], v1, s[8:11], s34 offen offset:0 sc1
v_mfma_f32_16x16x32_bf16 v[180:183], a[84:87], a[52:55], v[180:183]
ds_read_b64_tr_b16 a[114:115], v2 offset:50880
v_mfma_f32_16x16x32_bf16 v[180:183], a[80:83], a[36:39], v[180:183]
ds_read_b64_tr_b16 a[116:117], v2 offset:54464
v_mfma_f32_16x16x32_bf16 v[184:187], a[80:83], a[40:43], v[184:187]
s_cmp_eq_u32 s90, 0
s_cbranch_scc1 L_st12
L_st12r:
v_mfma_f32_16x16x32_bf16 v[184:187], a[84:87], a[56:59], v[184:187]
ds_read_b64_tr_b16 a[118:119], v2 offset:58048
v_mfma_f32_16x16x32_bf16 v[188:191], a[84:87], a[60:63], v[188:191]
v_mfma_f32_16x16x32_bf16 v[188:191], a[80:83], a[44:47], v[188:191]
v_mfma_f32_16x16x32_bf16 v[204:207], a[88:91], a[44:47], v[204:207]
v_mfma_f32_16x16x32_bf16 v[200:203], a[88:91], a[40:43], v[200:203]
v_mfma_f32_16x16x32_bf16 v[196:199], a[88:91], a[36:39], v[196:199]
v_mfma_f32_16x16x32_bf16 v[192:195], a[88:91], a[32:35], v[192:195]
s_waitcnt vmcnt(13) lgkmcnt(0)
s_barrier
v_mfma_f32_16x16x32_bf16 v[192:195], a[92:95], a[48:51], v[192:195]
ds_read_b64_tr_b16 a[64:65], v3 offset:0
v_mfma_f32_16x16x32_bf16 v[196:199], a[92:95], a[52:55], v[196:199]
ds_read_b64_tr_b16 a[66:67], v3 offset:3584
v_mfma_f32_16x16x32_bf16 v[200:203], a[92:95], a[56:59], v[200:203]
s_add_u32 m0, s35, 36864
s_nop 0
buffer_load_dwordx4 v8, s[4:7], 0 offen offset:0 lds
v_mfma_f32_16x16x32_bf16 v[204:207], a[92:95], a[60:63], v[204:207]
ds_read_b64_tr_b16 a[68:69], v3 offset:7168
v_mfma_f32_16x16x32_bf16 v[220:223], a[100:103], a[60:63], v[220:223]
v_mfma_f32_16x16x32_bf16 v[220:223], a[96:99], a[44:47], v[220:223]
ds_read_b64_tr_b16 a[70:71], v3 offset:10752
v_mfma_f32_16x16x32_bf16 v[216:219], a[96:99], a[40:43], v[216:219]
ds_read_b64_tr_b16 a[72:73], v3 offset:32
v_mfma_f32_16x16x32_bf16 v[216:219], a[100:103], a[56:59], v[216:219]
buffer_load_dwordx4 v9, s[4:7], 0 offen offset:1024 lds
v_mfma_f32_16x16x32_bf16 v[212:215], a[100:103], a[52:55], v[212:215]
ds_read_b64_tr_b16 a[74:75], v3 offset:3616
v_mfma_f32_16x16x32_bf16 v[212:215], a[96:99], a[36:39], v[212:215]
v_mfma_f32_16x16x32_bf16 v[208:211], a[96:99], a[32:35], v[208:211]
ds_read_b64_tr_b16 a[76:77], v3 offset:7200
v_mfma_f32_16x16x32_bf16 v[208:211], a[100:103], a[48:51], v[208:211]
ds_read_b64_tr_b16 a[78:79], v3 offset:10784
v_mfma_f32_16x16x32_bf16 v[224:227], a[108:111], a[48:51], v[224:227]
ds_read_b64_tr_b16 a[80:81], v3 offset:64
v_mfma_f32_16x16x32_bf16 v[224:227], a[104:107], a[32:35], v[224:227]
v_mfma_f32_16x16x32_bf16 v[228:231], a[104:107], a[36:39], v[228:231]
buffer_load_dwordx4 v10, s[4:7], 0 offen offset:2048 lds
v_mfma_f32_16x16x32_bf16 v[228:231], a[108:111], a[52:55], v[228:231]
ds_read_b64_tr_b16 a[82:83], v3 offset:3648
v_mfma_f32_16x16x32_bf16 v[232:235], a[108:111], a[56:59], v[232:235]
ds_read_b64_tr_b16 a[84:85], v3 offset:7232
v_mfma_f32_16x16x32_bf16 v[232:235], a[104:107], a[40:43], v[232:235]
ds_read_b64_tr_b16 a[86:87], v3 offset:10816
v_mfma_f32_16x16x32_bf16 v[236:239], a[104:107], a[44:47], v[236:239]
v_mfma_f32_16x16x32_bf16 v[236:239], a[108:111], a[60:63], v[236:239]
s_cmp_eq_u32 s91, 0
s_cbranch_scc1 L_st13
L_st13r:
v_mfma_f32_16x16x32_bf16 v[252:255], a[116:119], a[60:63], v[252:255]
ds_read_b64_tr_b16 a[88:89], v3 offset:96
v_mfma_f32_16x16x32_bf16 v[252:255], a[112:115], a[44:47], v[252:255]
ds_read_b64_tr_b16 a[90:91], v3 offset:3680
v_mfma_f32_16x16x32_bf16 v[248:251], a[112:115], a[40:43], v[248:251]
v_mfma_f32_16x16x32_bf16 v[248:251], a[116:119], a[56:59], v[248:251]
v_mfma_f32_16x16x32_bf16 v[244:247], a[116:119], a[52:55], v[244:247]
v_mfma_f32_16x16x32_bf16 v[244:247], a[112:115], a[36:39], v[244:247]
v_mfma_f32_16x16x32_bf16 v[240:243], a[112:115], a[32:35], v[240:243]
v_mfma_f32_16x16x32_bf16 v[240:243], a[116:119], a[48:51], v[240:243]
s_waitcnt vmcnt(12) lgkmcnt(0)
v_mfma_f32_16x16x32_bf16 v[32:35], a[64:67], a[184:187], v[32:35]
ds_read_b64_tr_b16 a[92:93], v3 offset:7264
v_mfma_f32_16x16x32_bf16 v[32:35], a[68:71], a[200:203], v[32:35]
buffer_load_dwordx4 a[16:19], v1, s[8:11], 0 offen offset:1024 sc1
v_mfma_f32_16x16x32_bf16 v[36:39], a[68:71], a[204:207], v[36:39]
ds_read_b64_tr_b16 a[94:95], v3 offset:10848
v_mfma_f32_16x16x32_bf16 v[36:39], a[64:67], a[188:191], v[36:39]
ds_read_b64_tr_b16 a[96:97], v3 offset:128
v_mfma_f32_16x16x32_bf16 v[40:43], a[64:67], a[192:195], v[40:43]
ds_read_b64_tr_b16 a[98:99], v3 offset:3712
v_mfma_f32_16x16x32_bf16 v[40:43], a[68:71], a[208:211], v[40:43]
v_mfma_f32_16x16x32_bf16 v[44:47], a[68:71], a[212:215], v[44:47]
buffer_load_dwordx4 a[20:23], v1, s[8:11], s32 offen offset:1024 sc1
v_mfma_f32_16x16x32_bf16 v[44:47], a[64:67], a[196:199], v[44:47]
ds_read_b64_tr_b16 a[100:101], v3 offset:7296
v_mfma_f32_16x16x32_bf16 v[60:63], a[72:75], a[196:199], v[60:63]
ds_read_b64_tr_b16 a[102:103], v3 offset:10880
v_mfma_f32_16x16x32_bf16 v[60:63], a[76:79], a[212:215], v[60:63]
ds_read_b64_tr_b16 a[104:105], v3 offset:160
v_mfma_f32_16x16x32_bf16 v[56:59], a[76:79], a[208:211], v[56:59]
buffer_load_dwordx4 a[24:27], v1, s[8:11], s33 offen offset:1024 sc1
v_mfma_f32_16x16x32_bf16 v[56:59], a[72:75], a[192:195], v[56:59]
v_mfma_f32_16x16x32_bf16 v[52:55], a[72:75], a[188:191], v[52:55]
ds_read_b64_tr_b16 a[106:107], v3 offset:3744
v_mfma_f32_16x16x32_bf16 v[52:55], a[76:79], a[204:207], v[52:55]
ds_read_b64_tr_b16 a[108:109], v3 offset:7328
v_mfma_f32_16x16x32_bf16 v[48:51], a[76:79], a[200:203], v[48:51]
ds_read_b64_tr_b16 a[110:111], v3 offset:10912
v_mfma_f32_16x16x32_bf16 v[48:51], a[72:75], a[184:187], v[48:51]
buffer_load_dwordx4 a[28:31], v1, s[8:11], s34 offen offset:1024 sc1
v_mfma_f32_16x16x32_bf16 v[64:67], a[80:83], a[184:187], v[64:67]
ds_read_b64_tr_b16 a[112:113], v3 offset:192
v_mfma_f32_16x16x32_bf16 v[64:67], a[84:87], a[200:203], v[64:67]
v_mfma_f32_16x16x32_bf16 v[68:71], a[84:87], a[204:207], v[68:71]
ds_read_b64_tr_b16 a[114:115], v3 offset:3776
v_mfma_f32_16x16x32_bf16 v[68:71], a[80:83], a[188:191], v[68:71]
ds_read_b64_tr_b16 a[116:117], v3 offset:7360
v_mfma_f32_16x16x32_bf16 v[72:75], a[80:83], a[192:195], v[72:75]
s_cmp_eq_u32 s88, 1
s_cbranch_scc1 L_st20
L_st20r:
v_mfma_f32_16x16x32_bf16 v[72:75], a[84:87], a[208:211], v[72:75]
ds_read_b64_tr_b16 a[118:119], v3 offset:10944
v_mfma_f32_16x16x32_bf16 v[76:79], a[84:87], a[212:215], v[76:79]
v_mfma_f32_16x16x32_bf16 v[76:79], a[80:83], a[196:199], v[76:79]
v_mfma_f32_16x16x32_bf16 v[92:95], a[88:91], a[196:199], v[92:95]
v_mfma_f32_16x16x32_bf16 v[88:91], a[88:91], a[192:195], v[88:91]
v_mfma_f32_16x16x32_bf16 v[84:87], a[88:91], a[188:191], v[84:87]
v_mfma_f32_16x16x32_bf16 v[80:83], a[88:91], a[184:187], v[80:83]
s_waitcnt vmcnt(16) lgkmcnt(0)
v_mfma_f32_16x16x32_bf16 v[80:83], a[92:95], a[200:203], v[80:83]
ds_read_b64_tr_b16 a[64:65], v3 offset:14336
v_mfma_f32_16x16x32_bf16 v[84:87], a[92:95], a[204:207], v[84:87]
s_xor_b32 s38, s71, 4
s_mul_i32 s38, s38, 458752
s_add_u32 s4, s40, s38
s_addc_u32 s5, s41, 0
v_mfma_f32_16x16x32_bf16 v[88:91], a[92:95], a[208:211], v[88:91]
ds_read_b64_tr_b16 a[66:67], v3 offset:17920
v_mfma_f32_16x16x32_bf16 v[92:95], a[92:95], a[212:215], v[92:95]
ds_read_b64_tr_b16 a[68:69], v3 offset:21504
v_mfma_f32_16x16x32_bf16 v[108:111], a[100:103], a[212:215], v[108:111]
ds_read_b64_tr_b16 a[70:71], v3 offset:25088
v_mfma_f32_16x16x32_bf16 v[108:111], a[96:99], a[196:199], v[108:111]
s_add_u32 m0, s35, 65536
s_nop 0
buffer_load_dwordx4 v4, s[4:7], 0 offen offset:0 lds
v_mfma_f32_16x16x32_bf16 v[104:107], a[96:99], a[192:195], v[104:107]
ds_read_b64_tr_b16 a[72:73], v3 offset:14368
v_mfma_f32_16x16x32_bf16 v[104:107], a[100:103], a[208:211], v[104:107]
v_mfma_f32_16x16x32_bf16 v[100:103], a[100:103], a[204:207], v[100:103]
ds_read_b64_tr_b16 a[74:75], v3 offset:17952
v_mfma_f32_16x16x32_bf16 v[100:103], a[96:99], a[188:191], v[100:103]
buffer_load_dwordx4 v5, s[4:7], 0 offen offset:1024 lds
v_mfma_f32_16x16x32_bf16 v[96:99], a[96:99], a[184:187], v[96:99]
ds_read_b64_tr_b16 a[76:77], v3 offset:21536
v_mfma_f32_16x16x32_bf16 v[96:99], a[100:103], a[200:203], v[96:99]
ds_read_b64_tr_b16 a[78:79], v3 offset:25120
v_mfma_f32_16x16x32_bf16 v[112:115], a[108:111], a[200:203], v[112:115]
buffer_load_dwordx4 v6, s[4:7], 0 offen offset:2048 lds
v_mfma_f32_16x16x32_bf16 v[112:115], a[104:107], a[184:187], v[112:115]
ds_read_b64_tr_b16 a[80:81], v3 offset:14400
v_mfma_f32_16x16x32_bf16 v[116:119], a[104:107], a[188:191], v[116:119]
ds_read_b64_tr_b16 a[82:83], v3 offset:17984
v_mfma_f32_16x16x32_bf16 v[116:119], a[108:111], a[204:207], v[116:119]
v_mfma_f32_16x16x32_bf16 v[120:123], a[108:111], a[208:211], v[120:123]
ds_read_b64_tr_b16 a[84:85], v3 offset:21568
v_mfma_f32_16x16x32_bf16 v[120:123], a[104:107], a[192:195], v[120:123]
buffer_load_dwordx4 v7, s[4:7], 0 offen offset:3072 lds
v_mfma_f32_16x16x32_bf16 v[124:127], a[104:107], a[196:199], v[124:127]
ds_read_b64_tr_b16 a[86:87], v3 offset:25152
v_mfma_f32_16x16x32_bf16 v[124:127], a[108:111], a[212:215], v[124:127]
ds_read_b64_tr_b16 a[88:89], v3 offset:14432
v_mfma_f32_16x16x32_bf16 v[140:143], a[116:119], a[212:215], v[140:143]
s_cmp_eq_u32 s89, 1
s_cbranch_scc1 L_st21
L_st21r:
v_mfma_f32_16x16x32_bf16 v[140:143], a[112:115], a[196:199], v[140:143]
ds_read_b64_tr_b16 a[90:91], v3 offset:18016
v_mfma_f32_16x16x32_bf16 v[136:139], a[112:115], a[192:195], v[136:139]
v_mfma_f32_16x16x32_bf16 v[136:139], a[116:119], a[208:211], v[136:139]
v_mfma_f32_16x16x32_bf16 v[132:135], a[116:119], a[204:207], v[132:135]
v_mfma_f32_16x16x32_bf16 v[132:135], a[112:115], a[188:191], v[132:135]
v_mfma_f32_16x16x32_bf16 v[128:131], a[112:115], a[184:187], v[128:131]
v_mfma_f32_16x16x32_bf16 v[128:131], a[116:119], a[200:203], v[128:131]
v_min_u32 v11, 37, v0
v_lshlrev_b32 v11, 7, v11
v_add_u32 v11, 2293760, v11
buffer_load_dwordx2 a[254:255], v11, s[24:27], 0 offen offset:60
s_waitcnt lgkmcnt(0)
v_mfma_f32_16x16x32_bf16 v[144:147], a[64:67], a[184:187], v[144:147]
ds_read_b64_tr_b16 a[92:93], v3 offset:21600
v_mfma_f32_16x16x32_bf16 v[144:147], a[68:71], a[200:203], v[144:147]
s_xor_b32 s38, s71, 4
s_lshl_b32 s38, s38, 11
s_add_u32 s8, s42, s38
s_addc_u32 s9, s43, 0
v_mfma_f32_16x16x32_bf16 v[148:151], a[68:71], a[204:207], v[148:151]
ds_read_b64_tr_b16 a[94:95], v3 offset:25184
v_mfma_f32_16x16x32_bf16 v[148:151], a[64:67], a[188:191], v[148:151]
ds_read_b64_tr_b16 a[96:97], v3 offset:14464
v_mfma_f32_16x16x32_bf16 v[152:155], a[64:67], a[192:195], v[152:155]
ds_read_b64_tr_b16 a[98:99], v3 offset:18048
v_mfma_f32_16x16x32_bf16 v[152:155], a[68:71], a[208:211], v[152:155]
buffer_load_dwordx4 a[32:35], v1, s[8:11], 0 offen offset:0 sc1
v_mfma_f32_16x16x32_bf16 v[156:159], a[68:71], a[212:215], v[156:159]
ds_read_b64_tr_b16 a[100:101], v3 offset:21632
v_mfma_f32_16x16x32_bf16 v[156:159], a[64:67], a[196:199], v[156:159]
v_mfma_f32_16x16x32_bf16 v[172:175], a[72:75], a[196:199], v[172:175]
ds_read_b64_tr_b16 a[102:103], v3 offset:25216
v_mfma_f32_16x16x32_bf16 v[172:175], a[76:79], a[212:215], v[172:175]
buffer_load_dwordx4 a[36:39], v1, s[8:11], s32 offen offset:0 sc1
v_mfma_f32_16x16x32_bf16 v[168:171], a[76:79], a[208:211], v[168:171]
ds_read_b64_tr_b16 a[104:105], v3 offset:14496
v_mfma_f32_16x16x32_bf16 v[168:171], a[72:75], a[192:195], v[168:171]
ds_read_b64_tr_b16 a[106:107], v3 offset:18080
v_mfma_f32_16x16x32_bf16 v[164:167], a[72:75], a[188:191], v[164:167]
buffer_load_dwordx4 a[40:43], v1, s[8:11], s33 offen offset:0 sc1
v_mfma_f32_16x16x32_bf16 v[164:167], a[76:79], a[204:207], v[164:167]
ds_read_b64_tr_b16 a[108:109], v3 offset:21664
v_mfma_f32_16x16x32_bf16 v[160:163], a[76:79], a[200:203], v[160:163]
ds_read_b64_tr_b16 a[110:111], v3 offset:25248
v_mfma_f32_16x16x32_bf16 v[160:163], a[72:75], a[184:187], v[160:163]
v_mfma_f32_16x16x32_bf16 v[176:179], a[80:83], a[184:187], v[176:179]
ds_read_b64_tr_b16 a[112:113], v3 offset:14528
v_mfma_f32_16x16x32_bf16 v[176:179], a[84:87], a[200:203], v[176:179]
buffer_load_dwordx4 a[44:47], v1, s[8:11], s34 offen offset:0 sc1
v_mfma_f32_16x16x32_bf16 v[180:183], a[84:87], a[204:207], v[180:183]
ds_read_b64_tr_b16 a[114:115], v3 offset:18112
v_mfma_f32_16x16x32_bf16 v[180:183], a[80:83], a[188:191], v[180:183]
ds_read_b64_tr_b16 a[116:117], v3 offset:21696
v_mfma_f32_16x16x32_bf16 v[184:187], a[80:83], a[192:195], v[184:187]
s_cmp_eq_u32 s90, 1
s_cbranch_scc1 L_st22
L_st22r:
v_mfma_f32_16x16x32_bf16 v[184:187], a[84:87], a[208:211], v[184:187]
ds_read_b64_tr_b16 a[118:119], v3 offset:25280
v_mfma_f32_16x16x32_bf16 v[188:191], a[84:87], a[212:215], v[188:191]
v_mfma_f32_16x16x32_bf16 v[188:191], a[80:83], a[196:199], v[188:191]
v_mfma_f32_16x16x32_bf16 v[204:207], a[88:91], a[196:199], v[204:207]
v_mfma_f32_16x16x32_bf16 v[200:203], a[88:91], a[192:195], v[200:203]
v_mfma_f32_16x16x32_bf16 v[196:199], a[88:91], a[188:191], v[196:199]
v_mfma_f32_16x16x32_bf16 v[192:195], a[88:91], a[184:187], v[192:195]
s_waitcnt vmcnt(13) lgkmcnt(0)
s_barrier
v_mfma_f32_16x16x32_bf16 v[192:195], a[92:95], a[200:203], v[192:195]
ds_read_b64_tr_b16 a[64:65], v3 offset:32768
v_mfma_f32_16x16x32_bf16 v[196:199], a[92:95], a[204:207], v[196:199]
ds_read_b64_tr_b16 a[66:67], v3 offset:36352
v_mfma_f32_16x16x32_bf16 v[200:203], a[92:95], a[208:211], v[200:203]
s_add_u32 m0, s35, 69632
s_nop 0
buffer_load_dwordx4 v8, s[4:7], 0 offen offset:0 lds
v_mfma_f32_16x16x32_bf16 v[204:207], a[92:95], a[212:215], v[204:207]
ds_read_b64_tr_b16 a[68:69], v3 offset:39936
v_mfma_f32_16x16x32_bf16 v[220:223], a[100:103], a[212:215], v[220:223]
v_mfma_f32_16x16x32_bf16 v[220:223], a[96:99], a[196:199], v[220:223]
ds_read_b64_tr_b16 a[70:71], v3 offset:43520
v_mfma_f32_16x16x32_bf16 v[216:219], a[96:99], a[192:195], v[216:219]
ds_read_b64_tr_b16 a[72:73], v3 offset:32800
v_mfma_f32_16x16x32_bf16 v[216:219], a[100:103], a[208:211], v[216:219]
buffer_load_dwordx4 v9, s[4:7], 0 offen offset:1024 lds
v_mfma_f32_16x16x32_bf16 v[212:215], a[100:103], a[204:207], v[212:215]
ds_read_b64_tr_b16 a[74:75], v3 offset:36384
v_mfma_f32_16x16x32_bf16 v[212:215], a[96:99], a[188:191], v[212:215]
v_mfma_f32_16x16x32_bf16 v[208:211], a[96:99], a[184:187], v[208:211]
ds_read_b64_tr_b16 a[76:77], v3 offset:39968
v_mfma_f32_16x16x32_bf16 v[208:211], a[100:103], a[200:203], v[208:211]
ds_read_b64_tr_b16 a[78:79], v3 offset:43552
v_mfma_f32_16x16x32_bf16 v[224:227], a[108:111], a[200:203], v[224:227]
ds_read_b64_tr_b16 a[80:81], v3 offset:32832
v_mfma_f32_16x16x32_bf16 v[224:227], a[104:107], a[184:187], v[224:227]
v_mfma_f32_16x16x32_bf16 v[228:231], a[104:107], a[188:191], v[228:231]
buffer_load_dwordx4 v10, s[4:7], 0 offen offset:2048 lds
v_mfma_f32_16x16x32_bf16 v[228:231], a[108:111], a[204:207], v[228:231]
ds_read_b64_tr_b16 a[82:83], v3 offset:36416
v_mfma_f32_16x16x32_bf16 v[232:235], a[108:111], a[208:211], v[232:235]
ds_read_b64_tr_b16 a[84:85], v3 offset:40000
v_mfma_f32_16x16x32_bf16 v[232:235], a[104:107], a[192:195], v[232:235]
ds_read_b64_tr_b16 a[86:87], v3 offset:43584
v_mfma_f32_16x16x32_bf16 v[236:239], a[104:107], a[196:199], v[236:239]
v_mfma_f32_16x16x32_bf16 v[236:239], a[108:111], a[212:215], v[236:239]
s_cmp_eq_u32 s91, 1
s_cbranch_scc1 L_st23
L_st23r:
v_mfma_f32_16x16x32_bf16 v[252:255], a[116:119], a[212:215], v[252:255]
ds_read_b64_tr_b16 a[88:89], v3 offset:32864
v_mfma_f32_16x16x32_bf16 v[252:255], a[112:115], a[196:199], v[252:255]
ds_read_b64_tr_b16 a[90:91], v3 offset:36448
v_mfma_f32_16x16x32_bf16 v[248:251], a[112:115], a[192:195], v[248:251]
v_mfma_f32_16x16x32_bf16 v[248:251], a[116:119], a[208:211], v[248:251]
v_mfma_f32_16x16x32_bf16 v[244:247], a[116:119], a[204:207], v[244:247]
v_mfma_f32_16x16x32_bf16 v[244:247], a[112:115], a[188:191], v[244:247]
v_mfma_f32_16x16x32_bf16 v[240:243], a[112:115], a[184:187], v[240:243]
v_mfma_f32_16x16x32_bf16 v[240:243], a[116:119], a[200:203], v[240:243]
s_waitcnt vmcnt(12) lgkmcnt(0)
v_mfma_f32_16x16x32_bf16 v[32:35], a[64:67], a[0:3], v[32:35]
ds_read_b64_tr_b16 a[92:93], v3 offset:40032
v_mfma_f32_16x16x32_bf16 v[32:35], a[68:71], a[16:19], v[32:35]
buffer_load_dwordx4 a[48:51], v1, s[8:11], 0 offen offset:1024 sc1
v_mfma_f32_16x16x32_bf16 v[36:39], a[68:71], a[20:23], v[36:39]
ds_read_b64_tr_b16 a[94:95], v3 offset:43616
v_mfma_f32_16x16x32_bf16 v[36:39], a[64:67], a[4:7], v[36:39]
ds_read_b64_tr_b16 a[96:97], v3 offset:32896
v_mfma_f32_16x16x32_bf16 v[40:43], a[64:67], a[8:11], v[40:43]
ds_read_b64_tr_b16 a[98:99], v3 offset:36480
v_mfma_f32_16x16x32_bf16 v[40:43], a[68:71], a[24:27], v[40:43]
v_mfma_f32_16x16x32_bf16 v[44:47], a[68:71], a[28:31], v[44:47]
buffer_load_dwordx4 a[52:55], v1, s[8:11], s32 offen offset:1024 sc1
v_mfma_f32_16x16x32_bf16 v[44:47], a[64:67], a[12:15], v[44:47]
ds_read_b64_tr_b16 a[100:101], v3 offset:40064
v_mfma_f32_16x16x32_bf16 v[60:63], a[72:75], a[12:15], v[60:63]
ds_read_b64_tr_b16 a[102:103], v3 offset:43648
v_mfma_f32_16x16x32_bf16 v[60:63], a[76:79], a[28:31], v[60:63]
ds_read_b64_tr_b16 a[104:105], v3 offset:32928
v_mfma_f32_16x16x32_bf16 v[56:59], a[76:79], a[24:27], v[56:59]
buffer_load_dwordx4 a[56:59], v1, s[8:11], s33 offen offset:1024 sc1
v_mfma_f32_16x16x32_bf16 v[56:59], a[72:75], a[8:11], v[56:59]
v_mfma_f32_16x16x32_bf16 v[52:55], a[72:75], a[4:7], v[52:55]
ds_read_b64_tr_b16 a[106:107], v3 offset:36512
v_mfma_f32_16x16x32_bf16 v[52:55], a[76:79], a[20:23], v[52:55]
ds_read_b64_tr_b16 a[108:109], v3 offset:40096
v_mfma_f32_16x16x32_bf16 v[48:51], a[76:79], a[16:19], v[48:51]
ds_read_b64_tr_b16 a[110:111], v3 offset:43680
v_mfma_f32_16x16x32_bf16 v[48:51], a[72:75], a[0:3], v[48:51]
buffer_load_dwordx4 a[60:63], v1, s[8:11], s34 offen offset:1024 sc1
v_mfma_f32_16x16x32_bf16 v[64:67], a[80:83], a[0:3], v[64:67]
ds_read_b64_tr_b16 a[112:113], v3 offset:32960
v_mfma_f32_16x16x32_bf16 v[64:67], a[84:87], a[16:19], v[64:67]
v_mfma_f32_16x16x32_bf16 v[68:71], a[84:87], a[20:23], v[68:71]
ds_read_b64_tr_b16 a[114:115], v3 offset:36544
v_mfma_f32_16x16x32_bf16 v[68:71], a[80:83], a[4:7], v[68:71]
ds_read_b64_tr_b16 a[116:117], v3 offset:40128
v_mfma_f32_16x16x32_bf16 v[72:75], a[80:83], a[8:11], v[72:75]
s_cmp_eq_u32 s88, 1
s_cbranch_scc1 L_st30
L_st30r:
v_mfma_f32_16x16x32_bf16 v[72:75], a[84:87], a[24:27], v[72:75]
ds_read_b64_tr_b16 a[118:119], v3 offset:43712
v_mfma_f32_16x16x32_bf16 v[76:79], a[84:87], a[28:31], v[76:79]
v_mfma_f32_16x16x32_bf16 v[76:79], a[80:83], a[12:15], v[76:79]
v_mfma_f32_16x16x32_bf16 v[92:95], a[88:91], a[12:15], v[92:95]
v_mfma_f32_16x16x32_bf16 v[88:91], a[88:91], a[8:11], v[88:91]
v_mfma_f32_16x16x32_bf16 v[84:87], a[88:91], a[4:7], v[84:87]
v_mfma_f32_16x16x32_bf16 v[80:83], a[88:91], a[0:3], v[80:83]
s_waitcnt vmcnt(16) lgkmcnt(0)
v_mfma_f32_16x16x32_bf16 v[80:83], a[92:95], a[16:19], v[80:83]
ds_read_b64_tr_b16 a[64:65], v3 offset:47104
v_mfma_f32_16x16x32_bf16 v[84:87], a[92:95], a[20:23], v[84:87]
s_xor_b32 s38, s71, 5
s_mul_i32 s38, s38, 458752
s_add_u32 s4, s40, s38
s_addc_u32 s5, s41, 0
v_mfma_f32_16x16x32_bf16 v[88:91], a[92:95], a[24:27], v[88:91]
ds_read_b64_tr_b16 a[66:67], v3 offset:50688
v_mfma_f32_16x16x32_bf16 v[92:95], a[92:95], a[28:31], v[92:95]
ds_read_b64_tr_b16 a[68:69], v3 offset:54272
v_mfma_f32_16x16x32_bf16 v[108:111], a[100:103], a[28:31], v[108:111]
ds_read_b64_tr_b16 a[70:71], v3 offset:57856
v_mfma_f32_16x16x32_bf16 v[108:111], a[96:99], a[12:15], v[108:111]
s_add_u32 m0, s35, 98304
s_nop 0
buffer_load_dwordx4 v4, s[4:7], 0 offen offset:0 lds
v_mfma_f32_16x16x32_bf16 v[104:107], a[96:99], a[8:11], v[104:107]
ds_read_b64_tr_b16 a[72:73], v3 offset:47136
v_mfma_f32_16x16x32_bf16 v[104:107], a[100:103], a[24:27], v[104:107]
v_mfma_f32_16x16x32_bf16 v[100:103], a[100:103], a[20:23], v[100:103]
ds_read_b64_tr_b16 a[74:75], v3 offset:50720
v_mfma_f32_16x16x32_bf16 v[100:103], a[96:99], a[4:7], v[100:103]
buffer_load_dwordx4 v5, s[4:7], 0 offen offset:1024 lds
v_mfma_f32_16x16x32_bf16 v[96:99], a[96:99], a[0:3], v[96:99]
ds_read_b64_tr_b16 a[76:77], v3 offset:54304
v_mfma_f32_16x16x32_bf16 v[96:99], a[100:103], a[16:19], v[96:99]
ds_read_b64_tr_b16 a[78:79], v3 offset:57888
v_mfma_f32_16x16x32_bf16 v[112:115], a[108:111], a[16:19], v[112:115]
buffer_load_dwordx4 v6, s[4:7], 0 offen offset:2048 lds
v_mfma_f32_16x16x32_bf16 v[112:115], a[104:107], a[0:3], v[112:115]
ds_read_b64_tr_b16 a[80:81], v3 offset:47168
v_mfma_f32_16x16x32_bf16 v[116:119], a[104:107], a[4:7], v[116:119]
ds_read_b64_tr_b16 a[82:83], v3 offset:50752
v_mfma_f32_16x16x32_bf16 v[116:119], a[108:111], a[20:23], v[116:119]
L_wc41:
L_wp15:
s_cbranch_execz L_wp18
v_mfma_f32_16x16x32_bf16 v[120:123], a[108:111], a[24:27], v[120:123]
ds_read_b64_tr_b16 a[84:85], v3 offset:54336
v_mfma_f32_16x16x32_bf16 v[120:123], a[104:107], a[8:11], v[120:123]
buffer_load_dwordx4 v7, s[4:7], 0 offen offset:3072 lds
v_mfma_f32_16x16x32_bf16 v[124:127], a[104:107], a[12:15], v[124:127]
ds_read_b64_tr_b16 a[86:87], v3 offset:57920
v_mfma_f32_16x16x32_bf16 v[124:127], a[108:111], a[28:31], v[124:127]
ds_read_b64_tr_b16 a[88:89], v3 offset:47200
v_mfma_f32_16x16x32_bf16 v[140:143], a[116:119], a[28:31], v[140:143]
s_cmp_eq_u32 s89, 1
s_cbranch_scc1 L_st31
L_st31r:
v_mfma_f32_16x16x32_bf16 v[140:143], a[112:115], a[12:15], v[140:143]
ds_read_b64_tr_b16 a[90:91], v3 offset:50784
v_mfma_f32_16x16x32_bf16 v[136:139], a[112:115], a[8:11], v[136:139]
v_mfma_f32_16x16x32_bf16 v[136:139], a[116:119], a[24:27], v[136:139]
v_mfma_f32_16x16x32_bf16 v[132:135], a[116:119], a[20:23], v[132:135]
v_mfma_f32_16x16x32_bf16 v[132:135], a[112:115], a[4:7], v[132:135]
v_mfma_f32_16x16x32_bf16 v[128:131], a[112:115], a[0:3], v[128:131]
v_mfma_f32_16x16x32_bf16 v[128:131], a[116:119], a[16:19], v[128:131]
v_min_u32 v11, 37, v0
v_lshlrev_b32 v11, 7, v11
v_add_u32 v11, 2752512, v11
buffer_load_dwordx2 a[254:255], v11, s[24:27], 0 offen offset:60
s_waitcnt lgkmcnt(0)
v_mfma_f32_16x16x32_bf16 v[144:147], a[64:67], a[0:3], v[144:147]
ds_read_b64_tr_b16 a[92:93], v3 offset:54368
v_mfma_f32_16x16x32_bf16 v[144:147], a[68:71], a[16:19], v[144:147]
s_xor_b32 s38, s71, 5
s_lshl_b32 s38, s38, 11
s_add_u32 s8, s42, s38
s_addc_u32 s9, s43, 0
v_mfma_f32_16x16x32_bf16 v[148:151], a[68:71], a[20:23], v[148:151]
ds_read_b64_tr_b16 a[94:95], v3 offset:57952
v_mfma_f32_16x16x32_bf16 v[148:151], a[64:67], a[4:7], v[148:151]
ds_read_b64_tr_b16 a[96:97], v3 offset:47232
v_mfma_f32_16x16x32_bf16 v[152:155], a[64:67], a[8:11], v[152:155]
ds_read_b64_tr_b16 a[98:99], v3 offset:50816
v_mfma_f32_16x16x32_bf16 v[152:155], a[68:71], a[24:27], v[152:155]
buffer_load_dwordx4 a[184:187], v1, s[8:11], 0 offen offset:0 sc1
v_mfma_f32_16x16x32_bf16 v[156:159], a[68:71], a[28:31], v[156:159]
ds_read_b64_tr_b16 a[100:101], v3 offset:54400
v_mfma_f32_16x16x32_bf16 v[156:159], a[64:67], a[12:15], v[156:159]
v_mfma_f32_16x16x32_bf16 v[172:175], a[72:75], a[12:15], v[172:175]
ds_read_b64_tr_b16 a[102:103], v3 offset:57984
v_mfma_f32_16x16x32_bf16 v[172:175], a[76:79], a[28:31], v[172:175]
buffer_load_dwordx4 a[188:191], v1, s[8:11], s32 offen offset:0 sc1
v_mfma_f32_16x16x32_bf16 v[168:171], a[76:79], a[24:27], v[168:171]
ds_read_b64_tr_b16 a[104:105], v3 offset:47264
v_mfma_f32_16x16x32_bf16 v[168:171], a[72:75], a[8:11], v[168:171]
ds_read_b64_tr_b16 a[106:107], v3 offset:50848
v_mfma_f32_16x16x32_bf16 v[164:167], a[72:75], a[4:7], v[164:167]
buffer_load_dwordx4 a[192:195], v1, s[8:11], s33 offen offset:0 sc1
v_mfma_f32_16x16x32_bf16 v[164:167], a[76:79], a[20:23], v[164:167]
ds_read_b64_tr_b16 a[108:109], v3 offset:54432
v_mfma_f32_16x16x32_bf16 v[160:163], a[76:79], a[16:19], v[160:163]
ds_read_b64_tr_b16 a[110:111], v3 offset:58016
v_mfma_f32_16x16x32_bf16 v[160:163], a[72:75], a[0:3], v[160:163]
v_mfma_f32_16x16x32_bf16 v[176:179], a[80:83], a[0:3], v[176:179]
ds_read_b64_tr_b16 a[112:113], v3 offset:47296
v_mfma_f32_16x16x32_bf16 v[176:179], a[84:87], a[16:19], v[176:179]
buffer_load_dwordx4 a[196:199], v1, s[8:11], s34 offen offset:0 sc1
v_mfma_f32_16x16x32_bf16 v[180:183], a[84:87], a[20:23], v[180:183]
ds_read_b64_tr_b16 a[114:115], v3 offset:50880
v_mfma_f32_16x16x32_bf16 v[180:183], a[80:83], a[4:7], v[180:183]
ds_read_b64_tr_b16 a[116:117], v3 offset:54464
v_mfma_f32_16x16x32_bf16 v[184:187], a[80:83], a[8:11], v[184:187]
s_cmp_eq_u32 s90, 1
s_cbranch_scc1 L_st32
L_st32r:
v_mfma_f32_16x16x32_bf16 v[184:187], a[84:87], a[24:27], v[184:187]
ds_read_b64_tr_b16 a[118:119], v3 offset:58048
v_mfma_f32_16x16x32_bf16 v[188:191], a[84:87], a[28:31], v[188:191]
v_mfma_f32_16x16x32_bf16 v[188:191], a[80:83], a[12:15], v[188:191]
v_mfma_f32_16x16x32_bf16 v[204:207], a[88:91], a[12:15], v[204:207]
v_mfma_f32_16x16x32_bf16 v[200:203], a[88:91], a[8:11], v[200:203]
v_mfma_f32_16x16x32_bf16 v[196:199], a[88:91], a[4:7], v[196:199]
v_mfma_f32_16x16x32_bf16 v[192:195], a[88:91], a[0:3], v[192:195]
s_waitcnt vmcnt(13) lgkmcnt(0)
s_barrier
v_mfma_f32_16x16x32_bf16 v[192:195], a[92:95], a[16:19], v[192:195]
ds_read_b64_tr_b16 a[64:65], v2 offset:0
v_mfma_f32_16x16x32_bf16 v[196:199], a[92:95], a[20:23], v[196:199]
ds_read_b64_tr_b16 a[66:67], v2 offset:3584
v_mfma_f32_16x16x32_bf16 v[200:203], a[92:95], a[24:27], v[200:203]
s_add_u32 m0, s35, 102400
s_nop 0
buffer_load_dwordx4 v8, s[4:7], 0 offen offset:0 lds
v_mfma_f32_16x16x32_bf16 v[204:207], a[92:95], a[28:31], v[204:207]
ds_read_b64_tr_b16 a[68:69], v2 offset:7168
v_mfma_f32_16x16x32_bf16 v[220:223], a[100:103], a[28:31], v[220:223]
v_mfma_f32_16x16x32_bf16 v[220:223], a[96:99], a[12:15], v[220:223]
ds_read_b64_tr_b16 a[70:71], v2 offset:10752
v_mfma_f32_16x16x32_bf16 v[216:219], a[96:99], a[8:11], v[216:219]
ds_read_b64_tr_b16 a[72:73], v2 offset:32
v_mfma_f32_16x16x32_bf16 v[216:219], a[100:103], a[24:27], v[216:219]
buffer_load_dwordx4 v9, s[4:7], 0 offen offset:1024 lds
v_mfma_f32_16x16x32_bf16 v[212:215], a[100:103], a[20:23], v[212:215]
ds_read_b64_tr_b16 a[74:75], v2 offset:3616
v_mfma_f32_16x16x32_bf16 v[212:215], a[96:99], a[4:7], v[212:215]
v_mfma_f32_16x16x32_bf16 v[208:211], a[96:99], a[0:3], v[208:211]
ds_read_b64_tr_b16 a[76:77], v2 offset:7200
v_mfma_f32_16x16x32_bf16 v[208:211], a[100:103], a[16:19], v[208:211]
ds_read_b64_tr_b16 a[78:79], v2 offset:10784
v_mfma_f32_16x16x32_bf16 v[224:227], a[108:111], a[16:19], v[224:227]
ds_read_b64_tr_b16 a[80:81], v2 offset:64
v_mfma_f32_16x16x32_bf16 v[224:227], a[104:107], a[0:3], v[224:227]
v_mfma_f32_16x16x32_bf16 v[228:231], a[104:107], a[4:7], v[228:231]
buffer_load_dwordx4 v10, s[4:7], 0 offen offset:2048 lds
v_mfma_f32_16x16x32_bf16 v[228:231], a[108:111], a[20:23], v[228:231]
ds_read_b64_tr_b16 a[82:83], v2 offset:3648
v_mfma_f32_16x16x32_bf16 v[232:235], a[108:111], a[24:27], v[232:235]
ds_read_b64_tr_b16 a[84:85], v2 offset:7232
v_mfma_f32_16x16x32_bf16 v[232:235], a[104:107], a[8:11], v[232:235]
ds_read_b64_tr_b16 a[86:87], v2 offset:10816
v_mfma_f32_16x16x32_bf16 v[236:239], a[104:107], a[12:15], v[236:239]
v_mfma_f32_16x16x32_bf16 v[236:239], a[108:111], a[28:31], v[236:239]
s_cmp_eq_u32 s91, 1
s_cbranch_scc1 L_st33
L_st33r:
v_mfma_f32_16x16x32_bf16 v[252:255], a[116:119], a[28:31], v[252:255]
ds_read_b64_tr_b16 a[88:89], v2 offset:96
v_mfma_f32_16x16x32_bf16 v[252:255], a[112:115], a[12:15], v[252:255]
ds_read_b64_tr_b16 a[90:91], v2 offset:3680
v_mfma_f32_16x16x32_bf16 v[248:251], a[112:115], a[8:11], v[248:251]
v_mfma_f32_16x16x32_bf16 v[248:251], a[116:119], a[24:27], v[248:251]
v_mfma_f32_16x16x32_bf16 v[244:247], a[116:119], a[20:23], v[244:247]
v_mfma_f32_16x16x32_bf16 v[244:247], a[112:115], a[4:7], v[244:247]
v_mfma_f32_16x16x32_bf16 v[240:243], a[112:115], a[0:3], v[240:243]
v_mfma_f32_16x16x32_bf16 v[240:243], a[116:119], a[16:19], v[240:243]
s_waitcnt vmcnt(12) lgkmcnt(0)
v_mfma_f32_16x16x32_bf16 v[32:35], a[64:67], a[32:35], v[32:35]
ds_read_b64_tr_b16 a[92:93], v2 offset:7264
v_mfma_f32_16x16x32_bf16 v[32:35], a[68:71], a[48:51], v[32:35]
buffer_load_dwordx4 a[200:203], v1, s[8:11], 0 offen offset:1024 sc1
v_mfma_f32_16x16x32_bf16 v[36:39], a[68:71], a[52:55], v[36:39]
ds_read_b64_tr_b16 a[94:95], v2 offset:10848
v_mfma_f32_16x16x32_bf16 v[36:39], a[64:67], a[36:39], v[36:39]
ds_read_b64_tr_b16 a[96:97], v2 offset:128
v_mfma_f32_16x16x32_bf16 v[40:43], a[64:67], a[40:43], v[40:43]
ds_read_b64_tr_b16 a[98:99], v2 offset:3712
v_mfma_f32_16x16x32_bf16 v[40:43], a[68:71], a[56:59], v[40:43]
v_mfma_f32_16x16x32_bf16 v[44:47], a[68:71], a[60:63], v[44:47]
buffer_load_dwordx4 a[204:207], v1, s[8:11], s32 offen offset:1024 sc1
v_mfma_f32_16x16x32_bf16 v[44:47], a[64:67], a[44:47], v[44:47]
ds_read_b64_tr_b16 a[100:101], v2 offset:7296
v_mfma_f32_16x16x32_bf16 v[60:63], a[72:75], a[44:47], v[60:63]
ds_read_b64_tr_b16 a[102:103], v2 offset:10880
v_mfma_f32_16x16x32_bf16 v[60:63], a[76:79], a[60:63], v[60:63]
ds_read_b64_tr_b16 a[104:105], v2 offset:160
v_mfma_f32_16x16x32_bf16 v[56:59], a[76:79], a[56:59], v[56:59]
buffer_load_dwordx4 a[208:211], v1, s[8:11], s33 offen offset:1024 sc1
v_mfma_f32_16x16x32_bf16 v[56:59], a[72:75], a[40:43], v[56:59]
v_mfma_f32_16x16x32_bf16 v[52:55], a[72:75], a[36:39], v[52:55]
ds_read_b64_tr_b16 a[106:107], v2 offset:3744
v_mfma_f32_16x16x32_bf16 v[52:55], a[76:79], a[52:55], v[52:55]
ds_read_b64_tr_b16 a[108:109], v2 offset:7328
v_mfma_f32_16x16x32_bf16 v[48:51], a[76:79], a[48:51], v[48:51]
ds_read_b64_tr_b16 a[110:111], v2 offset:10912
v_mfma_f32_16x16x32_bf16 v[48:51], a[72:75], a[32:35], v[48:51]
buffer_load_dwordx4 a[212:215], v1, s[8:11], s34 offen offset:1024 sc1
v_mfma_f32_16x16x32_bf16 v[64:67], a[80:83], a[32:35], v[64:67]
ds_read_b64_tr_b16 a[112:113], v2 offset:192
v_mfma_f32_16x16x32_bf16 v[64:67], a[84:87], a[48:51], v[64:67]
v_mfma_f32_16x16x32_bf16 v[68:71], a[84:87], a[52:55], v[68:71]
ds_read_b64_tr_b16 a[114:115], v2 offset:3776
v_mfma_f32_16x16x32_bf16 v[68:71], a[80:83], a[36:39], v[68:71]
ds_read_b64_tr_b16 a[116:117], v2 offset:7360
v_mfma_f32_16x16x32_bf16 v[72:75], a[80:83], a[40:43], v[72:75]
s_cmp_eq_u32 s88, 2
s_cbranch_scc1 L_st40
L_st40r:
v_mfma_f32_16x16x32_bf16 v[72:75], a[84:87], a[56:59], v[72:75]
ds_read_b64_tr_b16 a[118:119], v2 offset:10944
v_mfma_f32_16x16x32_bf16 v[76:79], a[84:87], a[60:63], v[76:79]
v_mfma_f32_16x16x32_bf16 v[76:79], a[80:83], a[44:47], v[76:79]
v_mfma_f32_16x16x32_bf16 v[92:95], a[88:91], a[44:47], v[92:95]
v_mfma_f32_16x16x32_bf16 v[88:91], a[88:91], a[40:43], v[88:91]
v_mfma_f32_16x16x32_bf16 v[84:87], a[88:91], a[36:39], v[84:87]
v_mfma_f32_16x16x32_bf16 v[80:83], a[88:91], a[32:35], v[80:83]
s_waitcnt vmcnt(16) lgkmcnt(0)
v_mfma_f32_16x16x32_bf16 v[80:83], a[92:95], a[48:51], v[80:83]
ds_read_b64_tr_b16 a[64:65], v2 offset:14336
v_mfma_f32_16x16x32_bf16 v[84:87], a[92:95], a[52:55], v[84:87]
s_xor_b32 s38, s71, 6
s_mul_i32 s38, s38, 458752
s_add_u32 s4, s40, s38
s_addc_u32 s5, s41, 0
v_mfma_f32_16x16x32_bf16 v[88:91], a[92:95], a[56:59], v[88:91]
ds_read_b64_tr_b16 a[66:67], v2 offset:17920
v_mfma_f32_16x16x32_bf16 v[92:95], a[92:95], a[60:63], v[92:95]
ds_read_b64_tr_b16 a[68:69], v2 offset:21504
v_mfma_f32_16x16x32_bf16 v[108:111], a[100:103], a[60:63], v[108:111]
ds_read_b64_tr_b16 a[70:71], v2 offset:25088
v_mfma_f32_16x16x32_bf16 v[108:111], a[96:99], a[44:47], v[108:111]
s_add_u32 m0, s35, 0
s_nop 0
buffer_load_dwordx4 v4, s[4:7], 0 offen offset:0 lds
v_mfma_f32_16x16x32_bf16 v[104:107], a[96:99], a[40:43], v[104:107]
ds_read_b64_tr_b16 a[72:73], v2 offset:14368
v_mfma_f32_16x16x32_bf16 v[104:107], a[100:103], a[56:59], v[104:107]
v_mfma_f32_16x16x32_bf16 v[100:103], a[100:103], a[52:55], v[100:103]
ds_read_b64_tr_b16 a[74:75], v2 offset:17952
v_mfma_f32_16x16x32_bf16 v[100:103], a[96:99], a[36:39], v[100:103]
buffer_load_dwordx4 v5, s[4:7], 0 offen offset:1024 lds
v_mfma_f32_16x16x32_bf16 v[96:99], a[96:99], a[32:35], v[96:99]
ds_read_b64_tr_b16 a[76:77], v2 offset:21536
v_mfma_f32_16x16x32_bf16 v[96:99], a[100:103], a[48:51], v[96:99]
ds_read_b64_tr_b16 a[78:79], v2 offset:25120
v_mfma_f32_16x16x32_bf16 v[112:115], a[108:111], a[48:51], v[112:115]
buffer_load_dwordx4 v6, s[4:7], 0 offen offset:2048 lds
v_mfma_f32_16x16x32_bf16 v[112:115], a[104:107], a[32:35], v[112:115]
ds_read_b64_tr_b16 a[80:81], v2 offset:14400
v_mfma_f32_16x16x32_bf16 v[116:119], a[104:107], a[36:39], v[116:119]
ds_read_b64_tr_b16 a[82:83], v2 offset:17984
v_mfma_f32_16x16x32_bf16 v[116:119], a[108:111], a[52:55], v[116:119]
v_mfma_f32_16x16x32_bf16 v[120:123], a[108:111], a[56:59], v[120:123]
ds_read_b64_tr_b16 a[84:85], v2 offset:21568
v_mfma_f32_16x16x32_bf16 v[120:123], a[104:107], a[40:43], v[120:123]
buffer_load_dwordx4 v7, s[4:7], 0 offen offset:3072 lds
v_mfma_f32_16x16x32_bf16 v[124:127], a[104:107], a[44:47], v[124:127]
ds_read_b64_tr_b16 a[86:87], v2 offset:25152
v_mfma_f32_16x16x32_bf16 v[124:127], a[108:111], a[60:63], v[124:127]
ds_read_b64_tr_b16 a[88:89], v2 offset:14432
v_mfma_f32_16x16x32_bf16 v[140:143], a[116:119], a[60:63], v[140:143]
s_cmp_eq_u32 s89, 2
s_cbranch_scc1 L_st41
L_st41r:
v_mfma_f32_16x16x32_bf16 v[140:143], a[112:115], a[44:47], v[140:143]
ds_read_b64_tr_b16 a[90:91], v2 offset:18016
v_mfma_f32_16x16x32_bf16 v[136:139], a[112:115], a[40:43], v[136:139]
v_mfma_f32_16x16x32_bf16 v[136:139], a[116:119], a[56:59], v[136:139]
v_mfma_f32_16x16x32_bf16 v[132:135], a[116:119], a[52:55], v[132:135]
v_mfma_f32_16x16x32_bf16 v[132:135], a[112:115], a[36:39], v[132:135]
v_mfma_f32_16x16x32_bf16 v[128:131], a[112:115], a[32:35], v[128:131]
v_mfma_f32_16x16x32_bf16 v[128:131], a[116:119], a[48:51], v[128:131]
v_min_u32 v11, 37, v0
v_lshlrev_b32 v11, 7, v11
v_add_u32 v11, 3211264, v11
buffer_load_dwordx2 a[254:255], v11, s[24:27], 0 offen offset:60
s_waitcnt lgkmcnt(0)
v_mfma_f32_16x16x32_bf16 v[144:147], a[64:67], a[32:35], v[144:147]
ds_read_b64_tr_b16 a[92:93], v2 offset:21600
v_mfma_f32_16x16x32_bf16 v[144:147], a[68:71], a[48:51], v[144:147]
s_xor_b32 s38, s71, 6
s_lshl_b32 s38, s38, 11
s_add_u32 s8, s42, s38
s_addc_u32 s9, s43, 0
v_mfma_f32_16x16x32_bf16 v[148:151], a[68:71], a[52:55], v[148:151]
ds_read_b64_tr_b16 a[94:95], v2 offset:25184
v_mfma_f32_16x16x32_bf16 v[148:151], a[64:67], a[36:39], v[148:151]
ds_read_b64_tr_b16 a[96:97], v2 offset:14464
v_mfma_f32_16x16x32_bf16 v[152:155], a[64:67], a[40:43], v[152:155]
ds_read_b64_tr_b16 a[98:99], v2 offset:18048
v_mfma_f32_16x16x32_bf16 v[152:155], a[68:71], a[56:59], v[152:155]
buffer_load_dwordx4 a[0:3], v1, s[8:11], 0 offen offset:0 sc1
v_mfma_f32_16x16x32_bf16 v[156:159], a[68:71], a[60:63], v[156:159]
ds_read_b64_tr_b16 a[100:101], v2 offset:21632
v_mfma_f32_16x16x32_bf16 v[156:159], a[64:67], a[44:47], v[156:159]
v_mfma_f32_16x16x32_bf16 v[172:175], a[72:75], a[44:47], v[172:175]
ds_read_b64_tr_b16 a[102:103], v2 offset:25216
v_mfma_f32_16x16x32_bf16 v[172:175], a[76:79], a[60:63], v[172:175]
buffer_load_dwordx4 a[4:7], v1, s[8:11], s32 offen offset:0 sc1
v_mfma_f32_16x16x32_bf16 v[168:171], a[76:79], a[56:59], v[168:171]
ds_read_b64_tr_b16 a[104:105], v2 offset:14496
v_mfma_f32_16x16x32_bf16 v[168:171], a[72:75], a[40:43], v[168:171]
ds_read_b64_tr_b16 a[106:107], v2 offset:18080
v_mfma_f32_16x16x32_bf16 v[164:167], a[72:75], a[36:39], v[164:167]
buffer_load_dwordx4 a[8:11], v1, s[8:11], s33 offen offset:0 sc1
v_mfma_f32_16x16x32_bf16 v[164:167], a[76:79], a[52:55], v[164:167]
ds_read_b64_tr_b16 a[108:109], v2 offset:21664
v_mfma_f32_16x16x32_bf16 v[160:163], a[76:79], a[48:51], v[160:163]
ds_read_b64_tr_b16 a[110:111], v2 offset:25248
v_mfma_f32_16x16x32_bf16 v[160:163], a[72:75], a[32:35], v[160:163]
v_mfma_f32_16x16x32_bf16 v[176:179], a[80:83], a[32:35], v[176:179]
ds_read_b64_tr_b16 a[112:113], v2 offset:14528
v_mfma_f32_16x16x32_bf16 v[176:179], a[84:87], a[48:51], v[176:179]
buffer_load_dwordx4 a[12:15], v1, s[8:11], s34 offen offset:0 sc1
v_mfma_f32_16x16x32_bf16 v[180:183], a[84:87], a[52:55], v[180:183]
ds_read_b64_tr_b16 a[114:115], v2 offset:18112
v_mfma_f32_16x16x32_bf16 v[180:183], a[80:83], a[36:39], v[180:183]
ds_read_b64_tr_b16 a[116:117], v2 offset:21696
v_mfma_f32_16x16x32_bf16 v[184:187], a[80:83], a[40:43], v[184:187]
s_cmp_eq_u32 s90, 2
s_cbranch_scc1 L_st42
L_st42r:
v_mfma_f32_16x16x32_bf16 v[184:187], a[84:87], a[56:59], v[184:187]
ds_read_b64_tr_b16 a[118:119], v2 offset:25280
v_mfma_f32_16x16x32_bf16 v[188:191], a[84:87], a[60:63], v[188:191]
v_mfma_f32_16x16x32_bf16 v[188:191], a[80:83], a[44:47], v[188:191]
v_mfma_f32_16x16x32_bf16 v[204:207], a[88:91], a[44:47], v[204:207]
v_mfma_f32_16x16x32_bf16 v[200:203], a[88:91], a[40:43], v[200:203]
v_mfma_f32_16x16x32_bf16 v[196:199], a[88:91], a[36:39], v[196:199]
v_mfma_f32_16x16x32_bf16 v[192:195], a[88:91], a[32:35], v[192:195]
s_waitcnt vmcnt(13) lgkmcnt(0)
s_barrier
v_mfma_f32_16x16x32_bf16 v[192:195], a[92:95], a[48:51], v[192:195]
ds_read_b64_tr_b16 a[64:65], v2 offset:32768
v_mfma_f32_16x16x32_bf16 v[196:199], a[92:95], a[52:55], v[196:199]
ds_read_b64_tr_b16 a[66:67], v2 offset:36352
v_mfma_f32_16x16x32_bf16 v[200:203], a[92:95], a[56:59], v[200:203]
s_add_u32 m0, s35, 4096
s_nop 0
buffer_load_dwordx4 v8, s[4:7], 0 offen offset:0 lds
v_mfma_f32_16x16x32_bf16 v[204:207], a[92:95], a[60:63], v[204:207]
ds_read_b64_tr_b16 a[68:69], v2 offset:39936
v_mfma_f32_16x16x32_bf16 v[220:223], a[100:103], a[60:63], v[220:223]
v_mfma_f32_16x16x32_bf16 v[220:223], a[96:99], a[44:47], v[220:223]
ds_read_b64_tr_b16 a[70:71], v2 offset:43520
v_mfma_f32_16x16x32_bf16 v[216:219], a[96:99], a[40:43], v[216:219]
ds_read_b64_tr_b16 a[72:73], v2 offset:32800
v_mfma_f32_16x16x32_bf16 v[216:219], a[100:103], a[56:59], v[216:219]
buffer_load_dwordx4 v9, s[4:7], 0 offen offset:1024 lds
v_mfma_f32_16x16x32_bf16 v[212:215], a[100:103], a[52:55], v[212:215]
ds_read_b64_tr_b16 a[74:75], v2 offset:36384
v_mfma_f32_16x16x32_bf16 v[212:215], a[96:99], a[36:39], v[212:215]
v_mfma_f32_16x16x32_bf16 v[208:211], a[96:99], a[32:35], v[208:211]
ds_read_b64_tr_b16 a[76:77], v2 offset:39968
v_mfma_f32_16x16x32_bf16 v[208:211], a[100:103], a[48:51], v[208:211]
ds_read_b64_tr_b16 a[78:79], v2 offset:43552
v_mfma_f32_16x16x32_bf16 v[224:227], a[108:111], a[48:51], v[224:227]
ds_read_b64_tr_b16 a[80:81], v2 offset:32832
v_mfma_f32_16x16x32_bf16 v[224:227], a[104:107], a[32:35], v[224:227]
v_mfma_f32_16x16x32_bf16 v[228:231], a[104:107], a[36:39], v[228:231]
buffer_load_dwordx4 v10, s[4:7], 0 offen offset:2048 lds
v_mfma_f32_16x16x32_bf16 v[228:231], a[108:111], a[52:55], v[228:231]
ds_read_b64_tr_b16 a[82:83], v2 offset:36416
v_mfma_f32_16x16x32_bf16 v[232:235], a[108:111], a[56:59], v[232:235]
ds_read_b64_tr_b16 a[84:85], v2 offset:40000
v_mfma_f32_16x16x32_bf16 v[232:235], a[104:107], a[40:43], v[232:235]
ds_read_b64_tr_b16 a[86:87], v2 offset:43584
v_mfma_f32_16x16x32_bf16 v[236:239], a[104:107], a[44:47], v[236:239]
v_mfma_f32_16x16x32_bf16 v[236:239], a[108:111], a[60:63], v[236:239]
s_cmp_eq_u32 s91, 2
s_cbranch_scc1 L_st43
L_st43r:
v_mfma_f32_16x16x32_bf16 v[252:255], a[116:119], a[60:63], v[252:255]
ds_read_b64_tr_b16 a[88:89], v2 offset:32864
v_mfma_f32_16x16x32_bf16 v[252:255], a[112:115], a[44:47], v[252:255]
ds_read_b64_tr_b16 a[90:91], v2 offset:36448
v_mfma_f32_16x16x32_bf16 v[248:251], a[112:115], a[40:43], v[248:251]
v_mfma_f32_16x16x32_bf16 v[248:251], a[116:119], a[56:59], v[248:251]
v_mfma_f32_16x16x32_bf16 v[244:247], a[116:119], a[52:55], v[244:247]
v_mfma_f32_16x16x32_bf16 v[244:247], a[112:115], a[36:39], v[244:247]
v_mfma_f32_16x16x32_bf16 v[240:243], a[112:115], a[32:35], v[240:243]
v_mfma_f32_16x16x32_bf16 v[240:243], a[116:119], a[48:51], v[240:243]
s_waitcnt vmcnt(12) lgkmcnt(0)
v_mfma_f32_16x16x32_bf16 v[32:35], a[64:67], a[184:187], v[32:35]
ds_read_b64_tr_b16 a[92:93], v2 offset:40032
v_mfma_f32_16x16x32_bf16 v[32:35], a[68:71], a[200:203], v[32:35]
buffer_load_dwordx4 a[16:19], v1, s[8:11], 0 offen offset:1024 sc1
v_mfma_f32_16x16x32_bf16 v[36:39], a[68:71], a[204:207], v[36:39]
ds_read_b64_tr_b16 a[94:95], v2 offset:43616
v_mfma_f32_16x16x32_bf16 v[36:39], a[64:67], a[188:191], v[36:39]
ds_read_b64_tr_b16 a[96:97], v2 offset:32896
v_mfma_f32_16x16x32_bf16 v[40:43], a[64:67], a[192:195], v[40:43]
ds_read_b64_tr_b16 a[98:99], v2 offset:36480
v_mfma_f32_16x16x32_bf16 v[40:43], a[68:71], a[208:211], v[40:43]
v_mfma_f32_16x16x32_bf16 v[44:47], a[68:71], a[212:215], v[44:47]
buffer_load_dwordx4 a[20:23], v1, s[8:11], s32 offen offset:1024 sc1
v_mfma_f32_16x16x32_bf16 v[44:47], a[64:67], a[196:199], v[44:47]
ds_read_b64_tr_b16 a[100:101], v2 offset:40064
v_mfma_f32_16x16x32_bf16 v[60:63], a[72:75], a[196:199], v[60:63]
ds_read_b64_tr_b16 a[102:103], v2 offset:43648
v_mfma_f32_16x16x32_bf16 v[60:63], a[76:79], a[212:215], v[60:63]
ds_read_b64_tr_b16 a[104:105], v2 offset:32928
v_mfma_f32_16x16x32_bf16 v[56:59], a[76:79], a[208:211], v[56:59]
buffer_load_dwordx4 a[24:27], v1, s[8:11], s33 offen offset:1024 sc1
v_mfma_f32_16x16x32_bf16 v[56:59], a[72:75], a[192:195], v[56:59]
v_mfma_f32_16x16x32_bf16 v[52:55], a[72:75], a[188:191], v[52:55]
ds_read_b64_tr_b16 a[106:107], v2 offset:36512
v_mfma_f32_16x16x32_bf16 v[52:55], a[76:79], a[204:207], v[52:55]
ds_read_b64_tr_b16 a[108:109], v2 offset:40096
v_mfma_f32_16x16x32_bf16 v[48:51], a[76:79], a[200:203], v[48:51]
ds_read_b64_tr_b16 a[110:111], v2 offset:43680
v_mfma_f32_16x16x32_bf16 v[48:51], a[72:75], a[184:187], v[48:51]
buffer_load_dwordx4 a[28:31], v1, s[8:11], s34 offen offset:1024 sc1
v_mfma_f32_16x16x32_bf16 v[64:67], a[80:83], a[184:187], v[64:67]
ds_read_b64_tr_b16 a[112:113], v2 offset:32960
v_mfma_f32_16x16x32_bf16 v[64:67], a[84:87], a[200:203], v[64:67]
v_mfma_f32_16x16x32_bf16 v[68:71], a[84:87], a[204:207], v[68:71]
ds_read_b64_tr_b16 a[114:115], v2 offset:36544
v_mfma_f32_16x16x32_bf16 v[68:71], a[80:83], a[188:191], v[68:71]
ds_read_b64_tr_b16 a[116:117], v2 offset:40128
v_mfma_f32_16x16x32_bf16 v[72:75], a[80:83], a[192:195], v[72:75]
s_cmp_eq_u32 s88, 2
s_cbranch_scc1 L_st50
L_st50r:
v_mfma_f32_16x16x32_bf16 v[72:75], a[84:87], a[208:211], v[72:75]
ds_read_b64_tr_b16 a[118:119], v2 offset:43712
v_mfma_f32_16x16x32_bf16 v[76:79], a[84:87], a[212:215], v[76:79]
v_mfma_f32_16x16x32_bf16 v[76:79], a[80:83], a[196:199], v[76:79]
v_mfma_f32_16x16x32_bf16 v[92:95], a[88:91], a[196:199], v[92:95]
v_mfma_f32_16x16x32_bf16 v[88:91], a[88:91], a[192:195], v[88:91]
v_mfma_f32_16x16x32_bf16 v[84:87], a[88:91], a[188:191], v[84:87]
v_mfma_f32_16x16x32_bf16 v[80:83], a[88:91], a[184:187], v[80:83]
s_waitcnt vmcnt(16) lgkmcnt(0)
v_mfma_f32_16x16x32_bf16 v[80:83], a[92:95], a[200:203], v[80:83]
ds_read_b64_tr_b16 a[64:65], v2 offset:47104
v_mfma_f32_16x16x32_bf16 v[84:87], a[92:95], a[204:207], v[84:87]
s_xor_b32 s38, s71, 7
s_mul_i32 s38, s38, 458752
s_add_u32 s4, s40, s38
s_addc_u32 s5, s41, 0
v_mfma_f32_16x16x32_bf16 v[88:91], a[92:95], a[208:211], v[88:91]
ds_read_b64_tr_b16 a[66:67], v2 offset:50688
v_mfma_f32_16x16x32_bf16 v[92:95], a[92:95], a[212:215], v[92:95]
ds_read_b64_tr_b16 a[68:69], v2 offset:54272
v_mfma_f32_16x16x32_bf16 v[108:111], a[100:103], a[212:215], v[108:111]
ds_read_b64_tr_b16 a[70:71], v2 offset:57856
v_mfma_f32_16x16x32_bf16 v[108:111], a[96:99], a[196:199], v[108:111]
s_add_u32 m0, s35, 32768
s_nop 0
buffer_load_dwordx4 v4, s[4:7], 0 offen offset:0 lds
v_mfma_f32_16x16x32_bf16 v[104:107], a[96:99], a[192:195], v[104:107]
ds_read_b64_tr_b16 a[72:73], v2 offset:47136
v_mfma_f32_16x16x32_bf16 v[104:107], a[100:103], a[208:211], v[104:107]
v_mfma_f32_16x16x32_bf16 v[100:103], a[100:103], a[204:207], v[100:103]
ds_read_b64_tr_b16 a[74:75], v2 offset:50720
v_mfma_f32_16x16x32_bf16 v[100:103], a[96:99], a[188:191], v[100:103]
buffer_load_dwordx4 v5, s[4:7], 0 offen offset:1024 lds
v_mfma_f32_16x16x32_bf16 v[96:99], a[96:99], a[184:187], v[96:99]
ds_read_b64_tr_b16 a[76:77], v2 offset:54304
v_mfma_f32_16x16x32_bf16 v[96:99], a[100:103], a[200:203], v[96:99]
ds_read_b64_tr_b16 a[78:79], v2 offset:57888
v_mfma_f32_16x16x32_bf16 v[112:115], a[108:111], a[200:203], v[112:115]
buffer_load_dwordx4 v6, s[4:7], 0 offen offset:2048 lds
v_mfma_f32_16x16x32_bf16 v[112:115], a[104:107], a[184:187], v[112:115]
ds_read_b64_tr_b16 a[80:81], v2 offset:47168
v_mfma_f32_16x16x32_bf16 v[116:119], a[104:107], a[188:191], v[116:119]
ds_read_b64_tr_b16 a[82:83], v2 offset:50752
v_mfma_f32_16x16x32_bf16 v[116:119], a[108:111], a[204:207], v[116:119]
v_mfma_f32_16x16x32_bf16 v[120:123], a[108:111], a[208:211], v[120:123]
ds_read_b64_tr_b16 a[84:85], v2 offset:54336
v_mfma_f32_16x16x32_bf16 v[120:123], a[104:107], a[192:195], v[120:123]
buffer_load_dwordx4 v7, s[4:7], 0 offen offset:3072 lds
v_mfma_f32_16x16x32_bf16 v[124:127], a[104:107], a[196:199], v[124:127]
ds_read_b64_tr_b16 a[86:87], v2 offset:57920
v_mfma_f32_16x16x32_bf16 v[124:127], a[108:111], a[212:215], v[124:127]
ds_read_b64_tr_b16 a[88:89], v2 offset:47200
v_mfma_f32_16x16x32_bf16 v[140:143], a[116:119], a[212:215], v[140:143]
s_cmp_eq_u32 s89, 2
s_cbranch_scc1 L_st51
L_st51r:
v_mfma_f32_16x16x32_bf16 v[140:143], a[112:115], a[196:199], v[140:143]
ds_read_b64_tr_b16 a[90:91], v2 offset:50784
v_mfma_f32_16x16x32_bf16 v[136:139], a[112:115], a[192:195], v[136:139]
v_mfma_f32_16x16x32_bf16 v[136:139], a[116:119], a[208:211], v[136:139]
v_mfma_f32_16x16x32_bf16 v[132:135], a[116:119], a[204:207], v[132:135]
v_mfma_f32_16x16x32_bf16 v[132:135], a[112:115], a[188:191], v[132:135]
v_mfma_f32_16x16x32_bf16 v[128:131], a[112:115], a[184:187], v[128:131]
v_mfma_f32_16x16x32_bf16 v[128:131], a[116:119], a[200:203], v[128:131]
v_and_b32 v12, 31, v0
v_lshlrev_b32 v12, 2, v12
s_and_b32 s39, s2, 7
s_lshl_b32 s39, s39, 7
s_add_u32 s39, s39, 63533056
buffer_load_dword v18, v12, s[12:15], s39 offen sc1
s_waitcnt lgkmcnt(0)
v_mfma_f32_16x16x32_bf16 v[144:147], a[64:67], a[184:187], v[144:147]
ds_read_b64_tr_b16 a[92:93], v2 offset:54368
v_mfma_f32_16x16x32_bf16 v[144:147], a[68:71], a[200:203], v[144:147]
s_xor_b32 s38, s71, 7
s_lshl_b32 s38, s38, 11
s_add_u32 s8, s42, s38
s_addc_u32 s9, s43, 0
v_mfma_f32_16x16x32_bf16 v[148:151], a[68:71], a[204:207], v[148:151]
ds_read_b64_tr_b16 a[94:95], v2 offset:57952
v_mfma_f32_16x16x32_bf16 v[148:151], a[64:67], a[188:191], v[148:151]
ds_read_b64_tr_b16 a[96:97], v2 offset:47232
v_mfma_f32_16x16x32_bf16 v[152:155], a[64:67], a[192:195], v[152:155]
ds_read_b64_tr_b16 a[98:99], v2 offset:50816
v_mfma_f32_16x16x32_bf16 v[152:155], a[68:71], a[208:211], v[152:155]
buffer_load_dwordx4 a[32:35], v1, s[8:11], 0 offen offset:0 sc1
v_mfma_f32_16x16x32_bf16 v[156:159], a[68:71], a[212:215], v[156:159]
ds_read_b64_tr_b16 a[100:101], v2 offset:54400
v_mfma_f32_16x16x32_bf16 v[156:159], a[64:67], a[196:199], v[156:159]
v_mfma_f32_16x16x32_bf16 v[172:175], a[72:75], a[196:199], v[172:175]
ds_read_b64_tr_b16 a[102:103], v2 offset:57984
v_mfma_f32_16x16x32_bf16 v[172:175], a[76:79], a[212:215], v[172:175]
buffer_load_dwordx4 a[36:39], v1, s[8:11], s32 offen offset:0 sc1
v_mfma_f32_16x16x32_bf16 v[168:171], a[76:79], a[208:211], v[168:171]
ds_read_b64_tr_b16 a[104:105], v2 offset:47264
v_mfma_f32_16x16x32_bf16 v[168:171], a[72:75], a[192:195], v[168:171]
ds_read_b64_tr_b16 a[106:107], v2 offset:50848
v_mfma_f32_16x16x32_bf16 v[164:167], a[72:75], a[188:191], v[164:167]
buffer_load_dwordx4 a[40:43], v1, s[8:11], s33 offen offset:0 sc1
v_mfma_f32_16x16x32_bf16 v[164:167], a[76:79], a[204:207], v[164:167]
ds_read_b64_tr_b16 a[108:109], v2 offset:54432
v_mfma_f32_16x16x32_bf16 v[160:163], a[76:79], a[200:203], v[160:163]
ds_read_b64_tr_b16 a[110:111], v2 offset:58016
v_mfma_f32_16x16x32_bf16 v[160:163], a[72:75], a[184:187], v[160:163]
v_mfma_f32_16x16x32_bf16 v[176:179], a[80:83], a[184:187], v[176:179]
ds_read_b64_tr_b16 a[112:113], v2 offset:47296
v_mfma_f32_16x16x32_bf16 v[176:179], a[84:87], a[200:203], v[176:179]
buffer_load_dwordx4 a[44:47], v1, s[8:11], s34 offen offset:0 sc1
v_mfma_f32_16x16x32_bf16 v[180:183], a[84:87], a[204:207], v[180:183]
ds_read_b64_tr_b16 a[114:115], v2 offset:50880
v_mfma_f32_16x16x32_bf16 v[180:183], a[80:83], a[188:191], v[180:183]
ds_read_b64_tr_b16 a[116:117], v2 offset:54464
v_mfma_f32_16x16x32_bf16 v[184:187], a[80:83], a[192:195], v[184:187]
s_cmp_eq_u32 s90, 2
s_cbranch_scc1 L_st52
L_st52r:
v_mfma_f32_16x16x32_bf16 v[184:187], a[84:87], a[208:211], v[184:187]
ds_read_b64_tr_b16 a[118:119], v2 offset:58048
v_mfma_f32_16x16x32_bf16 v[188:191], a[84:87], a[212:215], v[188:191]
v_mfma_f32_16x16x32_bf16 v[188:191], a[80:83], a[196:199], v[188:191]
v_mfma_f32_16x16x32_bf16 v[204:207], a[88:91], a[196:199], v[204:207]
v_mfma_f32_16x16x32_bf16 v[200:203], a[88:91], a[192:195], v[200:203]
v_mfma_f32_16x16x32_bf16 v[196:199], a[88:91], a[188:191], v[196:199]
v_mfma_f32_16x16x32_bf16 v[192:195], a[88:91], a[184:187], v[192:195]
s_waitcnt vmcnt(13) lgkmcnt(0)
s_barrier
v_mfma_f32_16x16x32_bf16 v[192:195], a[92:95], a[200:203], v[192:195]
ds_read_b64_tr_b16 a[64:65], v3 offset:0
v_mfma_f32_16x16x32_bf16 v[196:199], a[92:95], a[204:207], v[196:199]
ds_read_b64_tr_b16 a[66:67], v3 offset:3584
v_mfma_f32_16x16x32_bf16 v[200:203], a[92:95], a[208:211], v[200:203]
s_add_u32 m0, s35, 36864
s_nop 0
buffer_load_dwordx4 v8, s[4:7], 0 offen offset:0 lds
v_mfma_f32_16x16x32_bf16 v[204:207], a[92:95], a[212:215], v[204:207]
ds_read_b64_tr_b16 a[68:69], v3 offset:7168
v_mfma_f32_16x16x32_bf16 v[220:223], a[100:103], a[212:215], v[220:223]
v_mfma_f32_16x16x32_bf16 v[220:223], a[96:99], a[196:199], v[220:223]
ds_read_b64_tr_b16 a[70:71], v3 offset:10752
v_mfma_f32_16x16x32_bf16 v[216:219], a[96:99], a[192:195], v[216:219]
ds_read_b64_tr_b16 a[72:73], v3 offset:32
v_mfma_f32_16x16x32_bf16 v[216:219], a[100:103], a[208:211], v[216:219]
buffer_load_dwordx4 v9, s[4:7], 0 offen offset:1024 lds
v_mfma_f32_16x16x32_bf16 v[212:215], a[100:103], a[204:207], v[212:215]
ds_read_b64_tr_b16 a[74:75], v3 offset:3616
v_mfma_f32_16x16x32_bf16 v[212:215], a[96:99], a[188:191], v[212:215]
v_mfma_f32_16x16x32_bf16 v[208:211], a[96:99], a[184:187], v[208:211]
ds_read_b64_tr_b16 a[76:77], v3 offset:7200
v_mfma_f32_16x16x32_bf16 v[208:211], a[100:103], a[200:203], v[208:211]
ds_read_b64_tr_b16 a[78:79], v3 offset:10784
v_mfma_f32_16x16x32_bf16 v[224:227], a[108:111], a[200:203], v[224:227]
ds_read_b64_tr_b16 a[80:81], v3 offset:64
v_mfma_f32_16x16x32_bf16 v[224:227], a[104:107], a[184:187], v[224:227]
v_mfma_f32_16x16x32_bf16 v[228:231], a[104:107], a[188:191], v[228:231]
buffer_load_dwordx4 v10, s[4:7], 0 offen offset:2048 lds
v_mfma_f32_16x16x32_bf16 v[228:231], a[108:111], a[204:207], v[228:231]
ds_read_b64_tr_b16 a[82:83], v3 offset:3648
v_mfma_f32_16x16x32_bf16 v[232:235], a[108:111], a[208:211], v[232:235]
ds_read_b64_tr_b16 a[84:85], v3 offset:7232
v_mfma_f32_16x16x32_bf16 v[232:235], a[104:107], a[192:195], v[232:235]
ds_read_b64_tr_b16 a[86:87], v3 offset:10816
v_mfma_f32_16x16x32_bf16 v[236:239], a[104:107], a[196:199], v[236:239]
L_wc42:
L_wp16:
s_cbranch_execz L_wp19
v_mfma_f32_16x16x32_bf16 v[236:239], a[108:111], a[212:215], v[236:239]
s_cmp_eq_u32 s91, 2
s_cbranch_scc1 L_st53
L_st53r:
v_mfma_f32_16x16x32_bf16 v[252:255], a[116:119], a[212:215], v[252:255]
ds_read_b64_tr_b16 a[88:89], v3 offset:96
v_mfma_f32_16x16x32_bf16 v[252:255], a[112:115], a[196:199], v[252:255]
ds_read_b64_tr_b16 a[90:91], v3 offset:3680
v_mfma_f32_16x16x32_bf16 v[248:251], a[112:115], a[192:195], v[248:251]
v_mfma_f32_16x16x32_bf16 v[248:251], a[116:119], a[208:211], v[248:251]
v_mfma_f32_16x16x32_bf16 v[244:247], a[116:119], a[204:207], v[244:247]
v_mfma_f32_16x16x32_bf16 v[244:247], a[112:115], a[188:191], v[244:247]
v_mfma_f32_16x16x32_bf16 v[240:243], a[112:115], a[184:187], v[240:243]
v_mfma_f32_16x16x32_bf16 v[240:243], a[116:119], a[200:203], v[240:243]
s_waitcnt vmcnt(12) lgkmcnt(0)
v_mfma_f32_16x16x32_bf16 v[32:35], a[64:67], a[0:3], v[32:35]
ds_read_b64_tr_b16 a[92:93], v3 offset:7264
v_mfma_f32_16x16x32_bf16 v[32:35], a[68:71], a[16:19], v[32:35]
buffer_load_dwordx4 a[48:51], v1, s[8:11], 0 offen offset:1024 sc1
v_mfma_f32_16x16x32_bf16 v[36:39], a[68:71], a[20:23], v[36:39]
ds_read_b64_tr_b16 a[94:95], v3 offset:10848
v_mfma_f32_16x16x32_bf16 v[36:39], a[64:67], a[4:7], v[36:39]
ds_read_b64_tr_b16 a[96:97], v3 offset:128
v_mfma_f32_16x16x32_bf16 v[40:43], a[64:67], a[8:11], v[40:43]
ds_read_b64_tr_b16 a[98:99], v3 offset:3712
v_mfma_f32_16x16x32_bf16 v[40:43], a[68:71], a[24:27], v[40:43]
s_getpc_b64 s[58:59]
L_m_rf4a:
s_and_b32 s58, s58, 0xffffff80
v_mfma_f32_16x16x32_bf16 v[44:47], a[68:71], a[28:31], v[44:47]
buffer_load_dwordx4 a[52:55], v1, s[8:11], s32 offen offset:1024 sc1
v_mfma_f32_16x16x32_bf16 v[44:47], a[64:67], a[12:15], v[44:47]
ds_read_b64_tr_b16 a[100:101], v3 offset:7296
v_mfma_f32_16x16x32_bf16 v[60:63], a[72:75], a[12:15], v[60:63]
ds_read_b64_tr_b16 a[102:103], v3 offset:10880
v_mfma_f32_16x16x32_bf16 v[60:63], a[76:79], a[28:31], v[60:63]
ds_read_b64_tr_b16 a[104:105], v3 offset:160
v_mfma_f32_16x16x32_bf16 v[56:59], a[76:79], a[24:27], v[56:59]
buffer_load_dwordx4 a[56:59], v1, s[8:11], s33 offen offset:1024 sc1
v_mfma_f32_16x16x32_bf16 v[56:59], a[72:75], a[8:11], v[56:59]
v_mfma_f32_16x16x32_bf16 v[52:55], a[72:75], a[4:7], v[52:55]
ds_read_b64_tr_b16 a[106:107], v3 offset:3744
v_mfma_f32_16x16x32_bf16 v[52:55], a[76:79], a[20:23], v[52:55]
ds_read_b64_tr_b16 a[108:109], v3 offset:7328
s_lshr_b32 s60, s2, 3
s_lshl_b32 s60, s60, 2
s_add_u32 s60, s60, s3
s_mul_i32 s60, s60, 2
v_mfma_f32_16x16x32_bf16 v[48:51], a[76:79], a[16:19], v[48:51]
ds_read_b64_tr_b16 a[110:111], v3 offset:10912
v_mfma_f32_16x16x32_bf16 v[48:51], a[72:75], a[0:3], v[48:51]
buffer_load_dwordx4 a[60:63], v1, s[8:11], s34 offen offset:1024 sc1
v_mfma_f32_16x16x32_bf16 v[64:67], a[80:83], a[0:3], v[64:67]
ds_read_b64_tr_b16 a[112:113], v3 offset:192
v_mfma_f32_16x16x32_bf16 v[64:67], a[84:87], a[16:19], v[64:67]
v_mfma_f32_16x16x32_bf16 v[68:71], a[84:87], a[20:23], v[68:71]
ds_read_b64_tr_b16 a[114:115], v3 offset:3776
v_min_u32 v13, 1, v0
v_mfma_f32_16x16x32_bf16 v[68:71], a[80:83], a[4:7], v[68:71]
ds_read_b64_tr_b16 a[116:117], v3 offset:7360
v_mfma_f32_16x16x32_bf16 v[72:75], a[80:83], a[8:11], v[72:75]
s_cmp_eq_u32 s88, 3
s_cbranch_scc1 L_st60
L_st60r:
v_mfma_f32_16x16x32_bf16 v[72:75], a[84:87], a[24:27], v[72:75]
ds_read_b64_tr_b16 a[118:119], v3 offset:10944
v_mfma_f32_16x16x32_bf16 v[76:79], a[84:87], a[28:31], v[76:79]
v_add_lshl_u32 v13, v13, s60, 7
v_mfma_f32_16x16x32_bf16 v[76:79], a[80:83], a[12:15], v[76:79]
v_mfma_f32_16x16x32_bf16 v[92:95], a[88:91], a[12:15], v[92:95]
v_mfma_f32_16x16x32_bf16 v[88:91], a[88:91], a[8:11], v[88:91]
v_min_u32 v13, L_p4end-L_m_rf4a-128, v13
v_mfma_f32_16x16x32_bf16 v[84:87], a[88:91], a[4:7], v[84:87]
v_mfma_f32_16x16x32_bf16 v[80:83], a[88:91], a[0:3], v[80:83]
global_load_dwordx2 a[254:255], v13, s[58:59] offset:60
s_waitcnt vmcnt(17) lgkmcnt(0)
v_mfma_f32_16x16x32_bf16 v[80:83], a[92:95], a[16:19], v[80:83]
ds_read_b64_tr_b16 a[64:65], v3 offset:14336
v_mfma_f32_16x16x32_bf16 v[84:87], a[92:95], a[20:23], v[84:87]
s_xor_b32 s38, s71, 8
s_mul_i32 s38, s38, 458752
s_add_u32 s4, s40, s38
s_addc_u32 s5, s41, 0
v_mfma_f32_16x16x32_bf16 v[88:91], a[92:95], a[24:27], v[88:91]
ds_read_b64_tr_b16 a[66:67], v3 offset:17920
v_mfma_f32_16x16x32_bf16 v[92:95], a[92:95], a[28:31], v[92:95]
ds_read_b64_tr_b16 a[68:69], v3 offset:21504
v_mfma_f32_16x16x32_bf16 v[108:111], a[100:103], a[28:31], v[108:111]
ds_read_b64_tr_b16 a[70:71], v3 offset:25088
v_mfma_f32_16x16x32_bf16 v[108:111], a[96:99], a[12:15], v[108:111]
s_add_u32 m0, s35, 65536
s_nop 0
buffer_load_dwordx4 v4, s[4:7], 0 offen offset:0 lds
v_mfma_f32_16x16x32_bf16 v[104:107], a[96:99], a[8:11], v[104:107]
ds_read_b64_tr_b16 a[72:73], v3 offset:14368
v_mfma_f32_16x16x32_bf16 v[104:107], a[100:103], a[24:27], v[104:107]
v_mfma_f32_16x16x32_bf16 v[100:103], a[100:103], a[20:23], v[100:103]
ds_read_b64_tr_b16 a[74:75], v3 offset:17952
v_mfma_f32_16x16x32_bf16 v[100:103], a[96:99], a[4:7], v[100:103]
buffer_load_dwordx4 v5, s[4:7], 0 offen offset:1024 lds
v_mfma_f32_16x16x32_bf16 v[96:99], a[96:99], a[0:3], v[96:99]
ds_read_b64_tr_b16 a[76:77], v3 offset:21536
v_mfma_f32_16x16x32_bf16 v[96:99], a[100:103], a[16:19], v[96:99]
ds_read_b64_tr_b16 a[78:79], v3 offset:25120
v_mfma_f32_16x16x32_bf16 v[112:115], a[108:111], a[16:19], v[112:115]
buffer_load_dwordx4 v6, s[4:7], 0 offen offset:2048 lds
v_mfma_f32_16x16x32_bf16 v[112:115], a[104:107], a[0:3], v[112:115]
ds_read_b64_tr_b16 a[80:81], v3 offset:14400
v_mfma_f32_16x16x32_bf16 v[116:119], a[104:107], a[4:7], v[116:119]
ds_read_b64_tr_b16 a[82:83], v3 offset:17984
v_mfma_f32_16x16x32_bf16 v[116:119], a[108:111], a[20:23], v[116:119]
v_mfma_f32_16x16x32_bf16 v[120:123], a[108:111], a[24:27], v[120:123]
ds_read_b64_tr_b16 a[84:85], v3 offset:21568
v_mfma_f32_16x16x32_bf16 v[120:123], a[104:107], a[8:11], v[120:123]
buffer_load_dwordx4 v7, s[4:7], 0 offen offset:3072 lds
v_mfma_f32_16x16x32_bf16 v[124:127], a[104:107], a[12:15], v[124:127]
ds_read_b64_tr_b16 a[86:87], v3 offset:25152
v_mfma_f32_16x16x32_bf16 v[124:127], a[108:111], a[28:31], v[124:127]
ds_read_b64_tr_b16 a[88:89], v3 offset:14432
v_mfma_f32_16x16x32_bf16 v[140:143], a[116:119], a[28:31], v[140:143]
s_cmp_eq_u32 s89, 3
s_cbranch_scc1 L_st61
L_st61r:
v_mfma_f32_16x16x32_bf16 v[140:143], a[112:115], a[12:15], v[140:143]
ds_read_b64_tr_b16 a[90:91], v3 offset:18016
v_mfma_f32_16x16x32_bf16 v[136:139], a[112:115], a[8:11], v[136:139]
v_mfma_f32_16x16x32_bf16 v[136:139], a[116:119], a[24:27], v[136:139]
v_mfma_f32_16x16x32_bf16 v[132:135], a[116:119], a[20:23], v[132:135]
v_mfma_f32_16x16x32_bf16 v[132:135], a[112:115], a[4:7], v[132:135]
v_mfma_f32_16x16x32_bf16 v[128:131], a[112:115], a[0:3], v[128:131]
v_mfma_f32_16x16x32_bf16 v[128:131], a[116:119], a[16:19], v[128:131]
s_waitcnt lgkmcnt(0)
v_mfma_f32_16x16x32_bf16 v[144:147], a[64:67], a[0:3], v[144:147]
ds_read_b64_tr_b16 a[92:93], v3 offset:21600
v_mfma_f32_16x16x32_bf16 v[144:147], a[68:71], a[16:19], v[144:147]
s_xor_b32 s38, s71, 8
s_lshl_b32 s38, s38, 11
s_add_u32 s8, s42, s38
s_addc_u32 s9, s43, 0
v_mfma_f32_16x16x32_bf16 v[148:151], a[68:71], a[20:23], v[148:151]
ds_read_b64_tr_b16 a[94:95], v3 offset:25184
v_mfma_f32_16x16x32_bf16 v[148:151], a[64:67], a[4:7], v[148:151]
ds_read_b64_tr_b16 a[96:97], v3 offset:14464
v_mfma_f32_16x16x32_bf16 v[152:155], a[64:67], a[8:11], v[152:155]
ds_read_b64_tr_b16 a[98:99], v3 offset:18048
v_mfma_f32_16x16x32_bf16 v[152:155], a[68:71], a[24:27], v[152:155]
buffer_load_dwordx4 a[184:187], v1, s[8:11], 0 offen offset:0 sc1
v_mfma_f32_16x16x32_bf16 v[156:159], a[68:71], a[28:31], v[156:159]
ds_read_b64_tr_b16 a[100:101], v3 offset:21632
v_mfma_f32_16x16x32_bf16 v[156:159], a[64:67], a[12:15], v[156:159]
v_mfma_f32_16x16x32_bf16 v[172:175], a[72:75], a[12:15], v[172:175]
ds_read_b64_tr_b16 a[102:103], v3 offset:25216
v_mfma_f32_16x16x32_bf16 v[172:175], a[76:79], a[28:31], v[172:175]
buffer_load_dwordx4 a[188:191], v1, s[8:11], s32 offen offset:0 sc1
v_mfma_f32_16x16x32_bf16 v[168:171], a[76:79], a[24:27], v[168:171]
ds_read_b64_tr_b16 a[104:105], v3 offset:14496
v_mfma_f32_16x16x32_bf16 v[168:171], a[72:75], a[8:11], v[168:171]
ds_read_b64_tr_b16 a[106:107], v3 offset:18080
v_mfma_f32_16x16x32_bf16 v[164:167], a[72:75], a[4:7], v[164:167]
buffer_load_dwordx4 a[192:195], v1, s[8:11], s33 offen offset:0 sc1
v_mfma_f32_16x16x32_bf16 v[164:167], a[76:79], a[20:23], v[164:167]
ds_read_b64_tr_b16 a[108:109], v3 offset:21664
v_mfma_f32_16x16x32_bf16 v[160:163], a[76:79], a[16:19], v[160:163]
ds_read_b64_tr_b16 a[110:111], v3 offset:25248
v_mfma_f32_16x16x32_bf16 v[160:163], a[72:75], a[0:3], v[160:163]
v_mfma_f32_16x16x32_bf16 v[176:179], a[80:83], a[0:3], v[176:179]
ds_read_b64_tr_b16 a[112:113], v3 offset:14528
v_mfma_f32_16x16x32_bf16 v[176:179], a[84:87], a[16:19], v[176:179]
buffer_load_dwordx4 a[196:199], v1, s[8:11], s34 offen offset:0 sc1
v_mfma_f32_16x16x32_bf16 v[180:183], a[84:87], a[20:23], v[180:183]
ds_read_b64_tr_b16 a[114:115], v3 offset:18112
v_mfma_f32_16x16x32_bf16 v[180:183], a[80:83], a[4:7], v[180:183]
ds_read_b64_tr_b16 a[116:117], v3 offset:21696
v_mfma_f32_16x16x32_bf16 v[184:187], a[80:83], a[8:11], v[184:187]
s_cmp_eq_u32 s90, 3
s_cbranch_scc1 L_st62
L_st62r:
v_mfma_f32_16x16x32_bf16 v[184:187], a[84:87], a[24:27], v[184:187]
ds_read_b64_tr_b16 a[118:119], v3 offset:25280
v_mfma_f32_16x16x32_bf16 v[188:191], a[84:87], a[28:31], v[188:191]
v_mfma_f32_16x16x32_bf16 v[188:191], a[80:83], a[12:15], v[188:191]
v_mfma_f32_16x16x32_bf16 v[204:207], a[88:91], a[12:15], v[204:207]
v_mfma_f32_16x16x32_bf16 v[200:203], a[88:91], a[8:11], v[200:203]
v_mfma_f32_16x16x32_bf16 v[196:199], a[88:91], a[4:7], v[196:199]
v_mfma_f32_16x16x32_bf16 v[192:195], a[88:91], a[0:3], v[192:195]
s_waitcnt vmcnt(13) lgkmcnt(0)
s_barrier
v_mfma_f32_16x16x32_bf16 v[192:195], a[92:95], a[16:19], v[192:195]
ds_read_b64_tr_b16 a[64:65], v3 offset:32768
v_mfma_f32_16x16x32_bf16 v[196:199], a[92:95], a[20:23], v[196:199]
ds_read_b64_tr_b16 a[66:67], v3 offset:36352
v_mfma_f32_16x16x32_bf16 v[200:203], a[92:95], a[24:27], v[200:203]
s_add_u32 m0, s35, 69632
s_nop 0
buffer_load_dwordx4 v8, s[4:7], 0 offen offset:0 lds
v_mfma_f32_16x16x32_bf16 v[204:207], a[92:95], a[28:31], v[204:207]
ds_read_b64_tr_b16 a[68:69], v3 offset:39936
v_mfma_f32_16x16x32_bf16 v[220:223], a[100:103], a[28:31], v[220:223]
v_mfma_f32_16x16x32_bf16 v[220:223], a[96:99], a[12:15], v[220:223]
ds_read_b64_tr_b16 a[70:71], v3 offset:43520
v_mfma_f32_16x16x32_bf16 v[216:219], a[96:99], a[8:11], v[216:219]
ds_read_b64_tr_b16 a[72:73], v3 offset:32800
v_mfma_f32_16x16x32_bf16 v[216:219], a[100:103], a[24:27], v[216:219]
buffer_load_dwordx4 v9, s[4:7], 0 offen offset:1024 lds
v_mfma_f32_16x16x32_bf16 v[212:215], a[100:103], a[20:23], v[212:215]
ds_read_b64_tr_b16 a[74:75], v3 offset:36384
v_mfma_f32_16x16x32_bf16 v[212:215], a[96:99], a[4:7], v[212:215]
v_mfma_f32_16x16x32_bf16 v[208:211], a[96:99], a[0:3], v[208:211]
ds_read_b64_tr_b16 a[76:77], v3 offset:39968
v_mfma_f32_16x16x32_bf16 v[208:211], a[100:103], a[16:19], v[208:211]
ds_read_b64_tr_b16 a[78:79], v3 offset:43552
v_mfma_f32_16x16x32_bf16 v[224:227], a[108:111], a[16:19], v[224:227]
ds_read_b64_tr_b16 a[80:81], v3 offset:32832
v_mfma_f32_16x16x32_bf16 v[224:227], a[104:107], a[0:3], v[224:227]
v_mfma_f32_16x16x32_bf16 v[228:231], a[104:107], a[4:7], v[228:231]
buffer_load_dwordx4 v10, s[4:7], 0 offen offset:2048 lds
v_mfma_f32_16x16x32_bf16 v[228:231], a[108:111], a[20:23], v[228:231]
ds_read_b64_tr_b16 a[82:83], v3 offset:36416
v_mfma_f32_16x16x32_bf16 v[232:235], a[108:111], a[24:27], v[232:235]
ds_read_b64_tr_b16 a[84:85], v3 offset:40000
v_mfma_f32_16x16x32_bf16 v[232:235], a[104:107], a[8:11], v[232:235]
ds_read_b64_tr_b16 a[86:87], v3 offset:43584
v_mfma_f32_16x16x32_bf16 v[236:239], a[104:107], a[12:15], v[236:239]
v_mfma_f32_16x16x32_bf16 v[236:239], a[108:111], a[28:31], v[236:239]
s_cmp_eq_u32 s91, 3
s_cbranch_scc1 L_st63
L_st63r:
v_mfma_f32_16x16x32_bf16 v[252:255], a[116:119], a[28:31], v[252:255]
ds_read_b64_tr_b16 a[88:89], v3 offset:32864
v_mfma_f32_16x16x32_bf16 v[252:255], a[112:115], a[12:15], v[252:255]
ds_read_b64_tr_b16 a[90:91], v3 offset:36448
v_mfma_f32_16x16x32_bf16 v[248:251], a[112:115], a[8:11], v[248:251]
v_mfma_f32_16x16x32_bf16 v[248:251], a[116:119], a[24:27], v[248:251]
v_mfma_f32_16x16x32_bf16 v[244:247], a[116:119], a[20:23], v[244:247]
v_mfma_f32_16x16x32_bf16 v[244:247], a[112:115], a[4:7], v[244:247]
v_mfma_f32_16x16x32_bf16 v[240:243], a[112:115], a[0:3], v[240:243]
v_mfma_f32_16x16x32_bf16 v[240:243], a[116:119], a[16:19], v[240:243]
s_waitcnt vmcnt(12) lgkmcnt(0)
v_mfma_f32_16x16x32_bf16 v[32:35], a[64:67], a[32:35], v[32:35]
ds_read_b64_tr_b16 a[92:93], v3 offset:40032
buffer_load_dwordx4 a[200:203], v1, s[8:11], 0 offen offset:1024 sc1
v_mfma_f32_16x16x32_bf16 v[32:35], a[68:71], a[48:51], v[32:35]
ds_read_b64_tr_b16 a[94:95], v3 offset:43616
v_mfma_f32_16x16x32_bf16 v[36:39], a[68:71], a[52:55], v[36:39]
buffer_load_dwordx4 a[204:207], v1, s[8:11], s32 offen offset:1024 sc1
v_mfma_f32_16x16x32_bf16 v[36:39], a[64:67], a[36:39], v[36:39]
ds_read_b64_tr_b16 a[96:97], v3 offset:32896
v_mfma_f32_16x16x32_bf16 v[40:43], a[64:67], a[40:43], v[40:43]
ds_read_b64_tr_b16 a[98:99], v3 offset:36480
v_mfma_f32_16x16x32_bf16 v[40:43], a[68:71], a[56:59], v[40:43]
buffer_load_dwordx4 a[208:211], v1, s[8:11], s33 offen offset:1024 sc1
v_mfma_f32_16x16x32_bf16 v[44:47], a[68:71], a[60:63], v[44:47]
ds_read_b64_tr_b16 a[100:101], v3 offset:40064
v_mfma_f32_16x16x32_bf16 v[44:47], a[64:67], a[44:47], v[44:47]
buffer_load_dwordx4 a[212:215], v1, s[8:11], s34 offen offset:1024 sc1
v_mfma_f32_16x16x32_bf16 v[60:63], a[72:75], a[44:47], v[60:63]
ds_read_b64_tr_b16 a[102:103], v3 offset:43648
v_mfma_f32_16x16x32_bf16 v[60:63], a[76:79], a[60:63], v[60:63]
s_xor_b32 s38, s71, 9
s_mul_i32 s38, s38, 458752
s_add_u32 s4, s40, s38
s_addc_u32 s5, s41, 0
v_mfma_f32_16x16x32_bf16 v[56:59], a[76:79], a[56:59], v[56:59]
ds_read_b64_tr_b16 a[104:105], v3 offset:32928
v_mfma_f32_16x16x32_bf16 v[56:59], a[72:75], a[40:43], v[56:59]
ds_read_b64_tr_b16 a[106:107], v3 offset:36512
v_mfma_f32_16x16x32_bf16 v[52:55], a[72:75], a[36:39], v[52:55]
s_add_u32 m0, s35, 98304
s_nop 0
buffer_load_dwordx4 v4, s[4:7], 0 offen offset:0 lds
v_mfma_f32_16x16x32_bf16 v[52:55], a[76:79], a[52:55], v[52:55]
ds_read_b64_tr_b16 a[108:109], v3 offset:40096
v_mfma_f32_16x16x32_bf16 v[48:51], a[76:79], a[48:51], v[48:51]
buffer_load_dwordx4 v5, s[4:7], 0 offen offset:1024 lds
v_mfma_f32_16x16x32_bf16 v[48:51], a[72:75], a[32:35], v[48:51]
ds_read_b64_tr_b16 a[110:111], v3 offset:43680
v_mfma_f32_16x16x32_bf16 v[64:67], a[80:83], a[32:35], v[64:67]
ds_read_b64_tr_b16 a[112:113], v3 offset:32960
v_mfma_f32_16x16x32_bf16 v[64:67], a[84:87], a[48:51], v[64:67]
buffer_load_dwordx4 v6, s[4:7], 0 offen offset:2048 lds
v_mfma_f32_16x16x32_bf16 v[68:71], a[84:87], a[52:55], v[68:71]
ds_read_b64_tr_b16 a[114:115], v3 offset:36544
v_mfma_f32_16x16x32_bf16 v[68:71], a[80:83], a[36:39], v[68:71]
buffer_load_dwordx4 v7, s[4:7], 0 offen offset:3072 lds
v_mfma_f32_16x16x32_bf16 v[72:75], a[80:83], a[40:43], v[72:75]
ds_read_b64_tr_b16 a[116:117], v3 offset:40128
v_mfma_f32_16x16x32_bf16 v[72:75], a[84:87], a[56:59], v[72:75]
s_cmp_eq_u32 s88, 3
s_cbranch_scc1 L_st70
L_st70r:
v_mfma_f32_16x16x32_bf16 v[76:79], a[84:87], a[60:63], v[76:79]
ds_read_b64_tr_b16 a[118:119], v3 offset:43712
v_mfma_f32_16x16x32_bf16 v[76:79], a[80:83], a[44:47], v[76:79]
v_mfma_f32_16x16x32_bf16 v[92:95], a[88:91], a[44:47], v[92:95]
v_mfma_f32_16x16x32_bf16 v[88:91], a[88:91], a[40:43], v[88:91]
v_mfma_f32_16x16x32_bf16 v[84:87], a[88:91], a[36:39], v[84:87]
v_mfma_f32_16x16x32_bf16 v[80:83], a[88:91], a[32:35], v[80:83]
s_waitcnt vmcnt(20) lgkmcnt(0)
v_mfma_f32_16x16x32_bf16 v[80:83], a[92:95], a[48:51], v[80:83]
ds_read_b64_tr_b16 a[64:65], v3 offset:47104
v_mfma_f32_16x16x32_bf16 v[84:87], a[92:95], a[52:55], v[84:87]
ds_read_b64_tr_b16 a[66:67], v3 offset:50688
v_mfma_f32_16x16x32_bf16 v[88:91], a[92:95], a[56:59], v[88:91]
v_mfma_f32_16x16x32_bf16 v[92:95], a[92:95], a[60:63], v[92:95]
ds_read_b64_tr_b16 a[68:69], v3 offset:54272
v_mfma_f32_16x16x32_bf16 v[108:111], a[100:103], a[60:63], v[108:111]
ds_read_b64_tr_b16 a[70:71], v3 offset:57856
v_mfma_f32_16x16x32_bf16 v[108:111], a[96:99], a[44:47], v[108:111]
v_mfma_f32_16x16x32_bf16 v[104:107], a[96:99], a[40:43], v[104:107]
ds_read_b64_tr_b16 a[72:73], v3 offset:47136
v_mfma_f32_16x16x32_bf16 v[104:107], a[100:103], a[56:59], v[104:107]
ds_read_b64_tr_b16 a[74:75], v3 offset:50720
v_mfma_f32_16x16x32_bf16 v[100:103], a[100:103], a[52:55], v[100:103]
v_mfma_f32_16x16x32_bf16 v[100:103], a[96:99], a[36:39], v[100:103]
ds_read_b64_tr_b16 a[76:77], v3 offset:54304
v_mfma_f32_16x16x32_bf16 v[96:99], a[96:99], a[32:35], v[96:99]
s_cmp_eq_u32 s89, 3
s_cbranch_scc1 L_st71
L_st71r:
v_mfma_f32_16x16x32_bf16 v[96:99], a[100:103], a[48:51], v[96:99]
v_mfma_f32_16x16x32_bf16 v[112:115], a[108:111], a[48:51], v[112:115]
ds_read_b64_tr_b16 a[78:79], v3 offset:57888
v_mfma_f32_16x16x32_bf16 v[112:115], a[104:107], a[32:35], v[112:115]
ds_read_b64_tr_b16 a[80:81], v3 offset:47168
v_mfma_f32_16x16x32_bf16 v[116:119], a[104:107], a[36:39], v[116:119]
v_mfma_f32_16x16x32_bf16 v[116:119], a[108:111], a[52:55], v[116:119]
ds_read_b64_tr_b16 a[82:83], v3 offset:50752
v_mfma_f32_16x16x32_bf16 v[120:123], a[108:111], a[56:59], v[120:123]
ds_read_b64_tr_b16 a[84:85], v3 offset:54336
v_mfma_f32_16x16x32_bf16 v[120:123], a[104:107], a[40:43], v[120:123]
v_mfma_f32_16x16x32_bf16 v[124:127], a[104:107], a[44:47], v[124:127]
ds_read_b64_tr_b16 a[86:87], v3 offset:57920
v_mfma_f32_16x16x32_bf16 v[124:127], a[108:111], a[60:63], v[124:127]
ds_read_b64_tr_b16 a[88:89], v3 offset:47200
v_mfma_f32_16x16x32_bf16 v[140:143], a[116:119], a[60:63], v[140:143]
v_mfma_f32_16x16x32_bf16 v[140:143], a[112:115], a[44:47], v[140:143]
ds_read_b64_tr_b16 a[90:91], v3 offset:50784
v_mfma_f32_16x16x32_bf16 v[136:139], a[112:115], a[40:43], v[136:139]
v_mfma_f32_16x16x32_bf16 v[136:139], a[116:119], a[56:59], v[136:139]
v_mfma_f32_16x16x32_bf16 v[132:135], a[116:119], a[52:55], v[132:135]
v_mfma_f32_16x16x32_bf16 v[132:135], a[112:115], a[36:39], v[132:135]
v_mfma_f32_16x16x32_bf16 v[128:131], a[112:115], a[32:35], v[128:131]
v_mfma_f32_16x16x32_bf16 v[128:131], a[116:119], a[48:51], v[128:131]
s_getreg_b32 s39, hwreg(HW_REG_XCC_ID, 0, 4)
s_lshl_b32 s39, s39, 1
s_xor_b32 s39, s39, s63
s_waitcnt vmcnt(31)
v_cmp_ne_u32 vcc, s39, v18
s_or_b32 s99, vcc_lo, 0
s_waitcnt lgkmcnt(0)
v_mfma_f32_16x16x32_bf16 v[144:147], a[64:67], a[32:35], v[144:147]
ds_read_b64_tr_b16 a[92:93], v3 offset:54368
v_mfma_f32_16x16x32_bf16 v[144:147], a[68:71], a[48:51], v[144:147]
s_xor_b32 s38, s71, 9
s_lshl_b32 s38, s38, 11
s_add_u32 s8, s42, s38
s_addc_u32 s9, s43, 0
v_mfma_f32_16x16x32_bf16 v[148:151], a[68:71], a[52:55], v[148:151]
ds_read_b64_tr_b16 a[94:95], v3 offset:57952
v_mfma_f32_16x16x32_bf16 v[148:151], a[64:67], a[36:39], v[148:151]
buffer_load_dwordx4 a[0:3], v1, s[8:11], 0 offen offset:0 sc1
v_mfma_f32_16x16x32_bf16 v[152:155], a[64:67], a[40:43], v[152:155]
ds_read_b64_tr_b16 a[96:97], v3 offset:47232
v_mfma_f32_16x16x32_bf16 v[152:155], a[68:71], a[56:59], v[152:155]
ds_read_b64_tr_b16 a[98:99], v3 offset:50816
v_mfma_f32_16x16x32_bf16 v[156:159], a[68:71], a[60:63], v[156:159]
buffer_load_dwordx4 a[4:7], v1, s[8:11], s32 offen offset:0 sc1
v_mfma_f32_16x16x32_bf16 v[156:159], a[64:67], a[44:47], v[156:159]
ds_read_b64_tr_b16 a[100:101], v3 offset:54400
v_mfma_f32_16x16x32_bf16 v[172:175], a[72:75], a[44:47], v[172:175]
buffer_load_dwordx4 a[8:11], v1, s[8:11], s33 offen offset:0 sc1
v_mfma_f32_16x16x32_bf16 v[172:175], a[76:79], a[60:63], v[172:175]
ds_read_b64_tr_b16 a[102:103], v3 offset:57984
v_mfma_f32_16x16x32_bf16 v[168:171], a[76:79], a[56:59], v[168:171]
ds_read_b64_tr_b16 a[104:105], v3 offset:47264
v_mfma_f32_16x16x32_bf16 v[168:171], a[72:75], a[40:43], v[168:171]
buffer_load_dwordx4 a[12:15], v1, s[8:11], s34 offen offset:0 sc1
v_mfma_f32_16x16x32_bf16 v[164:167], a[72:75], a[36:39], v[164:167]
ds_read_b64_tr_b16 a[106:107], v3 offset:50848
v_mfma_f32_16x16x32_bf16 v[164:167], a[76:79], a[52:55], v[164:167]
ds_read_b64_tr_b16 a[108:109], v3 offset:54432
v_mfma_f32_16x16x32_bf16 v[160:163], a[76:79], a[48:51], v[160:163]
s_add_u32 m0, s35, 102400
s_nop 0
buffer_load_dwordx4 v8, s[4:7], 0 offen offset:0 lds
v_mfma_f32_16x16x32_bf16 v[160:163], a[72:75], a[32:35], v[160:163]
ds_read_b64_tr_b16 a[110:111], v3 offset:58016
v_mfma_f32_16x16x32_bf16 v[176:179], a[80:83], a[32:35], v[176:179]
buffer_load_dwordx4 v9, s[4:7], 0 offen offset:1024 lds
v_mfma_f32_16x16x32_bf16 v[176:179], a[84:87], a[48:51], v[176:179]
ds_read_b64_tr_b16 a[112:113], v3 offset:47296
v_mfma_f32_16x16x32_bf16 v[180:183], a[84:87], a[52:55], v[180:183]
ds_read_b64_tr_b16 a[114:115], v3 offset:50880
v_mfma_f32_16x16x32_bf16 v[180:183], a[80:83], a[36:39], v[180:183]
buffer_load_dwordx4 v10, s[4:7], 0 offen offset:2048 lds
v_mfma_f32_16x16x32_bf16 v[184:187], a[80:83], a[40:43], v[184:187]
ds_read_b64_tr_b16 a[116:117], v3 offset:54464
v_mfma_f32_16x16x32_bf16 v[184:187], a[84:87], a[56:59], v[184:187]
s_cmp_eq_u32 s90, 3
s_cbranch_scc1 L_st72
L_st72r:
v_mfma_f32_16x16x32_bf16 v[188:191], a[84:87], a[60:63], v[188:191]
ds_read_b64_tr_b16 a[118:119], v3 offset:58048
v_mfma_f32_16x16x32_bf16 v[188:191], a[80:83], a[44:47], v[188:191]
v_mfma_f32_16x16x32_bf16 v[204:207], a[88:91], a[44:47], v[204:207]
v_mfma_f32_16x16x32_bf16 v[200:203], a[88:91], a[40:43], v[200:203]
v_mfma_f32_16x16x32_bf16 v[196:199], a[88:91], a[36:39], v[196:199]
v_mfma_f32_16x16x32_bf16 v[192:195], a[88:91], a[32:35], v[192:195]
s_waitcnt vmcnt(15) lgkmcnt(0)
s_barrier
v_mfma_f32_16x16x32_bf16 v[192:195], a[92:95], a[48:51], v[192:195]
ds_read_b64_tr_b16 a[64:65], v2 offset:0
v_mfma_f32_16x16x32_bf16 v[196:199], a[92:95], a[52:55], v[196:199]
buffer_load_dwordx4 a[16:19], v1, s[8:11], 0 offen offset:1024 sc1
v_mfma_f32_16x16x32_bf16 v[200:203], a[92:95], a[56:59], v[200:203]
ds_read_b64_tr_b16 a[66:67], v2 offset:3584
v_mfma_f32_16x16x32_bf16 v[204:207], a[92:95], a[60:63], v[204:207]
ds_read_b64_tr_b16 a[68:69], v2 offset:7168
v_mfma_f32_16x16x32_bf16 v[220:223], a[100:103], a[60:63], v[220:223]
ds_read_b64_tr_b16 a[70:71], v2 offset:10752
v_mfma_f32_16x16x32_bf16 v[220:223], a[96:99], a[44:47], v[220:223]
v_mfma_f32_16x16x32_bf16 v[216:219], a[96:99], a[40:43], v[216:219]
buffer_load_dwordx4 a[20:23], v1, s[8:11], s32 offen offset:1024 sc1
v_mfma_f32_16x16x32_bf16 v[216:219], a[100:103], a[56:59], v[216:219]
ds_read_b64_tr_b16 a[72:73], v2 offset:32
v_mfma_f32_16x16x32_bf16 v[212:215], a[100:103], a[52:55], v[212:215]
ds_read_b64_tr_b16 a[74:75], v2 offset:3616
v_mfma_f32_16x16x32_bf16 v[212:215], a[96:99], a[36:39], v[212:215]
ds_read_b64_tr_b16 a[76:77], v2 offset:7200
v_mfma_f32_16x16x32_bf16 v[208:211], a[96:99], a[32:35], v[208:211]
buffer_load_dwordx4 a[24:27], v1, s[8:11], s33 offen offset:1024 sc1
v_mfma_f32_16x16x32_bf16 v[208:211], a[100:103], a[48:51], v[208:211]
v_mfma_f32_16x16x32_bf16 v[224:227], a[108:111], a[48:51], v[224:227]
ds_read_b64_tr_b16 a[78:79], v2 offset:10784
v_mfma_f32_16x16x32_bf16 v[224:227], a[104:107], a[32:35], v[224:227]
ds_read_b64_tr_b16 a[80:81], v2 offset:64
v_mfma_f32_16x16x32_bf16 v[228:231], a[104:107], a[36:39], v[228:231]
ds_read_b64_tr_b16 a[82:83], v2 offset:3648
v_mfma_f32_16x16x32_bf16 v[228:231], a[108:111], a[52:55], v[228:231]
buffer_load_dwordx4 a[28:31], v1, s[8:11], s34 offen offset:1024 sc1
v_mfma_f32_16x16x32_bf16 v[232:235], a[108:111], a[56:59], v[232:235]
ds_read_b64_tr_b16 a[84:85], v2 offset:7232
v_mfma_f32_16x16x32_bf16 v[232:235], a[104:107], a[40:43], v[232:235]
v_mfma_f32_16x16x32_bf16 v[236:239], a[104:107], a[44:47], v[236:239]
ds_read_b64_tr_b16 a[86:87], v2 offset:10816
v_mfma_f32_16x16x32_bf16 v[236:239], a[108:111], a[60:63], v[236:239]
ds_read_b64_tr_b16 a[88:89], v2 offset:96
v_mfma_f32_16x16x32_bf16 v[252:255], a[116:119], a[60:63], v[252:255]
s_cmp_eq_u32 s91, 3
s_cbranch_scc1 L_st73
L_st73r:
v_mfma_f32_16x16x32_bf16 v[252:255], a[112:115], a[44:47], v[252:255]
ds_read_b64_tr_b16 a[90:91], v2 offset:3680
v_mfma_f32_16x16x32_bf16 v[248:251], a[112:115], a[40:43], v[248:251]
v_mfma_f32_16x16x32_bf16 v[248:251], a[116:119], a[56:59], v[248:251]
v_mfma_f32_16x16x32_bf16 v[244:247], a[116:119], a[52:55], v[244:247]
v_mfma_f32_16x16x32_bf16 v[244:247], a[112:115], a[36:39], v[244:247]
v_mfma_f32_16x16x32_bf16 v[240:243], a[112:115], a[32:35], v[240:243]
v_mfma_f32_16x16x32_bf16 v[240:243], a[116:119], a[48:51], v[240:243]
L_p4mid:
s_waitcnt vmcnt(15) lgkmcnt(0)
v_mfma_f32_16x16x32_bf16 v[32:35], a[64:67], a[184:187], v[32:35]
ds_read_b64_tr_b16 a[92:93], v2 offset:7264
v_mfma_f32_16x16x32_bf16 v[32:35], a[68:71], a[200:203], v[32:35]
s_xor_b32 s38, s71, 10
s_mul_i32 s38, s38, 458752
s_add_u32 s4, s40, s38
s_addc_u32 s5, s41, 0
v_mfma_f32_16x16x32_bf16 v[36:39], a[68:71], a[204:207], v[36:39]
ds_read_b64_tr_b16 a[94:95], v2 offset:10848
v_mfma_f32_16x16x32_bf16 v[36:39], a[64:67], a[188:191], v[36:39]
ds_read_b64_tr_b16 a[96:97], v2 offset:128
v_mfma_f32_16x16x32_bf16 v[40:43], a[64:67], a[192:195], v[40:43]
ds_read_b64_tr_b16 a[98:99], v2 offset:3712
v_mfma_f32_16x16x32_bf16 v[40:43], a[68:71], a[208:211], v[40:43]
v_mfma_f32_16x16x32_bf16 v[44:47], a[68:71], a[212:215], v[44:47]
s_add_u32 m0, s35, 0
s_nop 0
buffer_load_dwordx4 v4, s[4:7], 0 offen offset:0 lds
v_mfma_f32_16x16x32_bf16 v[44:47], a[64:67], a[196:199], v[44:47]
ds_read_b64_tr_b16 a[100:101], v2 offset:7296
v_mfma_f32_16x16x32_bf16 v[60:63], a[72:75], a[196:199], v[60:63]
ds_read_b64_tr_b16 a[102:103], v2 offset:10880
v_mfma_f32_16x16x32_bf16 v[60:63], a[76:79], a[212:215], v[60:63]
ds_read_b64_tr_b16 a[104:105], v2 offset:160
v_mfma_f32_16x16x32_bf16 v[56:59], a[76:79], a[208:211], v[56:59]
buffer_load_dwordx4 v5, s[4:7], 0 offen offset:1024 lds
v_mfma_f32_16x16x32_bf16 v[56:59], a[72:75], a[192:195], v[56:59]
v_mfma_f32_16x16x32_bf16 v[52:55], a[72:75], a[188:191], v[52:55]
ds_read_b64_tr_b16 a[106:107], v2 offset:3744
v_mfma_f32_16x16x32_bf16 v[52:55], a[76:79], a[204:207], v[52:55]
ds_read_b64_tr_b16 a[108:109], v2 offset:7328
v_mfma_f32_16x16x32_bf16 v[48:51], a[76:79], a[200:203], v[48:51]
ds_read_b64_tr_b16 a[110:111], v2 offset:10912
v_mfma_f32_16x16x32_bf16 v[48:51], a[72:75], a[184:187], v[48:51]
buffer_load_dwordx4 v6, s[4:7], 0 offen offset:2048 lds
v_mfma_f32_16x16x32_bf16 v[64:67], a[80:83], a[184:187], v[64:67]
ds_read_b64_tr_b16 a[112:113], v2 offset:192
v_mfma_f32_16x16x32_bf16 v[64:67], a[84:87], a[200:203], v[64:67]
v_mfma_f32_16x16x32_bf16 v[68:71], a[84:87], a[204:207], v[68:71]
ds_read_b64_tr_b16 a[114:115], v2 offset:3776
v_mfma_f32_16x16x32_bf16 v[68:71], a[80:83], a[188:191], v[68:71]
ds_read_b64_tr_b16 a[116:117], v2 offset:7360
v_mfma_f32_16x16x32_bf16 v[72:75], a[80:83], a[192:195], v[72:75]
buffer_load_dwordx4 v7, s[4:7], 0 offen offset:3072 lds
v_mfma_f32_16x16x32_bf16 v[72:75], a[84:87], a[208:211], v[72:75]
ds_read_b64_tr_b16 a[118:119], v2 offset:10944
v_mfma_f32_16x16x32_bf16 v[76:79], a[84:87], a[212:215], v[76:79]
v_mfma_f32_16x16x32_bf16 v[76:79], a[80:83], a[196:199], v[76:79]
v_mfma_f32_16x16x32_bf16 v[92:95], a[88:91], a[196:199], v[92:95]
v_mfma_f32_16x16x32_bf16 v[88:91], a[88:91], a[192:195], v[88:91]
v_mfma_f32_16x16x32_bf16 v[84:87], a[88:91], a[188:191], v[84:87]
v_mfma_f32_16x16x32_bf16 v[80:83], a[88:91], a[184:187], v[80:83]
s_waitcnt vmcnt(19) lgkmcnt(0)
v_mfma_f32_16x16x32_bf16 v[80:83], a[92:95], a[200:203], v[80:83]
ds_read_b64_tr_b16 a[64:65], v2 offset:14336
v_mfma_f32_16x16x32_bf16 v[84:87], a[92:95], a[204:207], v[84:87]
s_xor_b32 s38, s71, 10
s_lshl_b32 s38, s38, 11
s_add_u32 s8, s42, s38
s_addc_u32 s9, s43, 0
v_mfma_f32_16x16x32_bf16 v[88:91], a[92:95], a[208:211], v[88:91]
ds_read_b64_tr_b16 a[66:67], v2 offset:17920
v_mov_b32 v11, s63
v_mfma_f32_16x16x32_bf16 v[92:95], a[92:95], a[212:215], v[92:95]
ds_read_b64_tr_b16 a[68:69], v2 offset:21504
v_mfma_f32_16x16x32_bf16 v[108:111], a[100:103], a[212:215], v[108:111]
ds_read_b64_tr_b16 a[70:71], v2 offset:25088
v_accvgpr_read_b32 v12, a148
v_mfma_f32_16x16x32_bf16 v[108:111], a[96:99], a[196:199], v[108:111]
v_accvgpr_read_b32 v13, a149
v_mfma_f32_16x16x32_bf16 v[104:107], a[96:99], a[192:195], v[104:107]
buffer_load_dwordx4 a[32:35], v1, s[8:11], 0 offen offset:0 sc1
v_mfma_f32_16x16x32_bf16 v[104:107], a[100:103], a[208:211], v[104:107]
ds_read_b64_tr_b16 a[72:73], v2 offset:14368
v_accvgpr_read_b32 v14, a150
v_mfma_f32_16x16x32_bf16 v[100:103], a[100:103], a[204:207], v[100:103]
ds_read_b64_tr_b16 a[74:75], v2 offset:17952
v_mfma_f32_16x16x32_bf16 v[100:103], a[96:99], a[188:191], v[100:103]
ds_read_b64_tr_b16 a[76:77], v2 offset:21536
v_accvgpr_read_b32 v15, a151
v_mfma_f32_16x16x32_bf16 v[96:99], a[96:99], a[184:187], v[96:99]
buffer_load_dwordx4 a[36:39], v1, s[8:11], s32 offen offset:0 sc1
v_mfma_f32_16x16x32_bf16 v[96:99], a[100:103], a[200:203], v[96:99]
v_perm_b32 v12, v12, v11, s44
v_mfma_f32_16x16x32_bf16 v[112:115], a[108:111], a[200:203], v[112:115]
ds_read_b64_tr_b16 a[78:79], v2 offset:25120
v_perm_b32 v13, v13, v11, s45
v_mfma_f32_16x16x32_bf16 v[112:115], a[104:107], a[184:187], v[112:115]
ds_read_b64_tr_b16 a[80:81], v2 offset:14400
v_mfma_f32_16x16x32_bf16 v[116:119], a[104:107], a[188:191], v[116:119]
ds_read_b64_tr_b16 a[82:83], v2 offset:17984
v_perm_b32 v14, v14, v11, s46
v_mfma_f32_16x16x32_bf16 v[116:119], a[108:111], a[204:207], v[116:119]
buffer_load_dwordx4 a[40:43], v1, s[8:11], s33 offen offset:0 sc1
L_wc43:
L_wp17:
s_cbranch_execz L_wp20
v_mfma_f32_16x16x32_bf16 v[120:123], a[108:111], a[208:211], v[120:123]
ds_read_b64_tr_b16 a[84:85], v2 offset:21568
v_perm_b32 v15, v15, v11, s47
v_mfma_f32_16x16x32_bf16 v[120:123], a[104:107], a[192:195], v[120:123]
v_and_b32 v16, 15, v0
v_mfma_f32_16x16x32_bf16 v[124:127], a[104:107], a[196:199], v[124:127]
ds_read_b64_tr_b16 a[86:87], v2 offset:25152
v_mfma_f32_16x16x32_bf16 v[124:127], a[108:111], a[212:215], v[124:127]
ds_read_b64_tr_b16 a[88:89], v2 offset:14432
v_lshlrev_b32 v16, 6, v16
v_mfma_f32_16x16x32_bf16 v[140:143], a[116:119], a[212:215], v[140:143]
buffer_load_dwordx4 a[44:47], v1, s[8:11], s34 offen offset:0 sc1
v_mfma_f32_16x16x32_bf16 v[140:143], a[112:115], a[196:199], v[140:143]
ds_read_b64_tr_b16 a[90:91], v2 offset:18016
v_and_b32 v17, 48, v0
v_mfma_f32_16x16x32_bf16 v[136:139], a[112:115], a[192:195], v[136:139]
v_add_u32 v16, v16, v17
v_mfma_f32_16x16x32_bf16 v[136:139], a[116:119], a[208:211], v[136:139]
v_mfma_f32_16x16x32_bf16 v[132:135], a[116:119], a[204:207], v[132:135]
v_mfma_f32_16x16x32_bf16 v[132:135], a[112:115], a[188:191], v[132:135]
s_lshl_b32 s39, s37, 3
s_add_u32 s39, s39, s36
s_lshl_b32 s39, s39, 2
s_add_u32 s39, s39, s3
s_lshl_b32 s39, s39, 9
s_add_u32 s39, s39, 64487424
v_mfma_f32_16x16x32_bf16 v[128:131], a[112:115], a[184:187], v[128:131]
v_mfma_f32_16x16x32_bf16 v[128:131], a[116:119], a[200:203], v[128:131]
s_mov_b32 exec_lo, 0x00ff00ff
s_mov_b32 exec_hi, 0x00ff00ff
buffer_store_dwordx4 v[12:15], v16, s[12:15], s39 offen sc1
s_mov_b64 exec, -1
s_waitcnt lgkmcnt(0)
v_mfma_f32_16x16x32_bf16 v[144:147], a[64:67], a[184:187], v[144:147]
ds_read_b64_tr_b16 a[92:93], v2 offset:21600
v_mfma_f32_16x16x32_bf16 v[144:147], a[68:71], a[200:203], v[144:147]
ds_read_b64_tr_b16 a[94:95], v2 offset:25184
v_mfma_f32_16x16x32_bf16 v[148:151], a[68:71], a[204:207], v[148:151]
s_add_u32 m0, s35, 4096
s_nop 0
buffer_load_dwordx4 v8, s[4:7], 0 offen offset:0 lds
v_mfma_f32_16x16x32_bf16 v[148:151], a[64:67], a[188:191], v[148:151]
v_mfma_f32_16x16x32_bf16 v[152:155], a[64:67], a[192:195], v[152:155]
ds_read_b64_tr_b16 a[96:97], v2 offset:14464
v_mfma_f32_16x16x32_bf16 v[152:155], a[68:71], a[208:211], v[152:155]
ds_read_b64_tr_b16 a[98:99], v2 offset:18048
v_mfma_f32_16x16x32_bf16 v[156:159], a[68:71], a[212:215], v[156:159]
ds_read_b64_tr_b16 a[100:101], v2 offset:21632
v_mfma_f32_16x16x32_bf16 v[156:159], a[64:67], a[196:199], v[156:159]
v_mfma_f32_16x16x32_bf16 v[172:175], a[72:75], a[196:199], v[172:175]
ds_read_b64_tr_b16 a[102:103], v2 offset:25216
v_mfma_f32_16x16x32_bf16 v[172:175], a[76:79], a[212:215], v[172:175]
ds_read_b64_tr_b16 a[104:105], v2 offset:14496
v_mfma_f32_16x16x32_bf16 v[168:171], a[76:79], a[208:211], v[168:171]
buffer_load_dwordx4 v9, s[4:7], 0 offen offset:1024 lds
v_mfma_f32_16x16x32_bf16 v[168:171], a[72:75], a[192:195], v[168:171]
v_mfma_f32_16x16x32_bf16 v[164:167], a[72:75], a[188:191], v[164:167]
ds_read_b64_tr_b16 a[106:107], v2 offset:18080
v_mfma_f32_16x16x32_bf16 v[164:167], a[76:79], a[204:207], v[164:167]
ds_read_b64_tr_b16 a[108:109], v2 offset:21664
v_mfma_f32_16x16x32_bf16 v[160:163], a[76:79], a[200:203], v[160:163]
ds_read_b64_tr_b16 a[110:111], v2 offset:25248
v_mfma_f32_16x16x32_bf16 v[160:163], a[72:75], a[184:187], v[160:163]
v_mfma_f32_16x16x32_bf16 v[176:179], a[80:83], a[184:187], v[176:179]
ds_read_b64_tr_b16 a[112:113], v2 offset:14528
v_mfma_f32_16x16x32_bf16 v[176:179], a[84:87], a[200:203], v[176:179]
ds_read_b64_tr_b16 a[114:115], v2 offset:18112
v_mfma_f32_16x16x32_bf16 v[180:183], a[84:87], a[204:207], v[180:183]
buffer_load_dwordx4 v10, s[4:7], 0 offen offset:2048 lds
v_mfma_f32_16x16x32_bf16 v[180:183], a[80:83], a[188:191], v[180:183]
v_mfma_f32_16x16x32_bf16 v[184:187], a[80:83], a[192:195], v[184:187]
ds_read_b64_tr_b16 a[116:117], v2 offset:21696
v_mfma_f32_16x16x32_bf16 v[184:187], a[84:87], a[208:211], v[184:187]
ds_read_b64_tr_b16 a[118:119], v2 offset:25280
v_mfma_f32_16x16x32_bf16 v[188:191], a[84:87], a[212:215], v[188:191]
v_mfma_f32_16x16x32_bf16 v[188:191], a[80:83], a[196:199], v[188:191]
v_mfma_f32_16x16x32_bf16 v[204:207], a[88:91], a[196:199], v[204:207]
v_mfma_f32_16x16x32_bf16 v[200:203], a[88:91], a[192:195], v[200:203]
v_mfma_f32_16x16x32_bf16 v[196:199], a[88:91], a[188:191], v[196:199]
v_mfma_f32_16x16x32_bf16 v[192:195], a[88:91], a[184:187], v[192:195]
s_waitcnt vmcnt(16) lgkmcnt(0)
s_barrier
v_mfma_f32_16x16x32_bf16 v[192:195], a[92:95], a[200:203], v[192:195]
ds_read_b64_tr_b16 a[64:65], v2 offset:32768
v_mfma_f32_16x16x32_bf16 v[196:199], a[92:95], a[204:207], v[196:199]
buffer_load_dwordx4 a[48:51], v1, s[8:11], 0 offen offset:1024 sc1
v_mfma_f32_16x16x32_bf16 v[200:203], a[92:95], a[208:211], v[200:203]
ds_read_b64_tr_b16 a[66:67], v2 offset:36352
v_mfma_f32_16x16x32_bf16 v[204:207], a[92:95], a[212:215], v[204:207]
buffer_load_dwordx4 a[52:55], v1, s[8:11], s32 offen offset:1024 sc1
v_mfma_f32_16x16x32_bf16 v[220:223], a[100:103], a[212:215], v[220:223]
ds_read_b64_tr_b16 a[68:69], v2 offset:39936
v_mfma_f32_16x16x32_bf16 v[220:223], a[96:99], a[196:199], v[220:223]
ds_read_b64_tr_b16 a[70:71], v2 offset:43520
v_mfma_f32_16x16x32_bf16 v[216:219], a[96:99], a[192:195], v[216:219]
buffer_load_dwordx4 a[56:59], v1, s[8:11], s33 offen offset:1024 sc1
v_mfma_f32_16x16x32_bf16 v[216:219], a[100:103], a[208:211], v[216:219]
ds_read_b64_tr_b16 a[72:73], v2 offset:32800
v_mfma_f32_16x16x32_bf16 v[212:215], a[100:103], a[204:207], v[212:215]
buffer_load_dwordx4 a[60:63], v1, s[8:11], s34 offen offset:1024 sc1
v_mfma_f32_16x16x32_bf16 v[212:215], a[96:99], a[188:191], v[212:215]
ds_read_b64_tr_b16 a[74:75], v2 offset:36384
v_mfma_f32_16x16x32_bf16 v[208:211], a[96:99], a[184:187], v[208:211]
ds_read_b64_tr_b16 a[76:77], v2 offset:39968
v_mfma_f32_16x16x32_bf16 v[208:211], a[100:103], a[200:203], v[208:211]
s_xor_b32 s38, s71, 11
s_mul_i32 s38, s38, 458752
s_add_u32 s4, s40, s38
s_addc_u32 s5, s41, 0
v_mfma_f32_16x16x32_bf16 v[224:227], a[108:111], a[200:203], v[224:227]
ds_read_b64_tr_b16 a[78:79], v2 offset:43552
v_mfma_f32_16x16x32_bf16 v[224:227], a[104:107], a[184:187], v[224:227]
ds_read_b64_tr_b16 a[80:81], v2 offset:32832
v_mfma_f32_16x16x32_bf16 v[228:231], a[104:107], a[188:191], v[228:231]
s_add_u32 m0, s35, 32768
s_nop 0
buffer_load_dwordx4 v4, s[4:7], 0 offen offset:0 lds
v_mfma_f32_16x16x32_bf16 v[228:231], a[108:111], a[204:207], v[228:231]
ds_read_b64_tr_b16 a[82:83], v2 offset:36416
v_mfma_f32_16x16x32_bf16 v[232:235], a[108:111], a[208:211], v[232:235]
buffer_load_dwordx4 v5, s[4:7], 0 offen offset:1024 lds
v_mfma_f32_16x16x32_bf16 v[232:235], a[104:107], a[192:195], v[232:235]
ds_read_b64_tr_b16 a[84:85], v2 offset:40000
v_mfma_f32_16x16x32_bf16 v[236:239], a[104:107], a[196:199], v[236:239]
ds_read_b64_tr_b16 a[86:87], v2 offset:43584
v_mfma_f32_16x16x32_bf16 v[236:239], a[108:111], a[212:215], v[236:239]
buffer_load_dwordx4 v6, s[4:7], 0 offen offset:2048 lds
v_mfma_f32_16x16x32_bf16 v[252:255], a[116:119], a[212:215], v[252:255]
ds_read_b64_tr_b16 a[88:89], v2 offset:32864
v_mfma_f32_16x16x32_bf16 v[252:255], a[112:115], a[196:199], v[252:255]
buffer_load_dwordx4 v7, s[4:7], 0 offen offset:3072 lds
v_mfma_f32_16x16x32_bf16 v[248:251], a[112:115], a[192:195], v[248:251]
ds_read_b64_tr_b16 a[90:91], v2 offset:36448
v_mfma_f32_16x16x32_bf16 v[248:251], a[116:119], a[208:211], v[248:251]
v_mfma_f32_16x16x32_bf16 v[244:247], a[116:119], a[204:207], v[244:247]
v_mfma_f32_16x16x32_bf16 v[244:247], a[112:115], a[188:191], v[244:247]
v_mfma_f32_16x16x32_bf16 v[240:243], a[112:115], a[184:187], v[240:243]
v_mfma_f32_16x16x32_bf16 v[240:243], a[116:119], a[200:203], v[240:243]
s_waitcnt vmcnt(20) lgkmcnt(0)
v_mfma_f32_16x16x32_bf16 v[32:35], a[64:67], a[0:3], v[32:35]
ds_read_b64_tr_b16 a[92:93], v2 offset:40032
v_mfma_f32_16x16x32_bf16 v[32:35], a[68:71], a[16:19], v[32:35]
ds_read_b64_tr_b16 a[94:95], v2 offset:43616
v_mfma_f32_16x16x32_bf16 v[36:39], a[68:71], a[20:23], v[36:39]
v_mfma_f32_16x16x32_bf16 v[36:39], a[64:67], a[4:7], v[36:39]
ds_read_b64_tr_b16 a[96:97], v2 offset:32896
v_mfma_f32_16x16x32_bf16 v[40:43], a[64:67], a[8:11], v[40:43]
ds_read_b64_tr_b16 a[98:99], v2 offset:36480
v_mfma_f32_16x16x32_bf16 v[40:43], a[68:71], a[24:27], v[40:43]
v_mfma_f32_16x16x32_bf16 v[44:47], a[68:71], a[28:31], v[44:47]
ds_read_b64_tr_b16 a[100:101], v2 offset:40064
v_mfma_f32_16x16x32_bf16 v[44:47], a[64:67], a[12:15], v[44:47]
v_mfma_f32_16x16x32_bf16 v[60:63], a[72:75], a[12:15], v[60:63]
ds_read_b64_tr_b16 a[102:103], v2 offset:43648
v_mfma_f32_16x16x32_bf16 v[60:63], a[76:79], a[28:31], v[60:63]
ds_read_b64_tr_b16 a[104:105], v2 offset:32928
v_mfma_f32_16x16x32_bf16 v[56:59], a[76:79], a[24:27], v[56:59]
v_mfma_f32_16x16x32_bf16 v[56:59], a[72:75], a[8:11], v[56:59]
ds_read_b64_tr_b16 a[106:107], v2 offset:36512
v_mfma_f32_16x16x32_bf16 v[52:55], a[72:75], a[4:7], v[52:55]
v_mfma_f32_16x16x32_bf16 v[52:55], a[76:79], a[20:23], v[52:55]
ds_read_b64_tr_b16 a[108:109], v2 offset:40096
v_mfma_f32_16x16x32_bf16 v[48:51], a[76:79], a[16:19], v[48:51]
ds_read_b64_tr_b16 a[110:111], v2 offset:43680
v_mfma_f32_16x16x32_bf16 v[48:51], a[72:75], a[0:3], v[48:51]
v_mfma_f32_16x16x32_bf16 v[64:67], a[80:83], a[0:3], v[64:67]
ds_read_b64_tr_b16 a[112:113], v2 offset:32960
v_mfma_f32_16x16x32_bf16 v[64:67], a[84:87], a[16:19], v[64:67]
s_lshl_b32 s39, s69, 11
s_add_u32 s39, s39, 63963136
s_add_u32 s61, s39, 4096
v_lshlrev_b32 v12, 4, v0
v_mfma_f32_16x16x32_bf16 v[68:71], a[84:87], a[20:23], v[68:71]
ds_read_b64_tr_b16 a[114:115], v2 offset:36544
v_mfma_f32_16x16x32_bf16 v[68:71], a[80:83], a[4:7], v[68:71]
ds_read_b64_tr_b16 a[116:117], v2 offset:40128
v_mfma_f32_16x16x32_bf16 v[72:75], a[80:83], a[8:11], v[72:75]
v_mfma_f32_16x16x32_bf16 v[72:75], a[84:87], a[24:27], v[72:75]
ds_read_b64_tr_b16 a[118:119], v2 offset:43712
v_mfma_f32_16x16x32_bf16 v[76:79], a[84:87], a[28:31], v[76:79]
v_mfma_f32_16x16x32_bf16 v[76:79], a[80:83], a[12:15], v[76:79]
buffer_load_dwordx4 a[152:155], v12, s[12:15], s39 offen offset:0 sc1
v_mfma_f32_16x16x32_bf16 v[92:95], a[88:91], a[12:15], v[92:95]
v_mfma_f32_16x16x32_bf16 v[88:91], a[88:91], a[8:11], v[88:91]
v_mfma_f32_16x16x32_bf16 v[84:87], a[88:91], a[4:7], v[84:87]
v_mfma_f32_16x16x32_bf16 v[80:83], a[88:91], a[0:3], v[80:83]
buffer_load_dwordx4 a[156:159], v12, s[12:15], s39 offen offset:1024 sc1
s_waitcnt vmcnt(22) lgkmcnt(0)
v_mfma_f32_16x16x32_bf16 v[80:83], a[92:95], a[16:19], v[80:83]
ds_read_b64_tr_b16 a[64:65], v2 offset:47104
v_mfma_f32_16x16x32_bf16 v[84:87], a[92:95], a[20:23], v[84:87]
s_xor_b32 s38, s71, 11
s_lshl_b32 s38, s38, 11
s_add_u32 s8, s42, s38
s_addc_u32 s9, s43, 0
v_mfma_f32_16x16x32_bf16 v[88:91], a[92:95], a[24:27], v[88:91]
ds_read_b64_tr_b16 a[66:67], v2 offset:50688
v_mfma_f32_16x16x32_bf16 v[92:95], a[92:95], a[28:31], v[92:95]
ds_read_b64_tr_b16 a[68:69], v2 offset:54272
v_mfma_f32_16x16x32_bf16 v[108:111], a[100:103], a[28:31], v[108:111]
buffer_load_dwordx4 a[184:187], v1, s[8:11], 0 offen offset:0 sc1
v_mfma_f32_16x16x32_bf16 v[108:111], a[96:99], a[12:15], v[108:111]
ds_read_b64_tr_b16 a[70:71], v2 offset:57856
v_mfma_f32_16x16x32_bf16 v[104:107], a[96:99], a[8:11], v[104:107]
buffer_load_dwordx4 a[188:191], v1, s[8:11], s32 offen offset:0 sc1
v_mfma_f32_16x16x32_bf16 v[104:107], a[100:103], a[24:27], v[104:107]
ds_read_b64_tr_b16 a[72:73], v2 offset:47136
v_mfma_f32_16x16x32_bf16 v[100:103], a[100:103], a[20:23], v[100:103]
ds_read_b64_tr_b16 a[74:75], v2 offset:50720
v_mfma_f32_16x16x32_bf16 v[100:103], a[96:99], a[4:7], v[100:103]
buffer_load_dwordx4 a[192:195], v1, s[8:11], s33 offen offset:0 sc1
v_mfma_f32_16x16x32_bf16 v[96:99], a[96:99], a[0:3], v[96:99]
ds_read_b64_tr_b16 a[76:77], v2 offset:54304
v_mfma_f32_16x16x32_bf16 v[96:99], a[100:103], a[16:19], v[96:99]
ds_read_b64_tr_b16 a[78:79], v2 offset:57888
v_mfma_f32_16x16x32_bf16 v[112:115], a[108:111], a[16:19], v[112:115]
buffer_load_dwordx4 a[196:199], v1, s[8:11], s34 offen offset:0 sc1
v_mfma_f32_16x16x32_bf16 v[112:115], a[104:107], a[0:3], v[112:115]
ds_read_b64_tr_b16 a[80:81], v2 offset:47168
v_mfma_f32_16x16x32_bf16 v[116:119], a[104:107], a[4:7], v[116:119]
ds_read_b64_tr_b16 a[82:83], v2 offset:50752
v_mfma_f32_16x16x32_bf16 v[116:119], a[108:111], a[20:23], v[116:119]
s_add_u32 m0, s35, 36864
s_nop 0
buffer_load_dwordx4 v8, s[4:7], 0 offen offset:0 lds
v_mfma_f32_16x16x32_bf16 v[120:123], a[108:111], a[24:27], v[120:123]
ds_read_b64_tr_b16 a[84:85], v2 offset:54336
v_mfma_f32_16x16x32_bf16 v[120:123], a[104:107], a[8:11], v[120:123]
buffer_load_dwordx4 v9, s[4:7], 0 offen offset:1024 lds
buffer_load_dwordx4 a[160:163], v12, s[12:15], s39 offen offset:2048 sc1
v_mfma_f32_16x16x32_bf16 v[124:127], a[104:107], a[12:15], v[124:127]
ds_read_b64_tr_b16 a[86:87], v2 offset:57920
v_mfma_f32_16x16x32_bf16 v[124:127], a[108:111], a[28:31], v[124:127]
ds_read_b64_tr_b16 a[88:89], v2 offset:47200
v_mfma_f32_16x16x32_bf16 v[140:143], a[116:119], a[28:31], v[140:143]
buffer_load_dwordx4 v10, s[4:7], 0 offen offset:2048 lds
v_mfma_f32_16x16x32_bf16 v[140:143], a[112:115], a[12:15], v[140:143]
ds_read_b64_tr_b16 a[90:91], v2 offset:50784
v_mfma_f32_16x16x32_bf16 v[136:139], a[112:115], a[8:11], v[136:139]
v_mfma_f32_16x16x32_bf16 v[136:139], a[116:119], a[24:27], v[136:139]
v_mfma_f32_16x16x32_bf16 v[132:135], a[116:119], a[20:23], v[132:135]
v_mfma_f32_16x16x32_bf16 v[132:135], a[112:115], a[4:7], v[132:135]
v_mfma_f32_16x16x32_bf16 v[128:131], a[112:115], a[0:3], v[128:131]
v_mfma_f32_16x16x32_bf16 v[128:131], a[116:119], a[16:19], v[128:131]
buffer_load_dwordx4 a[164:167], v12, s[12:15], s39 offen offset:3072 sc1
s_waitcnt lgkmcnt(0)
v_mfma_f32_16x16x32_bf16 v[144:147], a[64:67], a[0:3], v[144:147]
ds_read_b64_tr_b16 a[92:93], v2 offset:54368
v_mfma_f32_16x16x32_bf16 v[144:147], a[68:71], a[16:19], v[144:147]
ds_read_b64_tr_b16 a[94:95], v2 offset:57952
v_mfma_f32_16x16x32_bf16 v[148:151], a[68:71], a[20:23], v[148:151]
v_mfma_f32_16x16x32_bf16 v[148:151], a[64:67], a[4:7], v[148:151]
ds_read_b64_tr_b16 a[96:97], v2 offset:47232
v_mfma_f32_16x16x32_bf16 v[152:155], a[64:67], a[8:11], v[152:155]
ds_read_b64_tr_b16 a[98:99], v2 offset:50816
v_mfma_f32_16x16x32_bf16 v[152:155], a[68:71], a[24:27], v[152:155]
v_mfma_f32_16x16x32_bf16 v[156:159], a[68:71], a[28:31], v[156:159]
ds_read_b64_tr_b16 a[100:101], v2 offset:54400
v_mfma_f32_16x16x32_bf16 v[156:159], a[64:67], a[12:15], v[156:159]
v_mfma_f32_16x16x32_bf16 v[172:175], a[72:75], a[12:15], v[172:175]
ds_read_b64_tr_b16 a[102:103], v2 offset:57984
v_mfma_f32_16x16x32_bf16 v[172:175], a[76:79], a[28:31], v[172:175]
ds_read_b64_tr_b16 a[104:105], v2 offset:47264
v_mfma_f32_16x16x32_bf16 v[168:171], a[76:79], a[24:27], v[168:171]
v_mfma_f32_16x16x32_bf16 v[168:171], a[72:75], a[8:11], v[168:171]
ds_read_b64_tr_b16 a[106:107], v2 offset:50848
v_mfma_f32_16x16x32_bf16 v[164:167], a[72:75], a[4:7], v[164:167]
v_mfma_f32_16x16x32_bf16 v[164:167], a[76:79], a[20:23], v[164:167]
ds_read_b64_tr_b16 a[108:109], v2 offset:54432
v_mfma_f32_16x16x32_bf16 v[160:163], a[76:79], a[16:19], v[160:163]
ds_read_b64_tr_b16 a[110:111], v2 offset:58016
v_mfma_f32_16x16x32_bf16 v[160:163], a[72:75], a[0:3], v[160:163]
buffer_load_dwordx4 a[168:171], v12, s[12:15], s61 offen offset:0 sc1
v_mfma_f32_16x16x32_bf16 v[176:179], a[80:83], a[0:3], v[176:179]
ds_read_b64_tr_b16 a[112:113], v2 offset:47296
v_mfma_f32_16x16x32_bf16 v[176:179], a[84:87], a[16:19], v[176:179]
v_mfma_f32_16x16x32_bf16 v[180:183], a[84:87], a[20:23], v[180:183]
ds_read_b64_tr_b16 a[114:115], v2 offset:50880
v_mfma_f32_16x16x32_bf16 v[180:183], a[80:83], a[4:7], v[180:183]
ds_read_b64_tr_b16 a[116:117], v2 offset:54464
v_mfma_f32_16x16x32_bf16 v[184:187], a[80:83], a[8:11], v[184:187]
v_mfma_f32_16x16x32_bf16 v[184:187], a[84:87], a[24:27], v[184:187]
ds_read_b64_tr_b16 a[118:119], v2 offset:58048
v_mfma_f32_16x16x32_bf16 v[188:191], a[84:87], a[28:31], v[188:191]
v_mfma_f32_16x16x32_bf16 v[188:191], a[80:83], a[12:15], v[188:191]
v_mfma_f32_16x16x32_bf16 v[204:207], a[88:91], a[12:15], v[204:207]
v_mfma_f32_16x16x32_bf16 v[200:203], a[88:91], a[8:11], v[200:203]
v_mfma_f32_16x16x32_bf16 v[196:199], a[88:91], a[4:7], v[196:199]
v_mfma_f32_16x16x32_bf16 v[192:195], a[88:91], a[0:3], v[192:195]
buffer_load_dwordx4 a[172:175], v12, s[12:15], s61 offen offset:1024 sc1
s_waitcnt vmcnt(21) lgkmcnt(0)
s_barrier
v_mfma_f32_16x16x32_bf16 v[192:195], a[92:95], a[16:19], v[192:195]
ds_read_b64_tr_b16 a[64:65], v3 offset:0
v_mfma_f32_16x16x32_bf16 v[196:199], a[92:95], a[20:23], v[196:199]
buffer_load_dwordx4 a[200:203], v1, s[8:11], 0 offen offset:1024 sc1
v_mfma_f32_16x16x32_bf16 v[200:203], a[92:95], a[24:27], v[200:203]
ds_read_b64_tr_b16 a[66:67], v3 offset:3584
v_mfma_f32_16x16x32_bf16 v[204:207], a[92:95], a[28:31], v[204:207]
buffer_load_dwordx4 a[204:207], v1, s[8:11], s32 offen offset:1024 sc1
v_mfma_f32_16x16x32_bf16 v[220:223], a[100:103], a[28:31], v[220:223]
ds_read_b64_tr_b16 a[68:69], v3 offset:7168
v_mfma_f32_16x16x32_bf16 v[220:223], a[96:99], a[12:15], v[220:223]
ds_read_b64_tr_b16 a[70:71], v3 offset:10752
v_mfma_f32_16x16x32_bf16 v[216:219], a[96:99], a[8:11], v[216:219]
buffer_load_dwordx4 a[208:211], v1, s[8:11], s33 offen offset:1024 sc1
v_mfma_f32_16x16x32_bf16 v[216:219], a[100:103], a[24:27], v[216:219]
ds_read_b64_tr_b16 a[72:73], v3 offset:32
v_mfma_f32_16x16x32_bf16 v[212:215], a[100:103], a[20:23], v[212:215]
buffer_load_dwordx4 a[212:215], v1, s[8:11], s34 offen offset:1024 sc1
v_mfma_f32_16x16x32_bf16 v[212:215], a[96:99], a[4:7], v[212:215]
ds_read_b64_tr_b16 a[74:75], v3 offset:3616
v_mfma_f32_16x16x32_bf16 v[208:211], a[96:99], a[0:3], v[208:211]
ds_read_b64_tr_b16 a[76:77], v3 offset:7200
v_mfma_f32_16x16x32_bf16 v[208:211], a[100:103], a[16:19], v[208:211]
s_xor_b32 s38, s71, 12
s_mul_i32 s38, s38, 458752
s_add_u32 s4, s40, s38
s_addc_u32 s5, s41, 0
v_mfma_f32_16x16x32_bf16 v[224:227], a[108:111], a[16:19], v[224:227]
ds_read_b64_tr_b16 a[78:79], v3 offset:10784
v_mfma_f32_16x16x32_bf16 v[224:227], a[104:107], a[0:3], v[224:227]
ds_read_b64_tr_b16 a[80:81], v3 offset:64
v_mfma_f32_16x16x32_bf16 v[228:231], a[104:107], a[4:7], v[228:231]
s_add_u32 m0, s35, 65536
s_nop 0
buffer_load_dwordx4 v4, s[4:7], 0 offen offset:0 lds
v_mfma_f32_16x16x32_bf16 v[228:231], a[108:111], a[20:23], v[228:231]
ds_read_b64_tr_b16 a[82:83], v3 offset:3648
v_mfma_f32_16x16x32_bf16 v[232:235], a[108:111], a[24:27], v[232:235]
buffer_load_dwordx4 v5, s[4:7], 0 offen offset:1024 lds
v_mfma_f32_16x16x32_bf16 v[232:235], a[104:107], a[8:11], v[232:235]
ds_read_b64_tr_b16 a[84:85], v3 offset:7232
buffer_load_dwordx4 a[176:179], v12, s[12:15], s61 offen offset:2048 sc1
v_mfma_f32_16x16x32_bf16 v[236:239], a[104:107], a[12:15], v[236:239]
ds_read_b64_tr_b16 a[86:87], v3 offset:10816
v_mfma_f32_16x16x32_bf16 v[236:239], a[108:111], a[28:31], v[236:239]
buffer_load_dwordx4 v6, s[4:7], 0 offen offset:2048 lds
v_mfma_f32_16x16x32_bf16 v[252:255], a[116:119], a[28:31], v[252:255]
ds_read_b64_tr_b16 a[88:89], v3 offset:96
v_mfma_f32_16x16x32_bf16 v[252:255], a[112:115], a[12:15], v[252:255]
buffer_load_dwordx4 v7, s[4:7], 0 offen offset:3072 lds
v_mfma_f32_16x16x32_bf16 v[248:251], a[112:115], a[8:11], v[248:251]
ds_read_b64_tr_b16 a[90:91], v3 offset:3680
v_mfma_f32_16x16x32_bf16 v[248:251], a[116:119], a[24:27], v[248:251]
v_mfma_f32_16x16x32_bf16 v[244:247], a[116:119], a[20:23], v[244:247]
v_mfma_f32_16x16x32_bf16 v[244:247], a[112:115], a[4:7], v[244:247]
v_mfma_f32_16x16x32_bf16 v[240:243], a[112:115], a[0:3], v[240:243]
v_mfma_f32_16x16x32_bf16 v[240:243], a[116:119], a[16:19], v[240:243]
buffer_load_dwordx4 a[180:183], v12, s[12:15], s61 offen offset:3072 sc1
s_waitcnt vmcnt(27) lgkmcnt(0)
v_mfma_f32_16x16x32_bf16 v[32:35], a[64:67], a[32:35], v[32:35]
ds_read_b64_tr_b16 a[92:93], v3 offset:7264
v_mfma_f32_16x16x32_bf16 v[32:35], a[68:71], a[48:51], v[32:35]
ds_read_b64_tr_b16 a[94:95], v3 offset:10848
v_mfma_f32_16x16x32_bf16 v[36:39], a[68:71], a[52:55], v[36:39]
v_mfma_f32_16x16x32_bf16 v[36:39], a[64:67], a[36:39], v[36:39]
ds_read_b64_tr_b16 a[96:97], v3 offset:128
v_mfma_f32_16x16x32_bf16 v[40:43], a[64:67], a[40:43], v[40:43]
ds_read_b64_tr_b16 a[98:99], v3 offset:3712
v_mfma_f32_16x16x32_bf16 v[40:43], a[68:71], a[56:59], v[40:43]
v_mfma_f32_16x16x32_bf16 v[44:47], a[68:71], a[60:63], v[44:47]
ds_read_b64_tr_b16 a[100:101], v3 offset:7296
v_mfma_f32_16x16x32_bf16 v[44:47], a[64:67], a[44:47], v[44:47]
v_mfma_f32_16x16x32_bf16 v[60:63], a[72:75], a[44:47], v[60:63]
ds_read_b64_tr_b16 a[102:103], v3 offset:10880
v_mfma_f32_16x16x32_bf16 v[60:63], a[76:79], a[60:63], v[60:63]
ds_read_b64_tr_b16 a[104:105], v3 offset:160
v_mfma_f32_16x16x32_bf16 v[56:59], a[76:79], a[56:59], v[56:59]
v_mfma_f32_16x16x32_bf16 v[56:59], a[72:75], a[40:43], v[56:59]
ds_read_b64_tr_b16 a[106:107], v3 offset:3744
v_mfma_f32_16x16x32_bf16 v[52:55], a[72:75], a[36:39], v[52:55]
v_mfma_f32_16x16x32_bf16 v[52:55], a[76:79], a[52:55], v[52:55]
ds_read_b64_tr_b16 a[108:109], v3 offset:7328
v_mfma_f32_16x16x32_bf16 v[48:51], a[76:79], a[48:51], v[48:51]
ds_read_b64_tr_b16 a[110:111], v3 offset:10912
v_mfma_f32_16x16x32_bf16 v[48:51], a[72:75], a[32:35], v[48:51]
v_mfma_f32_16x16x32_bf16 v[64:67], a[80:83], a[32:35], v[64:67]
ds_read_b64_tr_b16 a[112:113], v3 offset:192
v_mfma_f32_16x16x32_bf16 v[64:67], a[84:87], a[48:51], v[64:67]
v_mfma_f32_16x16x32_bf16 v[68:71], a[84:87], a[52:55], v[68:71]
ds_read_b64_tr_b16 a[114:115], v3 offset:3776
v_mfma_f32_16x16x32_bf16 v[68:71], a[80:83], a[36:39], v[68:71]
ds_read_b64_tr_b16 a[116:117], v3 offset:7360
v_mfma_f32_16x16x32_bf16 v[72:75], a[80:83], a[40:43], v[72:75]
v_mfma_f32_16x16x32_bf16 v[72:75], a[84:87], a[56:59], v[72:75]
ds_read_b64_tr_b16 a[118:119], v3 offset:10944
v_mfma_f32_16x16x32_bf16 v[76:79], a[84:87], a[60:63], v[76:79]
v_mfma_f32_16x16x32_bf16 v[76:79], a[80:83], a[44:47], v[76:79]
v_mfma_f32_16x16x32_bf16 v[92:95], a[88:91], a[44:47], v[92:95]
v_mfma_f32_16x16x32_bf16 v[88:91], a[88:91], a[40:43], v[88:91]
v_mfma_f32_16x16x32_bf16 v[84:87], a[88:91], a[36:39], v[84:87]
v_mfma_f32_16x16x32_bf16 v[80:83], a[88:91], a[32:35], v[80:83]
s_waitcnt vmcnt(27) lgkmcnt(0)
v_mfma_f32_16x16x32_bf16 v[80:83], a[92:95], a[48:51], v[80:83]
ds_read_b64_tr_b16 a[64:65], v3 offset:14336
v_mfma_f32_16x16x32_bf16 v[84:87], a[92:95], a[52:55], v[84:87]
s_xor_b32 s38, s71, 12
s_lshl_b32 s38, s38, 11
s_add_u32 s8, s42, s38
s_addc_u32 s9, s43, 0
v_mfma_f32_16x16x32_bf16 v[88:91], a[92:95], a[56:59], v[88:91]
ds_read_b64_tr_b16 a[66:67], v3 offset:17920
v_mfma_f32_16x16x32_bf16 v[92:95], a[92:95], a[60:63], v[92:95]
ds_read_b64_tr_b16 a[68:69], v3 offset:21504
v_mfma_f32_16x16x32_bf16 v[108:111], a[100:103], a[60:63], v[108:111]
buffer_load_dwordx4 a[0:3], v1, s[8:11], 0 offen offset:0 sc1
v_mfma_f32_16x16x32_bf16 v[108:111], a[96:99], a[44:47], v[108:111]
ds_read_b64_tr_b16 a[70:71], v3 offset:25088
v_mfma_f32_16x16x32_bf16 v[104:107], a[96:99], a[40:43], v[104:107]
buffer_load_dwordx4 a[4:7], v1, s[8:11], s32 offen offset:0 sc1
v_mfma_f32_16x16x32_bf16 v[104:107], a[100:103], a[56:59], v[104:107]
ds_read_b64_tr_b16 a[72:73], v3 offset:14368
v_mfma_f32_16x16x32_bf16 v[100:103], a[100:103], a[52:55], v[100:103]
ds_read_b64_tr_b16 a[74:75], v3 offset:17952
v_mfma_f32_16x16x32_bf16 v[100:103], a[96:99], a[36:39], v[100:103]
buffer_load_dwordx4 a[8:11], v1, s[8:11], s33 offen offset:0 sc1
v_mfma_f32_16x16x32_bf16 v[96:99], a[96:99], a[32:35], v[96:99]
ds_read_b64_tr_b16 a[76:77], v3 offset:21536
v_mfma_f32_16x16x32_bf16 v[96:99], a[100:103], a[48:51], v[96:99]
ds_read_b64_tr_b16 a[78:79], v3 offset:25120
v_mfma_f32_16x16x32_bf16 v[112:115], a[108:111], a[48:51], v[112:115]
buffer_load_dwordx4 a[12:15], v1, s[8:11], s34 offen offset:0 sc1
v_mfma_f32_16x16x32_bf16 v[112:115], a[104:107], a[32:35], v[112:115]
ds_read_b64_tr_b16 a[80:81], v3 offset:14400
v_mfma_f32_16x16x32_bf16 v[116:119], a[104:107], a[36:39], v[116:119]
ds_read_b64_tr_b16 a[82:83], v3 offset:17984
v_mfma_f32_16x16x32_bf16 v[116:119], a[108:111], a[52:55], v[116:119]
s_add_u32 m0, s35, 69632
s_nop 0
buffer_load_dwordx4 v8, s[4:7], 0 offen offset:0 lds
v_mfma_f32_16x16x32_bf16 v[120:123], a[108:111], a[56:59], v[120:123]
ds_read_b64_tr_b16 a[84:85], v3 offset:21568
v_mfma_f32_16x16x32_bf16 v[120:123], a[104:107], a[40:43], v[120:123]
buffer_load_dwordx4 v9, s[4:7], 0 offen offset:1024 lds
v_mfma_f32_16x16x32_bf16 v[124:127], a[104:107], a[44:47], v[124:127]
ds_read_b64_tr_b16 a[86:87], v3 offset:25152
v_mfma_f32_16x16x32_bf16 v[124:127], a[108:111], a[60:63], v[124:127]
ds_read_b64_tr_b16 a[88:89], v3 offset:14432
v_mfma_f32_16x16x32_bf16 v[140:143], a[116:119], a[60:63], v[140:143]
buffer_load_dwordx4 v10, s[4:7], 0 offen offset:2048 lds
v_mfma_f32_16x16x32_bf16 v[140:143], a[112:115], a[44:47], v[140:143]
ds_read_b64_tr_b16 a[90:91], v3 offset:18016
v_mfma_f32_16x16x32_bf16 v[136:139], a[112:115], a[40:43], v[136:139]
v_mfma_f32_16x16x32_bf16 v[136:139], a[116:119], a[56:59], v[136:139]
v_mfma_f32_16x16x32_bf16 v[132:135], a[116:119], a[52:55], v[132:135]
v_mfma_f32_16x16x32_bf16 v[132:135], a[112:115], a[36:39], v[132:135]
v_mfma_f32_16x16x32_bf16 v[128:131], a[112:115], a[32:35], v[128:131]
v_mfma_f32_16x16x32_bf16 v[128:131], a[116:119], a[48:51], v[128:131]
s_waitcnt lgkmcnt(0)
v_mfma_f32_16x16x32_bf16 v[144:147], a[64:67], a[32:35], v[144:147]
ds_read_b64_tr_b16 a[92:93], v3 offset:21600
v_mfma_f32_16x16x32_bf16 v[144:147], a[68:71], a[48:51], v[144:147]
buffer_load_dwordx4 a[16:19], v1, s[8:11], 0 offen offset:1024 sc1
v_mfma_f32_16x16x32_bf16 v[148:151], a[68:71], a[52:55], v[148:151]
ds_read_b64_tr_b16 a[94:95], v3 offset:25184
v_mfma_f32_16x16x32_bf16 v[148:151], a[64:67], a[36:39], v[148:151]
buffer_load_dwordx4 a[20:23], v1, s[8:11], s32 offen offset:1024 sc1
v_mfma_f32_16x16x32_bf16 v[152:155], a[64:67], a[40:43], v[152:155]
ds_read_b64_tr_b16 a[96:97], v3 offset:14464
v_mfma_f32_16x16x32_bf16 v[152:155], a[68:71], a[56:59], v[152:155]
ds_read_b64_tr_b16 a[98:99], v3 offset:18048
v_mfma_f32_16x16x32_bf16 v[156:159], a[68:71], a[60:63], v[156:159]
buffer_load_dwordx4 a[24:27], v1, s[8:11], s33 offen offset:1024 sc1
v_mfma_f32_16x16x32_bf16 v[156:159], a[64:67], a[44:47], v[156:159]
ds_read_b64_tr_b16 a[100:101], v3 offset:21632
v_mfma_f32_16x16x32_bf16 v[172:175], a[72:75], a[44:47], v[172:175]
buffer_load_dwordx4 a[28:31], v1, s[8:11], s34 offen offset:1024 sc1
v_mfma_f32_16x16x32_bf16 v[172:175], a[76:79], a[60:63], v[172:175]
ds_read_b64_tr_b16 a[102:103], v3 offset:25216
v_mfma_f32_16x16x32_bf16 v[168:171], a[76:79], a[56:59], v[168:171]
ds_read_b64_tr_b16 a[104:105], v3 offset:14496
v_mfma_f32_16x16x32_bf16 v[168:171], a[72:75], a[40:43], v[168:171]
s_xor_b32 s38, s71, 13
s_mul_i32 s38, s38, 458752
s_add_u32 s4, s40, s38
s_addc_u32 s5, s41, 0
v_mfma_f32_16x16x32_bf16 v[164:167], a[72:75], a[36:39], v[164:167]
ds_read_b64_tr_b16 a[106:107], v3 offset:18080
v_mfma_f32_16x16x32_bf16 v[164:167], a[76:79], a[52:55], v[164:167]
ds_read_b64_tr_b16 a[108:109], v3 offset:21664
v_mfma_f32_16x16x32_bf16 v[160:163], a[76:79], a[48:51], v[160:163]
s_add_u32 m0, s35, 98304
s_nop 0
buffer_load_dwordx4 v4, s[4:7], 0 offen offset:0 lds
v_mfma_f32_16x16x32_bf16 v[160:163], a[72:75], a[32:35], v[160:163]
ds_read_b64_tr_b16 a[110:111], v3 offset:25248
v_mfma_f32_16x16x32_bf16 v[176:179], a[80:83], a[32:35], v[176:179]
buffer_load_dwordx4 v5, s[4:7], 0 offen offset:1024 lds
v_mfma_f32_16x16x32_bf16 v[176:179], a[84:87], a[48:51], v[176:179]
ds_read_b64_tr_b16 a[112:113], v3 offset:14528
v_mfma_f32_16x16x32_bf16 v[180:183], a[84:87], a[52:55], v[180:183]
ds_read_b64_tr_b16 a[114:115], v3 offset:18112
v_mfma_f32_16x16x32_bf16 v[180:183], a[80:83], a[36:39], v[180:183]
buffer_load_dwordx4 v6, s[4:7], 0 offen offset:2048 lds
v_mfma_f32_16x16x32_bf16 v[184:187], a[80:83], a[40:43], v[184:187]
ds_read_b64_tr_b16 a[116:117], v3 offset:21696
v_mfma_f32_16x16x32_bf16 v[184:187], a[84:87], a[56:59], v[184:187]
buffer_load_dwordx4 v7, s[4:7], 0 offen offset:3072 lds
v_mfma_f32_16x16x32_bf16 v[188:191], a[84:87], a[60:63], v[188:191]
ds_read_b64_tr_b16 a[118:119], v3 offset:25280
v_mfma_f32_16x16x32_bf16 v[188:191], a[80:83], a[44:47], v[188:191]
v_mfma_f32_16x16x32_bf16 v[204:207], a[88:91], a[44:47], v[204:207]
v_mfma_f32_16x16x32_bf16 v[200:203], a[88:91], a[40:43], v[200:203]
v_mfma_f32_16x16x32_bf16 v[196:199], a[88:91], a[36:39], v[196:199]
v_mfma_f32_16x16x32_bf16 v[192:195], a[88:91], a[32:35], v[192:195]
s_waitcnt vmcnt(28) lgkmcnt(0)
s_barrier
v_mfma_f32_16x16x32_bf16 v[192:195], a[92:95], a[48:51], v[192:195]
ds_read_b64_tr_b16 a[64:65], v3 offset:32768
v_mfma_f32_16x16x32_bf16 v[196:199], a[92:95], a[52:55], v[196:199]
ds_read_b64_tr_b16 a[66:67], v3 offset:36352
v_mfma_f32_16x16x32_bf16 v[200:203], a[92:95], a[56:59], v[200:203]
v_mfma_f32_16x16x32_bf16 v[204:207], a[92:95], a[60:63], v[204:207]
ds_read_b64_tr_b16 a[68:69], v3 offset:39936
v_mfma_f32_16x16x32_bf16 v[220:223], a[100:103], a[60:63], v[220:223]
ds_read_b64_tr_b16 a[70:71], v3 offset:43520
v_mfma_f32_16x16x32_bf16 v[220:223], a[96:99], a[44:47], v[220:223]
v_mfma_f32_16x16x32_bf16 v[216:219], a[96:99], a[40:43], v[216:219]
ds_read_b64_tr_b16 a[72:73], v3 offset:32800
v_mfma_f32_16x16x32_bf16 v[216:219], a[100:103], a[56:59], v[216:219]
s_add_u32 s39, s56, 0
buffer_load_dwordx4 a[228:231], v1, s[12:15], s39 offen sc1
v_mfma_f32_16x16x32_bf16 v[212:215], a[100:103], a[52:55], v[212:215]
ds_read_b64_tr_b16 a[74:75], v3 offset:36384
v_mfma_f32_16x16x32_bf16 v[212:215], a[96:99], a[36:39], v[212:215]
ds_read_b64_tr_b16 a[76:77], v3 offset:39968
v_mfma_f32_16x16x32_bf16 v[208:211], a[96:99], a[32:35], v[208:211]
v_mfma_f32_16x16x32_bf16 v[208:211], a[100:103], a[48:51], v[208:211]
ds_read_b64_tr_b16 a[78:79], v3 offset:43552
v_mfma_f32_16x16x32_bf16 v[224:227], a[108:111], a[48:51], v[224:227]
v_mfma_f32_16x16x32_bf16 v[224:227], a[104:107], a[32:35], v[224:227]
ds_read_b64_tr_b16 a[80:81], v3 offset:32832
v_mfma_f32_16x16x32_bf16 v[228:231], a[104:107], a[36:39], v[228:231]
ds_read_b64_tr_b16 a[82:83], v3 offset:36416
v_mfma_f32_16x16x32_bf16 v[228:231], a[108:111], a[52:55], v[228:231]
s_add_u32 s39, s56, 32768
buffer_load_dwordx4 a[232:235], v1, s[12:15], s39 offen sc1
v_mfma_f32_16x16x32_bf16 v[232:235], a[108:111], a[56:59], v[232:235]
ds_read_b64_tr_b16 a[84:85], v3 offset:40000
v_mfma_f32_16x16x32_bf16 v[232:235], a[104:107], a[40:43], v[232:235]
L_wp18:
s_cbranch_execz L_wp21
v_mfma_f32_16x16x32_bf16 v[236:239], a[104:107], a[44:47], v[236:239]
ds_read_b64_tr_b16 a[86:87], v3 offset:43584
v_mfma_f32_16x16x32_bf16 v[236:239], a[108:111], a[60:63], v[236:239]
ds_read_b64_tr_b16 a[88:89], v3 offset:32864
v_mfma_f32_16x16x32_bf16 v[252:255], a[116:119], a[60:63], v[252:255]
v_mfma_f32_16x16x32_bf16 v[252:255], a[112:115], a[44:47], v[252:255]
ds_read_b64_tr_b16 a[90:91], v3 offset:36448
v_mfma_f32_16x16x32_bf16 v[248:251], a[112:115], a[40:43], v[248:251]
s_add_u32 s39, s56, 65536
buffer_load_dwordx4 a[236:239], v1, s[12:15], s39 offen sc1
v_mfma_f32_16x16x32_bf16 v[248:251], a[116:119], a[56:59], v[248:251]
v_mfma_f32_16x16x32_bf16 v[244:247], a[116:119], a[52:55], v[244:247]
v_mfma_f32_16x16x32_bf16 v[244:247], a[112:115], a[36:39], v[244:247]
v_mfma_f32_16x16x32_bf16 v[240:243], a[112:115], a[32:35], v[240:243]
v_mfma_f32_16x16x32_bf16 v[240:243], a[116:119], a[48:51], v[240:243]
s_add_u32 s39, s56, 98304
buffer_load_dwordx4 a[240:243], v1, s[12:15], s39 offen sc1
s_waitcnt vmcnt(25) lgkmcnt(0)
s_waitcnt vmcnt(19)
v_mfma_f32_16x16x32_bf16 v[32:35], a[64:67], a[184:187], v[32:35]
ds_read_b64_tr_b16 a[92:93], v3 offset:40032
v_mfma_f32_16x16x32_bf16 v[32:35], a[68:71], a[200:203], v[32:35]
s_xor_b32 s38, s71, 13
s_lshl_b32 s38, s38, 11
s_add_u32 s8, s42, s38
s_addc_u32 s9, s43, 0
v_mfma_f32_16x16x32_bf16 v[36:39], a[68:71], a[204:207], v[36:39]
ds_read_b64_tr_b16 a[94:95], v3 offset:43616
v_mfma_f32_16x16x32_bf16 v[36:39], a[64:67], a[188:191], v[36:39]
ds_read_b64_tr_b16 a[96:97], v3 offset:32896
v_accvgpr_read_b32 v12, a152
v_mfma_f32_16x16x32_bf16 v[40:43], a[64:67], a[192:195], v[40:43]
buffer_load_dwordx4 a[32:35], v1, s[8:11], 0 offen offset:0 sc1
v_mfma_f32_16x16x32_bf16 v[40:43], a[68:71], a[208:211], v[40:43]
ds_read_b64_tr_b16 a[98:99], v3 offset:36480
v_accvgpr_read_b32 v13, a153
v_mfma_f32_16x16x32_bf16 v[44:47], a[68:71], a[212:215], v[44:47]
buffer_load_dwordx4 a[36:39], v1, s[8:11], s32 offen offset:0 sc1
v_mfma_f32_16x16x32_bf16 v[44:47], a[64:67], a[196:199], v[44:47]
ds_read_b64_tr_b16 a[100:101], v3 offset:40064
v_mfma_f32_16x16x32_bf16 v[60:63], a[72:75], a[196:199], v[60:63]
ds_read_b64_tr_b16 a[102:103], v3 offset:43648
v_accvgpr_read_b32 v14, a154
v_mfma_f32_16x16x32_bf16 v[60:63], a[76:79], a[212:215], v[60:63]
buffer_load_dwordx4 a[40:43], v1, s[8:11], s33 offen offset:0 sc1
v_mfma_f32_16x16x32_bf16 v[56:59], a[76:79], a[208:211], v[56:59]
ds_read_b64_tr_b16 a[104:105], v3 offset:32928
v_accvgpr_read_b32 v15, a155
v_mfma_f32_16x16x32_bf16 v[56:59], a[72:75], a[192:195], v[56:59]
ds_read_b64_tr_b16 a[106:107], v3 offset:36512
v_mfma_f32_16x16x32_bf16 v[52:55], a[72:75], a[188:191], v[52:55]
buffer_load_dwordx4 a[44:47], v1, s[8:11], s34 offen offset:0 sc1
v_mfma_f32_16x16x32_bf16 v[52:55], a[76:79], a[204:207], v[52:55]
ds_read_b64_tr_b16 a[108:109], v3 offset:40096
v_accvgpr_read_b32 v16, a156
v_mfma_f32_16x16x32_bf16 v[48:51], a[76:79], a[200:203], v[48:51]
ds_read_b64_tr_b16 a[110:111], v3 offset:43680
v_mfma_f32_16x16x32_bf16 v[48:51], a[72:75], a[184:187], v[48:51]
s_add_u32 m0, s35, 102400
s_nop 0
buffer_load_dwordx4 v8, s[4:7], 0 offen offset:0 lds
v_mfma_f32_16x16x32_bf16 v[64:67], a[80:83], a[184:187], v[64:67]
ds_read_b64_tr_b16 a[112:113], v3 offset:32960
v_accvgpr_read_b32 v17, a157
v_mfma_f32_16x16x32_bf16 v[64:67], a[84:87], a[200:203], v[64:67]
buffer_load_dwordx4 v9, s[4:7], 0 offen offset:1024 lds
v_mfma_f32_16x16x32_bf16 v[68:71], a[84:87], a[204:207], v[68:71]
ds_read_b64_tr_b16 a[114:115], v3 offset:36544
v_accvgpr_read_b32 v18, a158
v_mfma_f32_16x16x32_bf16 v[68:71], a[80:83], a[188:191], v[68:71]
ds_read_b64_tr_b16 a[116:117], v3 offset:40128
v_mfma_f32_16x16x32_bf16 v[72:75], a[80:83], a[192:195], v[72:75]
buffer_load_dwordx4 v10, s[4:7], 0 offen offset:2048 lds
v_mfma_f32_16x16x32_bf16 v[72:75], a[84:87], a[208:211], v[72:75]
ds_read_b64_tr_b16 a[118:119], v3 offset:43712
v_accvgpr_read_b32 v19, a159
v_mfma_f32_16x16x32_bf16 v[76:79], a[84:87], a[212:215], v[76:79]
v_add_f32 v12, v12, v16
v_mfma_f32_16x16x32_bf16 v[76:79], a[80:83], a[196:199], v[76:79]
v_mfma_f32_16x16x32_bf16 v[92:95], a[88:91], a[196:199], v[92:95]
v_add_f32 v13, v13, v17
v_mfma_f32_16x16x32_bf16 v[88:91], a[88:91], a[192:195], v[88:91]
v_add_f32 v14, v14, v18
v_mfma_f32_16x16x32_bf16 v[84:87], a[88:91], a[188:191], v[84:87]
v_add_f32 v15, v15, v19
v_mfma_f32_16x16x32_bf16 v[80:83], a[88:91], a[184:187], v[80:83]
v_accvgpr_read_b32 v16, a160
s_waitcnt vmcnt(32) lgkmcnt(0)
v_mfma_f32_16x16x32_bf16 v[80:83], a[92:95], a[200:203], v[80:83]
ds_read_b64_tr_b16 a[64:65], v3 offset:47104
v_mfma_f32_16x16x32_bf16 v[84:87], a[92:95], a[204:207], v[84:87]
ds_read_b64_tr_b16 a[66:67], v3 offset:50688
v_mfma_f32_16x16x32_bf16 v[88:91], a[92:95], a[208:211], v[88:91]
v_accvgpr_read_b32 v17, a161
v_mfma_f32_16x16x32_bf16 v[92:95], a[92:95], a[212:215], v[92:95]
ds_read_b64_tr_b16 a[68:69], v3 offset:54272
v_mfma_f32_16x16x32_bf16 v[108:111], a[100:103], a[212:215], v[108:111]
ds_read_b64_tr_b16 a[70:71], v3 offset:57856
v_accvgpr_read_b32 v18, a162
v_mfma_f32_16x16x32_bf16 v[108:111], a[96:99], a[196:199], v[108:111]
v_mfma_f32_16x16x32_bf16 v[104:107], a[96:99], a[192:195], v[104:107]
ds_read_b64_tr_b16 a[72:73], v3 offset:47136
v_accvgpr_read_b32 v19, a163
v_mfma_f32_16x16x32_bf16 v[104:107], a[100:103], a[208:211], v[104:107]
v_mfma_f32_16x16x32_bf16 v[100:103], a[100:103], a[204:207], v[100:103]
ds_read_b64_tr_b16 a[74:75], v3 offset:50720
v_add_f32 v12, v12, v16
v_mfma_f32_16x16x32_bf16 v[100:103], a[96:99], a[188:191], v[100:103]
ds_read_b64_tr_b16 a[76:77], v3 offset:54304
v_mfma_f32_16x16x32_bf16 v[96:99], a[96:99], a[184:187], v[96:99]
v_add_f32 v13, v13, v17
v_mfma_f32_16x16x32_bf16 v[96:99], a[100:103], a[200:203], v[96:99]
ds_read_b64_tr_b16 a[78:79], v3 offset:57888
v_mfma_f32_16x16x32_bf16 v[112:115], a[108:111], a[200:203], v[112:115]
v_add_f32 v14, v14, v18
v_mfma_f32_16x16x32_bf16 v[112:115], a[104:107], a[184:187], v[112:115]
ds_read_b64_tr_b16 a[80:81], v3 offset:47168
v_mfma_f32_16x16x32_bf16 v[116:119], a[104:107], a[188:191], v[116:119]
ds_read_b64_tr_b16 a[82:83], v3 offset:50752
v_mfma_f32_16x16x32_bf16 v[116:119], a[108:111], a[204:207], v[116:119]
v_add_f32 v15, v15, v19
v_mfma_f32_16x16x32_bf16 v[120:123], a[108:111], a[208:211], v[120:123]
ds_read_b64_tr_b16 a[84:85], v3 offset:54336
v_mfma_f32_16x16x32_bf16 v[120:123], a[104:107], a[192:195], v[120:123]
v_accvgpr_read_b32 v16, a164
v_mfma_f32_16x16x32_bf16 v[124:127], a[104:107], a[196:199], v[124:127]
ds_read_b64_tr_b16 a[86:87], v3 offset:57920
v_mfma_f32_16x16x32_bf16 v[124:127], a[108:111], a[212:215], v[124:127]
ds_read_b64_tr_b16 a[88:89], v3 offset:47200
v_accvgpr_read_b32 v17, a165
v_mfma_f32_16x16x32_bf16 v[140:143], a[116:119], a[212:215], v[140:143]
v_mfma_f32_16x16x32_bf16 v[140:143], a[112:115], a[196:199], v[140:143]
ds_read_b64_tr_b16 a[90:91], v3 offset:50784
v_accvgpr_read_b32 v18, a166
v_mfma_f32_16x16x32_bf16 v[136:139], a[112:115], a[192:195], v[136:139]
v_mfma_f32_16x16x32_bf16 v[136:139], a[116:119], a[208:211], v[136:139]
v_accvgpr_read_b32 v19, a167
v_mfma_f32_16x16x32_bf16 v[132:135], a[116:119], a[204:207], v[132:135]
v_add_f32 v12, v12, v16
v_mfma_f32_16x16x32_bf16 v[132:135], a[112:115], a[188:191], v[132:135]
v_mfma_f32_16x16x32_bf16 v[128:131], a[112:115], a[184:187], v[128:131]
v_add_f32 v13, v13, v17
v_mfma_f32_16x16x32_bf16 v[128:131], a[116:119], a[200:203], v[128:131]
v_add_f32 v14, v14, v18
s_waitcnt lgkmcnt(0)
v_mfma_f32_16x16x32_bf16 v[144:147], a[64:67], a[184:187], v[144:147]
ds_read_b64_tr_b16 a[92:93], v3 offset:54368
v_mfma_f32_16x16x32_bf16 v[144:147], a[68:71], a[200:203], v[144:147]
buffer_load_dwordx4 a[48:51], v1, s[8:11], 0 offen offset:1024 sc1
v_add_f32 v15, v15, v19
v_mfma_f32_16x16x32_bf16 v[148:151], a[68:71], a[204:207], v[148:151]
ds_read_b64_tr_b16 a[94:95], v3 offset:57952
v_mfma_f32_16x16x32_bf16 v[148:151], a[64:67], a[188:191], v[148:151]
buffer_load_dwordx4 a[52:55], v1, s[8:11], s32 offen offset:1024 sc1
v_mfma_f32_16x16x32_bf16 v[152:155], a[64:67], a[192:195], v[152:155]
ds_read_b64_tr_b16 a[96:97], v3 offset:47232
v_permlane16_swap_b32 v12, v13
v_mfma_f32_16x16x32_bf16 v[152:155], a[68:71], a[208:211], v[152:155]
ds_read_b64_tr_b16 a[98:99], v3 offset:50816
v_mfma_f32_16x16x32_bf16 v[156:159], a[68:71], a[212:215], v[156:159]
buffer_load_dwordx4 a[56:59], v1, s[8:11], s33 offen offset:1024 sc1
v_mfma_f32_16x16x32_bf16 v[156:159], a[64:67], a[196:199], v[156:159]
ds_read_b64_tr_b16 a[100:101], v3 offset:54400
v_mfma_f32_16x16x32_bf16 v[172:175], a[72:75], a[196:199], v[172:175]
buffer_load_dwordx4 a[60:63], v1, s[8:11], s34 offen offset:1024 sc1
v_permlane16_swap_b32 v14, v15
v_mfma_f32_16x16x32_bf16 v[172:175], a[76:79], a[212:215], v[172:175]
ds_read_b64_tr_b16 a[102:103], v3 offset:57984
v_add_f32 v13, v12, v13
v_mfma_f32_16x16x32_bf16 v[168:171], a[76:79], a[208:211], v[168:171]
ds_read_b64_tr_b16 a[104:105], v3 offset:47264
v_mfma_f32_16x16x32_bf16 v[168:171], a[72:75], a[192:195], v[168:171]
s_xor_b32 s38, s71, 14
s_mul_i32 s38, s38, 458752
s_add_u32 s4, s40, s38
s_addc_u32 s5, s41, 0
v_mfma_f32_16x16x32_bf16 v[164:167], a[72:75], a[188:191], v[164:167]
ds_read_b64_tr_b16 a[106:107], v3 offset:50848
v_add_f32 v15, v14, v15
v_mfma_f32_16x16x32_bf16 v[164:167], a[76:79], a[204:207], v[164:167]
ds_read_b64_tr_b16 a[108:109], v3 offset:54432
v_mfma_f32_16x16x32_bf16 v[160:163], a[76:79], a[200:203], v[160:163]
s_add_u32 m0, s35, 0
s_nop 0
buffer_load_dwordx4 v4, s[4:7], 0 offen offset:0 lds
v_mfma_f32_16x16x32_bf16 v[160:163], a[72:75], a[184:187], v[160:163]
ds_read_b64_tr_b16 a[110:111], v3 offset:58016
v_mfma_f32_16x16x32_bf16 v[176:179], a[80:83], a[184:187], v[176:179]
buffer_load_dwordx4 v5, s[4:7], 0 offen offset:1024 lds
v_permlane32_swap_b32 v13, v15
v_mfma_f32_16x16x32_bf16 v[176:179], a[84:87], a[200:203], v[176:179]
ds_read_b64_tr_b16 a[112:113], v3 offset:47296
v_mfma_f32_16x16x32_bf16 v[180:183], a[84:87], a[204:207], v[180:183]
ds_read_b64_tr_b16 a[114:115], v3 offset:50880
v_add_f32 v13, v13, v15
v_mfma_f32_16x16x32_bf16 v[180:183], a[80:83], a[188:191], v[180:183]
buffer_load_dwordx4 v6, s[4:7], 0 offen offset:2048 lds
v_mov_b32 v15, v13
v_mfma_f32_16x16x32_bf16 v[184:187], a[80:83], a[192:195], v[184:187]
ds_read_b64_tr_b16 a[116:117], v3 offset:54464
v_mfma_f32_16x16x32_bf16 v[184:187], a[84:87], a[208:211], v[184:187]
buffer_load_dwordx4 v7, s[4:7], 0 offen offset:3072 lds
v_mfma_f32_16x16x32_bf16 v[188:191], a[84:87], a[212:215], v[188:191]
ds_read_b64_tr_b16 a[118:119], v3 offset:58048
v_mfma_f32_16x16x32_bf16 v[188:191], a[80:83], a[196:199], v[188:191]
v_permlane32_swap_b32 v13, v15
v_mov_b32 v12, v13
v_mfma_f32_16x16x32_bf16 v[204:207], a[88:91], a[196:199], v[204:207]
v_mov_b32 v14, v15
v_mfma_f32_16x16x32_bf16 v[200:203], a[88:91], a[192:195], v[200:203]
v_mfma_f32_16x16x32_bf16 v[196:199], a[88:91], a[188:191], v[196:199]
v_permlane16_swap_b32 v12, v13
v_mfma_f32_16x16x32_bf16 v[192:195], a[88:91], a[184:187], v[192:195]
v_permlane16_swap_b32 v14, v15
s_waitcnt vmcnt(27) lgkmcnt(0)
s_barrier
v_mfma_f32_16x16x32_bf16 v[192:195], a[92:95], a[200:203], v[192:195]
ds_read_b64_tr_b16 a[64:65], v2 offset:0
v_mfma_f32_16x16x32_bf16 v[196:199], a[92:95], a[204:207], v[196:199]
ds_read_b64_tr_b16 a[66:67], v2 offset:3584
v_mfma_f32_16x16x32_bf16 v[200:203], a[92:95], a[208:211], v[200:203]
v_mul_f32 v20, 0xba800000, v12
v_mfma_f32_16x16x32_bf16 v[204:207], a[92:95], a[212:215], v[204:207]
ds_read_b64_tr_b16 a[68:69], v2 offset:7168
v_mfma_f32_16x16x32_bf16 v[220:223], a[100:103], a[212:215], v[220:223]
ds_read_b64_tr_b16 a[70:71], v2 offset:10752
v_mul_f32 v23, 0xba800000, v14
v_mfma_f32_16x16x32_bf16 v[220:223], a[96:99], a[196:199], v[220:223]
v_mul_f32 v22, 0x3a800000, v13
v_mfma_f32_16x16x32_bf16 v[216:219], a[96:99], a[192:195], v[216:219]
ds_read_b64_tr_b16 a[72:73], v2 offset:32
v_mfma_f32_16x16x32_bf16 v[216:219], a[100:103], a[208:211], v[216:219]
v_mul_f32 v25, 0x3a800000, v15
v_mfma_f32_16x16x32_bf16 v[212:215], a[100:103], a[204:207], v[212:215]
ds_read_b64_tr_b16 a[74:75], v2 offset:3616
v_mfma_f32_16x16x32_bf16 v[212:215], a[96:99], a[188:191], v[212:215]
ds_read_b64_tr_b16 a[76:77], v2 offset:7200
v_mfma_f32_16x16x32_bf16 v[208:211], a[96:99], a[184:187], v[208:211]
v_fma_f32 v22, -v20, v20, v22
v_mfma_f32_16x16x32_bf16 v[208:211], a[100:103], a[200:203], v[208:211]
ds_read_b64_tr_b16 a[78:79], v2 offset:10784
v_fma_f32 v25, -v23, v23, v25
v_mfma_f32_16x16x32_bf16 v[224:227], a[108:111], a[200:203], v[224:227]
v_mfma_f32_16x16x32_bf16 v[224:227], a[104:107], a[184:187], v[224:227]
ds_read_b64_tr_b16 a[80:81], v2 offset:64
v_max_f32 v22, 0, v22
v_mfma_f32_16x16x32_bf16 v[228:231], a[104:107], a[188:191], v[228:231]
ds_read_b64_tr_b16 a[82:83], v2 offset:3648
v_mfma_f32_16x16x32_bf16 v[228:231], a[108:111], a[204:207], v[228:231]
v_max_f32 v25, 0, v25
v_mfma_f32_16x16x32_bf16 v[232:235], a[108:111], a[208:211], v[232:235]
ds_read_b64_tr_b16 a[84:85], v2 offset:7232
v_mfma_f32_16x16x32_bf16 v[232:235], a[104:107], a[192:195], v[232:235]
v_add_f32 v22, 0x3727c5ac, v22
v_mfma_f32_16x16x32_bf16 v[236:239], a[104:107], a[196:199], v[236:239]
ds_read_b64_tr_b16 a[86:87], v2 offset:10816
v_mfma_f32_16x16x32_bf16 v[236:239], a[108:111], a[212:215], v[236:239]
ds_read_b64_tr_b16 a[88:89], v2 offset:96
v_add_f32 v25, 0x3727c5ac, v25
v_mfma_f32_16x16x32_bf16 v[252:255], a[116:119], a[212:215], v[252:255]
v_mfma_f32_16x16x32_bf16 v[252:255], a[112:115], a[196:199], v[252:255]
ds_read_b64_tr_b16 a[90:91], v2 offset:3680
v_mfma_f32_16x16x32_bf16 v[248:251], a[112:115], a[192:195], v[248:251]
v_rsq_f32 v21, v22
v_mfma_f32_16x16x32_bf16 v[248:251], a[116:119], a[208:211], v[248:251]
v_mfma_f32_16x16x32_bf16 v[244:247], a[116:119], a[204:207], v[244:247]
v_mfma_f32_16x16x32_bf16 v[244:247], a[112:115], a[188:191], v[244:247]
v_rsq_f32 v24, v25
v_mfma_f32_16x16x32_bf16 v[240:243], a[112:115], a[184:187], v[240:243]
v_mul_f32 v21, 0xbfb8aa3b, v21
v_mfma_f32_16x16x32_bf16 v[240:243], a[116:119], a[200:203], v[240:243]
v_mul_f32 v24, 0xbfb8aa3b, v24
s_waitcnt vmcnt(23) lgkmcnt(0)
v_mfma_f32_16x16x32_bf16 v[32:35], a[64:67], a[0:3], v[32:35]
ds_read_b64_tr_b16 a[92:93], v2 offset:7264
v_mfma_f32_16x16x32_bf16 v[32:35], a[68:71], a[16:19], v[32:35]
s_xor_b32 s38, s71, 14
s_lshl_b32 s38, s38, 11
s_add_u32 s8, s42, s38
s_addc_u32 s9, s43, 0
v_mfma_f32_16x16x32_bf16 v[36:39], a[68:71], a[20:23], v[36:39]
ds_read_b64_tr_b16 a[94:95], v2 offset:10848
v_mfma_f32_16x16x32_bf16 v[36:39], a[64:67], a[4:7], v[36:39]
ds_read_b64_tr_b16 a[96:97], v2 offset:128
v_accvgpr_read_b32 v12, a168
v_mfma_f32_16x16x32_bf16 v[40:43], a[64:67], a[8:11], v[40:43]
buffer_load_dwordx4 a[184:187], v1, s[8:11], 0 offen offset:0 sc1
v_mfma_f32_16x16x32_bf16 v[40:43], a[68:71], a[24:27], v[40:43]
ds_read_b64_tr_b16 a[98:99], v2 offset:3712
v_accvgpr_read_b32 v13, a169
v_mfma_f32_16x16x32_bf16 v[44:47], a[68:71], a[28:31], v[44:47]
buffer_load_dwordx4 a[188:191], v1, s[8:11], s32 offen offset:0 sc1
v_mfma_f32_16x16x32_bf16 v[44:47], a[64:67], a[12:15], v[44:47]
ds_read_b64_tr_b16 a[100:101], v2 offset:7296
v_mfma_f32_16x16x32_bf16 v[60:63], a[72:75], a[12:15], v[60:63]
ds_read_b64_tr_b16 a[102:103], v2 offset:10880
v_accvgpr_read_b32 v14, a170
v_mfma_f32_16x16x32_bf16 v[60:63], a[76:79], a[28:31], v[60:63]
buffer_load_dwordx4 a[192:195], v1, s[8:11], s33 offen offset:0 sc1
v_mfma_f32_16x16x32_bf16 v[56:59], a[76:79], a[24:27], v[56:59]
ds_read_b64_tr_b16 a[104:105], v2 offset:160
v_accvgpr_read_b32 v15, a171
v_mfma_f32_16x16x32_bf16 v[56:59], a[72:75], a[8:11], v[56:59]
ds_read_b64_tr_b16 a[106:107], v2 offset:3744
v_mfma_f32_16x16x32_bf16 v[52:55], a[72:75], a[4:7], v[52:55]
buffer_load_dwordx4 a[196:199], v1, s[8:11], s34 offen offset:0 sc1
v_mfma_f32_16x16x32_bf16 v[52:55], a[76:79], a[20:23], v[52:55]
ds_read_b64_tr_b16 a[108:109], v2 offset:7328
v_accvgpr_read_b32 v16, a172
v_mfma_f32_16x16x32_bf16 v[48:51], a[76:79], a[16:19], v[48:51]
ds_read_b64_tr_b16 a[110:111], v2 offset:10912
v_mfma_f32_16x16x32_bf16 v[48:51], a[72:75], a[0:3], v[48:51]
s_add_u32 m0, s35, 4096
s_nop 0
buffer_load_dwordx4 v8, s[4:7], 0 offen offset:0 lds
v_mfma_f32_16x16x32_bf16 v[64:67], a[80:83], a[0:3], v[64:67]
ds_read_b64_tr_b16 a[112:113], v2 offset:192
v_accvgpr_read_b32 v17, a173
v_mfma_f32_16x16x32_bf16 v[64:67], a[84:87], a[16:19], v[64:67]
buffer_load_dwordx4 v9, s[4:7], 0 offen offset:1024 lds
v_mfma_f32_16x16x32_bf16 v[68:71], a[84:87], a[20:23], v[68:71]
ds_read_b64_tr_b16 a[114:115], v2 offset:3776
v_accvgpr_read_b32 v18, a174
v_mfma_f32_16x16x32_bf16 v[68:71], a[80:83], a[4:7], v[68:71]
ds_read_b64_tr_b16 a[116:117], v2 offset:7360
v_mfma_f32_16x16x32_bf16 v[72:75], a[80:83], a[8:11], v[72:75]
buffer_load_dwordx4 v10, s[4:7], 0 offen offset:2048 lds
v_mfma_f32_16x16x32_bf16 v[72:75], a[84:87], a[24:27], v[72:75]
ds_read_b64_tr_b16 a[118:119], v2 offset:10944
v_accvgpr_read_b32 v19, a175
v_mfma_f32_16x16x32_bf16 v[76:79], a[84:87], a[28:31], v[76:79]
v_add_f32 v12, v12, v16
v_mfma_f32_16x16x32_bf16 v[76:79], a[80:83], a[12:15], v[76:79]
v_mfma_f32_16x16x32_bf16 v[92:95], a[88:91], a[12:15], v[92:95]
v_add_f32 v13, v13, v17
v_mfma_f32_16x16x32_bf16 v[88:91], a[88:91], a[8:11], v[88:91]
v_add_f32 v14, v14, v18
v_mfma_f32_16x16x32_bf16 v[84:87], a[88:91], a[4:7], v[84:87]
v_add_f32 v15, v15, v19
v_mfma_f32_16x16x32_bf16 v[80:83], a[88:91], a[0:3], v[80:83]
v_accvgpr_read_b32 v16, a176
s_waitcnt vmcnt(30) lgkmcnt(0)
v_mfma_f32_16x16x32_bf16 v[80:83], a[92:95], a[16:19], v[80:83]
ds_read_b64_tr_b16 a[64:65], v2 offset:14336
v_mfma_f32_16x16x32_bf16 v[84:87], a[92:95], a[20:23], v[84:87]
s_xor_b32 s38, s71, 15
s_mul_i32 s38, s38, 458752
s_add_u32 s4, s40, s38
s_addc_u32 s5, s41, 0
v_mfma_f32_16x16x32_bf16 v[88:91], a[92:95], a[24:27], v[88:91]
ds_read_b64_tr_b16 a[66:67], v2 offset:17920
v_mfma_f32_16x16x32_bf16 v[92:95], a[92:95], a[28:31], v[92:95]
ds_read_b64_tr_b16 a[68:69], v2 offset:21504
v_accvgpr_read_b32 v17, a177
v_mfma_f32_16x16x32_bf16 v[108:111], a[100:103], a[28:31], v[108:111]
ds_read_b64_tr_b16 a[70:71], v2 offset:25088
v_mfma_f32_16x16x32_bf16 v[108:111], a[96:99], a[12:15], v[108:111]
v_accvgpr_read_b32 v18, a178
v_mfma_f32_16x16x32_bf16 v[104:107], a[96:99], a[8:11], v[104:107]
s_add_u32 m0, s35, 32768
s_nop 0
buffer_load_dwordx4 v4, s[4:7], 0 offen offset:0 lds
v_mfma_f32_16x16x32_bf16 v[104:107], a[100:103], a[24:27], v[104:107]
ds_read_b64_tr_b16 a[72:73], v2 offset:14368
v_mfma_f32_16x16x32_bf16 v[100:103], a[100:103], a[20:23], v[100:103]
ds_read_b64_tr_b16 a[74:75], v2 offset:17952
v_accvgpr_read_b32 v19, a179
v_mfma_f32_16x16x32_bf16 v[100:103], a[96:99], a[4:7], v[100:103]
ds_read_b64_tr_b16 a[76:77], v2 offset:21536
v_mfma_f32_16x16x32_bf16 v[96:99], a[96:99], a[0:3], v[96:99]
buffer_load_dwordx4 v5, s[4:7], 0 offen offset:1024 lds
v_add_f32 v12, v12, v16
v_mfma_f32_16x16x32_bf16 v[96:99], a[100:103], a[16:19], v[96:99]
v_mfma_f32_16x16x32_bf16 v[112:115], a[108:111], a[16:19], v[112:115]
ds_read_b64_tr_b16 a[78:79], v2 offset:25120
v_add_f32 v13, v13, v17
v_mfma_f32_16x16x32_bf16 v[112:115], a[104:107], a[0:3], v[112:115]
ds_read_b64_tr_b16 a[80:81], v2 offset:14400
v_mfma_f32_16x16x32_bf16 v[116:119], a[104:107], a[4:7], v[116:119]
ds_read_b64_tr_b16 a[82:83], v2 offset:17984
v_add_f32 v14, v14, v18
v_mfma_f32_16x16x32_bf16 v[116:119], a[108:111], a[20:23], v[116:119]
buffer_load_dwordx4 v6, s[4:7], 0 offen offset:2048 lds
v_mfma_f32_16x16x32_bf16 v[120:123], a[108:111], a[24:27], v[120:123]
ds_read_b64_tr_b16 a[84:85], v2 offset:21568
v_mfma_f32_16x16x32_bf16 v[120:123], a[104:107], a[8:11], v[120:123]
v_add_f32 v15, v15, v19
v_mfma_f32_16x16x32_bf16 v[124:127], a[104:107], a[12:15], v[124:127]
ds_read_b64_tr_b16 a[86:87], v2 offset:25152
v_accvgpr_read_b32 v16, a180
v_mfma_f32_16x16x32_bf16 v[124:127], a[108:111], a[28:31], v[124:127]
ds_read_b64_tr_b16 a[88:89], v2 offset:14432
v_mfma_f32_16x16x32_bf16 v[140:143], a[116:119], a[28:31], v[140:143]
buffer_load_dwordx4 v7, s[4:7], 0 offen offset:3072 lds
v_mfma_f32_16x16x32_bf16 v[140:143], a[112:115], a[12:15], v[140:143]
ds_read_b64_tr_b16 a[90:91], v2 offset:18016
v_accvgpr_read_b32 v17, a181
v_mfma_f32_16x16x32_bf16 v[136:139], a[112:115], a[8:11], v[136:139]
v_accvgpr_read_b32 v18, a182
v_mfma_f32_16x16x32_bf16 v[136:139], a[116:119], a[24:27], v[136:139]
v_mfma_f32_16x16x32_bf16 v[132:135], a[116:119], a[20:23], v[132:135]
v_accvgpr_read_b32 v19, a183
v_mfma_f32_16x16x32_bf16 v[132:135], a[112:115], a[4:7], v[132:135]
v_add_f32 v12, v12, v16
v_mfma_f32_16x16x32_bf16 v[128:131], a[112:115], a[0:3], v[128:131]
v_add_f32 v13, v13, v17
v_mfma_f32_16x16x32_bf16 v[128:131], a[116:119], a[16:19], v[128:131]
v_add_f32 v14, v14, v18
s_waitcnt lgkmcnt(0)
v_mfma_f32_16x16x32_bf16 v[144:147], a[64:67], a[0:3], v[144:147]
ds_read_b64_tr_b16 a[92:93], v2 offset:21600
v_mfma_f32_16x16x32_bf16 v[144:147], a[68:71], a[16:19], v[144:147]
ds_read_b64_tr_b16 a[94:95], v2 offset:25184
v_add_f32 v15, v15, v19
v_mfma_f32_16x16x32_bf16 v[148:151], a[68:71], a[20:23], v[148:151]
buffer_load_dwordx4 a[200:203], v1, s[8:11], 0 offen offset:1024 sc1
v_mfma_f32_16x16x32_bf16 v[148:151], a[64:67], a[4:7], v[148:151]
ds_read_b64_tr_b16 a[96:97], v2 offset:14464
v_mfma_f32_16x16x32_bf16 v[152:155], a[64:67], a[8:11], v[152:155]
v_permlane16_swap_b32 v12, v13
v_mfma_f32_16x16x32_bf16 v[152:155], a[68:71], a[24:27], v[152:155]
ds_read_b64_tr_b16 a[98:99], v2 offset:18048
v_mfma_f32_16x16x32_bf16 v[156:159], a[68:71], a[28:31], v[156:159]
ds_read_b64_tr_b16 a[100:101], v2 offset:21632
v_mfma_f32_16x16x32_bf16 v[156:159], a[64:67], a[12:15], v[156:159]
buffer_load_dwordx4 a[204:207], v1, s[8:11], s32 offen offset:1024 sc1
v_mfma_f32_16x16x32_bf16 v[172:175], a[72:75], a[12:15], v[172:175]
ds_read_b64_tr_b16 a[102:103], v2 offset:25216
v_permlane16_swap_b32 v14, v15
v_mfma_f32_16x16x32_bf16 v[172:175], a[76:79], a[28:31], v[172:175]
v_add_f32 v13, v12, v13
v_mfma_f32_16x16x32_bf16 v[168:171], a[76:79], a[24:27], v[168:171]
ds_read_b64_tr_b16 a[104:105], v2 offset:14496
v_mfma_f32_16x16x32_bf16 v[168:171], a[72:75], a[8:11], v[168:171]
ds_read_b64_tr_b16 a[106:107], v2 offset:18080
v_add_f32 v15, v14, v15
v_mfma_f32_16x16x32_bf16 v[164:167], a[72:75], a[4:7], v[164:167]
ds_read_b64_tr_b16 a[108:109], v2 offset:21664
v_mfma_f32_16x16x32_bf16 v[164:167], a[76:79], a[20:23], v[164:167]
v_mfma_f32_16x16x32_bf16 v[160:163], a[76:79], a[16:19], v[160:163]
buffer_load_dwordx4 a[208:211], v1, s[8:11], s33 offen offset:1024 sc1
v_permlane32_swap_b32 v13, v15
v_mfma_f32_16x16x32_bf16 v[160:163], a[72:75], a[0:3], v[160:163]
ds_read_b64_tr_b16 a[110:111], v2 offset:25248
v_mfma_f32_16x16x32_bf16 v[176:179], a[80:83], a[0:3], v[176:179]
ds_read_b64_tr_b16 a[112:113], v2 offset:14528
v_add_f32 v13, v13, v15
v_mfma_f32_16x16x32_bf16 v[176:179], a[84:87], a[16:19], v[176:179]
ds_read_b64_tr_b16 a[114:115], v2 offset:18112
v_mfma_f32_16x16x32_bf16 v[180:183], a[84:87], a[20:23], v[180:183]
v_mov_b32 v15, v13
v_mfma_f32_16x16x32_bf16 v[180:183], a[80:83], a[4:7], v[180:183]
buffer_load_dwordx4 a[212:215], v1, s[8:11], s34 offen offset:1024 sc1
v_mfma_f32_16x16x32_bf16 v[184:187], a[80:83], a[8:11], v[184:187]
ds_read_b64_tr_b16 a[116:117], v2 offset:21696
v_mfma_f32_16x16x32_bf16 v[184:187], a[84:87], a[24:27], v[184:187]
ds_read_b64_tr_b16 a[118:119], v2 offset:25280
v_permlane32_swap_b32 v13, v15
v_mfma_f32_16x16x32_bf16 v[188:191], a[84:87], a[28:31], v[188:191]
v_mov_b32 v12, v13
v_mfma_f32_16x16x32_bf16 v[188:191], a[80:83], a[12:15], v[188:191]
v_mov_b32 v14, v15
v_mfma_f32_16x16x32_bf16 v[204:207], a[88:91], a[12:15], v[204:207]
v_mfma_f32_16x16x32_bf16 v[200:203], a[88:91], a[8:11], v[200:203]
v_permlane16_swap_b32 v12, v13
v_mfma_f32_16x16x32_bf16 v[196:199], a[88:91], a[4:7], v[196:199]
v_mfma_f32_16x16x32_bf16 v[192:195], a[88:91], a[0:3], v[192:195]
v_permlane16_swap_b32 v14, v15
s_waitcnt vmcnt(23) lgkmcnt(0)
s_barrier
v_mfma_f32_16x16x32_bf16 v[192:195], a[92:95], a[16:19], v[192:195]
ds_read_b64_tr_b16 a[64:65], v2 offset:32768
v_mfma_f32_16x16x32_bf16 v[196:199], a[92:95], a[20:23], v[196:199]
ds_read_b64_tr_b16 a[66:67], v2 offset:36352
v_mfma_f32_16x16x32_bf16 v[200:203], a[92:95], a[24:27], v[200:203]
s_add_u32 m0, s35, 36864
s_nop 0
buffer_load_dwordx4 v8, s[4:7], 0 offen offset:0 lds
v_mul_f32 v26, 0xba800000, v12
v_mfma_f32_16x16x32_bf16 v[204:207], a[92:95], a[28:31], v[204:207]
v_mfma_f32_16x16x32_bf16 v[220:223], a[100:103], a[28:31], v[220:223]
ds_read_b64_tr_b16 a[68:69], v2 offset:39936
v_mul_f32 v29, 0xba800000, v14
v_mfma_f32_16x16x32_bf16 v[220:223], a[96:99], a[12:15], v[220:223]
ds_read_b64_tr_b16 a[70:71], v2 offset:43520
v_mfma_f32_16x16x32_bf16 v[216:219], a[96:99], a[8:11], v[216:219]
ds_read_b64_tr_b16 a[72:73], v2 offset:32800
v_mul_f32 v28, 0x3a800000, v13
v_mfma_f32_16x16x32_bf16 v[216:219], a[100:103], a[24:27], v[216:219]
v_mfma_f32_16x16x32_bf16 v[212:215], a[100:103], a[20:23], v[212:215]
ds_read_b64_tr_b16 a[74:75], v2 offset:36384
v_mul_f32 v31, 0x3a800000, v15
v_mfma_f32_16x16x32_bf16 v[212:215], a[96:99], a[4:7], v[212:215]
ds_read_b64_tr_b16 a[76:77], v2 offset:39968
v_mfma_f32_16x16x32_bf16 v[208:211], a[96:99], a[0:3], v[208:211]
buffer_load_dwordx4 v9, s[4:7], 0 offen offset:1024 lds
v_fma_f32 v28, -v26, v26, v28
v_mfma_f32_16x16x32_bf16 v[208:211], a[100:103], a[16:19], v[208:211]
v_fma_f32 v31, -v29, v29, v31
v_mfma_f32_16x16x32_bf16 v[224:227], a[108:111], a[16:19], v[224:227]
ds_read_b64_tr_b16 a[78:79], v2 offset:43552
v_mfma_f32_16x16x32_bf16 v[224:227], a[104:107], a[0:3], v[224:227]
ds_read_b64_tr_b16 a[80:81], v2 offset:32832
v_mfma_f32_16x16x32_bf16 v[228:231], a[104:107], a[4:7], v[228:231]
ds_read_b64_tr_b16 a[82:83], v2 offset:36416
v_max_f32 v28, 0, v28
v_mfma_f32_16x16x32_bf16 v[228:231], a[108:111], a[20:23], v[228:231]
v_max_f32 v31, 0, v31
v_mfma_f32_16x16x32_bf16 v[232:235], a[108:111], a[24:27], v[232:235]
ds_read_b64_tr_b16 a[84:85], v2 offset:40000
v_mfma_f32_16x16x32_bf16 v[232:235], a[104:107], a[8:11], v[232:235]
ds_read_b64_tr_b16 a[86:87], v2 offset:43584
v_mfma_f32_16x16x32_bf16 v[236:239], a[104:107], a[12:15], v[236:239]
buffer_load_dwordx4 v10, s[4:7], 0 offen offset:2048 lds
v_add_f32 v28, 0x3727c5ac, v28
v_mfma_f32_16x16x32_bf16 v[236:239], a[108:111], a[28:31], v[236:239]
v_add_f32 v31, 0x3727c5ac, v31
v_mfma_f32_16x16x32_bf16 v[252:255], a[116:119], a[28:31], v[252:255]
ds_read_b64_tr_b16 a[88:89], v2 offset:32864
v_mfma_f32_16x16x32_bf16 v[252:255], a[112:115], a[12:15], v[252:255]
ds_read_b64_tr_b16 a[90:91], v2 offset:36448
v_mfma_f32_16x16x32_bf16 v[248:251], a[112:115], a[8:11], v[248:251]
v_mfma_f32_16x16x32_bf16 v[248:251], a[116:119], a[24:27], v[248:251]
v_rsq_f32 v27, v28
v_mfma_f32_16x16x32_bf16 v[244:247], a[116:119], a[20:23], v[244:247]
v_mfma_f32_16x16x32_bf16 v[244:247], a[112:115], a[4:7], v[244:247]
v_rsq_f32 v30, v31
v_mfma_f32_16x16x32_bf16 v[240:243], a[112:115], a[0:3], v[240:243]
v_mul_f32 v27, 0xbfb8aa3b, v27
v_mfma_f32_16x16x32_bf16 v[240:243], a[116:119], a[16:19], v[240:243]
v_mul_f32 v30, 0xbfb8aa3b, v30
s_waitcnt vmcnt(22) lgkmcnt(0)
v_mfma_f32_16x16x32_bf16 v[32:35], a[64:67], a[32:35], v[32:35]
ds_read_b64_tr_b16 a[92:93], v2 offset:40032
v_mfma_f32_16x16x32_bf16 v[32:35], a[68:71], a[48:51], v[32:35]
s_xor_b32 s38, s71, 15
s_lshl_b32 s38, s38, 11
s_add_u32 s8, s42, s38
s_addc_u32 s9, s43, 0
v_mfma_f32_16x16x32_bf16 v[36:39], a[68:71], a[52:55], v[36:39]
ds_read_b64_tr_b16 a[94:95], v2 offset:43616
v_mfma_f32_16x16x32_bf16 v[36:39], a[64:67], a[36:39], v[36:39]
ds_read_b64_tr_b16 a[96:97], v2 offset:32896
v_mfma_f32_16x16x32_bf16 v[40:43], a[64:67], a[40:43], v[40:43]
ds_read_b64_tr_b16 a[98:99], v2 offset:36480
v_mfma_f32_16x16x32_bf16 v[40:43], a[68:71], a[56:59], v[40:43]
v_mfma_f32_16x16x32_bf16 v[44:47], a[68:71], a[60:63], v[44:47]
buffer_load_dwordx4 a[0:3], v1, s[8:11], 0 offen offset:0 sc1
v_mfma_f32_16x16x32_bf16 v[44:47], a[64:67], a[44:47], v[44:47]
ds_read_b64_tr_b16 a[100:101], v2 offset:40064
v_mfma_f32_16x16x32_bf16 v[60:63], a[72:75], a[44:47], v[60:63]
ds_read_b64_tr_b16 a[102:103], v2 offset:43648
v_mfma_f32_16x16x32_bf16 v[60:63], a[76:79], a[60:63], v[60:63]
ds_read_b64_tr_b16 a[104:105], v2 offset:32928
v_mfma_f32_16x16x32_bf16 v[56:59], a[76:79], a[56:59], v[56:59]
buffer_load_dwordx4 a[4:7], v1, s[8:11], s32 offen offset:0 sc1
v_mfma_f32_16x16x32_bf16 v[56:59], a[72:75], a[40:43], v[56:59]
L_wp19:
s_cbranch_execz L_wp22
v_mfma_f32_16x16x32_bf16 v[52:55], a[72:75], a[36:39], v[52:55]
ds_read_b64_tr_b16 a[106:107], v2 offset:36512
v_mfma_f32_16x16x32_bf16 v[52:55], a[76:79], a[52:55], v[52:55]
ds_read_b64_tr_b16 a[108:109], v2 offset:40096
v_mfma_f32_16x16x32_bf16 v[48:51], a[76:79], a[48:51], v[48:51]
ds_read_b64_tr_b16 a[110:111], v2 offset:43680
v_mfma_f32_16x16x32_bf16 v[48:51], a[72:75], a[32:35], v[48:51]
buffer_load_dwordx4 a[8:11], v1, s[8:11], s33 offen offset:0 sc1
v_mfma_f32_16x16x32_bf16 v[64:67], a[80:83], a[32:35], v[64:67]
ds_read_b64_tr_b16 a[112:113], v2 offset:32960
v_mfma_f32_16x16x32_bf16 v[64:67], a[84:87], a[48:51], v[64:67]
v_mfma_f32_16x16x32_bf16 v[68:71], a[84:87], a[52:55], v[68:71]
ds_read_b64_tr_b16 a[114:115], v2 offset:36544
v_mfma_f32_16x16x32_bf16 v[68:71], a[80:83], a[36:39], v[68:71]
ds_read_b64_tr_b16 a[116:117], v2 offset:40128
v_mfma_f32_16x16x32_bf16 v[72:75], a[80:83], a[40:43], v[72:75]
buffer_load_dwordx4 a[12:15], v1, s[8:11], s34 offen offset:0 sc1
v_mfma_f32_16x16x32_bf16 v[72:75], a[84:87], a[56:59], v[72:75]
ds_read_b64_tr_b16 a[118:119], v2 offset:43712
v_mfma_f32_16x16x32_bf16 v[76:79], a[84:87], a[60:63], v[76:79]
v_mfma_f32_16x16x32_bf16 v[76:79], a[80:83], a[44:47], v[76:79]
v_mfma_f32_16x16x32_bf16 v[92:95], a[88:91], a[44:47], v[92:95]
v_mfma_f32_16x16x32_bf16 v[88:91], a[88:91], a[40:43], v[88:91]
v_mfma_f32_16x16x32_bf16 v[84:87], a[88:91], a[36:39], v[84:87]
v_mfma_f32_16x16x32_bf16 v[80:83], a[88:91], a[32:35], v[80:83]
s_waitcnt vmcnt(26) lgkmcnt(0)
v_mfma_f32_16x16x32_bf16 v[80:83], a[92:95], a[48:51], v[80:83]
ds_read_b64_tr_b16 a[64:65], v2 offset:47104
v_mfma_f32_16x16x32_bf16 v[84:87], a[92:95], a[52:55], v[84:87]
ds_read_b64_tr_b16 a[66:67], v2 offset:50688
v_mfma_f32_16x16x32_bf16 v[88:91], a[92:95], a[56:59], v[88:91]
buffer_load_dwordx4 a[16:19], v1, s[8:11], 0 offen offset:1024 sc1
v_mfma_f32_16x16x32_bf16 v[92:95], a[92:95], a[60:63], v[92:95]
ds_read_b64_tr_b16 a[68:69], v2 offset:54272
v_mfma_f32_16x16x32_bf16 v[108:111], a[100:103], a[60:63], v[108:111]
v_mfma_f32_16x16x32_bf16 v[108:111], a[96:99], a[44:47], v[108:111]
ds_read_b64_tr_b16 a[70:71], v2 offset:57856
v_mfma_f32_16x16x32_bf16 v[104:107], a[96:99], a[40:43], v[104:107]
ds_read_b64_tr_b16 a[72:73], v2 offset:47136
v_mfma_f32_16x16x32_bf16 v[104:107], a[100:103], a[56:59], v[104:107]
buffer_load_dwordx4 a[20:23], v1, s[8:11], s32 offen offset:1024 sc1
v_mfma_f32_16x16x32_bf16 v[100:103], a[100:103], a[52:55], v[100:103]
ds_read_b64_tr_b16 a[74:75], v2 offset:50720
v_mfma_f32_16x16x32_bf16 v[100:103], a[96:99], a[36:39], v[100:103]
v_mfma_f32_16x16x32_bf16 v[96:99], a[96:99], a[32:35], v[96:99]
ds_read_b64_tr_b16 a[76:77], v2 offset:54304
v_mfma_f32_16x16x32_bf16 v[96:99], a[100:103], a[48:51], v[96:99]
ds_read_b64_tr_b16 a[78:79], v2 offset:57888
v_mfma_f32_16x16x32_bf16 v[112:115], a[108:111], a[48:51], v[112:115]
ds_read_b64_tr_b16 a[80:81], v2 offset:47168
v_mfma_f32_16x16x32_bf16 v[112:115], a[104:107], a[32:35], v[112:115]
v_mfma_f32_16x16x32_bf16 v[116:119], a[104:107], a[36:39], v[116:119]
buffer_load_dwordx4 a[24:27], v1, s[8:11], s33 offen offset:1024 sc1
v_mfma_f32_16x16x32_bf16 v[116:119], a[108:111], a[52:55], v[116:119]
ds_read_b64_tr_b16 a[82:83], v2 offset:50752
v_mfma_f32_16x16x32_bf16 v[120:123], a[108:111], a[56:59], v[120:123]
ds_read_b64_tr_b16 a[84:85], v2 offset:54336
v_mfma_f32_16x16x32_bf16 v[120:123], a[104:107], a[40:43], v[120:123]
ds_read_b64_tr_b16 a[86:87], v2 offset:57920
v_mfma_f32_16x16x32_bf16 v[124:127], a[104:107], a[44:47], v[124:127]
v_mfma_f32_16x16x32_bf16 v[124:127], a[108:111], a[60:63], v[124:127]
buffer_load_dwordx4 a[28:31], v1, s[8:11], s34 offen offset:1024 sc1
v_mfma_f32_16x16x32_bf16 v[140:143], a[116:119], a[60:63], v[140:143]
ds_read_b64_tr_b16 a[88:89], v2 offset:47200
v_mfma_f32_16x16x32_bf16 v[140:143], a[112:115], a[44:47], v[140:143]
ds_read_b64_tr_b16 a[90:91], v2 offset:50784
v_mfma_f32_16x16x32_bf16 v[136:139], a[112:115], a[40:43], v[136:139]
v_mfma_f32_16x16x32_bf16 v[136:139], a[116:119], a[56:59], v[136:139]
v_mfma_f32_16x16x32_bf16 v[132:135], a[116:119], a[52:55], v[132:135]
v_mfma_f32_16x16x32_bf16 v[132:135], a[112:115], a[36:39], v[132:135]
v_mfma_f32_16x16x32_bf16 v[128:131], a[112:115], a[32:35], v[128:131]
v_mfma_f32_16x16x32_bf16 v[128:131], a[116:119], a[48:51], v[128:131]
s_waitcnt lgkmcnt(0)
v_mfma_f32_16x16x32_bf16 v[144:147], a[64:67], a[32:35], v[144:147]
ds_read_b64_tr_b16 a[92:93], v2 offset:54368
v_lshrrev_b32 v1, 4, v0
v_mfma_f32_16x16x32_bf16 v[144:147], a[68:71], a[48:51], v[144:147]
ds_read_b64_tr_b16 a[94:95], v2 offset:57952
v_mul_u32_u24 v1, 768, v1
v_mfma_f32_16x16x32_bf16 v[148:151], a[68:71], a[52:55], v[148:151]
v_lshl_add_u32 v1, v0, 4, v1
v_mfma_f32_16x16x32_bf16 v[148:151], a[64:67], a[36:39], v[148:151]
ds_read_b64_tr_b16 a[96:97], v2 offset:47232
s_lshl_b32 s39, s37, 14
s_lshl_b32 s61, s3, 8
s_add_u32 s39, s39, s61
s_add_u32 s88, s39, 64487424
v_mfma_f32_16x16x32_bf16 v[152:155], a[64:67], a[40:43], v[152:155]
ds_read_b64_tr_b16 a[98:99], v2 offset:50816
v_mfma_f32_16x16x32_bf16 v[152:155], a[68:71], a[56:59], v[152:155]
s_add_u32 s89, s88, 4096
s_add_u32 s90, s88, 8192
s_add_u32 s91, s88, 12288
v_mfma_f32_16x16x32_bf16 v[156:159], a[68:71], a[60:63], v[156:159]
ds_read_b64_tr_b16 a[100:101], v2 offset:54400
s_and_b32 s39, s2, 7
s_lshl_b32 s39, s39, 5
s_lshr_b32 s61, s2, 3
s_add_u32 s39, s39, s61
v_mfma_f32_16x16x32_bf16 v[156:159], a[64:67], a[44:47], v[156:159]
s_lshl_b32 s39, s39, 2
s_add_u32 s39, s39, s3
s_mul_i32 s39, s39, 7168
v_min_u32 v19, 55, v0
v_mfma_f32_16x16x32_bf16 v[172:175], a[72:75], a[44:47], v[172:175]
ds_read_b64_tr_b16 a[102:103], v2 offset:57984
v_lshlrev_b32 v19, 7, v19
v_mfma_f32_16x16x32_bf16 v[172:175], a[76:79], a[60:63], v[172:175]
ds_read_b64_tr_b16 a[104:105], v2 offset:47264
buffer_load_dwordx4 v[4:7], v1, s[12:15], s88 offen sc1
v_mfma_f32_16x16x32_bf16 v[168:171], a[76:79], a[56:59], v[168:171]
buffer_load_dwordx4 v[8:11], v1, s[12:15], s89 offen sc1
buffer_load_dwordx4 v[12:15], v1, s[12:15], s90 offen sc1
v_mfma_f32_16x16x32_bf16 v[168:171], a[72:75], a[40:43], v[168:171]
ds_read_b64_tr_b16 a[106:107], v2 offset:50848
v_mfma_f32_16x16x32_bf16 v[164:167], a[72:75], a[36:39], v[164:167]
buffer_load_dwordx4 v[16:19], v1, s[12:15], s91 offen sc1
buffer_load_dwordx2 a[254:255], v19, s[28:31], s39 offen offset:60
v_mfma_f32_16x16x32_bf16 v[164:167], a[76:79], a[52:55], v[164:167]
ds_read_b64_tr_b16 a[108:109], v2 offset:54432
v_mfma_f32_16x16x32_bf16 v[160:163], a[76:79], a[48:51], v[160:163]
ds_read_b64_tr_b16 a[110:111], v2 offset:58016
v_mfma_f32_16x16x32_bf16 v[160:163], a[72:75], a[32:35], v[160:163]
v_mfma_f32_16x16x32_bf16 v[176:179], a[80:83], a[32:35], v[176:179]
ds_read_b64_tr_b16 a[112:113], v2 offset:47296
v_mfma_f32_16x16x32_bf16 v[176:179], a[84:87], a[48:51], v[176:179]
v_mfma_f32_16x16x32_bf16 v[180:183], a[84:87], a[52:55], v[180:183]
ds_read_b64_tr_b16 a[114:115], v2 offset:50880
v_mfma_f32_16x16x32_bf16 v[180:183], a[80:83], a[36:39], v[180:183]
ds_read_b64_tr_b16 a[116:117], v2 offset:54464
v_mfma_f32_16x16x32_bf16 v[184:187], a[80:83], a[40:43], v[184:187]
v_mfma_f32_16x16x32_bf16 v[184:187], a[84:87], a[56:59], v[184:187]
ds_read_b64_tr_b16 a[118:119], v2 offset:58048
v_mfma_f32_16x16x32_bf16 v[188:191], a[84:87], a[60:63], v[188:191]
v_mfma_f32_16x16x32_bf16 v[188:191], a[80:83], a[44:47], v[188:191]
v_mfma_f32_16x16x32_bf16 v[204:207], a[88:91], a[44:47], v[204:207]
v_mfma_f32_16x16x32_bf16 v[200:203], a[88:91], a[40:43], v[200:203]
v_mfma_f32_16x16x32_bf16 v[196:199], a[88:91], a[36:39], v[196:199]
v_mfma_f32_16x16x32_bf16 v[192:195], a[88:91], a[32:35], v[192:195]
s_waitcnt vmcnt(24) lgkmcnt(0)
s_barrier
v_mfma_f32_16x16x32_bf16 v[192:195], a[92:95], a[48:51], v[192:195]
ds_read_b64_tr_b16 a[64:65], v3 offset:0
v_mfma_f32_16x16x32_bf16 v[196:199], a[92:95], a[52:55], v[196:199]
ds_read_b64_tr_b16 a[66:67], v3 offset:3584
v_mfma_f32_16x16x32_bf16 v[200:203], a[92:95], a[56:59], v[200:203]
v_mfma_f32_16x16x32_bf16 v[204:207], a[92:95], a[60:63], v[204:207]
ds_read_b64_tr_b16 a[68:69], v3 offset:7168
v_mfma_f32_16x16x32_bf16 v[220:223], a[100:103], a[60:63], v[220:223]
ds_read_b64_tr_b16 a[70:71], v3 offset:10752
v_mfma_f32_16x16x32_bf16 v[220:223], a[96:99], a[44:47], v[220:223]
v_mfma_f32_16x16x32_bf16 v[216:219], a[96:99], a[40:43], v[216:219]
ds_read_b64_tr_b16 a[72:73], v3 offset:32
v_mfma_f32_16x16x32_bf16 v[216:219], a[100:103], a[56:59], v[216:219]
v_mfma_f32_16x16x32_bf16 v[212:215], a[100:103], a[52:55], v[212:215]
ds_read_b64_tr_b16 a[74:75], v3 offset:3616
v_mfma_f32_16x16x32_bf16 v[212:215], a[96:99], a[36:39], v[212:215]
ds_read_b64_tr_b16 a[76:77], v3 offset:7200
v_mfma_f32_16x16x32_bf16 v[208:211], a[96:99], a[32:35], v[208:211]
v_mfma_f32_16x16x32_bf16 v[208:211], a[100:103], a[48:51], v[208:211]
ds_read_b64_tr_b16 a[78:79], v3 offset:10784
v_mfma_f32_16x16x32_bf16 v[224:227], a[108:111], a[48:51], v[224:227]
v_mfma_f32_16x16x32_bf16 v[224:227], a[104:107], a[32:35], v[224:227]
ds_read_b64_tr_b16 a[80:81], v3 offset:64
v_mfma_f32_16x16x32_bf16 v[228:231], a[104:107], a[36:39], v[228:231]
ds_read_b64_tr_b16 a[82:83], v3 offset:3648
v_mfma_f32_16x16x32_bf16 v[228:231], a[108:111], a[52:55], v[228:231]
v_mfma_f32_16x16x32_bf16 v[232:235], a[108:111], a[56:59], v[232:235]
ds_read_b64_tr_b16 a[84:85], v3 offset:7232
v_mfma_f32_16x16x32_bf16 v[232:235], a[104:107], a[40:43], v[232:235]
v_mfma_f32_16x16x32_bf16 v[236:239], a[104:107], a[44:47], v[236:239]
ds_read_b64_tr_b16 a[86:87], v3 offset:10816
v_mfma_f32_16x16x32_bf16 v[236:239], a[108:111], a[60:63], v[236:239]
ds_read_b64_tr_b16 a[88:89], v3 offset:96
v_mfma_f32_16x16x32_bf16 v[252:255], a[116:119], a[60:63], v[252:255]
v_mfma_f32_16x16x32_bf16 v[252:255], a[112:115], a[44:47], v[252:255]
ds_read_b64_tr_b16 a[90:91], v3 offset:3680
v_mfma_f32_16x16x32_bf16 v[248:251], a[112:115], a[40:43], v[248:251]
v_mfma_f32_16x16x32_bf16 v[248:251], a[116:119], a[56:59], v[248:251]
v_mfma_f32_16x16x32_bf16 v[244:247], a[116:119], a[52:55], v[244:247]
v_mfma_f32_16x16x32_bf16 v[244:247], a[112:115], a[36:39], v[244:247]
v_mfma_f32_16x16x32_bf16 v[240:243], a[112:115], a[32:35], v[240:243]
v_mfma_f32_16x16x32_bf16 v[240:243], a[116:119], a[48:51], v[240:243]
s_waitcnt vmcnt(16) lgkmcnt(0)
v_mfma_f32_16x16x32_bf16 v[32:35], a[64:67], a[184:187], v[32:35]
ds_read_b64_tr_b16 a[92:93], v3 offset:7264
v_mfma_f32_16x16x32_bf16 v[32:35], a[68:71], a[200:203], v[32:35]
ds_read_b64_tr_b16 a[94:95], v3 offset:10848
v_mfma_f32_16x16x32_bf16 v[36:39], a[68:71], a[204:207], v[36:39]
v_mfma_f32_16x16x32_bf16 v[36:39], a[64:67], a[188:191], v[36:39]
ds_read_b64_tr_b16 a[96:97], v3 offset:128
v_mfma_f32_16x16x32_bf16 v[40:43], a[64:67], a[192:195], v[40:43]
ds_read_b64_tr_b16 a[98:99], v3 offset:3712
v_mfma_f32_16x16x32_bf16 v[40:43], a[68:71], a[208:211], v[40:43]
v_mfma_f32_16x16x32_bf16 v[44:47], a[68:71], a[212:215], v[44:47]
ds_read_b64_tr_b16 a[100:101], v3 offset:7296
v_mfma_f32_16x16x32_bf16 v[44:47], a[64:67], a[196:199], v[44:47]
v_mfma_f32_16x16x32_bf16 v[60:63], a[72:75], a[196:199], v[60:63]
ds_read_b64_tr_b16 a[102:103], v3 offset:10880
v_mfma_f32_16x16x32_bf16 v[60:63], a[76:79], a[212:215], v[60:63]
ds_read_b64_tr_b16 a[104:105], v3 offset:160
v_mfma_f32_16x16x32_bf16 v[56:59], a[76:79], a[208:211], v[56:59]
v_mfma_f32_16x16x32_bf16 v[56:59], a[72:75], a[192:195], v[56:59]
ds_read_b64_tr_b16 a[106:107], v3 offset:3744
v_mfma_f32_16x16x32_bf16 v[52:55], a[72:75], a[188:191], v[52:55]
v_mfma_f32_16x16x32_bf16 v[52:55], a[76:79], a[204:207], v[52:55]
ds_read_b64_tr_b16 a[108:109], v3 offset:7328
v_mfma_f32_16x16x32_bf16 v[48:51], a[76:79], a[200:203], v[48:51]
ds_read_b64_tr_b16 a[110:111], v3 offset:10912
v_mfma_f32_16x16x32_bf16 v[48:51], a[72:75], a[184:187], v[48:51]
v_mfma_f32_16x16x32_bf16 v[64:67], a[80:83], a[184:187], v[64:67]
ds_read_b64_tr_b16 a[112:113], v3 offset:192
v_mfma_f32_16x16x32_bf16 v[64:67], a[84:87], a[200:203], v[64:67]
v_mfma_f32_16x16x32_bf16 v[68:71], a[84:87], a[204:207], v[68:71]
ds_read_b64_tr_b16 a[114:115], v3 offset:3776
v_mfma_f32_16x16x32_bf16 v[68:71], a[80:83], a[188:191], v[68:71]
ds_read_b64_tr_b16 a[116:117], v3 offset:7360
v_mfma_f32_16x16x32_bf16 v[72:75], a[80:83], a[192:195], v[72:75]
v_mfma_f32_16x16x32_bf16 v[72:75], a[84:87], a[208:211], v[72:75]
ds_read_b64_tr_b16 a[118:119], v3 offset:10944
v_mfma_f32_16x16x32_bf16 v[76:79], a[84:87], a[212:215], v[76:79]
v_mfma_f32_16x16x32_bf16 v[76:79], a[80:83], a[196:199], v[76:79]
v_mfma_f32_16x16x32_bf16 v[92:95], a[88:91], a[196:199], v[92:95]
v_mfma_f32_16x16x32_bf16 v[88:91], a[88:91], a[192:195], v[88:91]
v_mfma_f32_16x16x32_bf16 v[84:87], a[88:91], a[188:191], v[84:87]
v_mfma_f32_16x16x32_bf16 v[80:83], a[88:91], a[184:187], v[80:83]
v_accvgpr_read_b32 v2, a253
s_waitcnt vmcnt(16) lgkmcnt(0)
v_mfma_f32_16x16x32_bf16 v[80:83], a[92:95], a[200:203], v[80:83]
ds_read_b64_tr_b16 a[64:65], v3 offset:14336
v_mfma_f32_16x16x32_bf16 v[84:87], a[92:95], a[204:207], v[84:87]
ds_read_b64_tr_b16 a[66:67], v3 offset:17920
v_mfma_f32_16x16x32_bf16 v[88:91], a[92:95], a[208:211], v[88:91]
v_mfma_f32_16x16x32_bf16 v[92:95], a[92:95], a[212:215], v[92:95]
ds_read_b64_tr_b16 a[68:69], v3 offset:21504
v_mfma_f32_16x16x32_bf16 v[108:111], a[100:103], a[212:215], v[108:111]
ds_read_b64_tr_b16 a[70:71], v3 offset:25088
v_mfma_f32_16x16x32_bf16 v[108:111], a[96:99], a[196:199], v[108:111]
v_mfma_f32_16x16x32_bf16 v[104:107], a[96:99], a[192:195], v[104:107]
ds_read_b64_tr_b16 a[72:73], v3 offset:14368
v_mfma_f32_16x16x32_bf16 v[104:107], a[100:103], a[208:211], v[104:107]
v_mfma_f32_16x16x32_bf16 v[100:103], a[100:103], a[204:207], v[100:103]
ds_read_b64_tr_b16 a[74:75], v3 offset:17952
v_mfma_f32_16x16x32_bf16 v[100:103], a[96:99], a[188:191], v[100:103]
ds_read_b64_tr_b16 a[76:77], v3 offset:21536
v_mfma_f32_16x16x32_bf16 v[96:99], a[96:99], a[184:187], v[96:99]
v_mfma_f32_16x16x32_bf16 v[96:99], a[100:103], a[200:203], v[96:99]
ds_read_b64_tr_b16 a[78:79], v3 offset:25120
v_mfma_f32_16x16x32_bf16 v[112:115], a[108:111], a[200:203], v[112:115]
v_mfma_f32_16x16x32_bf16 v[112:115], a[104:107], a[184:187], v[112:115]
ds_read_b64_tr_b16 a[80:81], v3 offset:14400
v_mfma_f32_16x16x32_bf16 v[116:119], a[104:107], a[188:191], v[116:119]
ds_read_b64_tr_b16 a[82:83], v3 offset:17984
v_mfma_f32_16x16x32_bf16 v[116:119], a[108:111], a[204:207], v[116:119]
v_mfma_f32_16x16x32_bf16 v[120:123], a[108:111], a[208:211], v[120:123]
ds_read_b64_tr_b16 a[84:85], v3 offset:21568
v_mfma_f32_16x16x32_bf16 v[120:123], a[104:107], a[192:195], v[120:123]
v_mfma_f32_16x16x32_bf16 v[124:127], a[104:107], a[196:199], v[124:127]
ds_read_b64_tr_b16 a[86:87], v3 offset:25152
v_mfma_f32_16x16x32_bf16 v[124:127], a[108:111], a[212:215], v[124:127]
ds_read_b64_tr_b16 a[88:89], v3 offset:14432
v_mfma_f32_16x16x32_bf16 v[140:143], a[116:119], a[212:215], v[140:143]
v_mfma_f32_16x16x32_bf16 v[140:143], a[112:115], a[196:199], v[140:143]
ds_read_b64_tr_b16 a[90:91], v3 offset:18016
v_mfma_f32_16x16x32_bf16 v[136:139], a[112:115], a[192:195], v[136:139]
v_mfma_f32_16x16x32_bf16 v[136:139], a[116:119], a[208:211], v[136:139]
v_mfma_f32_16x16x32_bf16 v[132:135], a[116:119], a[204:207], v[132:135]
v_mfma_f32_16x16x32_bf16 v[132:135], a[112:115], a[188:191], v[132:135]
v_mfma_f32_16x16x32_bf16 v[128:131], a[112:115], a[184:187], v[128:131]
v_mfma_f32_16x16x32_bf16 v[128:131], a[116:119], a[200:203], v[128:131]
s_waitcnt lgkmcnt(0)
s_waitcnt vmcnt(1)
v_mfma_f32_16x16x32_bf16 v[144:147], a[64:67], a[184:187], v[144:147]
ds_read_b64_tr_b16 a[92:93], v3 offset:21600
v_mfma_f32_16x16x32_bf16 v[144:147], a[68:71], a[200:203], v[144:147]
ds_read_b64_tr_b16 a[94:95], v3 offset:25184
v_perm_b32 v1, v5, v4, s92
v_mfma_f32_16x16x32_bf16 v[148:151], a[68:71], a[204:207], v[148:151]
v_perm_b32 v1, v6, v1, s93
v_perm_b32 v1, v7, v1, s94
v_mfma_f32_16x16x32_bf16 v[148:151], a[64:67], a[188:191], v[148:151]
ds_read_b64_tr_b16 a[96:97], v3 offset:14464
v_cmp_ne_u32 vcc, s63, v1
v_mfma_f32_16x16x32_bf16 v[152:155], a[64:67], a[192:195], v[152:155]
ds_read_b64_tr_b16 a[98:99], v3 offset:18048
v_mfma_f32_16x16x32_bf16 v[152:155], a[68:71], a[208:211], v[152:155]
v_perm_b32 v1, v9, v8, s92
v_perm_b32 v1, v10, v1, s93
v_mfma_f32_16x16x32_bf16 v[156:159], a[68:71], a[212:215], v[156:159]
ds_read_b64_tr_b16 a[100:101], v3 offset:21632
v_perm_b32 v1, v11, v1, s94
v_mfma_f32_16x16x32_bf16 v[156:159], a[64:67], a[196:199], v[156:159]
v_cmp_ne_u32 s[4:5], s63, v1
s_or_b64 vcc, vcc, s[4:5]
v_mfma_f32_16x16x32_bf16 v[172:175], a[72:75], a[196:199], v[172:175]
ds_read_b64_tr_b16 a[102:103], v3 offset:25216
v_perm_b32 v1, v13, v12, s92
v_mfma_f32_16x16x32_bf16 v[172:175], a[76:79], a[212:215], v[172:175]
ds_read_b64_tr_b16 a[104:105], v3 offset:14496
v_perm_b32 v1, v14, v1, s93
v_mfma_f32_16x16x32_bf16 v[168:171], a[76:79], a[208:211], v[168:171]
v_perm_b32 v1, v15, v1, s94
v_mfma_f32_16x16x32_bf16 v[168:171], a[72:75], a[192:195], v[168:171]
ds_read_b64_tr_b16 a[106:107], v3 offset:18080
v_cmp_ne_u32 s[4:5], s63, v1
v_mfma_f32_16x16x32_bf16 v[164:167], a[72:75], a[188:191], v[164:167]
s_or_b64 vcc, vcc, s[4:5]
v_perm_b32 v1, v17, v16, s92
v_mfma_f32_16x16x32_bf16 v[164:167], a[76:79], a[204:207], v[164:167]
ds_read_b64_tr_b16 a[108:109], v3 offset:21664
v_perm_b32 v1, v18, v1, s93
v_mfma_f32_16x16x32_bf16 v[160:163], a[76:79], a[200:203], v[160:163]
ds_read_b64_tr_b16 a[110:111], v3 offset:25248
v_perm_b32 v1, v19, v1, s94
v_mfma_f32_16x16x32_bf16 v[160:163], a[72:75], a[184:187], v[160:163]
v_cmp_ne_u32 s[4:5], s63, v1
s_or_b64 vcc, vcc, s[4:5]
v_mfma_f32_16x16x32_bf16 v[176:179], a[80:83], a[184:187], v[176:179]
ds_read_b64_tr_b16 a[112:113], v3 offset:14528
s_cbranch_vccnz L_cr
L_cok:
v_mfma_f32_16x16x32_bf16 v[176:179], a[84:87], a[200:203], v[176:179]
v_and_b32 v4, 0xffffff00, v4
v_and_b32 v5, 0xffffff00, v5
v_mfma_f32_16x16x32_bf16 v[180:183], a[84:87], a[204:207], v[180:183]
ds_read_b64_tr_b16 a[114:115], v3 offset:18112
v_and_b32 v6, 0xffffff00, v6
v_mfma_f32_16x16x32_bf16 v[180:183], a[80:83], a[188:191], v[180:183]
ds_read_b64_tr_b16 a[116:117], v3 offset:21696
v_mfma_f32_16x16x32_bf16 v[184:187], a[80:83], a[192:195], v[184:187]
v_and_b32 v7, 0xffffff00, v7
v_and_b32 v8, 0xffffff00, v8
v_mfma_f32_16x16x32_bf16 v[184:187], a[84:87], a[208:211], v[184:187]
ds_read_b64_tr_b16 a[118:119], v3 offset:25280
v_and_b32 v9, 0xffffff00, v9
v_mfma_f32_16x16x32_bf16 v[188:191], a[84:87], a[212:215], v[188:191]
v_and_b32 v10, 0xffffff00, v10
v_mfma_f32_16x16x32_bf16 v[188:191], a[80:83], a[196:199], v[188:191]
v_and_b32 v11, 0xffffff00, v11
v_and_b32 v12, 0xffffff00, v12
v_mfma_f32_16x16x32_bf16 v[204:207], a[88:91], a[196:199], v[204:207]
v_and_b32 v13, 0xffffff00, v13
v_and_b32 v14, 0xffffff00, v14
v_mfma_f32_16x16x32_bf16 v[200:203], a[88:91], a[192:195], v[200:203]
v_and_b32 v15, 0xffffff00, v15
v_mfma_f32_16x16x32_bf16 v[196:199], a[88:91], a[188:191], v[196:199]
v_and_b32 v16, 0xffffff00, v16
v_and_b32 v17, 0xffffff00, v17
v_mfma_f32_16x16x32_bf16 v[192:195], a[88:91], a[184:187], v[192:195]
v_and_b32 v18, 0xffffff00, v18
v_and_b32 v19, 0xffffff00, v19
s_waitcnt vmcnt(13) lgkmcnt(0)
s_barrier
v_mfma_f32_16x16x32_bf16 v[192:195], a[92:95], a[200:203], v[192:195]
ds_read_b64_tr_b16 a[64:65], v3 offset:32768
v_mfma_f32_16x16x32_bf16 v[196:199], a[92:95], a[204:207], v[196:199]
ds_read_b64_tr_b16 a[66:67], v3 offset:36352
v_add_f32 v4, v4, v8
v_mfma_f32_16x16x32_bf16 v[200:203], a[92:95], a[208:211], v[200:203]
v_add_f32 v5, v5, v9
v_add_f32 v6, v6, v10
v_mfma_f32_16x16x32_bf16 v[204:207], a[92:95], a[212:215], v[204:207]
ds_read_b64_tr_b16 a[68:69], v3 offset:39936
v_mfma_f32_16x16x32_bf16 v[220:223], a[100:103], a[212:215], v[220:223]
ds_read_b64_tr_b16 a[70:71], v3 offset:43520
v_add_f32 v7, v7, v11
v_mfma_f32_16x16x32_bf16 v[220:223], a[96:99], a[196:199], v[220:223]
v_add_f32 v12, v12, v16
v_add_f32 v13, v13, v17
v_mfma_f32_16x16x32_bf16 v[216:219], a[96:99], a[192:195], v[216:219]
ds_read_b64_tr_b16 a[72:73], v3 offset:32800
v_mfma_f32_16x16x32_bf16 v[216:219], a[100:103], a[208:211], v[216:219]
v_add_f32 v14, v14, v18
v_add_f32 v15, v15, v19
v_mfma_f32_16x16x32_bf16 v[212:215], a[100:103], a[204:207], v[212:215]
ds_read_b64_tr_b16 a[74:75], v3 offset:36384
v_add_f32 v4, v4, v12
v_mfma_f32_16x16x32_bf16 v[212:215], a[96:99], a[188:191], v[212:215]
ds_read_b64_tr_b16 a[76:77], v3 offset:39968
v_mfma_f32_16x16x32_bf16 v[208:211], a[96:99], a[184:187], v[208:211]
v_add_f32 v5, v5, v13
v_add_f32 v6, v6, v14
v_mfma_f32_16x16x32_bf16 v[208:211], a[100:103], a[200:203], v[208:211]
ds_read_b64_tr_b16 a[78:79], v3 offset:43552
v_add_f32 v7, v7, v15
v_mfma_f32_16x16x32_bf16 v[224:227], a[108:111], a[200:203], v[224:227]
v_mfma_f32_16x16x32_bf16 v[224:227], a[104:107], a[184:187], v[224:227]
ds_read_b64_tr_b16 a[80:81], v3 offset:32832
v_permlane16_swap_b32 v4, v5
v_mfma_f32_16x16x32_bf16 v[228:231], a[104:107], a[188:191], v[228:231]
ds_read_b64_tr_b16 a[82:83], v3 offset:36416
v_mfma_f32_16x16x32_bf16 v[228:231], a[108:111], a[204:207], v[228:231]
v_permlane16_swap_b32 v6, v7
v_mfma_f32_16x16x32_bf16 v[232:235], a[108:111], a[208:211], v[232:235]
ds_read_b64_tr_b16 a[84:85], v3 offset:40000
v_add_f32 v5, v4, v5
v_mfma_f32_16x16x32_bf16 v[232:235], a[104:107], a[192:195], v[232:235]
v_add_f32 v7, v6, v7
v_mfma_f32_16x16x32_bf16 v[236:239], a[104:107], a[196:199], v[236:239]
ds_read_b64_tr_b16 a[86:87], v3 offset:43584
v_mfma_f32_16x16x32_bf16 v[236:239], a[108:111], a[212:215], v[236:239]
ds_read_b64_tr_b16 a[88:89], v3 offset:32864
v_permlane32_swap_b32 v5, v7
v_mfma_f32_16x16x32_bf16 v[252:255], a[116:119], a[212:215], v[252:255]
v_add_f32 v5, v5, v7
v_mfma_f32_16x16x32_bf16 v[252:255], a[112:115], a[196:199], v[252:255]
ds_read_b64_tr_b16 a[90:91], v3 offset:36448
v_and_b32 v12, 15, v0
v_mfma_f32_16x16x32_bf16 v[248:251], a[112:115], a[192:195], v[248:251]
v_lshrrev_b32 v13, 4, v0
v_lshlrev_b32 v13, 2, v13
v_mfma_f32_16x16x32_bf16 v[248:251], a[116:119], a[208:211], v[248:251]
v_lshl_add_u32 v12, v12, 4, v13
v_mfma_f32_16x16x32_bf16 v[244:247], a[116:119], a[204:207], v[244:247]
s_lshl_b32 s39, s3, 8
s_add_u32 s39, s39, 61440
v_add_u32 v12, s39, v12
v_mfma_f32_16x16x32_bf16 v[244:247], a[112:115], a[188:191], v[244:247]
ds_write_b32 v12, v5
v_mfma_f32_16x16x32_bf16 v[240:243], a[112:115], a[184:187], v[240:243]
v_lshlrev_b32 v1, 4, v0
v_mfma_f32_16x16x32_bf16 v[240:243], a[116:119], a[200:203], v[240:243]
s_mov_b32 exec_lo, 0xff000000
s_mov_b32 exec_hi, 0
v_add_u32 v1, 29360256, v1
s_mov_b64 exec, -1
s_waitcnt vmcnt(5) lgkmcnt(0)
v_mfma_f32_16x16x32_bf16 v[32:35], a[64:67], a[0:3], v[32:35]
ds_read_b64_tr_b16 a[92:93], v3 offset:40032
v_mfma_f32_16x16x32_bf16 v[32:35], a[68:71], a[16:19], v[32:35]
s_add_u32 m0, s70, 65536
s_add_u32 s68, s48, 0
s_lshl_b32 s68, s68, 6
buffer_load_dwordx4 v2, s[16:19], s68 offen lds
v_mfma_f32_16x16x32_bf16 v[36:39], a[68:71], a[20:23], v[36:39]
ds_read_b64_tr_b16 a[94:95], v3 offset:43616
v_mfma_f32_16x16x32_bf16 v[36:39], a[64:67], a[4:7], v[36:39]
ds_read_b64_tr_b16 a[96:97], v3 offset:32896
v_mfma_f32_16x16x32_bf16 v[40:43], a[64:67], a[8:11], v[40:43]
ds_read_b64_tr_b16 a[98:99], v3 offset:36480
v_mfma_f32_16x16x32_bf16 v[40:43], a[68:71], a[24:27], v[40:43]
buffer_load_dwordx4 v2, s[20:23], s68 offen offset:1024 lds
v_mfma_f32_16x16x32_bf16 v[44:47], a[68:71], a[28:31], v[44:47]
ds_read_b64_tr_b16 a[100:101], v3 offset:40064
v_mfma_f32_16x16x32_bf16 v[44:47], a[64:67], a[12:15], v[44:47]
v_mfma_f32_16x16x32_bf16 v[60:63], a[72:75], a[12:15], v[60:63]
ds_read_b64_tr_b16 a[102:103], v3 offset:43648
v_mfma_f32_16x16x32_bf16 v[60:63], a[76:79], a[28:31], v[60:63]
s_add_u32 m0, s70, 73728
s_add_u32 s68, s48, 1024
s_lshl_b32 s68, s68, 6
buffer_load_dwordx4 v2, s[16:19], s68 offen lds
v_mfma_f32_16x16x32_bf16 v[56:59], a[76:79], a[24:27], v[56:59]
ds_read_b64_tr_b16 a[104:105], v3 offset:32928
v_mfma_f32_16x16x32_bf16 v[56:59], a[72:75], a[8:11], v[56:59]
ds_read_b64_tr_b16 a[106:107], v3 offset:36512
v_mfma_f32_16x16x32_bf16 v[52:55], a[72:75], a[4:7], v[52:55]
buffer_load_dwordx4 v2, s[20:23], s68 offen offset:1024 lds
v_mfma_f32_16x16x32_bf16 v[52:55], a[76:79], a[20:23], v[52:55]
ds_read_b64_tr_b16 a[108:109], v3 offset:40096
v_mfma_f32_16x16x32_bf16 v[48:51], a[76:79], a[16:19], v[48:51]
ds_read_b64_tr_b16 a[110:111], v3 offset:43680
v_mfma_f32_16x16x32_bf16 v[48:51], a[72:75], a[0:3], v[48:51]
v_mfma_f32_16x16x32_bf16 v[64:67], a[80:83], a[0:3], v[64:67]
ds_read_b64_tr_b16 a[112:113], v3 offset:32960
v_mfma_f32_16x16x32_bf16 v[64:67], a[84:87], a[16:19], v[64:67]
s_add_u32 m0, s70, 81920
s_add_u32 s68, s48, 2048
s_lshl_b32 s68, s68, 6
buffer_load_dwordx4 v2, s[16:19], s68 offen lds
v_mfma_f32_16x16x32_bf16 v[68:71], a[84:87], a[20:23], v[68:71]
ds_read_b64_tr_b16 a[114:115], v3 offset:36544
v_mfma_f32_16x16x32_bf16 v[68:71], a[80:83], a[4:7], v[68:71]
ds_read_b64_tr_b16 a[116:117], v3 offset:40128
v_mfma_f32_16x16x32_bf16 v[72:75], a[80:83], a[8:11], v[72:75]
buffer_load_dwordx4 v2, s[20:23], s68 offen offset:1024 lds
v_mfma_f32_16x16x32_bf16 v[72:75], a[84:87], a[24:27], v[72:75]
ds_read_b64_tr_b16 a[118:119], v3 offset:43712
v_mfma_f32_16x16x32_bf16 v[76:79], a[84:87], a[28:31], v[76:79]
v_mfma_f32_16x16x32_bf16 v[76:79], a[80:83], a[12:15], v[76:79]
v_mfma_f32_16x16x32_bf16 v[92:95], a[88:91], a[12:15], v[92:95]
v_mfma_f32_16x16x32_bf16 v[88:91], a[88:91], a[8:11], v[88:91]
v_mfma_f32_16x16x32_bf16 v[84:87], a[88:91], a[4:7], v[84:87]
v_mfma_f32_16x16x32_bf16 v[80:83], a[88:91], a[0:3], v[80:83]
s_waitcnt vmcnt(11) lgkmcnt(0)
v_mfma_f32_16x16x32_bf16 v[80:83], a[92:95], a[16:19], v[80:83]
ds_read_b64_tr_b16 a[64:65], v3 offset:47104
v_mfma_f32_16x16x32_bf16 v[84:87], a[92:95], a[20:23], v[84:87]
s_add_u32 m0, s70, 90112
s_add_u32 s68, s49, 0
s_lshl_b32 s68, s68, 6
buffer_load_dwordx4 v2, s[16:19], s68 offen lds
v_mfma_f32_16x16x32_bf16 v[88:91], a[92:95], a[24:27], v[88:91]
ds_read_b64_tr_b16 a[66:67], v3 offset:50688
v_mfma_f32_16x16x32_bf16 v[92:95], a[92:95], a[28:31], v[92:95]
ds_read_b64_tr_b16 a[68:69], v3 offset:54272
v_mfma_f32_16x16x32_bf16 v[108:111], a[100:103], a[28:31], v[108:111]
ds_read_b64_tr_b16 a[70:71], v3 offset:57856
v_mfma_f32_16x16x32_bf16 v[108:111], a[96:99], a[12:15], v[108:111]
buffer_load_dwordx4 v2, s[20:23], s68 offen offset:1024 lds
v_mfma_f32_16x16x32_bf16 v[104:107], a[96:99], a[8:11], v[104:107]
ds_read_b64_tr_b16 a[72:73], v3 offset:47136
v_mfma_f32_16x16x32_bf16 v[104:107], a[100:103], a[24:27], v[104:107]
v_mfma_f32_16x16x32_bf16 v[100:103], a[100:103], a[20:23], v[100:103]
ds_read_b64_tr_b16 a[74:75], v3 offset:50720
v_mfma_f32_16x16x32_bf16 v[100:103], a[96:99], a[4:7], v[100:103]
s_add_u32 m0, s70, 98304
s_add_u32 s68, s50, 0
s_lshl_b32 s68, s68, 6
buffer_load_dwordx4 v2, s[16:19], s68 offen lds
v_mfma_f32_16x16x32_bf16 v[96:99], a[96:99], a[0:3], v[96:99]
ds_read_b64_tr_b16 a[76:77], v3 offset:54304
v_mfma_f32_16x16x32_bf16 v[96:99], a[100:103], a[16:19], v[96:99]
ds_read_b64_tr_b16 a[78:79], v3 offset:57888
v_mfma_f32_16x16x32_bf16 v[112:115], a[108:111], a[16:19], v[112:115]
buffer_load_dwordx4 v2, s[20:23], s68 offen offset:1024 lds
v_mfma_f32_16x16x32_bf16 v[112:115], a[104:107], a[0:3], v[112:115]
ds_read_b64_tr_b16 a[80:81], v3 offset:47168
v_mfma_f32_16x16x32_bf16 v[116:119], a[104:107], a[4:7], v[116:119]
ds_read_b64_tr_b16 a[82:83], v3 offset:50752
v_mfma_f32_16x16x32_bf16 v[116:119], a[108:111], a[20:23], v[116:119]
v_mfma_f32_16x16x32_bf16 v[120:123], a[108:111], a[24:27], v[120:123]
ds_read_b64_tr_b16 a[84:85], v3 offset:54336
v_mfma_f32_16x16x32_bf16 v[120:123], a[104:107], a[8:11], v[120:123]
s_add_u32 m0, s70, 106496
s_add_u32 s68, s51, 0
s_lshl_b32 s68, s68, 6
buffer_load_dwordx4 v2, s[16:19], s68 offen lds
v_mfma_f32_16x16x32_bf16 v[124:127], a[104:107], a[12:15], v[124:127]
ds_read_b64_tr_b16 a[86:87], v3 offset:57920
v_mfma_f32_16x16x32_bf16 v[124:127], a[108:111], a[28:31], v[124:127]
ds_read_b64_tr_b16 a[88:89], v3 offset:47200
v_mfma_f32_16x16x32_bf16 v[140:143], a[116:119], a[28:31], v[140:143]
buffer_load_dwordx4 v2, s[20:23], s68 offen offset:1024 lds
v_mfma_f32_16x16x32_bf16 v[140:143], a[112:115], a[12:15], v[140:143]
ds_read_b64_tr_b16 a[90:91], v3 offset:50784
v_mfma_f32_16x16x32_bf16 v[136:139], a[112:115], a[8:11], v[136:139]
v_mfma_f32_16x16x32_bf16 v[136:139], a[116:119], a[24:27], v[136:139]
v_mfma_f32_16x16x32_bf16 v[132:135], a[116:119], a[20:23], v[132:135]
v_mfma_f32_16x16x32_bf16 v[132:135], a[112:115], a[4:7], v[132:135]
L_wp20:
s_cbranch_execz L_wp23
v_mfma_f32_16x16x32_bf16 v[128:131], a[112:115], a[0:3], v[128:131]
v_mfma_f32_16x16x32_bf16 v[128:131], a[116:119], a[16:19], v[128:131]
s_waitcnt lgkmcnt(0)
v_mfma_f32_16x16x32_bf16 v[144:147], a[64:67], a[0:3], v[144:147]
ds_read_b64_tr_b16 a[92:93], v3 offset:54368
v_mfma_f32_16x16x32_bf16 v[144:147], a[68:71], a[16:19], v[144:147]
s_add_u32 m0, s70, 114688
s_add_u32 s68, s52, 0
s_lshl_b32 s68, s68, 6
buffer_load_dwordx4 v2, s[16:19], s68 offen lds
v_mfma_f32_16x16x32_bf16 v[148:151], a[68:71], a[20:23], v[148:151]
ds_read_b64_tr_b16 a[94:95], v3 offset:57952
v_mfma_f32_16x16x32_bf16 v[148:151], a[64:67], a[4:7], v[148:151]
ds_read_b64_tr_b16 a[96:97], v3 offset:47232
v_mfma_f32_16x16x32_bf16 v[152:155], a[64:67], a[8:11], v[152:155]
ds_read_b64_tr_b16 a[98:99], v3 offset:50816
v_mfma_f32_16x16x32_bf16 v[152:155], a[68:71], a[24:27], v[152:155]
buffer_load_dwordx4 v2, s[20:23], s68 offen offset:1024 lds
v_mfma_f32_16x16x32_bf16 v[156:159], a[68:71], a[28:31], v[156:159]
ds_read_b64_tr_b16 a[100:101], v3 offset:54400
v_mfma_f32_16x16x32_bf16 v[156:159], a[64:67], a[12:15], v[156:159]
v_mfma_f32_16x16x32_bf16 v[172:175], a[72:75], a[12:15], v[172:175]
ds_read_b64_tr_b16 a[102:103], v3 offset:57984
v_mfma_f32_16x16x32_bf16 v[172:175], a[76:79], a[28:31], v[172:175]
s_add_u32 m0, s70, 122880
s_add_u32 s68, s53, 0
s_lshl_b32 s68, s68, 6
buffer_load_dwordx4 v2, s[16:19], s68 offen lds
v_mfma_f32_16x16x32_bf16 v[168:171], a[76:79], a[24:27], v[168:171]
ds_read_b64_tr_b16 a[104:105], v3 offset:47264
v_mfma_f32_16x16x32_bf16 v[168:171], a[72:75], a[8:11], v[168:171]
ds_read_b64_tr_b16 a[106:107], v3 offset:50848
v_mfma_f32_16x16x32_bf16 v[164:167], a[72:75], a[4:7], v[164:167]
buffer_load_dwordx4 v2, s[20:23], s68 offen offset:1024 lds
v_mfma_f32_16x16x32_bf16 v[164:167], a[76:79], a[20:23], v[164:167]
ds_read_b64_tr_b16 a[108:109], v3 offset:54432
v_mfma_f32_16x16x32_bf16 v[160:163], a[76:79], a[16:19], v[160:163]
ds_read_b64_tr_b16 a[110:111], v3 offset:58016
v_mfma_f32_16x16x32_bf16 v[160:163], a[72:75], a[0:3], v[160:163]
v_mfma_f32_16x16x32_bf16 v[176:179], a[80:83], a[0:3], v[176:179]
ds_read_b64_tr_b16 a[112:113], v3 offset:47296
v_mfma_f32_16x16x32_bf16 v[176:179], a[84:87], a[16:19], v[176:179]
s_add_u32 m0, s70, 131072
s_add_u32 s68, s66, 0
s_lshl_b32 s68, s68, 6
buffer_load_dwordx4 v2, s[16:19], s68 offen lds
v_mfma_f32_16x16x32_bf16 v[180:183], a[84:87], a[20:23], v[180:183]
ds_read_b64_tr_b16 a[114:115], v3 offset:50880
v_mfma_f32_16x16x32_bf16 v[180:183], a[80:83], a[4:7], v[180:183]
ds_read_b64_tr_b16 a[116:117], v3 offset:54464
v_mfma_f32_16x16x32_bf16 v[184:187], a[80:83], a[8:11], v[184:187]
buffer_load_dwordx4 v2, s[20:23], s68 offen offset:1024 lds
v_mfma_f32_16x16x32_bf16 v[184:187], a[84:87], a[24:27], v[184:187]
ds_read_b64_tr_b16 a[118:119], v3 offset:58048
v_mfma_f32_16x16x32_bf16 v[188:191], a[84:87], a[28:31], v[188:191]
v_mfma_f32_16x16x32_bf16 v[188:191], a[80:83], a[12:15], v[188:191]
v_mfma_f32_16x16x32_bf16 v[204:207], a[88:91], a[12:15], v[204:207]
v_mfma_f32_16x16x32_bf16 v[200:203], a[88:91], a[8:11], v[200:203]
v_mfma_f32_16x16x32_bf16 v[196:199], a[88:91], a[4:7], v[196:199]
v_mfma_f32_16x16x32_bf16 v[192:195], a[88:91], a[0:3], v[192:195]
s_waitcnt lgkmcnt(0)
s_barrier
v_mfma_f32_16x16x32_bf16 v[192:195], a[92:95], a[16:19], v[192:195]
s_add_u32 m0, s70, 139264
s_add_u32 s68, s67, 0
s_lshl_b32 s68, s68, 6
buffer_load_dwordx4 v2, s[16:19], s68 offen lds
v_mfma_f32_16x16x32_bf16 v[196:199], a[92:95], a[20:23], v[196:199]
v_mfma_f32_16x16x32_bf16 v[200:203], a[92:95], a[24:27], v[200:203]
v_mfma_f32_16x16x32_bf16 v[204:207], a[92:95], a[28:31], v[204:207]
v_mfma_f32_16x16x32_bf16 v[220:223], a[100:103], a[28:31], v[220:223]
buffer_load_dwordx4 v2, s[20:23], s68 offen offset:1024 lds
v_mov_b32 v4, s63
s_waitcnt vmcnt(25)
s_mov_b64 exec, 1
buffer_store_dword v4, off, s[12:15], s98 sc1
s_mov_b64 exec, -1
v_mfma_f32_16x16x32_bf16 v[220:223], a[96:99], a[12:15], v[220:223]
v_and_b32 v3, 48, v0
v_mfma_f32_16x16x32_bf16 v[216:219], a[96:99], a[8:11], v[216:219]
v_add_u32 v3, 61440, v3
v_mfma_f32_16x16x32_bf16 v[216:219], a[100:103], a[24:27], v[216:219]
ds_read_b128 v[4:7], v3 offset:0
v_mfma_f32_16x16x32_bf16 v[212:215], a[100:103], a[20:23], v[212:215]
ds_read_b128 v[8:11], v3 offset:512
v_mfma_f32_16x16x32_bf16 v[212:215], a[96:99], a[4:7], v[212:215]
s_add_u32 m0, s70, 147456
s_add_u32 s68, s49, 1024
s_lshl_b32 s68, s68, 6
buffer_load_dwordx4 v2, s[16:19], s68 offen lds
v_mfma_f32_16x16x32_bf16 v[208:211], a[96:99], a[0:3], v[208:211]
ds_read_b128 v[12:15], v3 offset:64
v_mfma_f32_16x16x32_bf16 v[208:211], a[100:103], a[16:19], v[208:211]
ds_read_b128 v[16:19], v3 offset:576
v_mfma_f32_16x16x32_bf16 v[224:227], a[108:111], a[16:19], v[224:227]
v_mfma_f32_16x16x32_bf16 v[224:227], a[104:107], a[0:3], v[224:227]
s_mul_i32 s38, s37, 7
s_and_b32 s39, s37, 1
s_add_u32 s38, s38, s39
s_lshr_b32 s38, s38, 1
v_mfma_f32_16x16x32_bf16 v[228:231], a[104:107], a[4:7], v[228:231]
buffer_load_dwordx4 v2, s[20:23], s68 offen offset:1024 lds
v_mfma_f32_16x16x32_bf16 v[228:231], a[108:111], a[20:23], v[228:231]
s_mul_i32 s61, s69, 112
s_add_u32 s38, s38, s61
s_lshl_b32 s38, s38, 10
s_add_u32 s38, s38, 8388608
v_mfma_f32_16x16x32_bf16 v[232:235], a[108:111], a[24:27], v[232:235]
v_mfma_f32_16x16x32_bf16 v[232:235], a[104:107], a[8:11], v[232:235]
s_add_u32 s4, s38, 0
s_add_u32 s5, s38, 114688
s_add_u32 s6, s38, 229376
s_add_u32 s7, s38, 344064
v_mfma_f32_16x16x32_bf16 v[236:239], a[104:107], a[12:15], v[236:239]
s_add_u32 m0, s70, 155648
s_add_u32 s68, s50, 1024
s_lshl_b32 s68, s68, 6
buffer_load_dwordx4 v2, s[16:19], s68 offen lds
v_mfma_f32_16x16x32_bf16 v[236:239], a[108:111], a[28:31], v[236:239]
s_mov_b32 s61, 4294966280
s_cmp_eq_u32 s39, 0
s_cselect_b32 s61, 3072, s61
v_mfma_f32_16x16x32_bf16 v[252:255], a[116:119], a[28:31], v[252:255]
v_mfma_f32_16x16x32_bf16 v[252:255], a[112:115], a[12:15], v[252:255]
s_add_u32 s40, s4, s61
s_add_u32 s41, s5, s61
s_add_u32 s42, s6, s61
s_add_u32 s43, s7, s61
v_mfma_f32_16x16x32_bf16 v[248:251], a[112:115], a[8:11], v[248:251]
v_mfma_f32_16x16x32_bf16 v[248:251], a[116:119], a[24:27], v[248:251]
buffer_load_dwordx4 v2, s[20:23], s68 offen offset:1024 lds
s_mul_i32 s38, s69, 114688
s_lshr_b32 s39, s37, 3
s_mul_i32 s61, s39, 28672
s_add_u32 s38, s38, s61
v_mfma_f32_16x16x32_bf16 v[244:247], a[116:119], a[20:23], v[244:247]
v_mfma_f32_16x16x32_bf16 v[244:247], a[112:115], a[4:7], v[244:247]
s_add_u32 s38, s38, 8388608
s_add_u32 s8, s12, s38
s_addc_u32 s9, s13, 0
v_mfma_f32_16x16x32_bf16 v[240:243], a[112:115], a[0:3], v[240:243]
s_mov_b32 s10, 29818880
s_mov_b32 s26, 4194304
v_mfma_f32_16x16x32_bf16 v[240:243], a[116:119], a[16:19], v[240:243]
s_add_u32 s88, s56, 0
s_add_u32 s89, s56, 32768
s_add_u32 s90, s56, 65536
s_add_u32 s91, s56, 98304
s_waitcnt lgkmcnt(0)
s_nop 0
v_pk_fma_f32 v[32:33], v[4:5], v[20:21], v[32:33] op_sel:[0,0,0] op_sel_hi:[1,0,1]
v_pk_fma_f32 v[34:35], v[6:7], v[20:21], v[34:35] op_sel:[0,0,0] op_sel_hi:[1,0,1]
v_pk_fma_f32 v[48:49], v[12:13], v[20:21], v[48:49] op_sel:[0,0,0] op_sel_hi:[1,0,1]
v_pk_fma_f32 v[50:51], v[14:15], v[20:21], v[50:51] op_sel:[0,0,0] op_sel_hi:[1,0,1]
v_pk_fma_f32 v[144:145], v[8:9], v[20:21], v[144:145] op_sel:[0,0,0] op_sel_hi:[1,0,1]
v_pk_fma_f32 v[146:147], v[10:11], v[20:21], v[146:147] op_sel:[0,0,0] op_sel_hi:[1,0,1]
v_pk_fma_f32 v[160:161], v[16:17], v[20:21], v[160:161] op_sel:[0,0,0] op_sel_hi:[1,0,1]
v_pk_fma_f32 v[162:163], v[18:19], v[20:21], v[162:163] op_sel:[0,0,0] op_sel_hi:[1,0,1]
v_pk_mul_f32 v[144:145], v[144:145], v[32:33]
v_pk_mul_f32 v[146:147], v[146:147], v[34:35]
v_pk_mul_f32 v[160:161], v[160:161], v[48:49]
v_pk_mul_f32 v[162:163], v[162:163], v[50:51]
v_pk_mul_f32 v[32:33], v[32:33], v[20:21] op_sel:[0,1] op_sel_hi:[1,1]
v_pk_mul_f32 v[34:35], v[34:35], v[20:21] op_sel:[0,1] op_sel_hi:[1,1]
v_pk_mul_f32 v[48:49], v[48:49], v[20:21] op_sel:[0,1] op_sel_hi:[1,1]
v_pk_mul_f32 v[50:51], v[50:51], v[20:21] op_sel:[0,1] op_sel_hi:[1,1]
v_exp_f32 v32, v32
v_exp_f32 v33, v33
v_exp_f32 v34, v34
v_exp_f32 v35, v35
v_exp_f32 v48, v48
v_exp_f32 v49, v49
v_exp_f32 v50, v50
v_exp_f32 v51, v51
v_pk_fma_f32 v[32:33], v[32:33], v[22:23], v[22:23] op_sel:[0,0,0] op_sel_hi:[1,0,0]
v_pk_fma_f32 v[34:35], v[34:35], v[22:23], v[22:23] op_sel:[0,0,0] op_sel_hi:[1,0,0]
v_pk_fma_f32 v[48:49], v[48:49], v[22:23], v[22:23] op_sel:[0,0,0] op_sel_hi:[1,0,0]
v_pk_fma_f32 v[50:51], v[50:51], v[22:23], v[22:23] op_sel:[0,0,0] op_sel_hi:[1,0,0]
v_rcp_f32 v32, v32
v_rcp_f32 v33, v33
v_rcp_f32 v34, v34
v_rcp_f32 v35, v35
v_rcp_f32 v48, v48
v_rcp_f32 v49, v49
v_rcp_f32 v50, v50
v_rcp_f32 v51, v51
v_pk_mul_f32 v[32:33], v[32:33], v[144:145]
v_pk_mul_f32 v[34:35], v[34:35], v[146:147]
v_pk_mul_f32 v[48:49], v[48:49], v[160:161]
v_pk_mul_f32 v[50:51], v[50:51], v[162:163]
v_cvt_pk_bf16_f32 v144, v32, v33
v_cvt_pk_bf16_f32 v145, v34, v35
v_cvt_pk_bf16_f32 v146, v48, v49
v_cvt_pk_bf16_f32 v147, v50, v51
buffer_store_dwordx4 v[144:147], v1, s[12:15], s4 offen offset:0
v_pk_fma_f32 v[36:37], v[4:5], v[22:23], v[36:37] op_sel:[0,1,0] op_sel_hi:[1,1,1]
v_pk_fma_f32 v[38:39], v[6:7], v[22:23], v[38:39] op_sel:[0,1,0] op_sel_hi:[1,1,1]
v_pk_fma_f32 v[52:53], v[12:13], v[22:23], v[52:53] op_sel:[0,1,0] op_sel_hi:[1,1,1]
v_pk_fma_f32 v[54:55], v[14:15], v[22:23], v[54:55] op_sel:[0,1,0] op_sel_hi:[1,1,1]
v_pk_fma_f32 v[148:149], v[8:9], v[22:23], v[148:149] op_sel:[0,1,0] op_sel_hi:[1,1,1]
v_pk_fma_f32 v[150:151], v[10:11], v[22:23], v[150:151] op_sel:[0,1,0] op_sel_hi:[1,1,1]
v_pk_fma_f32 v[164:165], v[16:17], v[22:23], v[164:165] op_sel:[0,1,0] op_sel_hi:[1,1,1]
v_pk_fma_f32 v[166:167], v[18:19], v[22:23], v[166:167] op_sel:[0,1,0] op_sel_hi:[1,1,1]
v_pk_mul_f32 v[148:149], v[148:149], v[36:37]
v_pk_mul_f32 v[150:151], v[150:151], v[38:39]
v_pk_mul_f32 v[164:165], v[164:165], v[52:53]
v_pk_mul_f32 v[166:167], v[166:167], v[54:55]
v_pk_mul_f32 v[36:37], v[36:37], v[24:25] op_sel:[0,0] op_sel_hi:[1,0]
v_pk_mul_f32 v[38:39], v[38:39], v[24:25] op_sel:[0,0] op_sel_hi:[1,0]
v_pk_mul_f32 v[52:53], v[52:53], v[24:25] op_sel:[0,0] op_sel_hi:[1,0]
v_pk_mul_f32 v[54:55], v[54:55], v[24:25] op_sel:[0,0] op_sel_hi:[1,0]
v_exp_f32 v36, v36
v_exp_f32 v37, v37
v_exp_f32 v38, v38
v_exp_f32 v39, v39
v_exp_f32 v52, v52
v_exp_f32 v53, v53
v_exp_f32 v54, v54
v_exp_f32 v55, v55
v_pk_fma_f32 v[36:37], v[36:37], v[24:25], v[24:25] op_sel:[0,1,1] op_sel_hi:[1,1,1]
v_pk_fma_f32 v[38:39], v[38:39], v[24:25], v[24:25] op_sel:[0,1,1] op_sel_hi:[1,1,1]
v_pk_fma_f32 v[52:53], v[52:53], v[24:25], v[24:25] op_sel:[0,1,1] op_sel_hi:[1,1,1]
v_pk_fma_f32 v[54:55], v[54:55], v[24:25], v[24:25] op_sel:[0,1,1] op_sel_hi:[1,1,1]
v_rcp_f32 v36, v36
v_rcp_f32 v37, v37
v_rcp_f32 v38, v38
v_rcp_f32 v39, v39
v_rcp_f32 v52, v52
v_rcp_f32 v53, v53
v_rcp_f32 v54, v54
v_rcp_f32 v55, v55
v_pk_mul_f32 v[36:37], v[36:37], v[148:149]
v_pk_mul_f32 v[38:39], v[38:39], v[150:151]
v_pk_mul_f32 v[52:53], v[52:53], v[164:165]
v_pk_mul_f32 v[54:55], v[54:55], v[166:167]
v_cvt_pk_bf16_f32 v148, v36, v37
v_cvt_pk_bf16_f32 v149, v38, v39
v_cvt_pk_bf16_f32 v150, v52, v53
v_cvt_pk_bf16_f32 v151, v54, v55
buffer_store_dwordx4 v[148:151], v1, s[12:15], s5 offen offset:0
s_add_u32 m0, s70, 0
s_add_u32 s68, s51, 1024
s_lshl_b32 s68, s68, 6
buffer_load_dwordx4 v2, s[16:19], s68 offen lds
buffer_load_dwordx4 v2, s[20:23], s68 offen offset:1024 lds
s_getpc_b64 s[58:59]
L_m_rf5:
s_and_b32 s58, s58, 0xffffff80
s_lshr_b32 s60, s2, 3
s_lshl_b32 s60, s60, 2
s_add_u32 s60, s60, s3
s_mul_i32 s60, s60, 2
v_min_u32 v160, 1, v0
v_add_lshl_u32 v160, v160, s60, 7
v_min_u32 v160, L_fin-L_m_rf5-128, v160
global_load_dwordx2 a[254:255], v160, s[58:59] offset:60
v_pk_fma_f32 v[40:41], v[4:5], v[26:27], v[40:41] op_sel:[0,0,0] op_sel_hi:[1,0,1]
v_pk_fma_f32 v[42:43], v[6:7], v[26:27], v[42:43] op_sel:[0,0,0] op_sel_hi:[1,0,1]
v_pk_fma_f32 v[56:57], v[12:13], v[26:27], v[56:57] op_sel:[0,0,0] op_sel_hi:[1,0,1]
v_pk_fma_f32 v[58:59], v[14:15], v[26:27], v[58:59] op_sel:[0,0,0] op_sel_hi:[1,0,1]
v_pk_fma_f32 v[152:153], v[8:9], v[26:27], v[152:153] op_sel:[0,0,0] op_sel_hi:[1,0,1]
v_pk_fma_f32 v[154:155], v[10:11], v[26:27], v[154:155] op_sel:[0,0,0] op_sel_hi:[1,0,1]
v_pk_fma_f32 v[168:169], v[16:17], v[26:27], v[168:169] op_sel:[0,0,0] op_sel_hi:[1,0,1]
v_pk_fma_f32 v[170:171], v[18:19], v[26:27], v[170:171] op_sel:[0,0,0] op_sel_hi:[1,0,1]
v_pk_mul_f32 v[152:153], v[152:153], v[40:41]
v_pk_mul_f32 v[154:155], v[154:155], v[42:43]
v_pk_mul_f32 v[168:169], v[168:169], v[56:57]
v_pk_mul_f32 v[170:171], v[170:171], v[58:59]
v_pk_mul_f32 v[40:41], v[40:41], v[26:27] op_sel:[0,1] op_sel_hi:[1,1]
v_pk_mul_f32 v[42:43], v[42:43], v[26:27] op_sel:[0,1] op_sel_hi:[1,1]
v_pk_mul_f32 v[56:57], v[56:57], v[26:27] op_sel:[0,1] op_sel_hi:[1,1]
v_pk_mul_f32 v[58:59], v[58:59], v[26:27] op_sel:[0,1] op_sel_hi:[1,1]
v_exp_f32 v40, v40
v_exp_f32 v41, v41
v_exp_f32 v42, v42
v_exp_f32 v43, v43
v_exp_f32 v56, v56
v_exp_f32 v57, v57
v_exp_f32 v58, v58
v_exp_f32 v59, v59
v_pk_fma_f32 v[40:41], v[40:41], v[28:29], v[28:29] op_sel:[0,0,0] op_sel_hi:[1,0,0]
v_pk_fma_f32 v[42:43], v[42:43], v[28:29], v[28:29] op_sel:[0,0,0] op_sel_hi:[1,0,0]
v_pk_fma_f32 v[56:57], v[56:57], v[28:29], v[28:29] op_sel:[0,0,0] op_sel_hi:[1,0,0]
v_pk_fma_f32 v[58:59], v[58:59], v[28:29], v[28:29] op_sel:[0,0,0] op_sel_hi:[1,0,0]
v_rcp_f32 v40, v40
v_rcp_f32 v41, v41
v_rcp_f32 v42, v42
v_rcp_f32 v43, v43
v_rcp_f32 v56, v56
v_rcp_f32 v57, v57
v_rcp_f32 v58, v58
v_rcp_f32 v59, v59
v_pk_mul_f32 v[40:41], v[40:41], v[152:153]
v_pk_mul_f32 v[42:43], v[42:43], v[154:155]
v_pk_mul_f32 v[56:57], v[56:57], v[168:169]
v_pk_mul_f32 v[58:59], v[58:59], v[170:171]
v_cvt_pk_bf16_f32 v152, v40, v41
v_cvt_pk_bf16_f32 v153, v42, v43
v_cvt_pk_bf16_f32 v154, v56, v57
v_cvt_pk_bf16_f32 v155, v58, v59
buffer_store_dwordx4 v[152:155], v1, s[12:15], s6 offen offset:0
s_add_u32 m0, s70, 8192
s_add_u32 s68, s52, 1024
s_lshl_b32 s68, s68, 6
buffer_load_dwordx4 v2, s[16:19], s68 offen lds
buffer_load_dwordx4 v2, s[20:23], s68 offen offset:1024 lds
v_pk_fma_f32 v[44:45], v[4:5], v[28:29], v[44:45] op_sel:[0,1,0] op_sel_hi:[1,1,1]
v_pk_fma_f32 v[46:47], v[6:7], v[28:29], v[46:47] op_sel:[0,1,0] op_sel_hi:[1,1,1]
v_pk_fma_f32 v[60:61], v[12:13], v[28:29], v[60:61] op_sel:[0,1,0] op_sel_hi:[1,1,1]
v_pk_fma_f32 v[62:63], v[14:15], v[28:29], v[62:63] op_sel:[0,1,0] op_sel_hi:[1,1,1]
v_pk_fma_f32 v[156:157], v[8:9], v[28:29], v[156:157] op_sel:[0,1,0] op_sel_hi:[1,1,1]
v_pk_fma_f32 v[158:159], v[10:11], v[28:29], v[158:159] op_sel:[0,1,0] op_sel_hi:[1,1,1]
v_pk_fma_f32 v[172:173], v[16:17], v[28:29], v[172:173] op_sel:[0,1,0] op_sel_hi:[1,1,1]
v_pk_fma_f32 v[174:175], v[18:19], v[28:29], v[174:175] op_sel:[0,1,0] op_sel_hi:[1,1,1]
v_pk_mul_f32 v[156:157], v[156:157], v[44:45]
v_pk_mul_f32 v[158:159], v[158:159], v[46:47]
v_pk_mul_f32 v[172:173], v[172:173], v[60:61]
v_pk_mul_f32 v[174:175], v[174:175], v[62:63]
v_pk_mul_f32 v[44:45], v[44:45], v[30:31] op_sel:[0,0] op_sel_hi:[1,0]
v_pk_mul_f32 v[46:47], v[46:47], v[30:31] op_sel:[0,0] op_sel_hi:[1,0]
v_pk_mul_f32 v[60:61], v[60:61], v[30:31] op_sel:[0,0] op_sel_hi:[1,0]
v_pk_mul_f32 v[62:63], v[62:63], v[30:31] op_sel:[0,0] op_sel_hi:[1,0]
v_exp_f32 v44, v44
v_exp_f32 v45, v45
v_exp_f32 v46, v46
v_exp_f32 v47, v47
v_exp_f32 v60, v60
v_exp_f32 v61, v61
v_exp_f32 v62, v62
v_exp_f32_e64 v63, v63
v_pk_fma_f32 v[44:45], v[44:45], v[30:31], v[30:31] op_sel:[0,1,1] op_sel_hi:[1,1,1]
v_pk_fma_f32 v[46:47], v[46:47], v[30:31], v[30:31] op_sel:[0,1,1] op_sel_hi:[1,1,1]
v_pk_fma_f32 v[60:61], v[60:61], v[30:31], v[30:31] op_sel:[0,1,1] op_sel_hi:[1,1,1]
v_pk_fma_f32 v[62:63], v[62:63], v[30:31], v[30:31] op_sel:[0,1,1] op_sel_hi:[1,1,1]
v_rcp_f32 v44, v44
v_rcp_f32 v45, v45
v_rcp_f32 v46, v46
v_rcp_f32 v47, v47
v_rcp_f32 v60, v60
v_rcp_f32 v61, v61
v_rcp_f32 v62, v62
v_rcp_f32 v63, v63
v_pk_mul_f32 v[44:45], v[44:45], v[156:157]
v_pk_mul_f32 v[46:47], v[46:47], v[158:159]
v_pk_mul_f32 v[60:61], v[60:61], v[172:173]
v_pk_mul_f32 v[62:63], v[62:63], v[174:175]
v_cvt_pk_bf16_f32 v156, v44, v45
v_cvt_pk_bf16_f32 v157, v46, v47
v_cvt_pk_bf16_f32 v158, v60, v61
v_cvt_pk_bf16_f32 v159, v62, v63
buffer_store_dwordx4 v[156:159], v1, s[12:15], s7 offen offset:0
ds_read_b128 v[32:35], v3 offset:128
ds_read_b128 v[36:39], v3 offset:640
ds_read_b128 v[40:43], v3 offset:192
ds_read_b128 v[44:47], v3 offset:704
ds_read_b128 v[48:51], v3 offset:256
ds_read_b128 v[52:55], v3 offset:768
ds_read_b128 v[56:59], v3 offset:320
ds_read_b128 v[60:63], v3 offset:832
v_accvgpr_read_b32 v8, a248
v_accvgpr_read_b32 v9, a249
v_accvgpr_read_b32 v10, a250
v_accvgpr_read_b32 v11, a251
v_accvgpr_read_b32 v16, a252
v_mov_b32 v18, s63
s_waitcnt lgkmcnt(4)
s_add_u32 m0, s70, 16384
s_add_u32 s68, s53, 1024
s_lshl_b32 s68, s68, 6
buffer_load_dwordx4 v2, s[16:19], s68 offen lds
buffer_load_dwordx4 v2, s[20:23], s68 offen offset:1024 lds
v_pk_fma_f32 v[64:65], v[32:33], v[20:21], v[64:65] op_sel:[0,0,0] op_sel_hi:[1,0,1]
v_pk_fma_f32 v[66:67], v[34:35], v[20:21], v[66:67] op_sel:[0,0,0] op_sel_hi:[1,0,1]
v_pk_fma_f32 v[80:81], v[40:41], v[20:21], v[80:81] op_sel:[0,0,0] op_sel_hi:[1,0,1]
v_pk_fma_f32 v[82:83], v[42:43], v[20:21], v[82:83] op_sel:[0,0,0] op_sel_hi:[1,0,1]
v_pk_fma_f32 v[176:177], v[36:37], v[20:21], v[176:177] op_sel:[0,0,0] op_sel_hi:[1,0,1]
v_pk_fma_f32 v[178:179], v[38:39], v[20:21], v[178:179] op_sel:[0,0,0] op_sel_hi:[1,0,1]
v_pk_fma_f32 v[192:193], v[44:45], v[20:21], v[192:193] op_sel:[0,0,0] op_sel_hi:[1,0,1]
v_pk_fma_f32 v[194:195], v[46:47], v[20:21], v[194:195] op_sel:[0,0,0] op_sel_hi:[1,0,1]
v_pk_mul_f32 v[176:177], v[176:177], v[64:65]
v_pk_mul_f32 v[178:179], v[178:179], v[66:67]
v_pk_mul_f32 v[192:193], v[192:193], v[80:81]
v_pk_mul_f32 v[194:195], v[194:195], v[82:83]
v_pk_mul_f32 v[64:65], v[64:65], v[20:21] op_sel:[0,1] op_sel_hi:[1,1]
v_pk_mul_f32 v[66:67], v[66:67], v[20:21] op_sel:[0,1] op_sel_hi:[1,1]
v_pk_mul_f32 v[80:81], v[80:81], v[20:21] op_sel:[0,1] op_sel_hi:[1,1]
v_pk_mul_f32 v[82:83], v[82:83], v[20:21] op_sel:[0,1] op_sel_hi:[1,1]
v_exp_f32 v64, v64
v_exp_f32 v65, v65
v_exp_f32 v66, v66
v_exp_f32 v67, v67
v_exp_f32 v80, v80
v_exp_f32 v81, v81
v_exp_f32 v82, v82
v_exp_f32_e64 v83, v83
v_pk_fma_f32 v[64:65], v[64:65], v[22:23], v[22:23] op_sel:[0,0,0] op_sel_hi:[1,0,0]
v_pk_fma_f32 v[66:67], v[66:67], v[22:23], v[22:23] op_sel:[0,0,0] op_sel_hi:[1,0,0]
v_pk_fma_f32 v[80:81], v[80:81], v[22:23], v[22:23] op_sel:[0,0,0] op_sel_hi:[1,0,0]
v_pk_fma_f32 v[82:83], v[82:83], v[22:23], v[22:23] op_sel:[0,0,0] op_sel_hi:[1,0,0]
v_rcp_f32 v64, v64
v_rcp_f32 v65, v65
v_rcp_f32 v66, v66
v_rcp_f32 v67, v67
v_rcp_f32 v80, v80
v_rcp_f32 v81, v81
v_rcp_f32 v82, v82
v_rcp_f32 v83, v83
v_pk_mul_f32 v[64:65], v[64:65], v[176:177]
v_pk_mul_f32 v[66:67], v[66:67], v[178:179]
v_pk_mul_f32 v[80:81], v[80:81], v[192:193]
v_pk_mul_f32 v[82:83], v[82:83], v[194:195]
v_cvt_pk_bf16_f32 v176, v64, v65
v_cvt_pk_bf16_f32 v177, v66, v67
v_cvt_pk_bf16_f32 v178, v80, v81
v_cvt_pk_bf16_f32 v179, v82, v83
buffer_store_dwordx4 v[176:179], v1, s[12:15], s4 offen offset:1024
s_add_u32 m0, s70, 24576
s_add_u32 s68, s66, 1024
s_lshl_b32 s68, s68, 6
buffer_load_dwordx4 v2, s[16:19], s68 offen lds
buffer_load_dwordx4 v2, s[20:23], s68 offen offset:1024 lds
v_pk_fma_f32 v[68:69], v[32:33], v[22:23], v[68:69] op_sel:[0,1,0] op_sel_hi:[1,1,1]
v_pk_fma_f32 v[70:71], v[34:35], v[22:23], v[70:71] op_sel:[0,1,0] op_sel_hi:[1,1,1]
v_pk_fma_f32 v[84:85], v[40:41], v[22:23], v[84:85] op_sel:[0,1,0] op_sel_hi:[1,1,1]
v_pk_fma_f32 v[86:87], v[42:43], v[22:23], v[86:87] op_sel:[0,1,0] op_sel_hi:[1,1,1]
v_pk_fma_f32 v[180:181], v[36:37], v[22:23], v[180:181] op_sel:[0,1,0] op_sel_hi:[1,1,1]
v_pk_fma_f32 v[182:183], v[38:39], v[22:23], v[182:183] op_sel:[0,1,0] op_sel_hi:[1,1,1]
v_pk_fma_f32 v[196:197], v[44:45], v[22:23], v[196:197] op_sel:[0,1,0] op_sel_hi:[1,1,1]
v_pk_fma_f32 v[198:199], v[46:47], v[22:23], v[198:199] op_sel:[0,1,0] op_sel_hi:[1,1,1]
v_pk_mul_f32 v[180:181], v[180:181], v[68:69]
v_pk_mul_f32 v[182:183], v[182:183], v[70:71]
v_pk_mul_f32 v[196:197], v[196:197], v[84:85]
v_pk_mul_f32 v[198:199], v[198:199], v[86:87]
v_pk_mul_f32 v[68:69], v[68:69], v[24:25] op_sel:[0,0] op_sel_hi:[1,0]
v_pk_mul_f32 v[70:71], v[70:71], v[24:25] op_sel:[0,0] op_sel_hi:[1,0]
v_pk_mul_f32 v[84:85], v[84:85], v[24:25] op_sel:[0,0] op_sel_hi:[1,0]
v_pk_mul_f32 v[86:87], v[86:87], v[24:25] op_sel:[0,0] op_sel_hi:[1,0]
v_exp_f32 v68, v68
v_exp_f32 v69, v69
v_exp_f32 v70, v70
v_exp_f32 v71, v71
v_exp_f32 v84, v84
v_exp_f32 v85, v85
v_exp_f32 v86, v86
v_exp_f32_e64 v87, v87
v_pk_fma_f32 v[68:69], v[68:69], v[24:25], v[24:25] op_sel:[0,1,1] op_sel_hi:[1,1,1]
v_pk_fma_f32 v[70:71], v[70:71], v[24:25], v[24:25] op_sel:[0,1,1] op_sel_hi:[1,1,1]
v_pk_fma_f32 v[84:85], v[84:85], v[24:25], v[24:25] op_sel:[0,1,1] op_sel_hi:[1,1,1]
v_pk_fma_f32 v[86:87], v[86:87], v[24:25], v[24:25] op_sel:[0,1,1] op_sel_hi:[1,1,1]
v_rcp_f32 v68, v68
v_rcp_f32 v69, v69
v_rcp_f32 v70, v70
v_rcp_f32 v71, v71
v_rcp_f32 v84, v84
v_rcp_f32 v85, v85
v_rcp_f32 v86, v86
v_rcp_f32 v87, v87
v_pk_mul_f32 v[68:69], v[68:69], v[180:181]
v_pk_mul_f32 v[70:71], v[70:71], v[182:183]
v_pk_mul_f32 v[84:85], v[84:85], v[196:197]
v_pk_mul_f32 v[86:87], v[86:87], v[198:199]
v_cvt_pk_bf16_f32 v180, v68, v69
v_cvt_pk_bf16_f32 v181, v70, v71
v_cvt_pk_bf16_f32 v182, v84, v85
v_cvt_pk_bf16_f32 v183, v86, v87
buffer_store_dwordx4 v[180:183], v1, s[12:15], s5 offen offset:1024
s_add_u32 m0, s70, 32768
s_add_u32 s68, s67, 1024
s_lshl_b32 s68, s68, 6
buffer_load_dwordx4 v2, s[16:19], s68 offen lds
buffer_load_dwordx4 v2, s[20:23], s68 offen offset:1024 lds
v_pk_fma_f32 v[72:73], v[32:33], v[26:27], v[72:73] op_sel:[0,0,0] op_sel_hi:[1,0,1]
v_pk_fma_f32 v[74:75], v[34:35], v[26:27], v[74:75] op_sel:[0,0,0] op_sel_hi:[1,0,1]
v_pk_fma_f32 v[88:89], v[40:41], v[26:27], v[88:89] op_sel:[0,0,0] op_sel_hi:[1,0,1]
v_pk_fma_f32 v[90:91], v[42:43], v[26:27], v[90:91] op_sel:[0,0,0] op_sel_hi:[1,0,1]
v_pk_fma_f32 v[184:185], v[36:37], v[26:27], v[184:185] op_sel:[0,0,0] op_sel_hi:[1,0,1]
v_pk_fma_f32 v[186:187], v[38:39], v[26:27], v[186:187] op_sel:[0,0,0] op_sel_hi:[1,0,1]
v_pk_fma_f32 v[200:201], v[44:45], v[26:27], v[200:201] op_sel:[0,0,0] op_sel_hi:[1,0,1]
v_pk_fma_f32 v[202:203], v[46:47], v[26:27], v[202:203] op_sel:[0,0,0] op_sel_hi:[1,0,1]
v_pk_mul_f32 v[184:185], v[184:185], v[72:73]
v_pk_mul_f32 v[186:187], v[186:187], v[74:75]
v_pk_mul_f32 v[200:201], v[200:201], v[88:89]
v_pk_mul_f32 v[202:203], v[202:203], v[90:91]
v_pk_mul_f32 v[72:73], v[72:73], v[26:27] op_sel:[0,1] op_sel_hi:[1,1]
v_pk_mul_f32 v[74:75], v[74:75], v[26:27] op_sel:[0,1] op_sel_hi:[1,1]
v_pk_mul_f32 v[88:89], v[88:89], v[26:27] op_sel:[0,1] op_sel_hi:[1,1]
v_pk_mul_f32 v[90:91], v[90:91], v[26:27] op_sel:[0,1] op_sel_hi:[1,1]
v_exp_f32 v72, v72
v_exp_f32 v73, v73
v_exp_f32 v74, v74
v_exp_f32 v75, v75
v_exp_f32 v88, v88
v_exp_f32 v89, v89
v_exp_f32 v90, v90
v_exp_f32_e64 v91, v91
v_pk_fma_f32 v[72:73], v[72:73], v[28:29], v[28:29] op_sel:[0,0,0] op_sel_hi:[1,0,0]
v_pk_fma_f32 v[74:75], v[74:75], v[28:29], v[28:29] op_sel:[0,0,0] op_sel_hi:[1,0,0]
v_pk_fma_f32 v[88:89], v[88:89], v[28:29], v[28:29] op_sel:[0,0,0] op_sel_hi:[1,0,0]
v_pk_fma_f32 v[90:91], v[90:91], v[28:29], v[28:29] op_sel:[0,0,0] op_sel_hi:[1,0,0]
v_rcp_f32 v72, v72
v_rcp_f32 v73, v73
v_rcp_f32 v74, v74
v_rcp_f32 v75, v75
v_rcp_f32 v88, v88
v_rcp_f32 v89, v89
v_rcp_f32 v90, v90
v_rcp_f32 v91, v91
v_pk_mul_f32 v[72:73], v[72:73], v[184:185]
v_pk_mul_f32 v[74:75], v[74:75], v[186:187]
v_pk_mul_f32 v[88:89], v[88:89], v[200:201]
v_pk_mul_f32 v[90:91], v[90:91], v[202:203]
v_cvt_pk_bf16_f32 v184, v72, v73
v_cvt_pk_bf16_f32 v185, v74, v75
v_cvt_pk_bf16_f32 v186, v88, v89
v_cvt_pk_bf16_f32 v187, v90, v91
buffer_store_dwordx4 v[184:187], v1, s[12:15], s6 offen offset:1024
s_add_u32 m0, s70, 40960
s_add_u32 s68, s49, 2048
s_lshl_b32 s68, s68, 6
buffer_load_dwordx4 v2, s[16:19], s68 offen lds
buffer_load_dwordx4 v2, s[20:23], s68 offen offset:1024 lds
v_pk_fma_f32 v[76:77], v[32:33], v[28:29], v[76:77] op_sel:[0,1,0] op_sel_hi:[1,1,1]
v_pk_fma_f32 v[78:79], v[34:35], v[28:29], v[78:79] op_sel:[0,1,0] op_sel_hi:[1,1,1]
v_pk_fma_f32 v[92:93], v[40:41], v[28:29], v[92:93] op_sel:[0,1,0] op_sel_hi:[1,1,1]
v_pk_fma_f32 v[94:95], v[42:43], v[28:29], v[94:95] op_sel:[0,1,0] op_sel_hi:[1,1,1]
v_pk_fma_f32 v[188:189], v[36:37], v[28:29], v[188:189] op_sel:[0,1,0] op_sel_hi:[1,1,1]
v_pk_fma_f32 v[190:191], v[38:39], v[28:29], v[190:191] op_sel:[0,1,0] op_sel_hi:[1,1,1]
v_pk_fma_f32 v[204:205], v[44:45], v[28:29], v[204:205] op_sel:[0,1,0] op_sel_hi:[1,1,1]
v_pk_fma_f32 v[206:207], v[46:47], v[28:29], v[206:207] op_sel:[0,1,0] op_sel_hi:[1,1,1]
v_pk_mul_f32 v[188:189], v[188:189], v[76:77]
v_pk_mul_f32 v[190:191], v[190:191], v[78:79]
v_pk_mul_f32 v[204:205], v[204:205], v[92:93]
v_pk_mul_f32 v[206:207], v[206:207], v[94:95]
v_pk_mul_f32 v[76:77], v[76:77], v[30:31] op_sel:[0,0] op_sel_hi:[1,0]
v_pk_mul_f32 v[78:79], v[78:79], v[30:31] op_sel:[0,0] op_sel_hi:[1,0]
v_pk_mul_f32 v[92:93], v[92:93], v[30:31] op_sel:[0,0] op_sel_hi:[1,0]
v_pk_mul_f32 v[94:95], v[94:95], v[30:31] op_sel:[0,0] op_sel_hi:[1,0]
v_exp_f32 v76, v76
v_exp_f32 v77, v77
v_exp_f32 v78, v78
v_exp_f32 v79, v79
v_exp_f32 v92, v92
v_exp_f32 v93, v93
v_exp_f32 v94, v94
v_exp_f32_e64 v95, v95
v_pk_fma_f32 v[76:77], v[76:77], v[30:31], v[30:31] op_sel:[0,1,1] op_sel_hi:[1,1,1]
v_pk_fma_f32 v[78:79], v[78:79], v[30:31], v[30:31] op_sel:[0,1,1] op_sel_hi:[1,1,1]
v_pk_fma_f32 v[92:93], v[92:93], v[30:31], v[30:31] op_sel:[0,1,1] op_sel_hi:[1,1,1]
v_pk_fma_f32 v[94:95], v[94:95], v[30:31], v[30:31] op_sel:[0,1,1] op_sel_hi:[1,1,1]
v_rcp_f32 v76, v76
v_rcp_f32 v77, v77
v_rcp_f32 v78, v78
v_rcp_f32 v79, v79
v_rcp_f32 v92, v92
v_rcp_f32 v93, v93
v_rcp_f32 v94, v94
v_rcp_f32 v95, v95
v_pk_mul_f32 v[76:77], v[76:77], v[188:189]
v_pk_mul_f32 v[78:79], v[78:79], v[190:191]
v_pk_mul_f32 v[92:93], v[92:93], v[204:205]
v_pk_mul_f32 v[94:95], v[94:95], v[206:207]
v_cvt_pk_bf16_f32 v188, v76, v77
v_cvt_pk_bf16_f32 v189, v78, v79
v_cvt_pk_bf16_f32 v190, v92, v93
v_cvt_pk_bf16_f32 v191, v94, v95
buffer_store_dwordx4 v[188:191], v1, s[12:15], s7 offen offset:1024
ds_read_b128 v[32:35], v3 offset:384
ds_read_b128 v[36:39], v3 offset:896
s_waitcnt lgkmcnt(2)
s_add_u32 m0, s70, 49152
s_add_u32 s68, s50, 2048
s_lshl_b32 s68, s68, 6
buffer_load_dwordx4 v2, s[16:19], s68 offen lds
buffer_load_dwordx4 v2, s[20:23], s68 offen offset:1024 lds
v_pk_fma_f32 v[96:97], v[48:49], v[20:21], v[96:97] op_sel:[0,0,0] op_sel_hi:[1,0,1]
v_pk_fma_f32 v[98:99], v[50:51], v[20:21], v[98:99] op_sel:[0,0,0] op_sel_hi:[1,0,1]
v_pk_fma_f32 v[112:113], v[56:57], v[20:21], v[112:113] op_sel:[0,0,0] op_sel_hi:[1,0,1]
v_pk_fma_f32 v[114:115], v[58:59], v[20:21], v[114:115] op_sel:[0,0,0] op_sel_hi:[1,0,1]
v_pk_fma_f32 v[208:209], v[52:53], v[20:21], v[208:209] op_sel:[0,0,0] op_sel_hi:[1,0,1]
v_pk_fma_f32 v[210:211], v[54:55], v[20:21], v[210:211] op_sel:[0,0,0] op_sel_hi:[1,0,1]
v_pk_fma_f32 v[224:225], v[60:61], v[20:21], v[224:225] op_sel:[0,0,0] op_sel_hi:[1,0,1]
v_pk_fma_f32 v[226:227], v[62:63], v[20:21], v[226:227] op_sel:[0,0,0] op_sel_hi:[1,0,1]
v_pk_mul_f32 v[208:209], v[208:209], v[96:97]
v_pk_mul_f32 v[210:211], v[210:211], v[98:99]
v_pk_mul_f32 v[224:225], v[224:225], v[112:113]
v_pk_mul_f32 v[226:227], v[226:227], v[114:115]
v_pk_mul_f32 v[96:97], v[96:97], v[20:21] op_sel:[0,1] op_sel_hi:[1,1]
v_pk_mul_f32 v[98:99], v[98:99], v[20:21] op_sel:[0,1] op_sel_hi:[1,1]
v_pk_mul_f32 v[112:113], v[112:113], v[20:21] op_sel:[0,1] op_sel_hi:[1,1]
v_pk_mul_f32 v[114:115], v[114:115], v[20:21] op_sel:[0,1] op_sel_hi:[1,1]
v_exp_f32 v96, v96
v_exp_f32 v97, v97
v_exp_f32 v98, v98
v_exp_f32 v99, v99
v_exp_f32 v112, v112
v_exp_f32 v113, v113
v_exp_f32 v114, v114
v_exp_f32 v115, v115
v_pk_fma_f32 v[96:97], v[96:97], v[22:23], v[22:23] op_sel:[0,0,0] op_sel_hi:[1,0,0]
v_pk_fma_f32 v[98:99], v[98:99], v[22:23], v[22:23] op_sel:[0,0,0] op_sel_hi:[1,0,0]
v_pk_fma_f32 v[112:113], v[112:113], v[22:23], v[22:23] op_sel:[0,0,0] op_sel_hi:[1,0,0]
v_pk_fma_f32 v[114:115], v[114:115], v[22:23], v[22:23] op_sel:[0,0,0] op_sel_hi:[1,0,0]
v_rcp_f32 v96, v96
v_rcp_f32 v97, v97
v_rcp_f32 v98, v98
v_rcp_f32 v99, v99
v_rcp_f32 v112, v112
v_rcp_f32 v113, v113
L_wp21:
s_cbranch_execz L_wp24
v_rcp_f32 v114, v114
v_rcp_f32_e64 v115, v115
v_pk_mul_f32 v[96:97], v[96:97], v[208:209]
v_pk_mul_f32 v[98:99], v[98:99], v[210:211]
v_pk_mul_f32 v[112:113], v[112:113], v[224:225]
v_pk_mul_f32 v[114:115], v[114:115], v[226:227]
v_cvt_pk_bf16_f32 v208, v96, v97
v_cvt_pk_bf16_f32 v209, v98, v99
v_cvt_pk_bf16_f32 v210, v112, v113
v_cvt_pk_bf16_f32 v211, v114, v115
buffer_store_dwordx4 v[208:211], v1, s[12:15], s4 offen offset:2048
v_pk_fma_f32 v[100:101], v[48:49], v[22:23], v[100:101] op_sel:[0,1,0] op_sel_hi:[1,1,1]
v_pk_fma_f32 v[102:103], v[50:51], v[22:23], v[102:103] op_sel:[0,1,0] op_sel_hi:[1,1,1]
v_pk_fma_f32 v[116:117], v[56:57], v[22:23], v[116:117] op_sel:[0,1,0] op_sel_hi:[1,1,1]
v_pk_fma_f32 v[118:119], v[58:59], v[22:23], v[118:119] op_sel:[0,1,0] op_sel_hi:[1,1,1]
v_pk_fma_f32 v[212:213], v[52:53], v[22:23], v[212:213] op_sel:[0,1,0] op_sel_hi:[1,1,1]
v_pk_fma_f32 v[214:215], v[54:55], v[22:23], v[214:215] op_sel:[0,1,0] op_sel_hi:[1,1,1]
v_pk_fma_f32 v[228:229], v[60:61], v[22:23], v[228:229] op_sel:[0,1,0] op_sel_hi:[1,1,1]
v_pk_fma_f32 v[230:231], v[62:63], v[22:23], v[230:231] op_sel:[0,1,0] op_sel_hi:[1,1,1]
v_pk_mul_f32 v[212:213], v[212:213], v[100:101]
v_pk_mul_f32 v[214:215], v[214:215], v[102:103]
v_pk_mul_f32 v[228:229], v[228:229], v[116:117]
v_pk_mul_f32 v[230:231], v[230:231], v[118:119]
v_pk_mul_f32 v[100:101], v[100:101], v[24:25] op_sel:[0,0] op_sel_hi:[1,0]
v_pk_mul_f32 v[102:103], v[102:103], v[24:25] op_sel:[0,0] op_sel_hi:[1,0]
v_pk_mul_f32 v[116:117], v[116:117], v[24:25] op_sel:[0,0] op_sel_hi:[1,0]
v_pk_mul_f32 v[118:119], v[118:119], v[24:25] op_sel:[0,0] op_sel_hi:[1,0]
v_exp_f32 v100, v100
v_exp_f32 v101, v101
v_exp_f32 v102, v102
v_exp_f32 v103, v103
v_exp_f32 v116, v116
v_exp_f32 v117, v117
v_exp_f32 v118, v118
v_exp_f32 v119, v119
v_pk_fma_f32 v[100:101], v[100:101], v[24:25], v[24:25] op_sel:[0,1,1] op_sel_hi:[1,1,1]
v_pk_fma_f32 v[102:103], v[102:103], v[24:25], v[24:25] op_sel:[0,1,1] op_sel_hi:[1,1,1]
v_pk_fma_f32 v[116:117], v[116:117], v[24:25], v[24:25] op_sel:[0,1,1] op_sel_hi:[1,1,1]
v_pk_fma_f32 v[118:119], v[118:119], v[24:25], v[24:25] op_sel:[0,1,1] op_sel_hi:[1,1,1]
v_rcp_f32 v100, v100
v_rcp_f32 v101, v101
v_rcp_f32 v102, v102
v_rcp_f32 v103, v103
v_rcp_f32 v116, v116
v_rcp_f32 v117, v117
v_rcp_f32 v118, v118
v_rcp_f32 v119, v119
v_pk_mul_f32 v[100:101], v[100:101], v[212:213]
v_pk_mul_f32 v[102:103], v[102:103], v[214:215]
v_pk_mul_f32 v[116:117], v[116:117], v[228:229]
v_pk_mul_f32 v[118:119], v[118:119], v[230:231]
v_cvt_pk_bf16_f32 v212, v100, v101
v_cvt_pk_bf16_f32 v213, v102, v103
v_cvt_pk_bf16_f32 v214, v116, v117
v_cvt_pk_bf16_f32 v215, v118, v119
buffer_store_dwordx4 v[212:215], v1, s[12:15], s5 offen offset:2048
s_waitcnt vmcnt(16)
s_cmp_lg_u32 s99, 0
s_cbranch_scc1 L_ps0
s_mov_b64 exec, 1
buffer_store_dword v18, off, s[12:15], s62 offset:0
L_ps0x:
s_mov_b64 exec, -1
s_nop 0
v_pk_fma_f32 v[104:105], v[48:49], v[26:27], v[104:105] op_sel:[0,0,0] op_sel_hi:[1,0,1]
v_pk_fma_f32 v[106:107], v[50:51], v[26:27], v[106:107] op_sel:[0,0,0] op_sel_hi:[1,0,1]
v_pk_fma_f32 v[120:121], v[56:57], v[26:27], v[120:121] op_sel:[0,0,0] op_sel_hi:[1,0,1]
v_pk_fma_f32 v[122:123], v[58:59], v[26:27], v[122:123] op_sel:[0,0,0] op_sel_hi:[1,0,1]
v_pk_fma_f32 v[216:217], v[52:53], v[26:27], v[216:217] op_sel:[0,0,0] op_sel_hi:[1,0,1]
v_pk_fma_f32 v[218:219], v[54:55], v[26:27], v[218:219] op_sel:[0,0,0] op_sel_hi:[1,0,1]
v_pk_fma_f32 v[232:233], v[60:61], v[26:27], v[232:233] op_sel:[0,0,0] op_sel_hi:[1,0,1]
v_pk_fma_f32 v[234:235], v[62:63], v[26:27], v[234:235] op_sel:[0,0,0] op_sel_hi:[1,0,1]
v_pk_mul_f32 v[216:217], v[216:217], v[104:105]
v_pk_mul_f32 v[218:219], v[218:219], v[106:107]
v_pk_mul_f32 v[232:233], v[232:233], v[120:121]
v_pk_mul_f32 v[234:235], v[234:235], v[122:123]
v_pk_mul_f32 v[104:105], v[104:105], v[26:27] op_sel:[0,1] op_sel_hi:[1,1]
v_pk_mul_f32 v[106:107], v[106:107], v[26:27] op_sel:[0,1] op_sel_hi:[1,1]
v_pk_mul_f32 v[120:121], v[120:121], v[26:27] op_sel:[0,1] op_sel_hi:[1,1]
v_pk_mul_f32 v[122:123], v[122:123], v[26:27] op_sel:[0,1] op_sel_hi:[1,1]
v_exp_f32 v104, v104
v_exp_f32 v105, v105
v_exp_f32 v106, v106
v_exp_f32 v107, v107
v_exp_f32 v120, v120
v_exp_f32 v121, v121
v_exp_f32 v122, v122
v_exp_f32 v123, v123
v_pk_fma_f32 v[104:105], v[104:105], v[28:29], v[28:29] op_sel:[0,0,0] op_sel_hi:[1,0,0]
v_pk_fma_f32 v[106:107], v[106:107], v[28:29], v[28:29] op_sel:[0,0,0] op_sel_hi:[1,0,0]
v_pk_fma_f32 v[120:121], v[120:121], v[28:29], v[28:29] op_sel:[0,0,0] op_sel_hi:[1,0,0]
v_pk_fma_f32 v[122:123], v[122:123], v[28:29], v[28:29] op_sel:[0,0,0] op_sel_hi:[1,0,0]
v_rcp_f32 v104, v104
v_rcp_f32 v105, v105
v_rcp_f32 v106, v106
v_rcp_f32 v107, v107
v_rcp_f32 v120, v120
v_rcp_f32 v121, v121
v_rcp_f32 v122, v122
v_rcp_f32 v123, v123
v_pk_mul_f32 v[104:105], v[104:105], v[216:217]
v_pk_mul_f32 v[106:107], v[106:107], v[218:219]
v_pk_mul_f32 v[120:121], v[120:121], v[232:233]
v_pk_mul_f32 v[122:123], v[122:123], v[234:235]
v_cvt_pk_bf16_f32 v216, v104, v105
v_cvt_pk_bf16_f32 v217, v106, v107
v_cvt_pk_bf16_f32 v218, v120, v121
v_cvt_pk_bf16_f32 v219, v122, v123
buffer_store_dwordx4 v[216:219], v1, s[12:15], s6 offen offset:2048
v_pk_fma_f32 v[108:109], v[48:49], v[28:29], v[108:109] op_sel:[0,1,0] op_sel_hi:[1,1,1]
v_pk_fma_f32 v[110:111], v[50:51], v[28:29], v[110:111] op_sel:[0,1,0] op_sel_hi:[1,1,1]
v_pk_fma_f32 v[124:125], v[56:57], v[28:29], v[124:125] op_sel:[0,1,0] op_sel_hi:[1,1,1]
v_pk_fma_f32 v[126:127], v[58:59], v[28:29], v[126:127] op_sel:[0,1,0] op_sel_hi:[1,1,1]
v_pk_fma_f32 v[220:221], v[52:53], v[28:29], v[220:221] op_sel:[0,1,0] op_sel_hi:[1,1,1]
v_pk_fma_f32 v[222:223], v[54:55], v[28:29], v[222:223] op_sel:[0,1,0] op_sel_hi:[1,1,1]
v_pk_fma_f32 v[236:237], v[60:61], v[28:29], v[236:237] op_sel:[0,1,0] op_sel_hi:[1,1,1]
v_pk_fma_f32 v[238:239], v[62:63], v[28:29], v[238:239] op_sel:[0,1,0] op_sel_hi:[1,1,1]
v_pk_mul_f32 v[220:221], v[220:221], v[108:109]
v_pk_mul_f32 v[222:223], v[222:223], v[110:111]
v_pk_mul_f32 v[236:237], v[236:237], v[124:125]
v_pk_mul_f32 v[238:239], v[238:239], v[126:127]
v_pk_mul_f32 v[108:109], v[108:109], v[30:31] op_sel:[0,0] op_sel_hi:[1,0]
v_pk_mul_f32 v[110:111], v[110:111], v[30:31] op_sel:[0,0] op_sel_hi:[1,0]
v_pk_mul_f32 v[124:125], v[124:125], v[30:31] op_sel:[0,0] op_sel_hi:[1,0]
v_pk_mul_f32 v[126:127], v[126:127], v[30:31] op_sel:[0,0] op_sel_hi:[1,0]
v_exp_f32 v108, v108
v_exp_f32 v109, v109
v_exp_f32 v110, v110
v_exp_f32 v111, v111
v_exp_f32 v124, v124
v_exp_f32 v125, v125
v_exp_f32 v126, v126
v_exp_f32 v127, v127
v_pk_fma_f32 v[108:109], v[108:109], v[30:31], v[30:31] op_sel:[0,1,1] op_sel_hi:[1,1,1]
v_pk_fma_f32 v[110:111], v[110:111], v[30:31], v[30:31] op_sel:[0,1,1] op_sel_hi:[1,1,1]
v_pk_fma_f32 v[124:125], v[124:125], v[30:31], v[30:31] op_sel:[0,1,1] op_sel_hi:[1,1,1]
v_pk_fma_f32 v[126:127], v[126:127], v[30:31], v[30:31] op_sel:[0,1,1] op_sel_hi:[1,1,1]
v_rcp_f32 v108, v108
v_rcp_f32 v109, v109
v_rcp_f32 v110, v110
v_rcp_f32 v111, v111
v_rcp_f32 v124, v124
v_rcp_f32 v125, v125
v_rcp_f32 v126, v126
v_rcp_f32 v127, v127
v_pk_mul_f32 v[108:109], v[108:109], v[220:221]
v_pk_mul_f32 v[110:111], v[110:111], v[222:223]
v_pk_mul_f32 v[124:125], v[124:125], v[236:237]
v_pk_mul_f32 v[126:127], v[126:127], v[238:239]
v_cvt_pk_bf16_f32 v220, v108, v109
v_cvt_pk_bf16_f32 v221, v110, v111
v_cvt_pk_bf16_f32 v222, v124, v125
v_cvt_pk_bf16_f32 v223, v126, v127
buffer_store_dwordx4 v[220:223], v1, s[12:15], s7 offen offset:2048
s_waitcnt vmcnt(28) lgkmcnt(0)
s_barrier
ds_read_b64_tr_b16 a[160:161], v8 offset:0
ds_read_b64_tr_b16 a[162:163], v8 offset:4096
ds_read_b64_tr_b16 a[164:165], v9 offset:0
ds_read_b64_tr_b16 a[166:167], v9 offset:4096
ds_read_b64_tr_b16 a[168:169], v10 offset:0
ds_read_b64_tr_b16 a[170:171], v10 offset:4096
ds_read_b64_tr_b16 a[172:173], v11 offset:0
ds_read_b64_tr_b16 a[174:175], v11 offset:4096
ds_read_b64_tr_b16 a[176:177], v8 offset:1024
ds_read_b64_tr_b16 a[178:179], v8 offset:5120
ds_read_b64_tr_b16 a[180:181], v9 offset:1024
ds_read_b64_tr_b16 a[182:183], v9 offset:5120
ds_read_b64_tr_b16 a[184:185], v10 offset:1024
ds_read_b64_tr_b16 a[186:187], v10 offset:5120
ds_read_b64_tr_b16 a[188:189], v11 offset:1024
ds_read_b64_tr_b16 a[190:191], v11 offset:5120
s_load_dwordx2 s[24:25], s[0:1], 64
buffer_load_dword v17, v16, s[12:15], 0 offen sc1
v_pk_fma_f32 v[128:129], v[32:33], v[20:21], v[128:129] op_sel:[0,0,0] op_sel_hi:[1,0,1]
v_pk_fma_f32 v[130:131], v[34:35], v[20:21], v[130:131] op_sel:[0,0,0] op_sel_hi:[1,0,1]
v_pk_fma_f32 v[240:241], v[36:37], v[20:21], v[240:241] op_sel:[0,0,0] op_sel_hi:[1,0,1]
v_pk_fma_f32 v[242:243], v[38:39], v[20:21], v[242:243] op_sel:[0,0,0] op_sel_hi:[1,0,1]
v_pk_mul_f32 v[240:241], v[240:241], v[128:129]
v_pk_mul_f32 v[242:243], v[242:243], v[130:131]
v_pk_mul_f32 v[128:129], v[128:129], v[20:21] op_sel:[0,1] op_sel_hi:[1,1]
v_pk_mul_f32 v[130:131], v[130:131], v[20:21] op_sel:[0,1] op_sel_hi:[1,1]
v_exp_f32 v128, v128
v_exp_f32 v129, v129
v_exp_f32 v130, v130
v_exp_f32 v131, v131
v_pk_fma_f32 v[128:129], v[128:129], v[22:23], v[22:23] op_sel:[0,0,0] op_sel_hi:[1,0,0]
v_pk_fma_f32 v[130:131], v[130:131], v[22:23], v[22:23] op_sel:[0,0,0] op_sel_hi:[1,0,0]
v_rcp_f32 v128, v128
v_rcp_f32 v129, v129
v_rcp_f32 v130, v130
v_rcp_f32 v131, v131
v_pk_mul_f32 v[128:129], v[128:129], v[240:241]
v_pk_mul_f32 v[130:131], v[130:131], v[242:243]
v_cvt_pk_bf16_f32 v240, v128, v129
v_cvt_pk_bf16_f32 v241, v130, v131
buffer_store_dwordx2 v[240:241], v1, s[12:15], s40 offen
v_pk_fma_f32 v[132:133], v[32:33], v[22:23], v[132:133] op_sel:[0,1,0] op_sel_hi:[1,1,1]
v_pk_fma_f32 v[134:135], v[34:35], v[22:23], v[134:135] op_sel:[0,1,0] op_sel_hi:[1,1,1]
v_pk_fma_f32 v[244:245], v[36:37], v[22:23], v[244:245] op_sel:[0,1,0] op_sel_hi:[1,1,1]
v_pk_fma_f32 v[246:247], v[38:39], v[22:23], v[246:247] op_sel:[0,1,0] op_sel_hi:[1,1,1]
v_pk_mul_f32 v[244:245], v[244:245], v[132:133]
v_pk_mul_f32 v[246:247], v[246:247], v[134:135]
v_pk_mul_f32 v[132:133], v[132:133], v[24:25] op_sel:[0,0] op_sel_hi:[1,0]
v_pk_mul_f32 v[134:135], v[134:135], v[24:25] op_sel:[0,0] op_sel_hi:[1,0]
v_exp_f32 v132, v132
v_exp_f32 v133, v133
v_exp_f32 v134, v134
v_exp_f32 v135, v135
v_pk_fma_f32 v[132:133], v[132:133], v[24:25], v[24:25] op_sel:[0,1,1] op_sel_hi:[1,1,1]
v_pk_fma_f32 v[134:135], v[134:135], v[24:25], v[24:25] op_sel:[0,1,1] op_sel_hi:[1,1,1]
v_rcp_f32 v132, v132
v_rcp_f32 v133, v133
v_rcp_f32 v134, v134
v_rcp_f32 v135, v135
v_pk_mul_f32 v[132:133], v[132:133], v[244:245]
v_pk_mul_f32 v[134:135], v[134:135], v[246:247]
v_cvt_pk_bf16_f32 v244, v132, v133
v_cvt_pk_bf16_f32 v245, v134, v135
buffer_store_dwordx2 v[244:245], v1, s[12:15], s41 offen
v_pk_fma_f32 v[136:137], v[32:33], v[26:27], v[136:137] op_sel:[0,0,0] op_sel_hi:[1,0,1]
v_pk_fma_f32 v[138:139], v[34:35], v[26:27], v[138:139] op_sel:[0,0,0] op_sel_hi:[1,0,1]
v_pk_fma_f32 v[248:249], v[36:37], v[26:27], v[248:249] op_sel:[0,0,0] op_sel_hi:[1,0,1]
v_pk_fma_f32 v[250:251], v[38:39], v[26:27], v[250:251] op_sel:[0,0,0] op_sel_hi:[1,0,1]
v_pk_mul_f32 v[248:249], v[248:249], v[136:137]
v_pk_mul_f32 v[250:251], v[250:251], v[138:139]
v_pk_mul_f32 v[136:137], v[136:137], v[26:27] op_sel:[0,1] op_sel_hi:[1,1]
v_pk_mul_f32 v[138:139], v[138:139], v[26:27] op_sel:[0,1] op_sel_hi:[1,1]
v_exp_f32 v136, v136
v_exp_f32 v137, v137
v_exp_f32 v138, v138
v_exp_f32 v139, v139
v_pk_fma_f32 v[136:137], v[136:137], v[28:29], v[28:29] op_sel:[0,0,0] op_sel_hi:[1,0,0]
v_pk_fma_f32 v[138:139], v[138:139], v[28:29], v[28:29] op_sel:[0,0,0] op_sel_hi:[1,0,0]
v_rcp_f32 v136, v136
v_rcp_f32 v137, v137
v_rcp_f32 v138, v138
v_rcp_f32 v139, v139
v_pk_mul_f32 v[136:137], v[136:137], v[248:249]
v_pk_mul_f32 v[138:139], v[138:139], v[250:251]
v_cvt_pk_bf16_f32 v248, v136, v137
v_cvt_pk_bf16_f32 v249, v138, v139
buffer_store_dwordx2 v[248:249], v1, s[12:15], s42 offen
v_pk_fma_f32 v[140:141], v[32:33], v[28:29], v[140:141] op_sel:[0,1,0] op_sel_hi:[1,1,1]
v_pk_fma_f32 v[142:143], v[34:35], v[28:29], v[142:143] op_sel:[0,1,0] op_sel_hi:[1,1,1]
v_pk_fma_f32 v[252:253], v[36:37], v[28:29], v[252:253] op_sel:[0,1,0] op_sel_hi:[1,1,1]
v_pk_fma_f32 v[254:255], v[38:39], v[28:29], v[254:255] op_sel:[0,1,0] op_sel_hi:[1,1,1]
v_pk_mul_f32 v[252:253], v[252:253], v[140:141]
v_pk_mul_f32 v[254:255], v[254:255], v[142:143]
v_pk_mul_f32 v[140:141], v[140:141], v[30:31] op_sel:[0,0] op_sel_hi:[1,0]
v_pk_mul_f32 v[142:143], v[142:143], v[30:31] op_sel:[0,0] op_sel_hi:[1,0]
v_exp_f32 v140, v140
v_exp_f32 v141, v141
v_exp_f32 v142, v142
v_exp_f32 v143, v143
v_pk_fma_f32 v[140:141], v[140:141], v[30:31], v[30:31] op_sel:[0,1,1] op_sel_hi:[1,1,1]
v_pk_fma_f32 v[142:143], v[142:143], v[30:31], v[30:31] op_sel:[0,1,1] op_sel_hi:[1,1,1]
v_rcp_f32 v140, v140
v_rcp_f32 v141, v141
v_rcp_f32 v142, v142
v_rcp_f32 v143, v143
v_pk_mul_f32 v[140:141], v[140:141], v[252:253]
v_pk_mul_f32 v[142:143], v[142:143], v[254:255]
v_cvt_pk_bf16_f32 v252, v140, v141
v_cvt_pk_bf16_f32 v253, v142, v143
buffer_store_dwordx2 v[252:253], v1, s[12:15], s43 offen
L_p4end:
s_waitcnt lgkmcnt(0)
v_mfma_f32_16x16x32_bf16 v[32:35], a[160:163], v[144:147], 0
ds_read_b64_tr_b16 a[192:193], v8 offset:8192
v_add_u32 v20, 114688, v1
v_mfma_f32_16x16x32_bf16 v[36:39], a[160:163], v[148:151], 0
ds_read_b64_tr_b16 a[194:195], v8 offset:12288
v_add_u32 v21, 229376, v1
v_mfma_f32_16x16x32_bf16 v[40:43], a[160:163], v[152:155], 0
v_add_u32 v22, 344064, v1
v_mfma_f32_16x16x32_bf16 v[44:47], a[160:163], v[156:159], 0
ds_read_b64_tr_b16 a[196:197], v9 offset:8192
v_mfma_f32_16x16x32_bf16 v[60:63], a[164:167], v[156:159], 0
s_waitcnt vmcnt(12)
s_cmp_lg_u32 s99, 0
s_cbranch_scc1 L_ps1
s_mov_b64 exec, 1
buffer_store_dword v18, off, s[12:15], s62 offset:32
L_ps1x:
s_mov_b64 exec, -1
v_mfma_f32_16x16x32_bf16 v[56:59], a[164:167], v[152:155], 0
ds_read_b64_tr_b16 a[198:199], v9 offset:12288
v_mfma_f32_16x16x32_bf16 v[52:55], a[164:167], v[148:151], 0
ds_read_b64_tr_b16 a[200:201], v10 offset:8192
v_mfma_f32_16x16x32_bf16 v[48:51], a[164:167], v[144:147], 0
v_mfma_f32_16x16x32_bf16 v[64:67], a[168:171], v[144:147], 0
ds_read_b64_tr_b16 a[202:203], v10 offset:12288
v_mfma_f32_16x16x32_bf16 v[68:71], a[168:171], v[148:151], 0
v_mfma_f32_16x16x32_bf16 v[72:75], a[168:171], v[152:155], 0
ds_read_b64_tr_b16 a[204:205], v11 offset:8192
v_mfma_f32_16x16x32_bf16 v[76:79], a[168:171], v[156:159], 0
ds_read_b64_tr_b16 a[206:207], v11 offset:12288
v_mfma_f32_16x16x32_bf16 v[92:95], a[172:175], v[156:159], 0
v_mfma_f32_16x16x32_bf16 v[88:91], a[172:175], v[152:155], 0
ds_read_b64_tr_b16 a[208:209], v8 offset:9216
v_mfma_f32_16x16x32_bf16 v[84:87], a[172:175], v[148:151], 0
v_mfma_f32_16x16x32_bf16 v[80:83], a[172:175], v[144:147], 0
ds_read_b64_tr_b16 a[210:211], v8 offset:13312
v_mfma_f32_16x16x32_bf16 v[96:99], a[176:179], v[144:147], 0
ds_read_b64_tr_b16 a[212:213], v9 offset:9216
v_mfma_f32_16x16x32_bf16 v[100:103], a[176:179], v[148:151], 0
v_mfma_f32_16x16x32_bf16 v[104:107], a[176:179], v[152:155], 0
ds_read_b64_tr_b16 a[214:215], v9 offset:13312
v_mfma_f32_16x16x32_bf16 v[108:111], a[176:179], v[156:159], 0
v_mfma_f32_16x16x32_bf16 v[124:127], a[180:183], v[156:159], 0
ds_read_b64_tr_b16 a[216:217], v10 offset:9216
v_mfma_f32_16x16x32_bf16 v[120:123], a[180:183], v[152:155], 0
ds_read_b64_tr_b16 a[218:219], v10 offset:13312
v_mfma_f32_16x16x32_bf16 v[116:119], a[180:183], v[148:151], 0
v_mfma_f32_16x16x32_bf16 v[112:115], a[180:183], v[144:147], 0
ds_read_b64_tr_b16 a[220:221], v11 offset:9216
v_mfma_f32_16x16x32_bf16 v[128:131], a[184:187], v[144:147], 0
v_mfma_f32_16x16x32_bf16 v[132:135], a[184:187], v[148:151], 0
ds_read_b64_tr_b16 a[222:223], v11 offset:13312
v_mfma_f32_16x16x32_bf16 v[136:139], a[184:187], v[152:155], 0
v_mfma_f32_16x16x32_bf16 v[140:143], a[184:187], v[156:159], 0
v_mfma_f32_16x16x32_bf16 v[172:175], a[188:191], v[156:159], 0
v_mfma_f32_16x16x32_bf16 v[168:171], a[188:191], v[152:155], 0
v_mfma_f32_16x16x32_bf16 v[164:167], a[188:191], v[148:151], 0
v_mfma_f32_16x16x32_bf16 v[160:163], a[188:191], v[144:147], 0
s_waitcnt lgkmcnt(0)
s_waitcnt vmcnt(5)
v_cmp_ne_u32 vcc, s63, v17
s_and_b32 s61, vcc_lo, s54
s_cbranch_scc1 L_f50
L_f50x:
v_mfma_f32_16x16x32_bf16 v[32:35], a[192:195], v[176:179], v[32:35]
ds_read_b64_tr_b16 a[160:161], v8 offset:16384
v_mfma_f32_16x16x32_bf16 v[36:39], a[192:195], v[180:183], v[36:39]
buffer_load_dwordx4 a[0:3], v1, s[8:11], s49 offen offset:0 sc1
v_mfma_f32_16x16x32_bf16 v[40:43], a[192:195], v[184:187], v[40:43]
ds_read_b64_tr_b16 a[162:163], v8 offset:20480
v_mfma_f32_16x16x32_bf16 v[44:47], a[192:195], v[188:191], v[44:47]
ds_read_b64_tr_b16 a[164:165], v9 offset:16384
v_mfma_f32_16x16x32_bf16 v[60:63], a[196:199], v[188:191], v[60:63]
buffer_load_dwordx4 a[4:7], v20, s[8:11], s49 offen offset:0 sc1
v_mfma_f32_16x16x32_bf16 v[56:59], a[196:199], v[184:187], v[56:59]
ds_read_b64_tr_b16 a[166:167], v9 offset:20480
v_mfma_f32_16x16x32_bf16 v[52:55], a[196:199], v[180:183], v[52:55]
ds_read_b64_tr_b16 a[168:169], v10 offset:16384
v_mfma_f32_16x16x32_bf16 v[48:51], a[196:199], v[176:179], v[48:51]
buffer_load_dwordx4 a[8:11], v21, s[8:11], s49 offen offset:0 sc1
v_mfma_f32_16x16x32_bf16 v[64:67], a[200:203], v[176:179], v[64:67]
v_mfma_f32_16x16x32_bf16 v[68:71], a[200:203], v[180:183], v[68:71]
ds_read_b64_tr_b16 a[170:171], v10 offset:20480
v_mfma_f32_16x16x32_bf16 v[72:75], a[200:203], v[184:187], v[72:75]
ds_read_b64_tr_b16 a[172:173], v11 offset:16384
v_mfma_f32_16x16x32_bf16 v[76:79], a[200:203], v[188:191], v[76:79]
buffer_load_dwordx4 a[12:15], v22, s[8:11], s49 offen offset:0 sc1
v_mfma_f32_16x16x32_bf16 v[92:95], a[204:207], v[188:191], v[92:95]
ds_read_b64_tr_b16 a[174:175], v11 offset:20480
v_mfma_f32_16x16x32_bf16 v[88:91], a[204:207], v[184:187], v[88:91]
ds_read_b64_tr_b16 a[176:177], v8 offset:17408
v_mfma_f32_16x16x32_bf16 v[84:87], a[204:207], v[180:183], v[84:87]
buffer_load_dwordx4 a[16:19], v1, s[8:11], s50 offen offset:0 sc1
v_mfma_f32_16x16x32_bf16 v[80:83], a[204:207], v[176:179], v[80:83]
ds_read_b64_tr_b16 a[178:179], v8 offset:21504
v_mfma_f32_16x16x32_bf16 v[96:99], a[208:211], v[176:179], v[96:99]
ds_read_b64_tr_b16 a[180:181], v9 offset:17408
v_mfma_f32_16x16x32_bf16 v[100:103], a[208:211], v[180:183], v[100:103]
v_mfma_f32_16x16x32_bf16 v[104:107], a[208:211], v[184:187], v[104:107]
buffer_load_dwordx4 a[20:23], v20, s[8:11], s50 offen offset:0 sc1
v_mfma_f32_16x16x32_bf16 v[108:111], a[208:211], v[188:191], v[108:111]
ds_read_b64_tr_b16 a[182:183], v9 offset:21504
v_mfma_f32_16x16x32_bf16 v[124:127], a[212:215], v[188:191], v[124:127]
ds_read_b64_tr_b16 a[184:185], v10 offset:17408
v_mfma_f32_16x16x32_bf16 v[120:123], a[212:215], v[184:187], v[120:123]
buffer_load_dwordx4 a[24:27], v21, s[8:11], s50 offen offset:0 sc1
v_mfma_f32_16x16x32_bf16 v[116:119], a[212:215], v[180:183], v[116:119]
ds_read_b64_tr_b16 a[186:187], v10 offset:21504
v_mfma_f32_16x16x32_bf16 v[112:115], a[212:215], v[176:179], v[112:115]
ds_read_b64_tr_b16 a[188:189], v11 offset:17408
v_mfma_f32_16x16x32_bf16 v[128:131], a[216:219], v[176:179], v[128:131]
buffer_load_dwordx4 a[28:31], v22, s[8:11], s50 offen offset:0 sc1
v_mfma_f32_16x16x32_bf16 v[132:135], a[216:219], v[180:183], v[132:135]
ds_read_b64_tr_b16 a[190:191], v11 offset:21504
v_mfma_f32_16x16x32_bf16 v[136:139], a[216:219], v[184:187], v[136:139]
v_mfma_f32_16x16x32_bf16 v[140:143], a[216:219], v[188:191], v[140:143]
v_mfma_f32_16x16x32_bf16 v[172:175], a[220:223], v[188:191], v[172:175]
v_mfma_f32_16x16x32_bf16 v[168:171], a[220:223], v[184:187], v[168:171]
v_mfma_f32_16x16x32_bf16 v[164:167], a[220:223], v[180:183], v[164:167]
v_mfma_f32_16x16x32_bf16 v[160:163], a[220:223], v[176:179], v[160:163]
s_waitcnt lgkmcnt(0)
v_mfma_f32_16x16x32_bf16 v[32:35], a[160:163], v[208:211], v[32:35]
ds_read_b64_tr_b16 a[192:193], v8 offset:24576
v_mfma_f32_16x16x32_bf16 v[36:39], a[160:163], v[212:215], v[36:39]
buffer_load_dwordx4 a[32:35], v1, s[8:11], s51 offen offset:0 sc1
v_mfma_f32_16x16x32_bf16 v[40:43], a[160:163], v[216:219], v[40:43]
ds_read_b64_tr_b16 a[194:195], v8 offset:28672
v_mfma_f32_16x16x32_bf16 v[44:47], a[160:163], v[220:223], v[44:47]
buffer_load_dwordx4 a[36:39], v20, s[8:11], s51 offen offset:0 sc1
v_subrev_u32 v4, 0x10000, v8
v_mfma_f32_16x16x32_bf16 v[60:63], a[164:167], v[220:223], v[60:63]
ds_read_b64_tr_b16 a[196:197], v9 offset:24576
v_mfma_f32_16x16x32_bf16 v[56:59], a[164:167], v[216:219], v[56:59]
ds_read_b64_tr_b16 a[198:199], v9 offset:28672
v_mfma_f32_16x16x32_bf16 v[52:55], a[164:167], v[212:215], v[52:55]
buffer_load_dwordx4 a[40:43], v21, s[8:11], s51 offen offset:0 sc1
v_subrev_u32 v5, 0x10000, v9
v_mfma_f32_16x16x32_bf16 v[48:51], a[164:167], v[208:211], v[48:51]
ds_read_b64_tr_b16 a[200:201], v10 offset:24576
v_mfma_f32_16x16x32_bf16 v[64:67], a[168:171], v[208:211], v[64:67]
ds_read_b64_tr_b16 a[202:203], v10 offset:28672
v_mfma_f32_16x16x32_bf16 v[68:71], a[168:171], v[212:215], v[68:71]
buffer_load_dwordx4 a[44:47], v22, s[8:11], s51 offen offset:0 sc1
v_subrev_u32 v6, 0x10000, v10
v_mfma_f32_16x16x32_bf16 v[72:75], a[168:171], v[216:219], v[72:75]
ds_read_b64_tr_b16 a[204:205], v11 offset:24576
v_mfma_f32_16x16x32_bf16 v[76:79], a[168:171], v[220:223], v[76:79]
buffer_load_dwordx4 a[48:51], v1, s[8:11], s52 offen offset:0 sc1
v_mfma_f32_16x16x32_bf16 v[92:95], a[172:175], v[220:223], v[92:95]
ds_read_b64_tr_b16 a[206:207], v11 offset:28672
v_subrev_u32 v7, 0x10000, v11
v_mfma_f32_16x16x32_bf16 v[88:91], a[172:175], v[216:219], v[88:91]
ds_read_b64_tr_b16 a[208:209], v8 offset:25600
v_mfma_f32_16x16x32_bf16 v[84:87], a[172:175], v[212:215], v[84:87]
buffer_load_dwordx4 a[52:55], v20, s[8:11], s52 offen offset:0 sc1
v_mfma_f32_16x16x32_bf16 v[80:83], a[172:175], v[208:211], v[80:83]
ds_read_b64_tr_b16 a[210:211], v8 offset:29696
v_add_u32 v12, 0x10000, v8
v_mfma_f32_16x16x32_bf16 v[96:99], a[176:179], v[208:211], v[96:99]
buffer_load_dwordx4 a[56:59], v21, s[8:11], s52 offen offset:0 sc1
v_mfma_f32_16x16x32_bf16 v[100:103], a[176:179], v[212:215], v[100:103]
ds_read_b64_tr_b16 a[212:213], v9 offset:25600
v_mfma_f32_16x16x32_bf16 v[104:107], a[176:179], v[216:219], v[104:107]
ds_read_b64_tr_b16 a[214:215], v9 offset:29696
v_mfma_f32_16x16x32_bf16 v[108:111], a[176:179], v[220:223], v[108:111]
buffer_load_dwordx4 a[60:63], v22, s[8:11], s52 offen offset:0 sc1
v_add_u32 v13, 0x10000, v9
v_mfma_f32_16x16x32_bf16 v[124:127], a[180:183], v[220:223], v[124:127]
ds_read_b64_tr_b16 a[216:217], v10 offset:25600
v_mfma_f32_16x16x32_bf16 v[120:123], a[180:183], v[216:219], v[120:123]
ds_read_b64_tr_b16 a[218:219], v10 offset:29696
v_mfma_f32_16x16x32_bf16 v[116:119], a[180:183], v[212:215], v[116:119]
s_add_u32 m0, s70, 57344
s_add_u32 s68, s51, 2048
s_lshl_b32 s68, s68, 6
buffer_load_dwordx4 v2, s[16:19], s68 offen lds
v_mfma_f32_16x16x32_bf16 v[112:115], a[180:183], v[208:211], v[112:115]
ds_read_b64_tr_b16 a[220:221], v11 offset:25600
v_add_u32 v14, 0x10000, v10
v_mfma_f32_16x16x32_bf16 v[128:131], a[184:187], v[208:211], v[128:131]
buffer_load_dwordx4 v2, s[20:23], s68 offen offset:1024 lds
v_mfma_f32_16x16x32_bf16 v[132:135], a[184:187], v[212:215], v[132:135]
ds_read_b64_tr_b16 a[222:223], v11 offset:29696
v_mfma_f32_16x16x32_bf16 v[136:139], a[184:187], v[216:219], v[136:139]
v_add_u32 v15, 0x10000, v11
v_mfma_f32_16x16x32_bf16 v[140:143], a[184:187], v[220:223], v[140:143]
v_mfma_f32_16x16x32_bf16 v[172:175], a[188:191], v[220:223], v[172:175]
v_mfma_f32_16x16x32_bf16 v[168:171], a[188:191], v[216:219], v[168:171]
v_mfma_f32_16x16x32_bf16 v[164:167], a[188:191], v[212:215], v[164:167]
v_mfma_f32_16x16x32_bf16 v[160:163], a[188:191], v[208:211], v[160:163]
s_waitcnt vmcnt(19)
s_cmp_lg_u32 s99, 0
s_cbranch_scc1 L_ps2
s_mov_b64 exec, 1
buffer_store_dword v18, off, s[12:15], s62 offset:64
L_ps2x:
s_mov_b64 exec, -1
s_waitcnt vmcnt(15) lgkmcnt(0)
v_mfma_f32_16x16x32_bf16 v[32:35], a[192:195], a[0:3], v[32:35]
ds_read_b64_tr_b16 a[160:161], v8 offset:32768
v_mfma_f32_16x16x32_bf16 v[36:39], a[192:195], a[4:7], v[36:39]
buffer_load_dwordx4 a[64:67], v1, s[8:11], s53 offen offset:0 sc1
v_mfma_f32_16x16x32_bf16 v[40:43], a[192:195], a[8:11], v[40:43]
ds_read_b64_tr_b16 a[162:163], v8 offset:36864
v_mfma_f32_16x16x32_bf16 v[44:47], a[192:195], a[12:15], v[44:47]
ds_read_b64_tr_b16 a[164:165], v9 offset:32768
v_mfma_f32_16x16x32_bf16 v[60:63], a[196:199], a[12:15], v[60:63]
buffer_load_dwordx4 a[68:71], v20, s[8:11], s53 offen offset:0 sc1
v_mfma_f32_16x16x32_bf16 v[56:59], a[196:199], a[8:11], v[56:59]
ds_read_b64_tr_b16 a[166:167], v9 offset:36864
v_mfma_f32_16x16x32_bf16 v[52:55], a[196:199], a[4:7], v[52:55]
buffer_load_dwordx4 a[72:75], v21, s[8:11], s53 offen offset:0 sc1
v_mfma_f32_16x16x32_bf16 v[48:51], a[196:199], a[0:3], v[48:51]
ds_read_b64_tr_b16 a[168:169], v10 offset:32768
v_mfma_f32_16x16x32_bf16 v[64:67], a[200:203], a[0:3], v[64:67]
ds_read_b64_tr_b16 a[170:171], v10 offset:36864
v_mfma_f32_16x16x32_bf16 v[68:71], a[200:203], a[4:7], v[68:71]
buffer_load_dwordx4 a[76:79], v22, s[8:11], s53 offen offset:0 sc1
v_mfma_f32_16x16x32_bf16 v[72:75], a[200:203], a[8:11], v[72:75]
ds_read_b64_tr_b16 a[172:173], v11 offset:32768
v_mfma_f32_16x16x32_bf16 v[76:79], a[200:203], a[12:15], v[76:79]
ds_read_b64_tr_b16 a[174:175], v11 offset:36864
v_mfma_f32_16x16x32_bf16 v[92:95], a[204:207], a[12:15], v[92:95]
buffer_load_dwordx4 a[80:83], v1, s[8:11], s66 offen offset:0 sc1
v_mfma_f32_16x16x32_bf16 v[88:91], a[204:207], a[8:11], v[88:91]
v_mfma_f32_16x16x32_bf16 v[84:87], a[204:207], a[4:7], v[84:87]
ds_read_b64_tr_b16 a[176:177], v8 offset:33792
v_mfma_f32_16x16x32_bf16 v[80:83], a[204:207], a[0:3], v[80:83]
ds_read_b64_tr_b16 a[178:179], v8 offset:37888
v_mfma_f32_16x16x32_bf16 v[96:99], a[208:211], a[0:3], v[96:99]
buffer_load_dwordx4 a[84:87], v20, s[8:11], s66 offen offset:0 sc1
v_mfma_f32_16x16x32_bf16 v[100:103], a[208:211], a[4:7], v[100:103]
ds_read_b64_tr_b16 a[180:181], v9 offset:33792
v_mfma_f32_16x16x32_bf16 v[104:107], a[208:211], a[8:11], v[104:107]
ds_read_b64_tr_b16 a[182:183], v9 offset:37888
v_mfma_f32_16x16x32_bf16 v[108:111], a[208:211], a[12:15], v[108:111]
buffer_load_dwordx4 a[88:91], v21, s[8:11], s66 offen offset:0 sc1
v_mfma_f32_16x16x32_bf16 v[124:127], a[212:215], a[12:15], v[124:127]
ds_read_b64_tr_b16 a[184:185], v10 offset:33792
v_mfma_f32_16x16x32_bf16 v[120:123], a[212:215], a[8:11], v[120:123]
buffer_load_dwordx4 a[92:95], v22, s[8:11], s66 offen offset:0 sc1
v_mfma_f32_16x16x32_bf16 v[116:119], a[212:215], a[4:7], v[116:119]
ds_read_b64_tr_b16 a[186:187], v10 offset:37888
v_mfma_f32_16x16x32_bf16 v[112:115], a[212:215], a[0:3], v[112:115]
ds_read_b64_tr_b16 a[188:189], v11 offset:33792
v_mfma_f32_16x16x32_bf16 v[128:131], a[216:219], a[0:3], v[128:131]
buffer_load_dword v17, v16, s[12:15], 0 offen sc1
v_mfma_f32_16x16x32_bf16 v[132:135], a[216:219], a[4:7], v[132:135]
ds_read_b64_tr_b16 a[190:191], v11 offset:37888
v_mfma_f32_16x16x32_bf16 v[136:139], a[216:219], a[8:11], v[136:139]
v_mfma_f32_16x16x32_bf16 v[140:143], a[216:219], a[12:15], v[140:143]
v_mfma_f32_16x16x32_bf16 v[172:175], a[220:223], a[12:15], v[172:175]
v_mfma_f32_16x16x32_bf16 v[168:171], a[220:223], a[8:11], v[168:171]
v_mfma_f32_16x16x32_bf16 v[164:167], a[220:223], a[4:7], v[164:167]
v_mfma_f32_16x16x32_bf16 v[160:163], a[220:223], a[0:3], v[160:163]
s_waitcnt vmcnt(20) lgkmcnt(0)
v_mfma_f32_16x16x32_bf16 v[32:35], a[160:163], a[16:19], v[32:35]
ds_read_b64_tr_b16 a[192:193], v8 offset:40960
v_mfma_f32_16x16x32_bf16 v[36:39], a[160:163], a[20:23], v[36:39]
ds_read_b64_tr_b16 a[194:195], v8 offset:45056
v_mfma_f32_16x16x32_bf16 v[40:43], a[160:163], a[24:27], v[40:43]
buffer_load_dwordx4 a[96:99], v1, s[8:11], s67 offen offset:0 sc1
v_mfma_f32_16x16x32_bf16 v[44:47], a[160:163], a[28:31], v[44:47]
v_mfma_f32_16x16x32_bf16 v[60:63], a[164:167], a[28:31], v[60:63]
ds_read_b64_tr_b16 a[196:197], v9 offset:40960
v_mfma_f32_16x16x32_bf16 v[56:59], a[164:167], a[24:27], v[56:59]
ds_read_b64_tr_b16 a[198:199], v9 offset:45056
v_mfma_f32_16x16x32_bf16 v[52:55], a[164:167], a[20:23], v[52:55]
ds_read_b64_tr_b16 a[200:201], v10 offset:40960
v_mfma_f32_16x16x32_bf16 v[48:51], a[164:167], a[16:19], v[48:51]
v_mfma_f32_16x16x32_bf16 v[64:67], a[168:171], a[16:19], v[64:67]
ds_read_b64_tr_b16 a[202:203], v10 offset:45056
v_mfma_f32_16x16x32_bf16 v[68:71], a[168:171], a[20:23], v[68:71]
buffer_load_dwordx4 a[100:103], v20, s[8:11], s67 offen offset:0 sc1
v_mfma_f32_16x16x32_bf16 v[72:75], a[168:171], a[24:27], v[72:75]
ds_read_b64_tr_b16 a[204:205], v11 offset:40960
v_mfma_f32_16x16x32_bf16 v[76:79], a[168:171], a[28:31], v[76:79]
v_mfma_f32_16x16x32_bf16 v[92:95], a[172:175], a[28:31], v[92:95]
ds_read_b64_tr_b16 a[206:207], v11 offset:45056
v_mfma_f32_16x16x32_bf16 v[88:91], a[172:175], a[24:27], v[88:91]
ds_read_b64_tr_b16 a[208:209], v8 offset:41984
v_mfma_f32_16x16x32_bf16 v[84:87], a[172:175], a[20:23], v[84:87]
ds_read_b64_tr_b16 a[210:211], v8 offset:46080
v_mfma_f32_16x16x32_bf16 v[80:83], a[172:175], a[16:19], v[80:83]
v_mfma_f32_16x16x32_bf16 v[96:99], a[176:179], a[16:19], v[96:99]
buffer_load_dwordx4 a[104:107], v21, s[8:11], s67 offen offset:0 sc1
v_mfma_f32_16x16x32_bf16 v[100:103], a[176:179], a[20:23], v[100:103]
ds_read_b64_tr_b16 a[212:213], v9 offset:41984
v_mfma_f32_16x16x32_bf16 v[104:107], a[176:179], a[24:27], v[104:107]
ds_read_b64_tr_b16 a[214:215], v9 offset:46080
v_mfma_f32_16x16x32_bf16 v[108:111], a[176:179], a[28:31], v[108:111]
v_mfma_f32_16x16x32_bf16 v[124:127], a[180:183], a[28:31], v[124:127]
ds_read_b64_tr_b16 a[216:217], v10 offset:41984
v_mfma_f32_16x16x32_bf16 v[120:123], a[180:183], a[24:27], v[120:123]
ds_read_b64_tr_b16 a[218:219], v10 offset:46080
v_mfma_f32_16x16x32_bf16 v[116:119], a[180:183], a[20:23], v[116:119]
buffer_load_dwordx4 a[108:111], v22, s[8:11], s67 offen offset:0 sc1
v_mfma_f32_16x16x32_bf16 v[112:115], a[180:183], a[16:19], v[112:115]
v_mfma_f32_16x16x32_bf16 v[128:131], a[184:187], a[16:19], v[128:131]
ds_read_b64_tr_b16 a[220:221], v11 offset:41984
v_mfma_f32_16x16x32_bf16 v[132:135], a[184:187], a[20:23], v[132:135]
ds_read_b64_tr_b16 a[222:223], v11 offset:46080
v_mfma_f32_16x16x32_bf16 v[136:139], a[184:187], a[24:27], v[136:139]
L_wp22:
s_cbranch_execz L_wp25
v_mfma_f32_16x16x32_bf16 v[140:143], a[184:187], a[28:31], v[140:143]
v_mfma_f32_16x16x32_bf16 v[172:175], a[188:191], a[28:31], v[172:175]
v_mfma_f32_16x16x32_bf16 v[168:171], a[188:191], a[24:27], v[168:171]
v_mfma_f32_16x16x32_bf16 v[164:167], a[188:191], a[20:23], v[164:167]
v_mfma_f32_16x16x32_bf16 v[160:163], a[188:191], a[16:19], v[160:163]
s_waitcnt vmcnt(20) lgkmcnt(0)
s_waitcnt vmcnt(4)
v_cmp_ne_u32 vcc, s63, v17
s_lshl_b32 s54, s54, 8
s_and_b32 s61, vcc_lo, s54
s_cbranch_scc1 L_f51
L_f51x:
v_mfma_f32_16x16x32_bf16 v[32:35], a[192:195], a[32:35], v[32:35]
ds_read_b64_tr_b16 a[160:161], v8 offset:49152
v_mfma_f32_16x16x32_bf16 v[36:39], a[192:195], a[36:39], v[36:39]
buffer_load_dwordx4 a[112:115], v1, s[8:11], s49 offen offset:1024 sc1
v_mfma_f32_16x16x32_bf16 v[40:43], a[192:195], a[40:43], v[40:43]
ds_read_b64_tr_b16 a[162:163], v8 offset:53248
v_mfma_f32_16x16x32_bf16 v[44:47], a[192:195], a[44:47], v[44:47]
ds_read_b64_tr_b16 a[164:165], v9 offset:49152
v_mfma_f32_16x16x32_bf16 v[60:63], a[196:199], a[44:47], v[60:63]
buffer_load_dwordx4 a[116:119], v20, s[8:11], s49 offen offset:1024 sc1
v_mfma_f32_16x16x32_bf16 v[56:59], a[196:199], a[40:43], v[56:59]
ds_read_b64_tr_b16 a[166:167], v9 offset:53248
v_and_b32 v19, 15, v0
v_mfma_f32_16x16x32_bf16 v[52:55], a[196:199], a[36:39], v[52:55]
v_mfma_f32_16x16x32_bf16 v[48:51], a[196:199], a[32:35], v[48:51]
ds_read_b64_tr_b16 a[168:169], v10 offset:49152
v_mfma_f32_16x16x32_bf16 v[64:67], a[200:203], a[32:35], v[64:67]
ds_read_b64_tr_b16 a[170:171], v10 offset:53248
v_mfma_f32_16x16x32_bf16 v[68:71], a[200:203], a[36:39], v[68:71]
buffer_load_dwordx4 a[120:123], v21, s[8:11], s49 offen offset:1024 sc1
v_lshlrev_b32 v19, 11, v19
v_mfma_f32_16x16x32_bf16 v[72:75], a[200:203], a[40:43], v[72:75]
ds_read_b64_tr_b16 a[172:173], v11 offset:49152
v_mfma_f32_16x16x32_bf16 v[76:79], a[200:203], a[44:47], v[76:79]
ds_read_b64_tr_b16 a[174:175], v11 offset:53248
v_mfma_f32_16x16x32_bf16 v[92:95], a[204:207], a[44:47], v[92:95]
buffer_load_dwordx4 a[124:127], v22, s[8:11], s49 offen offset:1024 sc1
v_mfma_f32_16x16x32_bf16 v[88:91], a[204:207], a[40:43], v[88:91]
v_and_b32 v3, 16, v0
v_mfma_f32_16x16x32_bf16 v[84:87], a[204:207], a[36:39], v[84:87]
ds_read_b64_tr_b16 a[176:177], v8 offset:50176
v_mfma_f32_16x16x32_bf16 v[80:83], a[204:207], a[32:35], v[80:83]
ds_read_b64_tr_b16 a[178:179], v8 offset:54272
v_mfma_f32_16x16x32_bf16 v[96:99], a[208:211], a[32:35], v[96:99]
buffer_load_dwordx4 a[128:131], v1, s[8:11], s50 offen offset:1024 sc1
v_mfma_f32_16x16x32_bf16 v[100:103], a[208:211], a[36:39], v[100:103]
ds_read_b64_tr_b16 a[180:181], v9 offset:50176
v_mfma_f32_16x16x32_bf16 v[104:107], a[208:211], a[40:43], v[104:107]
ds_read_b64_tr_b16 a[182:183], v9 offset:54272
v_lshl_add_u32 v19, v3, 1, v19
v_mfma_f32_16x16x32_bf16 v[108:111], a[208:211], a[44:47], v[108:111]
ds_read_b64_tr_b16 a[184:185], v10 offset:50176
v_mfma_f32_16x16x32_bf16 v[124:127], a[212:215], a[44:47], v[124:127]
v_mfma_f32_16x16x32_bf16 v[120:123], a[212:215], a[40:43], v[120:123]
buffer_load_dwordx4 a[132:135], v20, s[8:11], s50 offen offset:1024 sc1
v_mfma_f32_16x16x32_bf16 v[116:119], a[212:215], a[36:39], v[116:119]
ds_read_b64_tr_b16 a[186:187], v10 offset:54272
v_and_b32 v3, 32, v0
v_mfma_f32_16x16x32_bf16 v[112:115], a[212:215], a[32:35], v[112:115]
ds_read_b64_tr_b16 a[188:189], v11 offset:50176
v_mfma_f32_16x16x32_bf16 v[128:131], a[216:219], a[32:35], v[128:131]
buffer_load_dwordx4 a[136:139], v21, s[8:11], s50 offen offset:1024 sc1
v_mfma_f32_16x16x32_bf16 v[132:135], a[216:219], a[36:39], v[132:135]
ds_read_b64_tr_b16 a[190:191], v11 offset:54272
v_mfma_f32_16x16x32_bf16 v[136:139], a[216:219], a[40:43], v[136:139]
v_lshrrev_b32 v3, 1, v3
v_mfma_f32_16x16x32_bf16 v[140:143], a[216:219], a[44:47], v[140:143]
v_mfma_f32_16x16x32_bf16 v[172:175], a[220:223], a[44:47], v[172:175]
v_mfma_f32_16x16x32_bf16 v[168:171], a[220:223], a[40:43], v[168:171]
v_add_u32 v23, v19, v3
v_mfma_f32_16x16x32_bf16 v[164:167], a[220:223], a[36:39], v[164:167]
v_mfma_f32_16x16x32_bf16 v[160:163], a[220:223], a[32:35], v[160:163]
v_lshlrev_b32 v3, 4, v0
s_waitcnt vmcnt(23) lgkmcnt(0)
v_mfma_f32_16x16x32_bf16 v[32:35], a[160:163], a[48:51], v[32:35]
ds_read_b64_tr_b16 a[192:193], v8 offset:57344
v_mfma_f32_16x16x32_bf16 v[36:39], a[160:163], a[52:55], v[36:39]
buffer_load_dwordx4 a[140:143], v22, s[8:11], s50 offen offset:1024 sc1
v_mfma_f32_16x16x32_bf16 v[40:43], a[160:163], a[56:59], v[40:43]
ds_read_b64_tr_b16 a[194:195], v8 offset:61440
v_mfma_f32_16x16x32_bf16 v[44:47], a[160:163], a[60:63], v[44:47]
ds_read_b64_tr_b16 a[196:197], v9 offset:57344
v_mfma_f32_16x16x32_bf16 v[60:63], a[164:167], a[60:63], v[60:63]
buffer_load_dwordx4 a[144:147], v1, s[8:11], s51 offen offset:1024 sc1
v_mfma_f32_16x16x32_bf16 v[56:59], a[164:167], a[56:59], v[56:59]
ds_read_b64_tr_b16 a[198:199], v9 offset:61440
v_mfma_f32_16x16x32_bf16 v[52:55], a[164:167], a[52:55], v[52:55]
v_mfma_f32_16x16x32_bf16 v[48:51], a[164:167], a[48:51], v[48:51]
ds_read_b64_tr_b16 a[200:201], v10 offset:57344
v_mfma_f32_16x16x32_bf16 v[64:67], a[168:171], a[48:51], v[64:67]
ds_read_b64_tr_b16 a[202:203], v10 offset:61440
v_mfma_f32_16x16x32_bf16 v[68:71], a[168:171], a[52:55], v[68:71]
buffer_load_dwordx4 a[148:151], v20, s[8:11], s51 offen offset:1024 sc1
v_mfma_f32_16x16x32_bf16 v[72:75], a[168:171], a[56:59], v[72:75]
ds_read_b64_tr_b16 a[204:205], v11 offset:57344
v_mfma_f32_16x16x32_bf16 v[76:79], a[168:171], a[60:63], v[76:79]
ds_read_b64_tr_b16 a[206:207], v11 offset:61440
v_mfma_f32_16x16x32_bf16 v[92:95], a[172:175], a[60:63], v[92:95]
buffer_load_dwordx4 a[152:155], v21, s[8:11], s51 offen offset:1024 sc1
v_mfma_f32_16x16x32_bf16 v[88:91], a[172:175], a[56:59], v[88:91]
v_mfma_f32_16x16x32_bf16 v[84:87], a[172:175], a[52:55], v[84:87]
ds_read_b64_tr_b16 a[208:209], v8 offset:58368
v_mfma_f32_16x16x32_bf16 v[80:83], a[172:175], a[48:51], v[80:83]
ds_read_b64_tr_b16 a[210:211], v8 offset:62464
v_mfma_f32_16x16x32_bf16 v[96:99], a[176:179], a[48:51], v[96:99]
buffer_load_dwordx4 a[156:159], v22, s[8:11], s51 offen offset:1024 sc1
v_mfma_f32_16x16x32_bf16 v[100:103], a[176:179], a[52:55], v[100:103]
ds_read_b64_tr_b16 a[212:213], v9 offset:58368
v_mfma_f32_16x16x32_bf16 v[104:107], a[176:179], a[56:59], v[104:107]
ds_read_b64_tr_b16 a[214:215], v9 offset:62464
v_mfma_f32_16x16x32_bf16 v[108:111], a[176:179], a[60:63], v[108:111]
ds_read_b64_tr_b16 a[216:217], v10 offset:58368
v_mfma_f32_16x16x32_bf16 v[124:127], a[180:183], a[60:63], v[124:127]
v_mfma_f32_16x16x32_bf16 v[120:123], a[180:183], a[56:59], v[120:123]
buffer_load_dwordx4 v[192:195], v1, s[8:11], s52 offen offset:1024 sc1
v_mfma_f32_16x16x32_bf16 v[116:119], a[180:183], a[52:55], v[116:119]
ds_read_b64_tr_b16 a[218:219], v10 offset:62464
v_mfma_f32_16x16x32_bf16 v[112:115], a[180:183], a[48:51], v[112:115]
ds_read_b64_tr_b16 a[220:221], v11 offset:58368
v_mfma_f32_16x16x32_bf16 v[128:131], a[184:187], a[48:51], v[128:131]
buffer_load_dwordx4 v[196:199], v20, s[8:11], s52 offen offset:1024 sc1
v_mfma_f32_16x16x32_bf16 v[132:135], a[184:187], a[52:55], v[132:135]
ds_read_b64_tr_b16 a[222:223], v11 offset:62464
v_mfma_f32_16x16x32_bf16 v[136:139], a[184:187], a[56:59], v[136:139]
v_mfma_f32_16x16x32_bf16 v[140:143], a[184:187], a[60:63], v[140:143]
v_mfma_f32_16x16x32_bf16 v[172:175], a[188:191], a[60:63], v[172:175]
v_mfma_f32_16x16x32_bf16 v[168:171], a[188:191], a[56:59], v[168:171]
v_mfma_f32_16x16x32_bf16 v[164:167], a[188:191], a[52:55], v[164:167]
v_mfma_f32_16x16x32_bf16 v[160:163], a[188:191], a[48:51], v[160:163]
s_waitcnt vmcnt(23) lgkmcnt(0)
s_barrier
v_mfma_f32_16x16x32_bf16 v[32:35], a[192:195], a[64:67], v[32:35]
ds_read_b64_tr_b16 a[160:161], v12 offset:0
buffer_load_dwordx4 v[200:203], v21, s[8:11], s52 offen offset:1024 sc1
v_mfma_f32_16x16x32_bf16 v[36:39], a[192:195], a[68:71], v[36:39]
ds_read_b64_tr_b16 a[162:163], v12 offset:4096
v_mfma_f32_16x16x32_bf16 v[40:43], a[192:195], a[72:75], v[40:43]
buffer_load_dwordx4 v[204:207], v22, s[8:11], s52 offen offset:1024 sc1
v_mfma_f32_16x16x32_bf16 v[44:47], a[192:195], a[76:79], v[44:47]
ds_read_b64_tr_b16 a[164:165], v13 offset:0
v_mfma_f32_16x16x32_bf16 v[60:63], a[196:199], a[76:79], v[60:63]
buffer_load_dwordx4 v[224:227], v1, s[8:11], s53 offen offset:1024 sc1
v_mfma_f32_16x16x32_bf16 v[56:59], a[196:199], a[72:75], v[56:59]
ds_read_b64_tr_b16 a[166:167], v13 offset:4096
v_mfma_f32_16x16x32_bf16 v[52:55], a[196:199], a[68:71], v[52:55]
ds_read_b64_tr_b16 a[168:169], v14 offset:0
v_mfma_f32_16x16x32_bf16 v[48:51], a[196:199], a[64:67], v[48:51]
buffer_load_dwordx4 v[228:231], v20, s[8:11], s53 offen offset:1024 sc1
v_mfma_f32_16x16x32_bf16 v[64:67], a[200:203], a[64:67], v[64:67]
ds_read_b64_tr_b16 a[170:171], v14 offset:4096
v_mfma_f32_16x16x32_bf16 v[68:71], a[200:203], a[68:71], v[68:71]
buffer_load_dwordx4 v[232:235], v21, s[8:11], s53 offen offset:1024 sc1
v_mfma_f32_16x16x32_bf16 v[72:75], a[200:203], a[72:75], v[72:75]
ds_read_b64_tr_b16 a[172:173], v15 offset:0
v_mfma_f32_16x16x32_bf16 v[76:79], a[200:203], a[76:79], v[76:79]
buffer_load_dwordx4 v[236:239], v22, s[8:11], s53 offen offset:1024 sc1
v_mfma_f32_16x16x32_bf16 v[92:95], a[204:207], a[76:79], v[92:95]
ds_read_b64_tr_b16 a[174:175], v15 offset:4096
v_mfma_f32_16x16x32_bf16 v[88:91], a[204:207], a[72:75], v[88:91]
ds_read_b64_tr_b16 a[176:177], v12 offset:1024
v_mfma_f32_16x16x32_bf16 v[84:87], a[204:207], a[68:71], v[84:87]
buffer_load_dwordx4 v[240:243], v1, s[8:11], s66 offen offset:1024 sc1
v_mfma_f32_16x16x32_bf16 v[80:83], a[204:207], a[64:67], v[80:83]
ds_read_b64_tr_b16 a[178:179], v12 offset:5120
v_mfma_f32_16x16x32_bf16 v[96:99], a[208:211], a[64:67], v[96:99]
buffer_load_dword v17, v16, s[12:15], 0 offen sc1
v_mfma_f32_16x16x32_bf16 v[100:103], a[208:211], a[68:71], v[100:103]
ds_read_b64_tr_b16 a[180:181], v13 offset:1024
v_mfma_f32_16x16x32_bf16 v[104:107], a[208:211], a[72:75], v[104:107]
s_add_u32 m0, s70, 65536
s_add_u32 s68, s52, 2048
s_lshl_b32 s68, s68, 6
buffer_load_dwordx4 v2, s[16:19], s68 offen lds
v_mfma_f32_16x16x32_bf16 v[108:111], a[208:211], a[76:79], v[108:111]
ds_read_b64_tr_b16 a[182:183], v13 offset:5120
v_mfma_f32_16x16x32_bf16 v[124:127], a[212:215], a[76:79], v[124:127]
ds_read_b64_tr_b16 a[184:185], v14 offset:1024
v_mfma_f32_16x16x32_bf16 v[120:123], a[212:215], a[72:75], v[120:123]
buffer_load_dwordx4 v2, s[20:23], s68 offen offset:1024 lds
v_mfma_f32_16x16x32_bf16 v[116:119], a[212:215], a[68:71], v[116:119]
ds_read_b64_tr_b16 a[186:187], v14 offset:5120
v_mfma_f32_16x16x32_bf16 v[112:115], a[212:215], a[64:67], v[112:115]
s_add_u32 m0, s70, 73728
s_add_u32 s68, s53, 2048
s_lshl_b32 s68, s68, 6
buffer_load_dwordx4 v2, s[16:19], s68 offen lds
v_mfma_f32_16x16x32_bf16 v[128:131], a[216:219], a[64:67], v[128:131]
ds_read_b64_tr_b16 a[188:189], v15 offset:1024
v_mfma_f32_16x16x32_bf16 v[132:135], a[216:219], a[68:71], v[132:135]
buffer_load_dwordx4 v2, s[20:23], s68 offen offset:1024 lds
v_mfma_f32_16x16x32_bf16 v[136:139], a[216:219], a[72:75], v[136:139]
ds_read_b64_tr_b16 a[190:191], v15 offset:5120
v_mfma_f32_16x16x32_bf16 v[140:143], a[216:219], a[76:79], v[140:143]
v_mfma_f32_16x16x32_bf16 v[172:175], a[220:223], a[76:79], v[172:175]
v_mfma_f32_16x16x32_bf16 v[168:171], a[220:223], a[72:75], v[168:171]
v_mfma_f32_16x16x32_bf16 v[164:167], a[220:223], a[68:71], v[164:167]
v_mfma_f32_16x16x32_bf16 v[160:163], a[220:223], a[64:67], v[160:163]
s_waitcnt vmcnt(31) lgkmcnt(0)
v_mfma_f32_16x16x32_bf16 v[32:35], a[160:163], a[80:83], v[32:35]
ds_read_b64_tr_b16 a[192:193], v12 offset:8192
v_mfma_f32_16x16x32_bf16 v[36:39], a[160:163], a[84:87], v[36:39]
buffer_load_dwordx4 v[244:247], v20, s[8:11], s66 offen offset:1024 sc1
v_mfma_f32_16x16x32_bf16 v[40:43], a[160:163], a[88:91], v[40:43]
ds_read_b64_tr_b16 a[194:195], v12 offset:12288
v_mfma_f32_16x16x32_bf16 v[44:47], a[160:163], a[92:95], v[44:47]
ds_read_b64_tr_b16 a[196:197], v13 offset:8192
v_mfma_f32_16x16x32_bf16 v[60:63], a[164:167], a[92:95], v[60:63]
buffer_load_dwordx4 v[248:251], v21, s[8:11], s66 offen offset:1024 sc1
v_mfma_f32_16x16x32_bf16 v[56:59], a[164:167], a[88:91], v[56:59]
ds_read_b64_tr_b16 a[198:199], v13 offset:12288
v_mfma_f32_16x16x32_bf16 v[52:55], a[164:167], a[84:87], v[52:55]
buffer_load_dwordx4 v[252:255], v22, s[8:11], s66 offen offset:1024 sc1
v_mfma_f32_16x16x32_bf16 v[48:51], a[164:167], a[80:83], v[48:51]
ds_read_b64_tr_b16 a[200:201], v14 offset:8192
v_mfma_f32_16x16x32_bf16 v[64:67], a[168:171], a[80:83], v[64:67]
ds_read_b64_tr_b16 a[202:203], v14 offset:12288
v_mfma_f32_16x16x32_bf16 v[68:71], a[168:171], a[84:87], v[68:71]
buffer_load_dwordx4 v[144:147], v1, s[8:11], s67 offen offset:1024 sc1
v_mfma_f32_16x16x32_bf16 v[72:75], a[168:171], a[88:91], v[72:75]
ds_read_b64_tr_b16 a[204:205], v15 offset:8192
v_mfma_f32_16x16x32_bf16 v[76:79], a[168:171], a[92:95], v[76:79]
ds_read_b64_tr_b16 a[206:207], v15 offset:12288
v_mfma_f32_16x16x32_bf16 v[92:95], a[172:175], a[92:95], v[92:95]
buffer_load_dwordx4 v[148:151], v20, s[8:11], s67 offen offset:1024 sc1
v_mfma_f32_16x16x32_bf16 v[88:91], a[172:175], a[88:91], v[88:91]
v_mfma_f32_16x16x32_bf16 v[84:87], a[172:175], a[84:87], v[84:87]
ds_read_b64_tr_b16 a[208:209], v12 offset:9216
v_mfma_f32_16x16x32_bf16 v[80:83], a[172:175], a[80:83], v[80:83]
ds_read_b64_tr_b16 a[210:211], v12 offset:13312
v_mfma_f32_16x16x32_bf16 v[96:99], a[176:179], a[80:83], v[96:99]
buffer_load_dwordx4 v[152:155], v21, s[8:11], s67 offen offset:1024 sc1
v_mfma_f32_16x16x32_bf16 v[100:103], a[176:179], a[84:87], v[100:103]
ds_read_b64_tr_b16 a[212:213], v13 offset:9216
v_mfma_f32_16x16x32_bf16 v[104:107], a[176:179], a[88:91], v[104:107]
ds_read_b64_tr_b16 a[214:215], v13 offset:13312
v_mfma_f32_16x16x32_bf16 v[108:111], a[176:179], a[92:95], v[108:111]
buffer_load_dwordx4 v[156:159], v22, s[8:11], s67 offen offset:1024 sc1
v_mfma_f32_16x16x32_bf16 v[124:127], a[180:183], a[92:95], v[124:127]
ds_read_b64_tr_b16 a[216:217], v14 offset:9216
v_mfma_f32_16x16x32_bf16 v[120:123], a[180:183], a[88:91], v[120:123]
s_add_u32 m0, s70, 81920
s_add_u32 s68, s66, 2048
s_lshl_b32 s68, s68, 6
buffer_load_dwordx4 v2, s[16:19], s68 offen lds
v_mfma_f32_16x16x32_bf16 v[116:119], a[180:183], a[84:87], v[116:119]
ds_read_b64_tr_b16 a[218:219], v14 offset:13312
v_mfma_f32_16x16x32_bf16 v[112:115], a[180:183], a[80:83], v[112:115]
ds_read_b64_tr_b16 a[220:221], v15 offset:9216
v_mfma_f32_16x16x32_bf16 v[128:131], a[184:187], a[80:83], v[128:131]
buffer_load_dwordx4 v2, s[20:23], s68 offen offset:1024 lds
v_mfma_f32_16x16x32_bf16 v[132:135], a[184:187], a[84:87], v[132:135]
ds_read_b64_tr_b16 a[222:223], v15 offset:13312
v_mfma_f32_16x16x32_bf16 v[136:139], a[184:187], a[88:91], v[136:139]
v_mfma_f32_16x16x32_bf16 v[140:143], a[184:187], a[92:95], v[140:143]
v_mfma_f32_16x16x32_bf16 v[172:175], a[188:191], a[92:95], v[172:175]
v_mfma_f32_16x16x32_bf16 v[168:171], a[188:191], a[88:91], v[168:171]
v_mfma_f32_16x16x32_bf16 v[164:167], a[188:191], a[84:87], v[164:167]
v_mfma_f32_16x16x32_bf16 v[160:163], a[188:191], a[80:83], v[160:163]
s_waitcnt vmcnt(35) lgkmcnt(0)
s_waitcnt vmcnt(13)
v_cmp_ne_u32 vcc, s63, v17
s_and_b32 s61, vcc_lo, 0xff0000
s_cbranch_scc1 L_f52
L_f52x:
v_mfma_f32_16x16x32_bf16 v[32:35], a[192:195], a[96:99], v[32:35]
ds_read_b64_tr_b16 a[160:161], v12 offset:16384
v_mfma_f32_16x16x32_bf16 v[36:39], a[192:195], a[100:103], v[36:39]
buffer_load_dwordx4 v[176:179], v1, s[8:11], s49 offen offset:2048 sc1
v_mfma_f32_16x16x32_bf16 v[40:43], a[192:195], a[104:107], v[40:43]
ds_read_b64_tr_b16 a[162:163], v12 offset:20480
v_mfma_f32_16x16x32_bf16 v[44:47], a[192:195], a[108:111], v[44:47]
ds_read_b64_tr_b16 a[164:165], v13 offset:16384
v_mfma_f32_16x16x32_bf16 v[60:63], a[196:199], a[108:111], v[60:63]
buffer_load_dwordx4 v[180:183], v20, s[8:11], s49 offen offset:2048 sc1
v_mfma_f32_16x16x32_bf16 v[56:59], a[196:199], a[104:107], v[56:59]
ds_read_b64_tr_b16 a[166:167], v13 offset:20480
v_mfma_f32_16x16x32_bf16 v[52:55], a[196:199], a[100:103], v[52:55]
buffer_load_dwordx4 v[184:187], v21, s[8:11], s49 offen offset:2048 sc1
v_mfma_f32_16x16x32_bf16 v[48:51], a[196:199], a[96:99], v[48:51]
ds_read_b64_tr_b16 a[168:169], v14 offset:16384
v_mfma_f32_16x16x32_bf16 v[64:67], a[200:203], a[96:99], v[64:67]
ds_read_b64_tr_b16 a[170:171], v14 offset:20480
v_mfma_f32_16x16x32_bf16 v[68:71], a[200:203], a[100:103], v[68:71]
buffer_load_dwordx4 v[188:191], v22, s[8:11], s49 offen offset:2048 sc1
v_mfma_f32_16x16x32_bf16 v[72:75], a[200:203], a[104:107], v[72:75]
ds_read_b64_tr_b16 a[172:173], v15 offset:16384
v_mfma_f32_16x16x32_bf16 v[76:79], a[200:203], a[108:111], v[76:79]
ds_read_b64_tr_b16 a[174:175], v15 offset:20480
v_mfma_f32_16x16x32_bf16 v[92:95], a[204:207], a[108:111], v[92:95]
buffer_load_dwordx4 v[208:211], v1, s[8:11], s50 offen offset:2048 sc1
v_mfma_f32_16x16x32_bf16 v[88:91], a[204:207], a[104:107], v[88:91]
v_mfma_f32_16x16x32_bf16 v[84:87], a[204:207], a[100:103], v[84:87]
ds_read_b64_tr_b16 a[176:177], v12 offset:17408
v_mfma_f32_16x16x32_bf16 v[80:83], a[204:207], a[96:99], v[80:83]
ds_read_b64_tr_b16 a[178:179], v12 offset:21504
v_mfma_f32_16x16x32_bf16 v[96:99], a[208:211], a[96:99], v[96:99]
buffer_load_dwordx4 v[212:215], v20, s[8:11], s50 offen offset:2048 sc1
v_mfma_f32_16x16x32_bf16 v[100:103], a[208:211], a[100:103], v[100:103]
ds_read_b64_tr_b16 a[180:181], v13 offset:17408
v_mfma_f32_16x16x32_bf16 v[104:107], a[208:211], a[104:107], v[104:107]
ds_read_b64_tr_b16 a[182:183], v13 offset:21504
v_mfma_f32_16x16x32_bf16 v[108:111], a[208:211], a[108:111], v[108:111]
buffer_load_dwordx4 v[216:219], v21, s[8:11], s50 offen offset:2048 sc1
v_mfma_f32_16x16x32_bf16 v[124:127], a[212:215], a[108:111], v[124:127]
ds_read_b64_tr_b16 a[184:185], v14 offset:17408
v_mfma_f32_16x16x32_bf16 v[120:123], a[212:215], a[104:107], v[120:123]
s_add_u32 m0, s70, 90112
s_add_u32 s68, s67, 2048
s_lshl_b32 s68, s68, 6
buffer_load_dwordx4 v2, s[16:19], s68 offen lds
v_mfma_f32_16x16x32_bf16 v[116:119], a[212:215], a[100:103], v[116:119]
ds_read_b64_tr_b16 a[186:187], v14 offset:21504
v_mfma_f32_16x16x32_bf16 v[112:115], a[212:215], a[96:99], v[112:115]
ds_read_b64_tr_b16 a[188:189], v15 offset:17408
v_mfma_f32_16x16x32_bf16 v[128:131], a[216:219], a[96:99], v[128:131]
buffer_load_dwordx4 v2, s[20:23], s68 offen offset:1024 lds
v_mfma_f32_16x16x32_bf16 v[132:135], a[216:219], a[100:103], v[132:135]
ds_read_b64_tr_b16 a[190:191], v15 offset:21504
v_mfma_f32_16x16x32_bf16 v[136:139], a[216:219], a[104:107], v[136:139]
v_mfma_f32_16x16x32_bf16 v[140:143], a[216:219], a[108:111], v[140:143]
v_mfma_f32_16x16x32_bf16 v[172:175], a[220:223], a[108:111], v[172:175]
v_mfma_f32_16x16x32_bf16 v[168:171], a[220:223], a[104:107], v[168:171]
v_mfma_f32_16x16x32_bf16 v[164:167], a[220:223], a[100:103], v[164:167]
v_mfma_f32_16x16x32_bf16 v[160:163], a[220:223], a[96:99], v[160:163]
s_waitcnt vmcnt(40) lgkmcnt(0)
v_mfma_f32_16x16x32_bf16 v[32:35], a[160:163], a[112:115], v[32:35]
ds_read_b64_tr_b16 a[192:193], v12 offset:24576
v_mfma_f32_16x16x32_bf16 v[36:39], a[160:163], a[116:119], v[36:39]
buffer_load_dwordx4 v[220:223], v22, s[8:11], s50 offen offset:2048 sc1
v_mfma_f32_16x16x32_bf16 v[40:43], a[160:163], a[120:123], v[40:43]
ds_read_b64_tr_b16 a[194:195], v12 offset:28672
v_mfma_f32_16x16x32_bf16 v[44:47], a[160:163], a[124:127], v[44:47]
buffer_load_dwordx4 a[0:3], v1, s[8:11], s51 offen offset:2048 sc1
v_mfma_f32_16x16x32_bf16 v[60:63], a[164:167], a[124:127], v[60:63]
ds_read_b64_tr_b16 a[196:197], v13 offset:24576
v_mfma_f32_16x16x32_bf16 v[56:59], a[164:167], a[120:123], v[56:59]
ds_read_b64_tr_b16 a[198:199], v13 offset:28672
v_mfma_f32_16x16x32_bf16 v[52:55], a[164:167], a[116:119], v[52:55]
buffer_load_dwordx4 a[4:7], v20, s[8:11], s51 offen offset:2048 sc1
v_mfma_f32_16x16x32_bf16 v[48:51], a[164:167], a[112:115], v[48:51]
ds_read_b64_tr_b16 a[200:201], v14 offset:24576
v_mfma_f32_16x16x32_bf16 v[64:67], a[168:171], a[112:115], v[64:67]
buffer_load_dwordx4 a[8:11], v21, s[8:11], s51 offen offset:2048 sc1
v_mfma_f32_16x16x32_bf16 v[68:71], a[168:171], a[116:119], v[68:71]
ds_read_b64_tr_b16 a[202:203], v14 offset:28672
v_mfma_f32_16x16x32_bf16 v[72:75], a[168:171], a[120:123], v[72:75]
ds_read_b64_tr_b16 a[204:205], v15 offset:24576
v_mfma_f32_16x16x32_bf16 v[76:79], a[168:171], a[124:127], v[76:79]
buffer_load_dwordx4 a[12:15], v22, s[8:11], s51 offen offset:2048 sc1
v_mfma_f32_16x16x32_bf16 v[92:95], a[172:175], a[124:127], v[92:95]
ds_read_b64_tr_b16 a[206:207], v15 offset:28672
v_mfma_f32_16x16x32_bf16 v[88:91], a[172:175], a[120:123], v[88:91]
buffer_load_dwordx4 a[16:19], v1, s[8:11], s52 offen offset:2048 sc1
v_mfma_f32_16x16x32_bf16 v[84:87], a[172:175], a[116:119], v[84:87]
ds_read_b64_tr_b16 a[208:209], v12 offset:25600
v_mfma_f32_16x16x32_bf16 v[80:83], a[172:175], a[112:115], v[80:83]
buffer_load_dwordx4 a[20:23], v20, s[8:11], s52 offen offset:2048 sc1
v_mfma_f32_16x16x32_bf16 v[96:99], a[176:179], a[112:115], v[96:99]
ds_read_b64_tr_b16 a[210:211], v12 offset:29696
v_mfma_f32_16x16x32_bf16 v[100:103], a[176:179], a[116:119], v[100:103]
ds_read_b64_tr_b16 a[212:213], v13 offset:25600
v_mfma_f32_16x16x32_bf16 v[104:107], a[176:179], a[120:123], v[104:107]
s_add_u32 m0, s70, 98304
s_mov_b32 s68, 196608
buffer_load_dwordx4 v2, s[16:19], s68 offen lds
v_mfma_f32_16x16x32_bf16 v[108:111], a[176:179], a[124:127], v[108:111]
ds_read_b64_tr_b16 a[214:215], v13 offset:29696
v_mfma_f32_16x16x32_bf16 v[124:127], a[180:183], a[124:127], v[124:127]
buffer_load_dwordx4 v2, s[20:23], s68 offen offset:1024 lds
v_mfma_f32_16x16x32_bf16 v[120:123], a[180:183], a[120:123], v[120:123]
ds_read_b64_tr_b16 a[216:217], v14 offset:25600
v_mfma_f32_16x16x32_bf16 v[116:119], a[180:183], a[116:119], v[116:119]
ds_read_b64_tr_b16 a[218:219], v14 offset:29696
v_mfma_f32_16x16x32_bf16 v[112:115], a[180:183], a[112:115], v[112:115]
s_add_u32 m0, s70, 106496
s_mov_b32 s68, 655360
buffer_load_dwordx4 v2, s[16:19], s68 offen lds
v_mfma_f32_16x16x32_bf16 v[128:131], a[184:187], a[112:115], v[128:131]
ds_read_b64_tr_b16 a[220:221], v15 offset:25600
v_mfma_f32_16x16x32_bf16 v[132:135], a[184:187], a[116:119], v[132:135]
buffer_load_dwordx4 v2, s[20:23], s68 offen offset:1024 lds
v_mfma_f32_16x16x32_bf16 v[136:139], a[184:187], a[120:123], v[136:139]
ds_read_b64_tr_b16 a[222:223], v15 offset:29696
v_mfma_f32_16x16x32_bf16 v[140:143], a[184:187], a[124:127], v[140:143]
v_mfma_f32_16x16x32_bf16 v[172:175], a[188:191], a[124:127], v[172:175]
v_mfma_f32_16x16x32_bf16 v[168:171], a[188:191], a[120:123], v[168:171]
v_mfma_f32_16x16x32_bf16 v[164:167], a[188:191], a[116:119], v[164:167]
v_mfma_f32_16x16x32_bf16 v[160:163], a[188:191], a[112:115], v[160:163]
s_waitcnt vmcnt(47) lgkmcnt(0)
s_barrier
v_mfma_f32_16x16x32_bf16 v[32:35], a[192:195], a[128:131], v[32:35]
ds_read_b64_tr_b16 a[160:161], v6 offset:1024
v_mfma_f32_16x16x32_bf16 v[36:39], a[192:195], a[132:135], v[36:39]
buffer_load_dwordx4 a[24:27], v21, s[8:11], s52 offen offset:2048 sc1
v_mfma_f32_16x16x32_bf16 v[40:43], a[192:195], a[136:139], v[40:43]
ds_read_b64_tr_b16 a[162:163], v6 offset:5120
v_mfma_f32_16x16x32_bf16 v[44:47], a[192:195], a[140:143], v[44:47]
ds_read_b64_tr_b16 a[164:165], v7 offset:1024
v_mfma_f32_16x16x32_bf16 v[60:63], a[196:199], a[140:143], v[60:63]
buffer_load_dwordx4 a[28:31], v22, s[8:11], s52 offen offset:2048 sc1
v_mfma_f32_16x16x32_bf16 v[56:59], a[196:199], a[136:139], v[56:59]
ds_read_b64_tr_b16 a[166:167], v7 offset:5120
v_mfma_f32_16x16x32_bf16 v[52:55], a[196:199], a[132:135], v[52:55]
buffer_load_dwordx4 a[32:35], v1, s[8:11], s53 offen offset:2048 sc1
v_mfma_f32_16x16x32_bf16 v[48:51], a[196:199], a[128:131], v[48:51]
ds_read_b64_tr_b16 a[168:169], v6 offset:9216
v_mfma_f32_16x16x32_bf16 v[64:67], a[200:203], a[128:131], v[64:67]
ds_read_b64_tr_b16 a[170:171], v6 offset:13312
v_mfma_f32_16x16x32_bf16 v[68:71], a[200:203], a[132:135], v[68:71]
buffer_load_dwordx4 a[36:39], v20, s[8:11], s53 offen offset:2048 sc1
v_mfma_f32_16x16x32_bf16 v[72:75], a[200:203], a[136:139], v[72:75]
ds_read_b64_tr_b16 a[172:173], v7 offset:9216
v_mfma_f32_16x16x32_bf16 v[76:79], a[200:203], a[140:143], v[76:79]
ds_read_b64_tr_b16 a[174:175], v7 offset:13312
v_mfma_f32_16x16x32_bf16 v[92:95], a[204:207], a[140:143], v[92:95]
buffer_load_dwordx4 a[40:43], v21, s[8:11], s53 offen offset:2048 sc1
v_mfma_f32_16x16x32_bf16 v[88:91], a[204:207], a[136:139], v[88:91]
v_mfma_f32_16x16x32_bf16 v[84:87], a[204:207], a[132:135], v[84:87]
ds_read_b64_tr_b16 a[176:177], v6 offset:17408
v_mfma_f32_16x16x32_bf16 v[80:83], a[204:207], a[128:131], v[80:83]
ds_read_b64_tr_b16 a[178:179], v6 offset:21504
v_mfma_f32_16x16x32_bf16 v[96:99], a[208:211], a[128:131], v[96:99]
buffer_load_dwordx4 a[44:47], v22, s[8:11], s53 offen offset:2048 sc1
v_mfma_f32_16x16x32_bf16 v[100:103], a[208:211], a[132:135], v[100:103]
ds_read_b64_tr_b16 a[180:181], v7 offset:17408
v_mfma_f32_16x16x32_bf16 v[104:107], a[208:211], a[136:139], v[104:107]
ds_read_b64_tr_b16 a[182:183], v7 offset:21504
v_mfma_f32_16x16x32_bf16 v[108:111], a[208:211], a[140:143], v[108:111]
buffer_load_dwordx4 a[48:51], v1, s[8:11], s66 offen offset:2048 sc1
v_mfma_f32_16x16x32_bf16 v[124:127], a[212:215], a[140:143], v[124:127]
ds_read_b64_tr_b16 a[184:185], v6 offset:25600
v_mfma_f32_16x16x32_bf16 v[120:123], a[212:215], a[136:139], v[120:123]
s_add_u32 m0, s70, 114688
s_mov_b32 s68, 1114112
buffer_load_dwordx4 v2, s[16:19], s68 offen lds
v_mfma_f32_16x16x32_bf16 v[116:119], a[212:215], a[132:135], v[116:119]
ds_read_b64_tr_b16 a[186:187], v6 offset:29696
v_mfma_f32_16x16x32_bf16 v[112:115], a[212:215], a[128:131], v[112:115]
ds_read_b64_tr_b16 a[188:189], v7 offset:25600
v_mfma_f32_16x16x32_bf16 v[128:131], a[216:219], a[128:131], v[128:131]
buffer_load_dwordx4 v2, s[20:23], s68 offen offset:1024 lds
v_mfma_f32_16x16x32_bf16 v[132:135], a[216:219], a[132:135], v[132:135]
ds_read_b64_tr_b16 a[190:191], v7 offset:29696
v_mfma_f32_16x16x32_bf16 v[136:139], a[216:219], a[136:139], v[136:139]
v_mfma_f32_16x16x32_bf16 v[140:143], a[216:219], a[140:143], v[140:143]
v_mfma_f32_16x16x32_bf16 v[172:175], a[220:223], a[140:143], v[172:175]
v_mfma_f32_16x16x32_bf16 v[168:171], a[220:223], a[136:139], v[168:171]
v_mfma_f32_16x16x32_bf16 v[164:167], a[220:223], a[132:135], v[164:167]
v_mfma_f32_16x16x32_bf16 v[160:163], a[220:223], a[128:131], v[160:163]
s_waitcnt vmcnt(35) lgkmcnt(0)
v_mfma_f32_16x16x32_bf16 v[128:131], a[160:163], a[144:147], v[128:131]
ds_read_b64_tr_b16 a[192:193], v4 offset:1024
v_mfma_f32_16x16x32_bf16 v[128:131], a[168:171], v[192:195], v[128:131]
buffer_load_dwordx4 a[52:55], v20, s[8:11], s66 offen offset:2048 sc1
v_mfma_f32_16x16x32_bf16 v[128:131], a[176:179], v[224:227], v[128:131]
ds_read_b64_tr_b16 a[194:195], v4 offset:5120
v_mfma_f32_16x16x32_bf16 v[128:131], a[184:187], v[240:243], v[128:131]
ds_read_b64_tr_b16 a[196:197], v5 offset:1024
v_mfma_f32_16x16x32_bf16 v[132:135], a[184:187], v[244:247], v[132:135]
buffer_load_dwordx4 a[56:59], v21, s[8:11], s66 offen offset:2048 sc1
v_mfma_f32_16x16x32_bf16 v[132:135], a[176:179], v[228:231], v[132:135]
ds_read_b64_tr_b16 a[198:199], v5 offset:5120
v_mfma_f32_16x16x32_bf16 v[132:135], a[168:171], v[196:199], v[132:135]
buffer_load_dwordx4 a[60:63], v22, s[8:11], s66 offen offset:2048 sc1
v_mfma_f32_16x16x32_bf16 v[132:135], a[160:163], a[148:151], v[132:135]
ds_read_b64_tr_b16 a[200:201], v4 offset:9216
v_mfma_f32_16x16x32_bf16 v[136:139], a[160:163], a[152:155], v[136:139]
ds_read_b64_tr_b16 a[202:203], v4 offset:13312
v_mfma_f32_16x16x32_bf16 v[136:139], a[168:171], v[200:203], v[136:139]
buffer_load_dwordx4 a[64:67], v1, s[8:11], s67 offen offset:2048 sc1
v_mfma_f32_16x16x32_bf16 v[136:139], a[176:179], v[232:235], v[136:139]
ds_read_b64_tr_b16 a[204:205], v5 offset:9216
v_mfma_f32_16x16x32_bf16 v[136:139], a[184:187], v[248:251], v[136:139]
ds_read_b64_tr_b16 a[206:207], v5 offset:13312
v_mfma_f32_16x16x32_bf16 v[140:143], a[184:187], v[252:255], v[140:143]
buffer_load_dwordx4 a[68:71], v20, s[8:11], s67 offen offset:2048 sc1
v_mfma_f32_16x16x32_bf16 v[140:143], a[176:179], v[236:239], v[140:143]
v_mfma_f32_16x16x32_bf16 v[140:143], a[168:171], v[204:207], v[140:143]
ds_read_b64_tr_b16 a[208:209], v4 offset:17408
v_mfma_f32_16x16x32_bf16 v[140:143], a[160:163], a[156:159], v[140:143]
ds_read_b64_tr_b16 a[210:211], v4 offset:21504
v_mfma_f32_16x16x32_bf16 v[172:175], a[164:167], a[156:159], v[172:175]
buffer_load_dwordx4 a[72:75], v21, s[8:11], s67 offen offset:2048 sc1
v_mfma_f32_16x16x32_bf16 v[172:175], a[172:175], v[204:207], v[172:175]
ds_read_b64_tr_b16 a[212:213], v5 offset:17408
v_mfma_f32_16x16x32_bf16 v[172:175], a[180:183], v[236:239], v[172:175]
ds_read_b64_tr_b16 a[214:215], v5 offset:21504
v_mfma_f32_16x16x32_bf16 v[172:175], a[188:191], v[252:255], v[172:175]
buffer_load_dwordx4 a[76:79], v22, s[8:11], s67 offen offset:2048 sc1
v_mfma_f32_16x16x32_bf16 v[168:171], a[188:191], v[248:251], v[168:171]
ds_read_b64_tr_b16 a[216:217], v4 offset:25600
v_mfma_f32_16x16x32_bf16 v[168:171], a[180:183], v[232:235], v[168:171]
s_add_u32 m0, s70, 122880
s_mov_b32 s68, 1572864
buffer_load_dwordx4 v2, s[16:19], s68 offen lds
v_mfma_f32_16x16x32_bf16 v[168:171], a[172:175], v[200:203], v[168:171]
ds_read_b64_tr_b16 a[218:219], v4 offset:29696
v_mfma_f32_16x16x32_bf16 v[168:171], a[164:167], a[152:155], v[168:171]
ds_read_b64_tr_b16 a[220:221], v5 offset:25600
v_mfma_f32_16x16x32_bf16 v[164:167], a[164:167], a[148:151], v[164:167]
buffer_load_dwordx4 v2, s[20:23], s68 offen offset:1024 lds
v_mfma_f32_16x16x32_bf16 v[164:167], a[172:175], v[196:199], v[164:167]
ds_read_b64_tr_b16 a[222:223], v5 offset:29696
v_mfma_f32_16x16x32_bf16 v[164:167], a[180:183], v[228:231], v[164:167]
v_mfma_f32_16x16x32_bf16 v[164:167], a[188:191], v[244:247], v[164:167]
v_mfma_f32_16x16x32_bf16 v[160:163], a[188:191], v[240:243], v[160:163]
v_mfma_f32_16x16x32_bf16 v[160:163], a[180:183], v[224:227], v[160:163]
v_mfma_f32_16x16x32_bf16 v[160:163], a[172:175], v[192:195], v[160:163]
v_mfma_f32_16x16x32_bf16 v[160:163], a[164:167], a[144:147], v[160:163]
s_waitcnt vmcnt(44) lgkmcnt(0)
v_mfma_f32_16x16x32_bf16 v[96:99], a[192:195], a[144:147], v[96:99]
ds_read_b64_tr_b16 a[160:161], v6 offset:33792
v_mfma_f32_16x16x32_bf16 v[96:99], a[200:203], v[192:195], v[96:99]
s_mov_b32 s39, 3072
buffer_load_dwordx4 a[80:83], v1, s[8:11], s39 offen sc1
v_mfma_f32_16x16x32_bf16 v[96:99], a[208:211], v[224:227], v[96:99]
ds_read_b64_tr_b16 a[162:163], v6 offset:37888
v_accvgpr_read_b32 v24, a228
v_mfma_f32_16x16x32_bf16 v[96:99], a[216:219], v[240:243], v[96:99]
ds_read_b64_tr_b16 a[164:165], v7 offset:33792
v_mfma_f32_16x16x32_bf16 v[100:103], a[216:219], v[244:247], v[100:103]
s_mov_b32 s39, 3072
buffer_load_dwordx4 a[84:87], v20, s[8:11], s39 offen sc1
v_lshlrev_b32 v30, 16, v24
v_mfma_f32_16x16x32_bf16 v[100:103], a[208:211], v[228:231], v[100:103]
ds_read_b64_tr_b16 a[166:167], v7 offset:37888
v_mfma_f32_16x16x32_bf16 v[100:103], a[200:203], v[196:199], v[100:103]
L_wp23:
s_cbranch_execz L_wr4
v_and_b32 v31, 0xffff0000, v24
v_mfma_f32_16x16x32_bf16 v[100:103], a[192:195], a[148:151], v[100:103]
ds_read_b64_tr_b16 a[168:169], v6 offset:41984
v_add_f32 v32, v32, v30
v_mfma_f32_16x16x32_bf16 v[104:107], a[192:195], a[152:155], v[104:107]
ds_read_b64_tr_b16 a[170:171], v6 offset:46080
v_mfma_f32_16x16x32_bf16 v[104:107], a[200:203], v[200:203], v[104:107]
s_mov_b32 s39, 3072
buffer_load_dwordx4 a[88:91], v21, s[8:11], s39 offen sc1
v_add_f32 v33, v33, v31
v_mfma_f32_16x16x32_bf16 v[104:107], a[208:211], v[232:235], v[104:107]
ds_read_b64_tr_b16 a[172:173], v7 offset:41984
v_mfma_f32_16x16x32_bf16 v[104:107], a[216:219], v[248:251], v[104:107]
ds_read_b64_tr_b16 a[174:175], v7 offset:46080
v_accvgpr_read_b32 v29, a229
v_mfma_f32_16x16x32_bf16 v[108:111], a[216:219], v[252:255], v[108:111]
s_mov_b32 s39, 3072
buffer_load_dwordx4 a[92:95], v22, s[8:11], s39 offen sc1
v_mfma_f32_16x16x32_bf16 v[108:111], a[208:211], v[236:239], v[108:111]
v_lshlrev_b32 v30, 16, v29
v_mfma_f32_16x16x32_bf16 v[108:111], a[200:203], v[204:207], v[108:111]
ds_read_b64_tr_b16 a[176:177], v6 offset:50176
v_and_b32 v31, 0xffff0000, v29
v_mfma_f32_16x16x32_bf16 v[108:111], a[192:195], a[156:159], v[108:111]
ds_read_b64_tr_b16 a[178:179], v6 offset:54272
v_mfma_f32_16x16x32_bf16 v[124:127], a[196:199], a[156:159], v[124:127]
s_mov_b32 s39, 10240
buffer_load_dwordx4 a[96:99], v1, s[8:11], s39 offen sc1
v_mfma_f32_16x16x32_bf16 v[124:127], a[204:207], v[204:207], v[124:127]
ds_read_b64_tr_b16 a[180:181], v7 offset:50176
v_add_f32 v34, v34, v30
v_mfma_f32_16x16x32_bf16 v[124:127], a[212:215], v[236:239], v[124:127]
ds_read_b64_tr_b16 a[182:183], v7 offset:54272
v_mfma_f32_16x16x32_bf16 v[124:127], a[220:223], v[252:255], v[124:127]
ds_read_b64_tr_b16 a[184:185], v6 offset:58368
v_add_f32 v35, v35, v31
v_mfma_f32_16x16x32_bf16 v[120:123], a[220:223], v[248:251], v[120:123]
v_accvgpr_read_b32 v28, a230
v_mfma_f32_16x16x32_bf16 v[120:123], a[212:215], v[232:235], v[120:123]
s_mov_b32 s39, 10240
buffer_load_dwordx4 a[100:103], v20, s[8:11], s39 offen sc1
v_mfma_f32_16x16x32_bf16 v[120:123], a[204:207], v[200:203], v[120:123]
ds_read_b64_tr_b16 a[186:187], v6 offset:62464
v_lshlrev_b32 v30, 16, v28
v_mfma_f32_16x16x32_bf16 v[120:123], a[196:199], a[152:155], v[120:123]
ds_read_b64_tr_b16 a[188:189], v7 offset:58368
v_mfma_f32_16x16x32_bf16 v[116:119], a[196:199], a[148:151], v[116:119]
s_mov_b32 s39, 10240
buffer_load_dwordx4 a[104:107], v21, s[8:11], s39 offen sc1
v_and_b32 v31, 0xffff0000, v28
v_mfma_f32_16x16x32_bf16 v[116:119], a[204:207], v[196:199], v[116:119]
ds_read_b64_tr_b16 a[190:191], v7 offset:62464
v_mfma_f32_16x16x32_bf16 v[116:119], a[212:215], v[228:231], v[116:119]
v_add_f32 v48, v48, v30
v_mfma_f32_16x16x32_bf16 v[116:119], a[220:223], v[244:247], v[116:119]
v_add_f32 v49, v49, v31
v_mfma_f32_16x16x32_bf16 v[112:115], a[220:223], v[240:243], v[112:115]
v_accvgpr_read_b32 v29, a231
v_mfma_f32_16x16x32_bf16 v[112:115], a[212:215], v[224:227], v[112:115]
v_lshlrev_b32 v30, 16, v29
v_mfma_f32_16x16x32_bf16 v[112:115], a[204:207], v[192:195], v[112:115]
v_and_b32 v31, 0xffff0000, v29
v_mfma_f32_16x16x32_bf16 v[112:115], a[196:199], a[144:147], v[112:115]
v_add_f32 v50, v50, v30
v_add_f32 v51, v51, v31
s_waitcnt vmcnt(31) lgkmcnt(0)
v_mfma_f32_16x16x32_bf16 v[128:131], a[160:163], v[144:147], v[128:131]
ds_read_b64_tr_b16 a[192:193], v4 offset:33792
v_mfma_f32_16x16x32_bf16 v[128:131], a[168:171], v[176:179], v[128:131]
s_mov_b32 s39, 10240
buffer_load_dwordx4 a[108:111], v22, s[8:11], s39 offen sc1
v_mfma_f32_16x16x32_bf16 v[128:131], a[176:179], v[208:211], v[128:131]
ds_read_b64_tr_b16 a[194:195], v4 offset:37888
v_accvgpr_read_b32 v25, a232
v_mfma_f32_16x16x32_bf16 v[128:131], a[184:187], a[0:3], v[128:131]
ds_read_b64_tr_b16 a[196:197], v5 offset:33792
v_mfma_f32_16x16x32_bf16 v[132:135], a[184:187], a[4:7], v[132:135]
s_mov_b32 s39, 17408
buffer_load_dwordx4 a[112:115], v1, s[8:11], s39 offen sc1
v_lshlrev_b32 v30, 16, v25
v_mfma_f32_16x16x32_bf16 v[132:135], a[176:179], v[212:215], v[132:135]
ds_read_b64_tr_b16 a[198:199], v5 offset:37888
v_mfma_f32_16x16x32_bf16 v[132:135], a[168:171], v[180:183], v[132:135]
v_and_b32 v31, 0xffff0000, v25
v_mfma_f32_16x16x32_bf16 v[132:135], a[160:163], v[148:151], v[132:135]
ds_read_b64_tr_b16 a[200:201], v4 offset:41984
v_add_f32 v36, v36, v30
v_mfma_f32_16x16x32_bf16 v[136:139], a[160:163], v[152:155], v[136:139]
ds_read_b64_tr_b16 a[202:203], v4 offset:46080
v_mfma_f32_16x16x32_bf16 v[136:139], a[168:171], v[184:187], v[136:139]
s_mov_b32 s39, 17408
buffer_load_dwordx4 a[116:119], v20, s[8:11], s39 offen sc1
v_add_f32 v37, v37, v31
v_mfma_f32_16x16x32_bf16 v[136:139], a[176:179], v[216:219], v[136:139]
ds_read_b64_tr_b16 a[204:205], v5 offset:41984
v_mfma_f32_16x16x32_bf16 v[136:139], a[184:187], a[8:11], v[136:139]
ds_read_b64_tr_b16 a[206:207], v5 offset:46080
v_accvgpr_read_b32 v29, a233
v_mfma_f32_16x16x32_bf16 v[140:143], a[184:187], a[12:15], v[140:143]
s_mov_b32 s39, 17408
buffer_load_dwordx4 a[120:123], v21, s[8:11], s39 offen sc1
v_mfma_f32_16x16x32_bf16 v[140:143], a[176:179], v[220:223], v[140:143]
v_lshlrev_b32 v30, 16, v29
v_mfma_f32_16x16x32_bf16 v[140:143], a[168:171], v[188:191], v[140:143]
ds_read_b64_tr_b16 a[208:209], v4 offset:50176
v_and_b32 v31, 0xffff0000, v29
v_mfma_f32_16x16x32_bf16 v[140:143], a[160:163], v[156:159], v[140:143]
ds_read_b64_tr_b16 a[210:211], v4 offset:54272
v_mfma_f32_16x16x32_bf16 v[172:175], a[164:167], v[156:159], v[172:175]
s_mov_b32 s39, 17408
buffer_load_dwordx4 a[124:127], v22, s[8:11], s39 offen sc1
v_mfma_f32_16x16x32_bf16 v[172:175], a[172:175], v[188:191], v[172:175]
ds_read_b64_tr_b16 a[212:213], v5 offset:50176
v_add_f32 v38, v38, v30
v_mfma_f32_16x16x32_bf16 v[172:175], a[180:183], v[220:223], v[172:175]
ds_read_b64_tr_b16 a[214:215], v5 offset:54272
v_mfma_f32_16x16x32_bf16 v[172:175], a[188:191], a[12:15], v[172:175]
ds_read_b64_tr_b16 a[216:217], v4 offset:58368
v_add_f32 v39, v39, v31
v_mfma_f32_16x16x32_bf16 v[168:171], a[188:191], a[8:11], v[168:171]
v_accvgpr_read_b32 v28, a234
v_mfma_f32_16x16x32_bf16 v[168:171], a[180:183], v[216:219], v[168:171]
s_mov_b32 s39, 24576
buffer_load_dwordx4 a[128:131], v1, s[8:11], s39 offen sc1
v_mfma_f32_16x16x32_bf16 v[168:171], a[172:175], v[184:187], v[168:171]
ds_read_b64_tr_b16 a[218:219], v4 offset:62464
v_lshlrev_b32 v30, 16, v28
v_mfma_f32_16x16x32_bf16 v[168:171], a[164:167], v[152:155], v[168:171]
ds_read_b64_tr_b16 a[220:221], v5 offset:58368
v_mfma_f32_16x16x32_bf16 v[164:167], a[164:167], v[148:151], v[164:167]
s_mov_b32 s39, 24576
buffer_load_dwordx4 a[132:135], v20, s[8:11], s39 offen sc1
v_and_b32 v31, 0xffff0000, v28
v_mfma_f32_16x16x32_bf16 v[164:167], a[172:175], v[180:183], v[164:167]
ds_read_b64_tr_b16 a[222:223], v5 offset:62464
v_mfma_f32_16x16x32_bf16 v[164:167], a[180:183], v[212:215], v[164:167]
v_add_f32 v52, v52, v30
v_mfma_f32_16x16x32_bf16 v[164:167], a[188:191], a[4:7], v[164:167]
v_add_f32 v53, v53, v31
v_mfma_f32_16x16x32_bf16 v[160:163], a[188:191], a[0:3], v[160:163]
v_accvgpr_read_b32 v29, a235
v_mfma_f32_16x16x32_bf16 v[160:163], a[180:183], v[208:211], v[160:163]
v_lshlrev_b32 v30, 16, v29
v_mfma_f32_16x16x32_bf16 v[160:163], a[172:175], v[176:179], v[160:163]
v_and_b32 v31, 0xffff0000, v29
v_mfma_f32_16x16x32_bf16 v[160:163], a[164:167], v[144:147], v[160:163]
v_add_f32 v54, v54, v30
v_add_f32 v55, v55, v31
s_waitcnt vmcnt(14) lgkmcnt(0)
s_barrier
v_mfma_f32_16x16x32_bf16 v[96:99], a[192:195], v[144:147], v[96:99]
ds_read_b64_tr_b16 a[160:161], v10 offset:1024
v_mfma_f32_16x16x32_bf16 v[96:99], a[200:203], v[176:179], v[96:99]
ds_read_b64_tr_b16 a[162:163], v10 offset:5120
v_mfma_f32_16x16x32_bf16 v[96:99], a[208:211], v[208:211], v[96:99]
v_accvgpr_read_b32 v26, a236
v_mfma_f32_16x16x32_bf16 v[96:99], a[216:219], a[0:3], v[96:99]
ds_read_b64_tr_b16 a[164:165], v11 offset:1024
v_lshlrev_b32 v30, 16, v26
v_mfma_f32_16x16x32_bf16 v[100:103], a[216:219], a[4:7], v[100:103]
ds_read_b64_tr_b16 a[166:167], v11 offset:5120
v_mfma_f32_16x16x32_bf16 v[100:103], a[208:211], v[212:215], v[100:103]
v_and_b32 v31, 0xffff0000, v26
v_mfma_f32_16x16x32_bf16 v[100:103], a[200:203], v[180:183], v[100:103]
s_mov_b32 s39, 24576
buffer_load_dwordx4 a[136:139], v21, s[8:11], s39 offen sc1
v_mfma_f32_16x16x32_bf16 v[100:103], a[192:195], v[148:151], v[100:103]
ds_read_b64_tr_b16 a[168:169], v10 offset:9216
v_add_f32 v40, v40, v30
v_mfma_f32_16x16x32_bf16 v[104:107], a[192:195], v[152:155], v[104:107]
v_add_f32 v41, v41, v31
v_mfma_f32_16x16x32_bf16 v[104:107], a[200:203], v[184:187], v[104:107]
ds_read_b64_tr_b16 a[170:171], v10 offset:13312
v_mfma_f32_16x16x32_bf16 v[104:107], a[208:211], v[216:219], v[104:107]
ds_read_b64_tr_b16 a[172:173], v11 offset:9216
v_accvgpr_read_b32 v29, a237
v_mfma_f32_16x16x32_bf16 v[104:107], a[216:219], a[8:11], v[104:107]
v_mfma_f32_16x16x32_bf16 v[108:111], a[216:219], a[12:15], v[108:111]
ds_read_b64_tr_b16 a[174:175], v11 offset:13312
v_lshlrev_b32 v30, 16, v29
v_mfma_f32_16x16x32_bf16 v[108:111], a[208:211], v[220:223], v[108:111]
ds_read_b64_tr_b16 a[176:177], v10 offset:17408
v_mfma_f32_16x16x32_bf16 v[108:111], a[200:203], v[188:191], v[108:111]
v_and_b32 v31, 0xffff0000, v29
v_mfma_f32_16x16x32_bf16 v[108:111], a[192:195], v[156:159], v[108:111]
ds_read_b64_tr_b16 a[178:179], v10 offset:21504
v_add_f32 v42, v42, v30
v_mfma_f32_16x16x32_bf16 v[124:127], a[196:199], v[156:159], v[124:127]
ds_read_b64_tr_b16 a[180:181], v11 offset:17408
v_mfma_f32_16x16x32_bf16 v[124:127], a[204:207], v[188:191], v[124:127]
v_add_f32 v43, v43, v31
v_mfma_f32_16x16x32_bf16 v[124:127], a[212:215], v[220:223], v[124:127]
ds_read_b64_tr_b16 a[182:183], v11 offset:21504
v_mfma_f32_16x16x32_bf16 v[124:127], a[220:223], a[12:15], v[124:127]
s_mov_b32 s39, 24576
buffer_load_dwordx4 a[140:143], v22, s[8:11], s39 offen sc1
v_accvgpr_read_b32 v28, a238
v_mfma_f32_16x16x32_bf16 v[120:123], a[220:223], a[8:11], v[120:123]
v_lshlrev_b32 v30, 16, v28
v_mfma_f32_16x16x32_bf16 v[120:123], a[212:215], v[216:219], v[120:123]
ds_read_b64_tr_b16 a[184:185], v10 offset:25600
v_mfma_f32_16x16x32_bf16 v[120:123], a[204:207], v[184:187], v[120:123]
ds_read_b64_tr_b16 a[186:187], v10 offset:29696
v_mfma_f32_16x16x32_bf16 v[120:123], a[196:199], v[152:155], v[120:123]
v_and_b32 v31, 0xffff0000, v28
v_mfma_f32_16x16x32_bf16 v[116:119], a[196:199], v[148:151], v[116:119]
ds_read_b64_tr_b16 a[188:189], v11 offset:25600
v_add_f32 v56, v56, v30
v_mfma_f32_16x16x32_bf16 v[116:119], a[204:207], v[180:183], v[116:119]
ds_read_b64_tr_b16 a[190:191], v11 offset:29696
v_mfma_f32_16x16x32_bf16 v[116:119], a[212:215], v[212:215], v[116:119]
v_add_f32 v57, v57, v31
v_mfma_f32_16x16x32_bf16 v[116:119], a[220:223], a[4:7], v[116:119]
v_accvgpr_read_b32 v29, a239
v_mfma_f32_16x16x32_bf16 v[112:115], a[220:223], a[0:3], v[112:115]
v_lshlrev_b32 v30, 16, v29
v_mfma_f32_16x16x32_bf16 v[112:115], a[212:215], v[208:211], v[112:115]
v_and_b32 v31, 0xffff0000, v29
v_mfma_f32_16x16x32_bf16 v[112:115], a[204:207], v[176:179], v[112:115]
v_add_f32 v58, v58, v30
v_mfma_f32_16x16x32_bf16 v[112:115], a[196:199], v[144:147], v[112:115]
v_add_f32 v59, v59, v31
s_waitcnt vmcnt(18) lgkmcnt(0)
v_mfma_f32_16x16x32_bf16 v[128:131], a[160:163], a[16:19], v[128:131]
ds_read_b64_tr_b16 a[192:193], v8 offset:1024
v_mfma_f32_16x16x32_bf16 v[128:131], a[168:171], a[32:35], v[128:131]
ds_read_b64_tr_b16 a[194:195], v8 offset:5120
v_mfma_f32_16x16x32_bf16 v[128:131], a[176:179], a[48:51], v[128:131]
v_accvgpr_read_b32 v27, a240
v_mfma_f32_16x16x32_bf16 v[128:131], a[184:187], a[64:67], v[128:131]
ds_read_b64_tr_b16 a[196:197], v9 offset:1024
v_lshlrev_b32 v30, 16, v27
v_mfma_f32_16x16x32_bf16 v[132:135], a[184:187], a[68:71], v[132:135]
ds_read_b64_tr_b16 a[198:199], v9 offset:5120
v_mfma_f32_16x16x32_bf16 v[132:135], a[176:179], a[52:55], v[132:135]
v_and_b32 v31, 0xffff0000, v27
v_mfma_f32_16x16x32_bf16 v[132:135], a[168:171], a[36:39], v[132:135]
v_accvgpr_read_b32 v16, a247
v_mfma_f32_16x16x32_bf16 v[132:135], a[160:163], a[20:23], v[132:135]
ds_read_b64_tr_b16 a[200:201], v8 offset:9216
v_add_f32 v44, v44, v30
v_mfma_f32_16x16x32_bf16 v[136:139], a[160:163], a[24:27], v[136:139]
v_add_f32 v45, v45, v31
v_mfma_f32_16x16x32_bf16 v[136:139], a[168:171], a[40:43], v[136:139]
ds_read_b64_tr_b16 a[202:203], v8 offset:13312
v_mfma_f32_16x16x32_bf16 v[136:139], a[176:179], a[56:59], v[136:139]
ds_read_b64_tr_b16 a[204:205], v9 offset:9216
v_accvgpr_read_b32 v29, a241
v_mfma_f32_16x16x32_bf16 v[136:139], a[184:187], a[72:75], v[136:139]
v_mfma_f32_16x16x32_bf16 v[140:143], a[184:187], a[76:79], v[140:143]
ds_read_b64_tr_b16 a[206:207], v9 offset:13312
v_lshlrev_b32 v30, 16, v29
v_mfma_f32_16x16x32_bf16 v[140:143], a[176:179], a[60:63], v[140:143]
ds_read_b64_tr_b16 a[208:209], v8 offset:17408
v_mfma_f32_16x16x32_bf16 v[140:143], a[168:171], a[44:47], v[140:143]
v_and_b32 v31, 0xffff0000, v29
v_mfma_f32_16x16x32_bf16 v[140:143], a[160:163], a[28:31], v[140:143]
ds_read_b64_tr_b16 a[210:211], v8 offset:21504
v_add_f32 v46, v46, v30
v_mfma_f32_16x16x32_bf16 v[172:175], a[164:167], a[28:31], v[172:175]
ds_read_b64_tr_b16 a[212:213], v9 offset:17408
v_mfma_f32_16x16x32_bf16 v[172:175], a[172:175], a[44:47], v[172:175]
v_add_f32 v47, v47, v31
v_mfma_f32_16x16x32_bf16 v[172:175], a[180:183], a[60:63], v[172:175]
ds_read_b64_tr_b16 a[214:215], v9 offset:21504
v_mfma_f32_16x16x32_bf16 v[172:175], a[188:191], a[76:79], v[172:175]
buffer_load_dword v17, v16, s[12:15], 0 offen sc1
v_accvgpr_read_b32 v28, a242
v_mfma_f32_16x16x32_bf16 v[168:171], a[188:191], a[72:75], v[168:171]
v_lshlrev_b32 v30, 16, v28
v_mfma_f32_16x16x32_bf16 v[168:171], a[180:183], a[56:59], v[168:171]
ds_read_b64_tr_b16 a[216:217], v8 offset:25600
v_mfma_f32_16x16x32_bf16 v[168:171], a[172:175], a[40:43], v[168:171]
ds_read_b64_tr_b16 a[218:219], v8 offset:29696
v_and_b32 v31, 0xffff0000, v28
v_mfma_f32_16x16x32_bf16 v[168:171], a[164:167], a[24:27], v[168:171]
v_mfma_f32_16x16x32_bf16 v[164:167], a[164:167], a[20:23], v[164:167]
ds_read_b64_tr_b16 a[220:221], v9 offset:25600
v_add_f32 v60, v60, v30
v_mfma_f32_16x16x32_bf16 v[164:167], a[172:175], a[36:39], v[164:167]
ds_read_b64_tr_b16 a[222:223], v9 offset:29696
v_mfma_f32_16x16x32_bf16 v[164:167], a[180:183], a[52:55], v[164:167]
v_add_f32 v61, v61, v31
v_mfma_f32_16x16x32_bf16 v[164:167], a[188:191], a[68:71], v[164:167]
v_accvgpr_read_b32 v29, a243
v_mfma_f32_16x16x32_bf16 v[160:163], a[188:191], a[64:67], v[160:163]
v_lshlrev_b32 v30, 16, v29
v_mfma_f32_16x16x32_bf16 v[160:163], a[180:183], a[48:51], v[160:163]
v_and_b32 v31, 0xffff0000, v29
v_mfma_f32_16x16x32_bf16 v[160:163], a[172:175], a[32:35], v[160:163]
v_add_f32 v62, v62, v30
v_mfma_f32_16x16x32_bf16 v[160:163], a[164:167], a[16:19], v[160:163]
v_add_f32 v63, v63, v31
s_waitcnt vmcnt(19) lgkmcnt(0)
v_mfma_f32_16x16x32_bf16 v[96:99], a[192:195], a[16:19], v[96:99]
ds_read_b64_tr_b16 a[160:161], v10 offset:33792
v_mfma_f32_16x16x32_bf16 v[96:99], a[200:203], a[32:35], v[96:99]
ds_read_b64_tr_b16 a[162:163], v10 offset:37888
v_mfma_f32_16x16x32_bf16 v[96:99], a[208:211], a[48:51], v[96:99]
v_mfma_f32_16x16x32_bf16 v[96:99], a[216:219], a[64:67], v[96:99]
ds_read_b64_tr_b16 a[164:165], v11 offset:33792
v_mfma_f32_16x16x32_bf16 v[100:103], a[216:219], a[68:71], v[100:103]
v_mfma_f32_16x16x32_bf16 v[100:103], a[208:211], a[52:55], v[100:103]
ds_read_b64_tr_b16 a[166:167], v11 offset:37888
v_mfma_f32_16x16x32_bf16 v[100:103], a[200:203], a[36:39], v[100:103]
ds_read_b64_tr_b16 a[168:169], v10 offset:41984
v_mfma_f32_16x16x32_bf16 v[100:103], a[192:195], a[20:23], v[100:103]
v_mfma_f32_16x16x32_bf16 v[104:107], a[192:195], a[24:27], v[104:107]
ds_read_b64_tr_b16 a[170:171], v10 offset:46080
v_accvgpr_read_b32 v28, a224
v_mfma_f32_16x16x32_bf16 v[104:107], a[200:203], a[40:43], v[104:107]
v_mfma_f32_16x16x32_bf16 v[104:107], a[208:211], a[56:59], v[104:107]
ds_read_b64_tr_b16 a[172:173], v11 offset:41984
v_mfma_f32_16x16x32_bf16 v[104:107], a[216:219], a[72:75], v[104:107]
ds_read_b64_tr_b16 a[174:175], v11 offset:46080
v_mfma_f32_16x16x32_bf16 v[108:111], a[216:219], a[76:79], v[108:111]
v_mfma_f32_16x16x32_bf16 v[108:111], a[208:211], a[60:63], v[108:111]
ds_read_b64_tr_b16 a[176:177], v10 offset:50176
v_mfma_f32_16x16x32_bf16 v[108:111], a[200:203], a[44:47], v[108:111]
v_mfma_f32_16x16x32_bf16 v[108:111], a[192:195], a[28:31], v[108:111]
ds_read_b64_tr_b16 a[178:179], v10 offset:54272
v_mfma_f32_16x16x32_bf16 v[124:127], a[196:199], a[28:31], v[124:127]
ds_read_b64_tr_b16 a[180:181], v11 offset:50176
v_mfma_f32_16x16x32_bf16 v[124:127], a[204:207], a[44:47], v[124:127]
v_accvgpr_read_b32 v29, a225
v_mfma_f32_16x16x32_bf16 v[124:127], a[212:215], a[60:63], v[124:127]
ds_read_b64_tr_b16 a[182:183], v11 offset:54272
v_mfma_f32_16x16x32_bf16 v[124:127], a[220:223], a[76:79], v[124:127]
v_mfma_f32_16x16x32_bf16 v[120:123], a[220:223], a[72:75], v[120:123]
ds_read_b64_tr_b16 a[184:185], v10 offset:58368
v_mfma_f32_16x16x32_bf16 v[120:123], a[212:215], a[56:59], v[120:123]
ds_read_b64_tr_b16 a[186:187], v10 offset:62464
v_mfma_f32_16x16x32_bf16 v[120:123], a[204:207], a[40:43], v[120:123]
v_mfma_f32_16x16x32_bf16 v[120:123], a[196:199], a[24:27], v[120:123]
ds_read_b64_tr_b16 a[188:189], v11 offset:58368
v_mfma_f32_16x16x32_bf16 v[116:119], a[196:199], a[20:23], v[116:119]
v_mfma_f32_16x16x32_bf16 v[116:119], a[204:207], a[36:39], v[116:119]
ds_read_b64_tr_b16 a[190:191], v11 offset:62464
v_accvgpr_read_b32 v30, a226
v_mfma_f32_16x16x32_bf16 v[116:119], a[212:215], a[52:55], v[116:119]
v_mfma_f32_16x16x32_bf16 v[116:119], a[220:223], a[68:71], v[116:119]
v_mfma_f32_16x16x32_bf16 v[112:115], a[220:223], a[64:67], v[112:115]
v_mfma_f32_16x16x32_bf16 v[112:115], a[212:215], a[48:51], v[112:115]
v_mfma_f32_16x16x32_bf16 v[112:115], a[204:207], a[32:35], v[112:115]
v_mfma_f32_16x16x32_bf16 v[112:115], a[196:199], a[16:19], v[112:115]
v_accvgpr_read_b32 v31, a227
s_waitcnt vmcnt(1) lgkmcnt(0)
s_waitcnt vmcnt(0)
v_cmp_ne_u32 vcc, s63, v17
s_and_b32 s61, vcc_lo, -1
s_cbranch_scc1 L_f53
L_f53x:
v_mfma_f32_16x16x32_bf16 v[128:131], a[160:163], a[80:83], v[128:131]
ds_read_b64_tr_b16 a[192:193], v8 offset:33792
v_mfma_f32_16x16x32_bf16 v[128:131], a[168:171], a[96:99], v[128:131]
ds_read_b64_tr_b16 a[194:195], v8 offset:37888
v_mfma_f32_16x16x32_bf16 v[128:131], a[176:179], a[112:115], v[128:131]
v_mfma_f32_16x16x32_bf16 v[128:131], a[184:187], a[128:131], v[128:131]
ds_read_b64_tr_b16 a[196:197], v9 offset:33792
v_mfma_f32_16x16x32_bf16 v[132:135], a[184:187], a[132:135], v[132:135]
v_mfma_f32_16x16x32_bf16 v[132:135], a[176:179], a[116:119], v[132:135]
ds_read_b64_tr_b16 a[198:199], v9 offset:37888
v_mfma_f32_16x16x32_bf16 v[132:135], a[168:171], a[100:103], v[132:135]
ds_read_b64_tr_b16 a[200:201], v8 offset:41984
v_mfma_f32_16x16x32_bf16 v[132:135], a[160:163], a[84:87], v[132:135]
v_mfma_f32_16x16x32_bf16 v[136:139], a[160:163], a[88:91], v[136:139]
ds_read_b64_tr_b16 a[202:203], v8 offset:46080
v_mfma_f32_16x16x32_bf16 v[136:139], a[168:171], a[104:107], v[136:139]
v_mfma_f32_16x16x32_bf16 v[136:139], a[176:179], a[120:123], v[136:139]
ds_read_b64_tr_b16 a[204:205], v9 offset:41984
v_mfma_f32_16x16x32_bf16 v[136:139], a[184:187], a[136:139], v[136:139]
ds_read_b64_tr_b16 a[206:207], v9 offset:46080
v_mfma_f32_16x16x32_bf16 v[140:143], a[184:187], a[140:143], v[140:143]
v_mfma_f32_16x16x32_bf16 v[140:143], a[176:179], a[124:127], v[140:143]
ds_read_b64_tr_b16 a[208:209], v8 offset:50176
v_mfma_f32_16x16x32_bf16 v[140:143], a[168:171], a[108:111], v[140:143]
v_mfma_f32_16x16x32_bf16 v[140:143], a[160:163], a[92:95], v[140:143]
ds_read_b64_tr_b16 a[210:211], v8 offset:54272
v_mfma_f32_16x16x32_bf16 v[172:175], a[164:167], a[92:95], v[172:175]
ds_read_b64_tr_b16 a[212:213], v9 offset:50176
v_mfma_f32_16x16x32_bf16 v[172:175], a[172:175], a[108:111], v[172:175]
v_mfma_f32_16x16x32_bf16 v[172:175], a[180:183], a[124:127], v[172:175]
ds_read_b64_tr_b16 a[214:215], v9 offset:54272
v_mfma_f32_16x16x32_bf16 v[172:175], a[188:191], a[140:143], v[172:175]
v_mfma_f32_16x16x32_bf16 v[168:171], a[188:191], a[136:139], v[168:171]
ds_read_b64_tr_b16 a[216:217], v8 offset:58368
v_mfma_f32_16x16x32_bf16 v[168:171], a[180:183], a[120:123], v[168:171]
ds_read_b64_tr_b16 a[218:219], v8 offset:62464
v_mfma_f32_16x16x32_bf16 v[168:171], a[172:175], a[104:107], v[168:171]
v_mfma_f32_16x16x32_bf16 v[168:171], a[164:167], a[88:91], v[168:171]
ds_read_b64_tr_b16 a[220:221], v9 offset:58368
v_mfma_f32_16x16x32_bf16 v[164:167], a[164:167], a[84:87], v[164:167]
v_mfma_f32_16x16x32_bf16 v[164:167], a[172:175], a[100:103], v[164:167]
ds_read_b64_tr_b16 a[222:223], v9 offset:62464
v_mfma_f32_16x16x32_bf16 v[164:167], a[180:183], a[116:119], v[164:167]
v_mfma_f32_16x16x32_bf16 v[164:167], a[188:191], a[132:135], v[164:167]
v_mfma_f32_16x16x32_bf16 v[160:163], a[188:191], a[128:131], v[160:163]
v_mfma_f32_16x16x32_bf16 v[160:163], a[180:183], a[112:115], v[160:163]
v_mfma_f32_16x16x32_bf16 v[160:163], a[172:175], a[96:99], v[160:163]
v_mfma_f32_16x16x32_bf16 v[160:163], a[164:167], a[80:83], v[160:163]
s_waitcnt vmcnt(1) lgkmcnt(0)
v_mfma_f32_16x16x32_bf16 v[96:99], a[192:195], a[80:83], v[96:99]
ds_read_b64_tr_b16 a[160:161], v6 offset:0
v_mfma_f32_16x16x32_bf16 v[96:99], a[200:203], a[96:99], v[96:99]
ds_read_b64_tr_b16 a[162:163], v6 offset:4096
v_mfma_f32_16x16x32_bf16 v[96:99], a[208:211], a[112:115], v[96:99]
v_mfma_f32_16x16x32_bf16 v[96:99], a[216:219], a[128:131], v[96:99]
ds_read_b64_tr_b16 a[164:165], v7 offset:0
s_xor_b32 s61, s95, 393216
v_mfma_f32_16x16x32_bf16 v[100:103], a[216:219], a[132:135], v[100:103]
v_cvt_pk_bf16_f32 v128, v128, v129
v_cvt_pk_bf16_f32 v129, v130, v131
v_mfma_f32_16x16x32_bf16 v[100:103], a[208:211], a[116:119], v[100:103]
ds_read_b64_tr_b16 a[166:167], v7 offset:4096
v_cvt_pk_bf16_f32 v130, v160, v161
v_mfma_f32_16x16x32_bf16 v[100:103], a[200:203], a[100:103], v[100:103]
ds_read_b64_tr_b16 a[168:169], v6 offset:8192
v_cvt_pk_bf16_f32 v131, v162, v163
v_mfma_f32_16x16x32_bf16 v[100:103], a[192:195], a[84:87], v[100:103]
buffer_store_dwordx4 v[128:131], v3, s[12:15], s61 offen offset:0 sc1
v_cvt_pk_bf16_f32 v132, v132, v133
v_mfma_f32_16x16x32_bf16 v[104:107], a[192:195], a[88:91], v[104:107]
ds_read_b64_tr_b16 a[170:171], v6 offset:12288
v_cvt_pk_bf16_f32 v133, v134, v135
v_mfma_f32_16x16x32_bf16 v[104:107], a[200:203], a[104:107], v[104:107]
v_cvt_pk_bf16_f32 v134, v164, v165
v_cvt_pk_bf16_f32 v135, v166, v167
v_mfma_f32_16x16x32_bf16 v[104:107], a[208:211], a[120:123], v[104:107]
ds_read_b64_tr_b16 a[172:173], v7 offset:8192
buffer_store_dwordx4 v[132:135], v3, s[12:15], s61 offen offset:1024 sc1
v_mfma_f32_16x16x32_bf16 v[104:107], a[216:219], a[136:139], v[104:107]
ds_read_b64_tr_b16 a[174:175], v7 offset:12288
v_cvt_pk_bf16_f32 v136, v136, v137
v_mfma_f32_16x16x32_bf16 v[108:111], a[216:219], a[140:143], v[108:111]
v_cvt_pk_bf16_f32 v137, v138, v139
v_cvt_pk_bf16_f32 v138, v168, v169
v_mfma_f32_16x16x32_bf16 v[108:111], a[208:211], a[124:127], v[108:111]
ds_read_b64_tr_b16 a[176:177], v6 offset:16384
v_cvt_pk_bf16_f32 v139, v170, v171
v_mfma_f32_16x16x32_bf16 v[108:111], a[200:203], a[108:111], v[108:111]
buffer_store_dwordx4 v[136:139], v3, s[12:15], s61 offen offset:2048 sc1
v_cvt_pk_bf16_f32 v140, v140, v141
v_mfma_f32_16x16x32_bf16 v[108:111], a[192:195], a[92:95], v[108:111]
ds_read_b64_tr_b16 a[178:179], v6 offset:20480
v_cvt_pk_bf16_f32 v141, v142, v143
v_mfma_f32_16x16x32_bf16 v[124:127], a[196:199], a[92:95], v[124:127]
ds_read_b64_tr_b16 a[180:181], v7 offset:16384
v_cvt_pk_bf16_f32 v142, v172, v173
v_mfma_f32_16x16x32_bf16 v[124:127], a[204:207], a[108:111], v[124:127]
v_cvt_pk_bf16_f32 v143, v174, v175
buffer_store_dwordx4 v[140:143], v3, s[12:15], s61 offen offset:3072 sc1
v_mfma_f32_16x16x32_bf16 v[124:127], a[212:215], a[124:127], v[124:127]
ds_read_b64_tr_b16 a[182:183], v7 offset:20480
v_mfma_f32_16x16x32_bf16 v[124:127], a[220:223], a[140:143], v[124:127]
v_mfma_f32_16x16x32_bf16 v[120:123], a[220:223], a[136:139], v[120:123]
ds_read_b64_tr_b16 a[184:185], v6 offset:24576
v_mfma_f32_16x16x32_bf16 v[120:123], a[212:215], a[120:123], v[120:123]
ds_read_b64_tr_b16 a[186:187], v6 offset:28672
v_mfma_f32_16x16x32_bf16 v[120:123], a[204:207], a[104:107], v[120:123]
v_mfma_f32_16x16x32_bf16 v[120:123], a[196:199], a[88:91], v[120:123]
ds_read_b64_tr_b16 a[188:189], v7 offset:24576
v_mfma_f32_16x16x32_bf16 v[116:119], a[196:199], a[84:87], v[116:119]
v_mfma_f32_16x16x32_bf16 v[116:119], a[204:207], a[100:103], v[116:119]
ds_read_b64_tr_b16 a[190:191], v7 offset:28672
v_mfma_f32_16x16x32_bf16 v[116:119], a[212:215], a[116:119], v[116:119]
v_mfma_f32_16x16x32_bf16 v[116:119], a[220:223], a[132:135], v[116:119]
v_mfma_f32_16x16x32_bf16 v[112:115], a[220:223], a[128:131], v[112:115]
v_mfma_f32_16x16x32_bf16 v[112:115], a[212:215], a[112:115], v[112:115]
v_mfma_f32_16x16x32_bf16 v[112:115], a[204:207], a[96:99], v[112:115]
v_mfma_f32_16x16x32_bf16 v[112:115], a[196:199], a[80:83], v[112:115]
s_waitcnt vmcnt(63) lgkmcnt(0)
v_mfma_f32_16x16x32_bf16 v[64:67], a[160:163], a[144:147], v[64:67]
ds_read_b64_tr_b16 a[192:193], v6 offset:32768
v_mfma_f32_16x16x32_bf16 v[64:67], a[168:171], v[192:195], v[64:67]
ds_read_b64_tr_b16 a[194:195], v6 offset:36864
v_mfma_f32_16x16x32_bf16 v[64:67], a[176:179], v[224:227], v[64:67]
v_mfma_f32_16x16x32_bf16 v[64:67], a[184:187], v[240:243], v[64:67]
ds_read_b64_tr_b16 a[196:197], v7 offset:32768
v_mfma_f32_16x16x32_bf16 v[68:71], a[184:187], v[244:247], v[68:71]
s_xor_b32 s61, s64, 524288
s_add_u32 s38, s61, 32768
s_add_u32 s55, s64, 32768
v_cvt_pk_bf16_f32 v96, v96, v97
v_mfma_f32_16x16x32_bf16 v[68:71], a[176:179], v[228:231], v[68:71]
ds_read_b64_tr_b16 a[198:199], v7 offset:36864
v_cvt_pk_bf16_f32 v97, v98, v99
v_mfma_f32_16x16x32_bf16 v[68:71], a[168:171], v[196:199], v[68:71]
ds_read_b64_tr_b16 a[200:201], v6 offset:40960
v_xor_b32 v96, s63, v96
v_mfma_f32_16x16x32_bf16 v[68:71], a[160:163], a[148:151], v[68:71]
v_cvt_pk_bf16_f32 v98, v112, v113
v_cvt_pk_bf16_f32 v99, v114, v115
v_mfma_f32_16x16x32_bf16 v[72:75], a[160:163], a[152:155], v[72:75]
ds_read_b64_tr_b16 a[202:203], v6 offset:45056
buffer_store_dwordx4 v[96:99], v1, s[12:15], s61 offen offset:0 sc1
v_mfma_f32_16x16x32_bf16 v[72:75], a[168:171], v[200:203], v[72:75]
v_cvt_pk_bf16_f32 v100, v100, v101
v_cvt_pk_bf16_f32 v101, v102, v103
v_mfma_f32_16x16x32_bf16 v[72:75], a[176:179], v[232:235], v[72:75]
ds_read_b64_tr_b16 a[204:205], v7 offset:40960
v_xor_b32 v100, s63, v100
v_mfma_f32_16x16x32_bf16 v[72:75], a[184:187], v[248:251], v[72:75]
ds_read_b64_tr_b16 a[206:207], v7 offset:45056
v_cvt_pk_bf16_f32 v102, v116, v117
v_mfma_f32_16x16x32_bf16 v[76:79], a[184:187], v[252:255], v[76:79]
v_cvt_pk_bf16_f32 v103, v118, v119
buffer_store_dwordx4 v[100:103], v1, s[12:15], s61 offen offset:1024 sc1
v_mfma_f32_16x16x32_bf16 v[76:79], a[176:179], v[236:239], v[76:79]
ds_read_b64_tr_b16 a[208:209], v6 offset:49152
v_cvt_pk_bf16_f32 v104, v104, v105
v_mfma_f32_16x16x32_bf16 v[76:79], a[168:171], v[204:207], v[76:79]
v_cvt_pk_bf16_f32 v105, v106, v107
v_xor_b32 v104, s63, v104
v_mfma_f32_16x16x32_bf16 v[76:79], a[160:163], a[156:159], v[76:79]
ds_read_b64_tr_b16 a[210:211], v6 offset:53248
v_cvt_pk_bf16_f32 v106, v120, v121
v_mfma_f32_16x16x32_bf16 v[92:95], a[164:167], a[156:159], v[92:95]
ds_read_b64_tr_b16 a[212:213], v7 offset:49152
v_cvt_pk_bf16_f32 v107, v122, v123
v_mfma_f32_16x16x32_bf16 v[92:95], a[172:175], v[204:207], v[92:95]
buffer_store_dwordx4 v[104:107], v1, s[12:15], s38 offen offset:0 sc1
v_cvt_pk_bf16_f32 v108, v108, v109
v_mfma_f32_16x16x32_bf16 v[92:95], a[180:183], v[236:239], v[92:95]
ds_read_b64_tr_b16 a[214:215], v7 offset:53248
v_cvt_pk_bf16_f32 v109, v110, v111
v_mfma_f32_16x16x32_bf16 v[92:95], a[188:191], v[252:255], v[92:95]
v_xor_b32 v108, s63, v108
v_cvt_pk_bf16_f32 v110, v124, v125
v_mfma_f32_16x16x32_bf16 v[88:91], a[188:191], v[248:251], v[88:91]
ds_read_b64_tr_b16 a[216:217], v6 offset:57344
v_cvt_pk_bf16_f32 v111, v126, v127
v_mfma_f32_16x16x32_bf16 v[88:91], a[180:183], v[232:235], v[88:91]
ds_read_b64_tr_b16 a[218:219], v6 offset:61440
buffer_store_dwordx4 v[108:111], v1, s[12:15], s38 offen offset:1024 sc1
v_mfma_f32_16x16x32_bf16 v[88:91], a[172:175], v[200:203], v[88:91]
v_mfma_f32_16x16x32_bf16 v[88:91], a[164:167], a[152:155], v[88:91]
ds_read_b64_tr_b16 a[220:221], v7 offset:57344
v_mfma_f32_16x16x32_bf16 v[84:87], a[164:167], a[148:151], v[84:87]
v_mfma_f32_16x16x32_bf16 v[84:87], a[172:175], v[196:199], v[84:87]
ds_read_b64_tr_b16 a[222:223], v7 offset:61440
v_mfma_f32_16x16x32_bf16 v[84:87], a[180:183], v[228:231], v[84:87]
v_mfma_f32_16x16x32_bf16 v[84:87], a[188:191], v[244:247], v[84:87]
v_mfma_f32_16x16x32_bf16 v[80:83], a[188:191], v[240:243], v[80:83]
v_mfma_f32_16x16x32_bf16 v[80:83], a[180:183], v[224:227], v[80:83]
L_wp24:
s_cbranch_execz L_wr4
v_mfma_f32_16x16x32_bf16 v[80:83], a[172:175], v[192:195], v[80:83]
v_mfma_f32_16x16x32_bf16 v[80:83], a[164:167], a[144:147], v[80:83]
s_waitcnt vmcnt(49) lgkmcnt(0)
v_mfma_f32_16x16x32_bf16 v[64:67], a[192:195], v[144:147], v[64:67]
ds_read_b64_tr_b16 a[160:161], v10 offset:0
v_mfma_f32_16x16x32_bf16 v[64:67], a[200:203], v[176:179], v[64:67]
ds_read_b64_tr_b16 a[162:163], v10 offset:4096
v_mfma_f32_16x16x32_bf16 v[64:67], a[208:211], v[208:211], v[64:67]
v_mfma_f32_16x16x32_bf16 v[64:67], a[216:219], a[0:3], v[64:67]
ds_read_b64_tr_b16 a[164:165], v11 offset:0
v_mfma_f32_16x16x32_bf16 v[68:71], a[216:219], a[4:7], v[68:71]
v_mfma_f32_16x16x32_bf16 v[68:71], a[208:211], v[212:215], v[68:71]
ds_read_b64_tr_b16 a[166:167], v11 offset:4096
v_mfma_f32_16x16x32_bf16 v[68:71], a[200:203], v[180:183], v[68:71]
ds_read_b64_tr_b16 a[168:169], v10 offset:8192
v_mfma_f32_16x16x32_bf16 v[68:71], a[192:195], v[148:151], v[68:71]
v_mfma_f32_16x16x32_bf16 v[72:75], a[192:195], v[152:155], v[72:75]
ds_read_b64_tr_b16 a[170:171], v10 offset:12288
v_mfma_f32_16x16x32_bf16 v[72:75], a[200:203], v[184:187], v[72:75]
v_mfma_f32_16x16x32_bf16 v[72:75], a[208:211], v[216:219], v[72:75]
ds_read_b64_tr_b16 a[172:173], v11 offset:8192
v_mfma_f32_16x16x32_bf16 v[72:75], a[216:219], a[8:11], v[72:75]
ds_read_b64_tr_b16 a[174:175], v11 offset:12288
v_mfma_f32_16x16x32_bf16 v[76:79], a[216:219], a[12:15], v[76:79]
v_mfma_f32_16x16x32_bf16 v[76:79], a[208:211], v[220:223], v[76:79]
ds_read_b64_tr_b16 a[176:177], v10 offset:16384
v_mfma_f32_16x16x32_bf16 v[76:79], a[200:203], v[188:191], v[76:79]
v_mfma_f32_16x16x32_bf16 v[76:79], a[192:195], v[156:159], v[76:79]
ds_read_b64_tr_b16 a[178:179], v10 offset:20480
v_mfma_f32_16x16x32_bf16 v[92:95], a[196:199], v[156:159], v[92:95]
ds_read_b64_tr_b16 a[180:181], v11 offset:16384
v_mfma_f32_16x16x32_bf16 v[92:95], a[204:207], v[188:191], v[92:95]
v_mfma_f32_16x16x32_bf16 v[92:95], a[212:215], v[220:223], v[92:95]
ds_read_b64_tr_b16 a[182:183], v11 offset:20480
v_mfma_f32_16x16x32_bf16 v[92:95], a[220:223], a[12:15], v[92:95]
v_mfma_f32_16x16x32_bf16 v[88:91], a[220:223], a[8:11], v[88:91]
ds_read_b64_tr_b16 a[184:185], v10 offset:24576
v_mfma_f32_16x16x32_bf16 v[88:91], a[212:215], v[216:219], v[88:91]
ds_read_b64_tr_b16 a[186:187], v10 offset:28672
v_mfma_f32_16x16x32_bf16 v[88:91], a[204:207], v[184:187], v[88:91]
v_mfma_f32_16x16x32_bf16 v[88:91], a[196:199], v[152:155], v[88:91]
ds_read_b64_tr_b16 a[188:189], v11 offset:24576
v_mfma_f32_16x16x32_bf16 v[84:87], a[196:199], v[148:151], v[84:87]
v_mfma_f32_16x16x32_bf16 v[84:87], a[204:207], v[180:183], v[84:87]
ds_read_b64_tr_b16 a[190:191], v11 offset:28672
v_mfma_f32_16x16x32_bf16 v[84:87], a[212:215], v[212:215], v[84:87]
v_mfma_f32_16x16x32_bf16 v[84:87], a[220:223], a[4:7], v[84:87]
v_mfma_f32_16x16x32_bf16 v[80:83], a[220:223], a[0:3], v[80:83]
v_mfma_f32_16x16x32_bf16 v[80:83], a[212:215], v[208:211], v[80:83]
v_mfma_f32_16x16x32_bf16 v[80:83], a[204:207], v[176:179], v[80:83]
v_mfma_f32_16x16x32_bf16 v[80:83], a[196:199], v[144:147], v[80:83]
s_waitcnt vmcnt(27) lgkmcnt(0)
v_mfma_f32_16x16x32_bf16 v[64:67], a[160:163], a[16:19], v[64:67]
ds_read_b64_tr_b16 a[192:193], v10 offset:32768
v_mfma_f32_16x16x32_bf16 v[64:67], a[168:171], a[32:35], v[64:67]
ds_read_b64_tr_b16 a[194:195], v10 offset:36864
v_mfma_f32_16x16x32_bf16 v[64:67], a[176:179], a[48:51], v[64:67]
v_mfma_f32_16x16x32_bf16 v[64:67], a[184:187], a[64:67], v[64:67]
ds_read_b64_tr_b16 a[196:197], v11 offset:32768
v_mfma_f32_16x16x32_bf16 v[68:71], a[184:187], a[68:71], v[68:71]
v_mfma_f32_16x16x32_bf16 v[68:71], a[176:179], a[52:55], v[68:71]
ds_read_b64_tr_b16 a[198:199], v11 offset:36864
v_mfma_f32_16x16x32_bf16 v[68:71], a[168:171], a[36:39], v[68:71]
ds_read_b64_tr_b16 a[200:201], v10 offset:40960
v_mfma_f32_16x16x32_bf16 v[68:71], a[160:163], a[20:23], v[68:71]
v_mfma_f32_16x16x32_bf16 v[72:75], a[160:163], a[24:27], v[72:75]
ds_read_b64_tr_b16 a[202:203], v10 offset:45056
v_mfma_f32_16x16x32_bf16 v[72:75], a[168:171], a[40:43], v[72:75]
v_mfma_f32_16x16x32_bf16 v[72:75], a[176:179], a[56:59], v[72:75]
ds_read_b64_tr_b16 a[204:205], v11 offset:40960
v_mfma_f32_16x16x32_bf16 v[72:75], a[184:187], a[72:75], v[72:75]
ds_read_b64_tr_b16 a[206:207], v11 offset:45056
v_mfma_f32_16x16x32_bf16 v[76:79], a[184:187], a[76:79], v[76:79]
v_mfma_f32_16x16x32_bf16 v[76:79], a[176:179], a[60:63], v[76:79]
ds_read_b64_tr_b16 a[208:209], v10 offset:49152
v_mfma_f32_16x16x32_bf16 v[76:79], a[168:171], a[44:47], v[76:79]
v_mfma_f32_16x16x32_bf16 v[76:79], a[160:163], a[28:31], v[76:79]
ds_read_b64_tr_b16 a[210:211], v10 offset:53248
v_mfma_f32_16x16x32_bf16 v[92:95], a[164:167], a[28:31], v[92:95]
ds_read_b64_tr_b16 a[212:213], v11 offset:49152
v_mfma_f32_16x16x32_bf16 v[92:95], a[172:175], a[44:47], v[92:95]
v_mfma_f32_16x16x32_bf16 v[92:95], a[180:183], a[60:63], v[92:95]
ds_read_b64_tr_b16 a[214:215], v11 offset:53248
v_mfma_f32_16x16x32_bf16 v[92:95], a[188:191], a[76:79], v[92:95]
v_mfma_f32_16x16x32_bf16 v[88:91], a[188:191], a[72:75], v[88:91]
ds_read_b64_tr_b16 a[216:217], v10 offset:57344
v_mfma_f32_16x16x32_bf16 v[88:91], a[180:183], a[56:59], v[88:91]
ds_read_b64_tr_b16 a[218:219], v10 offset:61440
v_mfma_f32_16x16x32_bf16 v[88:91], a[172:175], a[40:43], v[88:91]
v_mfma_f32_16x16x32_bf16 v[88:91], a[164:167], a[24:27], v[88:91]
ds_read_b64_tr_b16 a[220:221], v11 offset:57344
v_mfma_f32_16x16x32_bf16 v[84:87], a[164:167], a[20:23], v[84:87]
s_lshl_b32 s4, s69, 15
s_and_b32 s39, s37, 7
s_lshl_b32 s39, s39, 8
s_add_u32 s4, s4, s39
s_lshr_b32 s39, s37, 3
s_lshl_b32 s39, s39, 6
s_add_u32 s4, s4, s39
v_mfma_f32_16x16x32_bf16 v[84:87], a[172:175], a[36:39], v[84:87]
ds_read_b64_tr_b16 a[222:223], v11 offset:61440
v_mfma_f32_16x16x32_bf16 v[84:87], a[180:183], a[52:55], v[84:87]
v_mfma_f32_16x16x32_bf16 v[84:87], a[188:191], a[68:71], v[84:87]
v_mfma_f32_16x16x32_bf16 v[80:83], a[188:191], a[64:67], v[80:83]
v_mfma_f32_16x16x32_bf16 v[80:83], a[180:183], a[48:51], v[80:83]
v_mfma_f32_16x16x32_bf16 v[80:83], a[172:175], a[32:35], v[80:83]
v_mfma_f32_16x16x32_bf16 v[80:83], a[164:167], a[16:19], v[80:83]
s_add_u32 s5, s4, 32768
s_add_u32 s6, s4, 65536
s_add_u32 s7, s4, 98304
s_waitcnt vmcnt(9) lgkmcnt(0)
v_mfma_f32_16x16x32_bf16 v[64:67], a[192:195], a[80:83], v[64:67]
ds_read_b64_tr_b16 a[160:161], v4 offset:0
v_mfma_f32_16x16x32_bf16 v[64:67], a[200:203], a[96:99], v[64:67]
ds_read_b64_tr_b16 a[162:163], v4 offset:4096
v_mfma_f32_16x16x32_bf16 v[64:67], a[208:211], a[112:115], v[64:67]
buffer_load_dwordx4 v[160:163], v3, s[12:15], s95 offen offset:0 sc1
v_mfma_f32_16x16x32_bf16 v[64:67], a[216:219], a[128:131], v[64:67]
v_mfma_f32_16x16x32_bf16 v[68:71], a[216:219], a[132:135], v[68:71]
ds_read_b64_tr_b16 a[164:165], v5 offset:0
v_mfma_f32_16x16x32_bf16 v[68:71], a[208:211], a[116:119], v[68:71]
ds_read_b64_tr_b16 a[166:167], v5 offset:4096
v_mfma_f32_16x16x32_bf16 v[68:71], a[200:203], a[100:103], v[68:71]
ds_read_b64_tr_b16 a[168:169], v4 offset:8192
v_mfma_f32_16x16x32_bf16 v[68:71], a[192:195], a[84:87], v[68:71]
v_mfma_f32_16x16x32_bf16 v[72:75], a[192:195], a[88:91], v[72:75]
ds_read_b64_tr_b16 a[170:171], v4 offset:12288
v_mfma_f32_16x16x32_bf16 v[72:75], a[200:203], a[104:107], v[72:75]
buffer_load_dwordx4 v[164:167], v3, s[12:15], s95 offen offset:1024 sc1
v_mfma_f32_16x16x32_bf16 v[72:75], a[208:211], a[120:123], v[72:75]
ds_read_b64_tr_b16 a[172:173], v5 offset:8192
v_mfma_f32_16x16x32_bf16 v[72:75], a[216:219], a[136:139], v[72:75]
v_mfma_f32_16x16x32_bf16 v[76:79], a[216:219], a[140:143], v[76:79]
ds_read_b64_tr_b16 a[174:175], v5 offset:12288
v_mfma_f32_16x16x32_bf16 v[76:79], a[208:211], a[124:127], v[76:79]
ds_read_b64_tr_b16 a[176:177], v4 offset:16384
v_mfma_f32_16x16x32_bf16 v[76:79], a[200:203], a[108:111], v[76:79]
ds_read_b64_tr_b16 a[178:179], v4 offset:20480
v_mfma_f32_16x16x32_bf16 v[76:79], a[192:195], a[92:95], v[76:79]
v_mfma_f32_16x16x32_bf16 v[92:95], a[196:199], a[92:95], v[92:95]
buffer_load_dwordx4 v[168:171], v3, s[12:15], s95 offen offset:2048 sc1
v_mfma_f32_16x16x32_bf16 v[92:95], a[204:207], a[108:111], v[92:95]
ds_read_b64_tr_b16 a[180:181], v5 offset:16384
v_mfma_f32_16x16x32_bf16 v[92:95], a[212:215], a[124:127], v[92:95]
ds_read_b64_tr_b16 a[182:183], v5 offset:20480
v_mfma_f32_16x16x32_bf16 v[92:95], a[220:223], a[140:143], v[92:95]
v_mfma_f32_16x16x32_bf16 v[88:91], a[220:223], a[136:139], v[88:91]
ds_read_b64_tr_b16 a[184:185], v4 offset:24576
v_mfma_f32_16x16x32_bf16 v[88:91], a[212:215], a[120:123], v[88:91]
ds_read_b64_tr_b16 a[186:187], v4 offset:28672
v_mfma_f32_16x16x32_bf16 v[88:91], a[204:207], a[104:107], v[88:91]
buffer_load_dwordx4 v[172:175], v3, s[12:15], s95 offen offset:3072 sc1
v_mfma_f32_16x16x32_bf16 v[88:91], a[196:199], a[88:91], v[88:91]
v_mfma_f32_16x16x32_bf16 v[84:87], a[196:199], a[84:87], v[84:87]
ds_read_b64_tr_b16 a[188:189], v5 offset:24576
v_mfma_f32_16x16x32_bf16 v[84:87], a[204:207], a[100:103], v[84:87]
ds_read_b64_tr_b16 a[190:191], v5 offset:28672
v_mfma_f32_16x16x32_bf16 v[84:87], a[212:215], a[116:119], v[84:87]
v_mfma_f32_16x16x32_bf16 v[84:87], a[220:223], a[132:135], v[84:87]
v_mfma_f32_16x16x32_bf16 v[80:83], a[220:223], a[128:131], v[80:83]
v_mfma_f32_16x16x32_bf16 v[80:83], a[212:215], a[112:115], v[80:83]
v_mfma_f32_16x16x32_bf16 v[80:83], a[204:207], a[96:99], v[80:83]
v_mfma_f32_16x16x32_bf16 v[80:83], a[196:199], a[80:83], v[80:83]
s_waitcnt lgkmcnt(0)
v_mfma_f32_16x16x32_bf16 v[32:35], a[160:163], a[144:147], v[32:35]
ds_read_b64_tr_b16 a[192:193], v4 offset:32768
v_mfma_f32_16x16x32_bf16 v[32:35], a[168:171], v[192:195], v[32:35]
ds_read_b64_tr_b16 a[194:195], v4 offset:36864
v_mfma_f32_16x16x32_bf16 v[32:35], a[176:179], v[224:227], v[32:35]
buffer_load_dwordx4 v[112:115], v1, s[12:15], s64 offen offset:0 sc1
v_mfma_f32_16x16x32_bf16 v[32:35], a[184:187], v[240:243], v[32:35]
s_xor_b32 s40, s88, 1024
s_xor_b32 s41, s89, 1024
s_xor_b32 s42, s90, 1024
s_xor_b32 s43, s91, 1024
v_mfma_f32_16x16x32_bf16 v[36:39], a[184:187], v[244:247], v[36:39]
ds_read_b64_tr_b16 a[196:197], v5 offset:32768
v_cvt_pk_bf16_f32 v64, v64, v65
v_mfma_f32_16x16x32_bf16 v[36:39], a[176:179], v[228:231], v[36:39]
ds_read_b64_tr_b16 a[198:199], v5 offset:36864
v_cvt_pk_bf16_f32 v65, v66, v67
v_mfma_f32_16x16x32_bf16 v[36:39], a[168:171], v[196:199], v[36:39]
ds_read_b64_tr_b16 a[200:201], v4 offset:40960
v_xor_b32 v64, s63, v64
v_mfma_f32_16x16x32_bf16 v[36:39], a[160:163], a[148:151], v[36:39]
v_cvt_pk_bf16_f32 v66, v80, v81
v_cvt_pk_bf16_f32 v67, v82, v83
v_mfma_f32_16x16x32_bf16 v[40:43], a[160:163], a[152:155], v[40:43]
ds_read_b64_tr_b16 a[202:203], v4 offset:45056
buffer_store_dwordx4 v[64:67], v1, s[12:15], s40 offen
v_mfma_f32_16x16x32_bf16 v[40:43], a[168:171], v[200:203], v[40:43]
buffer_load_dwordx4 v[116:119], v1, s[12:15], s64 offen offset:1024 sc1
v_cvt_pk_bf16_f32 v68, v68, v69
v_mfma_f32_16x16x32_bf16 v[40:43], a[176:179], v[232:235], v[40:43]
ds_read_b64_tr_b16 a[204:205], v5 offset:40960
v_cvt_pk_bf16_f32 v69, v70, v71
v_mfma_f32_16x16x32_bf16 v[40:43], a[184:187], v[248:251], v[40:43]
v_xor_b32 v68, s63, v68
v_cvt_pk_bf16_f32 v70, v84, v85
v_mfma_f32_16x16x32_bf16 v[44:47], a[184:187], v[252:255], v[44:47]
ds_read_b64_tr_b16 a[206:207], v5 offset:45056
v_cvt_pk_bf16_f32 v71, v86, v87
v_mfma_f32_16x16x32_bf16 v[44:47], a[176:179], v[236:239], v[44:47]
ds_read_b64_tr_b16 a[208:209], v4 offset:49152
buffer_store_dwordx4 v[68:71], v1, s[12:15], s41 offen
v_mfma_f32_16x16x32_bf16 v[44:47], a[168:171], v[204:207], v[44:47]
ds_read_b64_tr_b16 a[210:211], v4 offset:53248
v_cvt_pk_bf16_f32 v72, v72, v73
v_mfma_f32_16x16x32_bf16 v[44:47], a[160:163], a[156:159], v[44:47]
v_cvt_pk_bf16_f32 v73, v74, v75
v_xor_b32 v72, s63, v72
v_mfma_f32_16x16x32_bf16 v[60:63], a[164:167], a[156:159], v[60:63]
buffer_load_dwordx4 v[120:123], v1, s[12:15], s55 offen offset:0 sc1
v_cvt_pk_bf16_f32 v74, v88, v89
v_mfma_f32_16x16x32_bf16 v[60:63], a[172:175], v[204:207], v[60:63]
ds_read_b64_tr_b16 a[212:213], v5 offset:49152
v_cvt_pk_bf16_f32 v75, v90, v91
v_mfma_f32_16x16x32_bf16 v[60:63], a[180:183], v[236:239], v[60:63]
ds_read_b64_tr_b16 a[214:215], v5 offset:53248
buffer_store_dwordx4 v[72:75], v1, s[12:15], s42 offen
v_mfma_f32_16x16x32_bf16 v[60:63], a[188:191], v[252:255], v[60:63]
v_cvt_pk_bf16_f32 v76, v76, v77
v_cvt_pk_bf16_f32 v77, v78, v79
v_mfma_f32_16x16x32_bf16 v[56:59], a[188:191], v[248:251], v[56:59]
ds_read_b64_tr_b16 a[216:217], v4 offset:57344
v_xor_b32 v76, s63, v76
v_mfma_f32_16x16x32_bf16 v[56:59], a[180:183], v[232:235], v[56:59]
ds_read_b64_tr_b16 a[218:219], v4 offset:61440
v_cvt_pk_bf16_f32 v78, v92, v93
v_mfma_f32_16x16x32_bf16 v[56:59], a[172:175], v[200:203], v[56:59]
buffer_load_dwordx4 v[124:127], v1, s[12:15], s55 offen offset:1024 sc1
v_cvt_pk_bf16_f32 v79, v94, v95
v_mfma_f32_16x16x32_bf16 v[56:59], a[164:167], a[152:155], v[56:59]
buffer_store_dwordx4 v[76:79], v1, s[12:15], s43 offen
s_cmp_lg_u32 s99, 0
s_cbranch_scc1 L_s1
L_s1x:
v_mfma_f32_16x16x32_bf16 v[52:55], a[164:167], a[148:151], v[52:55]
ds_read_b64_tr_b16 a[220:221], v5 offset:57344
v_mfma_f32_16x16x32_bf16 v[52:55], a[172:175], v[196:199], v[52:55]
ds_read_b64_tr_b16 a[222:223], v5 offset:61440
v_mfma_f32_16x16x32_bf16 v[52:55], a[180:183], v[228:231], v[52:55]
v_mfma_f32_16x16x32_bf16 v[52:55], a[188:191], v[244:247], v[52:55]
v_mfma_f32_16x16x32_bf16 v[48:51], a[188:191], v[240:243], v[48:51]
v_mfma_f32_16x16x32_bf16 v[48:51], a[180:183], v[224:227], v[48:51]
v_mfma_f32_16x16x32_bf16 v[48:51], a[172:175], v[192:195], v[48:51]
v_mfma_f32_16x16x32_bf16 v[48:51], a[164:167], a[144:147], v[48:51]
s_waitcnt lgkmcnt(0)
v_mfma_f32_16x16x32_bf16 v[32:35], a[192:195], v[144:147], v[32:35]
ds_read_b64_tr_b16 a[160:161], v8 offset:0
s_waitcnt vmcnt(8)
v_mfma_f32_16x16x32_bf16 v[32:35], a[200:203], v[176:179], v[32:35]
ds_read_b64_tr_b16 a[162:163], v8 offset:4096
v_perm_b32 v19, v161, v160, s92
v_mfma_f32_16x16x32_bf16 v[32:35], a[208:211], v[208:211], v[32:35]
v_perm_b32 v19, v162, v19, s93
v_perm_b32 v19, v163, v19, s94
v_mfma_f32_16x16x32_bf16 v[32:35], a[216:219], a[0:3], v[32:35]
ds_read_b64_tr_b16 a[164:165], v9 offset:0
v_cmp_eq_u32 vcc, s63, v19
v_mfma_f32_16x16x32_bf16 v[36:39], a[216:219], a[4:7], v[36:39]
v_perm_b32 v19, v165, v164, s92
v_mfma_f32_16x16x32_bf16 v[36:39], a[208:211], v[212:215], v[36:39]
ds_read_b64_tr_b16 a[166:167], v9 offset:4096
v_perm_b32 v19, v166, v19, s93
v_mfma_f32_16x16x32_bf16 v[36:39], a[200:203], v[180:183], v[36:39]
ds_read_b64_tr_b16 a[168:169], v8 offset:8192
v_perm_b32 v19, v167, v19, s94
v_mfma_f32_16x16x32_bf16 v[36:39], a[192:195], v[148:151], v[36:39]
v_cmp_eq_u32 s[8:9], s63, v19
s_or_b64 vcc, vcc, s[8:9]
v_mfma_f32_16x16x32_bf16 v[40:43], a[192:195], v[152:155], v[40:43]
ds_read_b64_tr_b16 a[170:171], v8 offset:12288
v_perm_b32 v19, v169, v168, s92
v_mfma_f32_16x16x32_bf16 v[40:43], a[200:203], v[184:187], v[40:43]
v_perm_b32 v19, v170, v19, s93
v_perm_b32 v19, v171, v19, s94
v_mfma_f32_16x16x32_bf16 v[40:43], a[208:211], v[216:219], v[40:43]
ds_read_b64_tr_b16 a[172:173], v9 offset:8192
v_cmp_eq_u32 s[8:9], s63, v19
s_or_b64 vcc, vcc, s[8:9]
v_mfma_f32_16x16x32_bf16 v[40:43], a[216:219], a[8:11], v[40:43]
ds_read_b64_tr_b16 a[174:175], v9 offset:12288
v_perm_b32 v19, v173, v172, s92
v_mfma_f32_16x16x32_bf16 v[44:47], a[216:219], a[12:15], v[44:47]
v_perm_b32 v19, v174, v19, s93
v_mfma_f32_16x16x32_bf16 v[44:47], a[208:211], v[220:223], v[44:47]
ds_read_b64_tr_b16 a[176:177], v8 offset:16384
v_perm_b32 v19, v175, v19, s94
v_mfma_f32_16x16x32_bf16 v[44:47], a[200:203], v[188:191], v[44:47]
v_cmp_eq_u32 s[8:9], s63, v19
s_or_b64 vcc, vcc, s[8:9]
s_cbranch_vccnz L_rt3
L_ok3:
v_mfma_f32_16x16x32_bf16 v[44:47], a[192:195], v[156:159], v[44:47]
ds_read_b64_tr_b16 a[178:179], v8 offset:20480
v_lshlrev_b32 v96, 16, v160
v_mfma_f32_16x16x32_bf16 v[60:63], a[196:199], v[156:159], v[60:63]
ds_read_b64_tr_b16 a[180:181], v9 offset:16384
v_and_b32 v97, 0xffff0000, v160
v_mfma_f32_16x16x32_bf16 v[60:63], a[204:207], v[188:191], v[60:63]
v_lshlrev_b32 v98, 16, v161
v_and_b32 v99, 0xffff0000, v161
v_mfma_f32_16x16x32_bf16 v[60:63], a[212:215], v[220:223], v[60:63]
ds_read_b64_tr_b16 a[182:183], v9 offset:20480
v_lshlrev_b32 v128, 16, v162
v_mfma_f32_16x16x32_bf16 v[60:63], a[220:223], a[12:15], v[60:63]
v_and_b32 v129, 0xffff0000, v162
v_mfma_f32_16x16x32_bf16 v[56:59], a[220:223], a[8:11], v[56:59]
ds_read_b64_tr_b16 a[184:185], v8 offset:24576
v_lshlrev_b32 v130, 16, v163
v_mfma_f32_16x16x32_bf16 v[56:59], a[212:215], v[216:219], v[56:59]
ds_read_b64_tr_b16 a[186:187], v8 offset:28672
v_and_b32 v131, 0xffff0000, v163
v_mfma_f32_16x16x32_bf16 v[56:59], a[204:207], v[184:187], v[56:59]
v_lshlrev_b32 v100, 16, v164
v_and_b32 v101, 0xffff0000, v164
v_mfma_f32_16x16x32_bf16 v[56:59], a[196:199], v[152:155], v[56:59]
ds_read_b64_tr_b16 a[188:189], v9 offset:24576
v_lshlrev_b32 v102, 16, v165
v_mfma_f32_16x16x32_bf16 v[52:55], a[196:199], v[148:151], v[52:55]
v_and_b32 v103, 0xffff0000, v165
v_lshlrev_b32 v132, 16, v166
v_mfma_f32_16x16x32_bf16 v[52:55], a[204:207], v[180:183], v[52:55]
ds_read_b64_tr_b16 a[190:191], v9 offset:28672
v_and_b32 v133, 0xffff0000, v166
v_mfma_f32_16x16x32_bf16 v[52:55], a[212:215], v[212:215], v[52:55]
v_lshlrev_b32 v134, 16, v167
v_mfma_f32_16x16x32_bf16 v[52:55], a[220:223], a[4:7], v[52:55]
v_and_b32 v135, 0xffff0000, v167
v_lshlrev_b32 v104, 16, v168
v_mfma_f32_16x16x32_bf16 v[48:51], a[220:223], a[0:3], v[48:51]
v_and_b32 v105, 0xffff0000, v168
v_lshlrev_b32 v106, 16, v169
v_mfma_f32_16x16x32_bf16 v[48:51], a[212:215], v[208:211], v[48:51]
v_and_b32 v107, 0xffff0000, v169
v_lshlrev_b32 v136, 16, v170
v_mfma_f32_16x16x32_bf16 v[48:51], a[204:207], v[176:179], v[48:51]
v_and_b32 v137, 0xffff0000, v170
v_lshlrev_b32 v138, 16, v171
v_mfma_f32_16x16x32_bf16 v[48:51], a[196:199], v[144:147], v[48:51]
v_and_b32 v139, 0xffff0000, v171
v_lshlrev_b32 v108, 16, v172
s_waitcnt lgkmcnt(0)
v_mfma_f32_16x16x32_bf16 v[32:35], a[160:163], a[16:19], v[32:35]
ds_read_b64_tr_b16 a[192:193], v8 offset:32768
v_mfma_f32_16x16x32_bf16 v[32:35], a[168:171], a[32:35], v[32:35]
ds_read_b64_tr_b16 a[194:195], v8 offset:36864
v_and_b32 v109, 0xffff0000, v172
v_mfma_f32_16x16x32_bf16 v[32:35], a[176:179], a[48:51], v[32:35]
v_lshlrev_b32 v110, 16, v173
v_and_b32 v111, 0xffff0000, v173
v_mfma_f32_16x16x32_bf16 v[32:35], a[184:187], a[64:67], v[32:35]
ds_read_b64_tr_b16 a[196:197], v9 offset:32768
v_lshlrev_b32 v140, 16, v174
v_mfma_f32_16x16x32_bf16 v[36:39], a[184:187], a[68:71], v[36:39]
v_and_b32 v141, 0xffff0000, v174
v_lshlrev_b32 v142, 16, v175
v_mfma_f32_16x16x32_bf16 v[36:39], a[176:179], a[52:55], v[36:39]
ds_read_b64_tr_b16 a[198:199], v9 offset:36864
v_and_b32 v143, 0xffff0000, v175
s_waitcnt vmcnt(1)
v_mfma_f32_16x16x32_bf16 v[36:39], a[168:171], a[36:39], v[36:39]
ds_read_b64_tr_b16 a[200:201], v8 offset:40960
v_cmp_eq_u32 vcc, v112, v28
v_mfma_f32_16x16x32_bf16 v[36:39], a[160:163], a[20:23], v[36:39]
v_cmp_eq_u32 s[48:49], v116, v29
v_mfma_f32_16x16x32_bf16 v[40:43], a[160:163], a[24:27], v[40:43]
ds_read_b64_tr_b16 a[202:203], v8 offset:45056
v_cmp_eq_u32 s[50:51], v120, v30
v_mfma_f32_16x16x32_bf16 v[40:43], a[168:171], a[40:43], v[40:43]
v_cmp_eq_u32 s[52:53], v124, v31
s_or_b64 vcc, vcc, s[48:49]
s_or_b64 s[50:51], s[50:51], s[52:53]
s_or_b64 vcc, vcc, s[50:51]
v_mfma_f32_16x16x32_bf16 v[40:43], a[176:179], a[56:59], v[40:43]
ds_read_b64_tr_b16 a[204:205], v9 offset:40960
s_cbranch_vccnz L_rt2
L_ok2:
v_mfma_f32_16x16x32_bf16 v[40:43], a[184:187], a[72:75], v[40:43]
ds_read_b64_tr_b16 a[206:207], v9 offset:45056
v_xor_b32 v112, s63, v112
v_mfma_f32_16x16x32_bf16 v[44:47], a[184:187], a[76:79], v[44:47]
v_xor_b32 v116, s63, v116
v_xor_b32 v120, s63, v120
v_mfma_f32_16x16x32_bf16 v[44:47], a[176:179], a[60:63], v[44:47]
ds_read_b64_tr_b16 a[208:209], v8 offset:49152
v_xor_b32 v124, s63, v124
v_mfma_f32_16x16x32_bf16 v[44:47], a[168:171], a[44:47], v[44:47]
v_lshlrev_b32 v160, 16, v112
v_and_b32 v112, 0xffff0000, v112
v_mfma_f32_16x16x32_bf16 v[44:47], a[160:163], a[28:31], v[44:47]
ds_read_b64_tr_b16 a[210:211], v8 offset:53248
v_add_f32 v96, v96, v160
v_mfma_f32_16x16x32_bf16 v[60:63], a[164:167], a[28:31], v[60:63]
ds_read_b64_tr_b16 a[212:213], v9 offset:49152
v_add_f32 v97, v97, v112
v_mfma_f32_16x16x32_bf16 v[60:63], a[172:175], a[44:47], v[60:63]
v_lshlrev_b32 v161, 16, v113
v_and_b32 v113, 0xffff0000, v113
v_mfma_f32_16x16x32_bf16 v[60:63], a[180:183], a[60:63], v[60:63]
ds_read_b64_tr_b16 a[214:215], v9 offset:53248
v_add_f32 v98, v98, v161
v_mfma_f32_16x16x32_bf16 v[60:63], a[188:191], a[76:79], v[60:63]
v_add_f32 v99, v99, v113
v_lshlrev_b32 v162, 16, v114
v_mfma_f32_16x16x32_bf16 v[56:59], a[188:191], a[72:75], v[56:59]
ds_read_b64_tr_b16 a[216:217], v8 offset:57344
v_mfma_f32_16x16x32_bf16 v[56:59], a[180:183], a[56:59], v[56:59]
ds_read_b64_tr_b16 a[218:219], v8 offset:61440
v_and_b32 v114, 0xffff0000, v114
v_mfma_f32_16x16x32_bf16 v[56:59], a[172:175], a[40:43], v[56:59]
v_add_f32 v128, v128, v162
v_add_f32 v129, v129, v114
v_mfma_f32_16x16x32_bf16 v[56:59], a[164:167], a[24:27], v[56:59]
ds_read_b64_tr_b16 a[220:221], v9 offset:57344
v_lshlrev_b32 v163, 16, v115
v_mfma_f32_16x16x32_bf16 v[52:55], a[164:167], a[20:23], v[52:55]
v_and_b32 v115, 0xffff0000, v115
v_add_f32 v130, v130, v163
v_mfma_f32_16x16x32_bf16 v[52:55], a[172:175], a[36:39], v[52:55]
ds_read_b64_tr_b16 a[222:223], v9 offset:61440
v_add_f32 v131, v131, v115
v_mfma_f32_16x16x32_bf16 v[52:55], a[180:183], a[52:55], v[52:55]
v_lshlrev_b32 v164, 16, v116
v_and_b32 v116, 0xffff0000, v116
v_mfma_f32_16x16x32_bf16 v[52:55], a[188:191], a[68:71], v[52:55]
v_add_f32 v100, v100, v164
v_add_f32 v101, v101, v116
v_mfma_f32_16x16x32_bf16 v[48:51], a[188:191], a[64:67], v[48:51]
v_lshlrev_b32 v165, 16, v117
v_and_b32 v117, 0xffff0000, v117
v_mfma_f32_16x16x32_bf16 v[48:51], a[180:183], a[48:51], v[48:51]
v_add_f32 v102, v102, v165
v_add_f32 v103, v103, v117
v_mfma_f32_16x16x32_bf16 v[48:51], a[172:175], a[32:35], v[48:51]
v_lshlrev_b32 v166, 16, v118
v_and_b32 v118, 0xffff0000, v118
v_mfma_f32_16x16x32_bf16 v[48:51], a[164:167], a[16:19], v[48:51]
v_add_f32 v132, v132, v166
v_add_f32 v133, v133, v118
s_waitcnt lgkmcnt(0)
v_mfma_f32_16x16x32_bf16 v[32:35], a[192:195], a[80:83], v[32:35]
buffer_load_dwordx4 v[80:83], v1, s[12:15], s88 offen sc1
v_mfma_f32_16x16x32_bf16 v[32:35], a[200:203], a[96:99], v[32:35]
v_lshlrev_b32 v167, 16, v119
v_mfma_f32_16x16x32_bf16 v[32:35], a[208:211], a[112:115], v[32:35]
v_and_b32 v119, 0xffff0000, v119
v_add_f32 v134, v134, v167
v_mfma_f32_16x16x32_bf16 v[32:35], a[216:219], a[128:131], v[32:35]
v_add_f32 v135, v135, v119
v_mfma_f32_16x16x32_bf16 v[36:39], a[216:219], a[132:135], v[36:39]
v_lshlrev_b32 v168, 16, v120
v_mfma_f32_16x16x32_bf16 v[36:39], a[208:211], a[116:119], v[36:39]
v_and_b32 v120, 0xffff0000, v120
v_mfma_f32_16x16x32_bf16 v[36:39], a[200:203], a[100:103], v[36:39]
v_add_f32 v104, v104, v168
v_mfma_f32_16x16x32_bf16 v[36:39], a[192:195], a[84:87], v[36:39]
buffer_load_dwordx4 v[84:87], v1, s[12:15], s89 offen sc1
v_add_f32 v105, v105, v120
v_mfma_f32_16x16x32_bf16 v[40:43], a[192:195], a[88:91], v[40:43]
v_lshlrev_b32 v169, 16, v121
v_mfma_f32_16x16x32_bf16 v[40:43], a[200:203], a[104:107], v[40:43]
v_and_b32 v121, 0xffff0000, v121
v_mfma_f32_16x16x32_bf16 v[40:43], a[208:211], a[120:123], v[40:43]
v_add_f32 v106, v106, v169
v_add_f32 v107, v107, v121
v_mfma_f32_16x16x32_bf16 v[40:43], a[216:219], a[136:139], v[40:43]
v_lshlrev_b32 v170, 16, v122
v_mfma_f32_16x16x32_bf16 v[44:47], a[216:219], a[140:143], v[44:47]
v_and_b32 v122, 0xffff0000, v122
v_mfma_f32_16x16x32_bf16 v[44:47], a[208:211], a[124:127], v[44:47]
v_add_f32 v136, v136, v170
v_mfma_f32_16x16x32_bf16 v[44:47], a[200:203], a[108:111], v[44:47]
v_add_f32 v137, v137, v122
v_mfma_f32_16x16x32_bf16 v[44:47], a[192:195], a[92:95], v[44:47]
buffer_load_dwordx4 v[88:91], v1, s[12:15], s90 offen sc1
v_lshlrev_b32 v171, 16, v123
v_mfma_f32_16x16x32_bf16 v[60:63], a[196:199], a[92:95], v[60:63]
v_and_b32 v123, 0xffff0000, v123
v_mfma_f32_16x16x32_bf16 v[60:63], a[204:207], a[108:111], v[60:63]
v_add_f32 v138, v138, v171
v_mfma_f32_16x16x32_bf16 v[60:63], a[212:215], a[124:127], v[60:63]
v_add_f32 v139, v139, v123
v_lshlrev_b32 v172, 16, v124
v_mfma_f32_16x16x32_bf16 v[60:63], a[220:223], a[140:143], v[60:63]
v_and_b32 v124, 0xffff0000, v124
v_mfma_f32_16x16x32_bf16 v[56:59], a[220:223], a[136:139], v[56:59]
v_add_f32 v108, v108, v172
v_mfma_f32_16x16x32_bf16 v[56:59], a[212:215], a[120:123], v[56:59]
v_add_f32 v109, v109, v124
v_mfma_f32_16x16x32_bf16 v[56:59], a[204:207], a[104:107], v[56:59]
v_lshlrev_b32 v173, 16, v125
v_mfma_f32_16x16x32_bf16 v[56:59], a[196:199], a[88:91], v[56:59]
buffer_load_dwordx4 v[92:95], v1, s[12:15], s91 offen sc1
v_and_b32 v125, 0xffff0000, v125
v_mfma_f32_16x16x32_bf16 v[52:55], a[196:199], a[84:87], v[52:55]
v_add_f32 v110, v110, v173
v_mfma_f32_16x16x32_bf16 v[52:55], a[204:207], a[100:103], v[52:55]
v_add_f32 v111, v111, v125
v_mfma_f32_16x16x32_bf16 v[52:55], a[212:215], a[116:119], v[52:55]
v_lshlrev_b32 v174, 16, v126
v_and_b32 v126, 0xffff0000, v126
v_mfma_f32_16x16x32_bf16 v[52:55], a[220:223], a[132:135], v[52:55]
v_add_f32 v140, v140, v174
v_mfma_f32_16x16x32_bf16 v[48:51], a[220:223], a[128:131], v[48:51]
v_add_f32 v141, v141, v126
v_mfma_f32_16x16x32_bf16 v[48:51], a[212:215], a[112:115], v[48:51]
v_lshlrev_b32 v175, 16, v127
v_mfma_f32_16x16x32_bf16 v[48:51], a[204:207], a[96:99], v[48:51]
v_and_b32 v127, 0xffff0000, v127
v_mfma_f32_16x16x32_bf16 v[48:51], a[196:199], a[80:83], v[48:51]
v_add_f32 v142, v142, v175
v_add_f32 v143, v143, v127
v_pk_add_f32 v[96:97], v[96:97], v[32:33]
v_pk_add_f32 v[98:99], v[98:99], v[34:35]
s_nop 3
v_pk_add_f32 v[128:129], v[128:129], v[48:49]
v_pk_add_f32 v[130:131], v[130:131], v[50:51]
v_pk_add_f32 v[100:101], v[100:101], v[36:37]
v_pk_add_f32 v[102:103], v[102:103], v[38:39]
v_pk_add_f32 v[132:133], v[132:133], v[52:53]
v_pk_add_f32 v[134:135], v[134:135], v[54:55]
v_pk_add_f32 v[104:105], v[104:105], v[40:41]
v_pk_add_f32 v[106:107], v[106:107], v[42:43]
v_pk_add_f32 v[136:137], v[136:137], v[56:57]
v_pk_add_f32 v[138:139], v[138:139], v[58:59]
v_pk_add_f32 v[108:109], v[108:109], v[44:45]
v_pk_add_f32 v[110:111], v[110:111], v[46:47]
v_pk_add_f32 v[140:141], v[140:141], v[60:61]
v_pk_add_f32 v[142:143], v[142:143], v[62:63]
s_waitcnt vmcnt(0)
v_cmp_eq_u32 vcc, v80, v24
v_cmp_eq_u32 s[48:49], v84, v25
v_cmp_eq_u32 s[50:51], v88, v26
v_cmp_eq_u32 s[52:53], v92, v27
s_or_b64 vcc, vcc, s[48:49]
s_or_b64 s[50:51], s[50:51], s[52:53]
s_or_b64 vcc, vcc, s[50:51]
s_cbranch_vccnz L_rt1
L_ok1:
v_xor_b32 v80, s63, v80
v_xor_b32 v84, s63, v84
v_xor_b32 v88, s63, v88
v_xor_b32 v92, s63, v92
v_lshlrev_b32 v32, 16, v80
v_and_b32 v33, 0xffff0000, v80
v_lshlrev_b32 v34, 16, v81
v_and_b32 v35, 0xffff0000, v81
v_lshlrev_b32 v48, 16, v82
v_and_b32 v49, 0xffff0000, v82
v_lshlrev_b32 v50, 16, v83
v_and_b32 v51, 0xffff0000, v83
v_pk_add_f32 v[96:97], v[96:97], v[32:33]
v_pk_add_f32 v[98:99], v[98:99], v[34:35]
v_pk_add_f32 v[128:129], v[128:129], v[48:49]
v_pk_add_f32 v[130:131], v[130:131], v[50:51]
v_cvt_pk_bf16_f32 v64, v96, v97
v_cvt_pk_bf16_f32 v65, v98, v99
v_cvt_pk_bf16_f32 v66, v128, v129
v_cvt_pk_bf16_f32 v67, v130, v131
s_nop 0
v_permlane16_swap_b32 v64, v66
v_permlane16_swap_b32 v65, v67
buffer_store_dwordx4 v[64:67], v23, s[24:27], s4 offen sc1
v_lshlrev_b32 v36, 16, v84
v_and_b32 v37, 0xffff0000, v84
v_lshlrev_b32 v38, 16, v85
v_and_b32 v39, 0xffff0000, v85
v_lshlrev_b32 v52, 16, v86
v_and_b32 v53, 0xffff0000, v86
v_lshlrev_b32_e64 v54, 16, v87
v_and_b32 v55, 0xffff0000, v87
v_pk_add_f32 v[100:101], v[100:101], v[36:37]
v_pk_add_f32 v[102:103], v[102:103], v[38:39]
v_pk_add_f32 v[132:133], v[132:133], v[52:53]
L_wp25:
s_cbranch_execz L_wr4
v_pk_add_f32 v[134:135], v[134:135], v[54:55]
v_cvt_pk_bf16_f32 v68, v100, v101
v_cvt_pk_bf16_f32 v69, v102, v103
v_cvt_pk_bf16_f32 v70, v132, v133
v_cvt_pk_bf16_f32 v71, v134, v135
s_nop 0
v_permlane16_swap_b32 v68, v70
v_permlane16_swap_b32 v69, v71
buffer_store_dwordx4 v[68:71], v23, s[24:27], s5 offen sc1
v_lshlrev_b32 v40, 16, v88
v_and_b32 v41, 0xffff0000, v88
v_lshlrev_b32 v42, 16, v89
v_and_b32 v43, 0xffff0000, v89
v_lshlrev_b32 v56, 16, v90
v_and_b32 v57, 0xffff0000, v90
v_lshlrev_b32 v58, 16, v91
v_and_b32 v59, 0xffff0000, v91
v_pk_add_f32 v[104:105], v[104:105], v[40:41]
v_pk_add_f32 v[106:107], v[106:107], v[42:43]
v_pk_add_f32 v[136:137], v[136:137], v[56:57]
v_pk_add_f32 v[138:139], v[138:139], v[58:59]
v_cvt_pk_bf16_f32 v72, v104, v105
v_cvt_pk_bf16_f32 v73, v106, v107
v_cvt_pk_bf16_f32 v74, v136, v137
v_cvt_pk_bf16_f32 v75, v138, v139
s_nop 0
v_permlane16_swap_b32 v72, v74
v_permlane16_swap_b32 v73, v75
buffer_store_dwordx4 v[72:75], v23, s[24:27], s6 offen sc1
v_lshlrev_b32 v44, 16, v92
v_and_b32 v45, 0xffff0000, v92
v_lshlrev_b32 v46, 16, v93
v_and_b32 v47, 0xffff0000, v93
v_lshlrev_b32 v60, 16, v94
v_and_b32 v61, 0xffff0000, v94
v_lshlrev_b32_e64 v62, 16, v95
v_and_b32 v63, 0xffff0000, v95
v_pk_add_f32 v[108:109], v[108:109], v[44:45]
v_pk_add_f32 v[110:111], v[110:111], v[46:47]
v_pk_add_f32 v[140:141], v[140:141], v[60:61]
v_pk_add_f32 v[142:143], v[142:143], v[62:63]
v_cvt_pk_bf16_f32 v76, v108, v109
v_cvt_pk_bf16_f32 v77, v110, v111
v_cvt_pk_bf16_f32 v78, v140, v141
v_cvt_pk_bf16_f32 v79, v142, v143
s_nop 0
v_permlane16_swap_b32 v76, v78
v_permlane16_swap_b32 v77, v79
buffer_store_dwordx4 v[76:79], v23, s[24:27], s7 offen sc1
L_end:
s_endpgm
L_nsp:
s_mov_b32 s65, 0
L_nsp2:
s_sleep 2
buffer_load_dword v227, v226, s[16:19], 0 offen sc1
s_waitcnt vmcnt(0)
v_readfirstlane_b32 s63, v227
s_add_u32 s65, s65, 1
s_cmp_ge_u32 s65, 20000
s_cbranch_scc1 L_nok
s_cmp_eq_u32 s63, 0
s_cbranch_scc1 L_nsp2
s_branch L_nok
L_fsp:
s_mov_b32 s65, 0
L_fsp2:
s_sleep 1
buffer_load_dword v227, v225, s[12:15], s60 offen sc1
s_waitcnt vmcnt(0)
v_cmp_ne_u32 vcc, v227, v226
s_add_u32 s65, s65, 1
s_cmp_ge_u32 s65, 20000
s_cbranch_scc1 L_fok
s_cbranch_vccnz L_fsp2
s_branch L_fok
L_cr:
s_mov_b32 s65, 0
L_cr2:
s_sleep 1
v_lshrrev_b32 v1, 4, v0
v_mul_u32_u24 v1, 768, v1
v_lshl_add_u32 v1, v0, 4, v1
buffer_load_dwordx4 v[4:7], v1, s[12:15], s88 offen sc1
buffer_load_dwordx4 v[8:11], v1, s[12:15], s89 offen sc1
buffer_load_dwordx4 v[12:15], v1, s[12:15], s90 offen sc1
buffer_load_dwordx4 v[16:19], v1, s[12:15], s91 offen sc1
s_waitcnt vmcnt(0)
v_perm_b32 v1, v5, v4, s92
v_perm_b32 v1, v6, v1, s93
v_perm_b32 v1, v7, v1, s94
v_cmp_ne_u32 vcc, s63, v1
v_perm_b32 v1, v9, v8, s92
v_perm_b32 v1, v10, v1, s93
v_perm_b32 v1, v11, v1, s94
v_cmp_ne_u32 s[4:5], s63, v1
s_or_b64 vcc, vcc, s[4:5]
v_perm_b32 v1, v13, v12, s92
v_perm_b32 v1, v14, v1, s93
v_perm_b32 v1, v15, v1, s94
v_cmp_ne_u32 s[4:5], s63, v1
s_or_b64 vcc, vcc, s[4:5]
v_perm_b32 v1, v17, v16, s92
v_perm_b32 v1, v18, v1, s93
v_perm_b32 v1, v19, v1, s94
v_cmp_ne_u32 s[4:5], s63, v1
s_or_b64 vcc, vcc, s[4:5]
s_add_u32 s65, s65, 1
s_cmp_ge_u32 s65, 20000
s_cbranch_scc1 L_cok
s_cbranch_vccnz L_cr2
s_branch L_cok
L_ps0:
buffer_store_dwordx4 v[144:147], v1, s[12:15], s4 offen offset:0 sc1
buffer_store_dwordx4 v[148:151], v1, s[12:15], s5 offen offset:0 sc1
buffer_store_dwordx4 v[152:155], v1, s[12:15], s6 offen offset:0 sc1
buffer_store_dwordx4 v[156:159], v1, s[12:15], s7 offen offset:0 sc1
s_waitcnt vmcnt(0)
s_mov_b64 exec, 1
buffer_store_dword v18, off, s[12:15], s62 offset:0 sc1
s_branch L_ps0x
L_f50:
s_mov_b32 s65, 0
L_f50l:
buffer_load_dword v17, v16, s[12:15], 0 offen sc1
s_waitcnt vmcnt(0)
v_cmp_ne_u32 vcc, s63, v17
s_add_u32 s65, s65, 1
s_cmp_ge_u32 s65, 20000
s_cbranch_scc1 L_f50x
s_and_b32 s61, vcc_lo, s54
s_cbranch_scc1 L_f50l
s_branch L_f50x
L_f51:
s_mov_b32 s65, 0
L_f51l:
buffer_load_dword v17, v16, s[12:15], 0 offen sc1
s_waitcnt vmcnt(0)
v_cmp_ne_u32 vcc, s63, v17
s_add_u32 s65, s65, 1
s_cmp_ge_u32 s65, 20000
s_cbranch_scc1 L_f51x
s_and_b32 s61, vcc_lo, s54
s_cbranch_scc1 L_f51l
s_branch L_f51x
L_f52:
s_mov_b32 s65, 0
L_f52l:
buffer_load_dword v17, v16, s[12:15], 0 offen sc1
s_waitcnt vmcnt(0)
v_cmp_ne_u32 vcc, s63, v17
s_add_u32 s65, s65, 1
s_cmp_ge_u32 s65, 20000
s_cbranch_scc1 L_f52x
s_and_b32 s61, vcc_lo, 0xff0000
s_cbranch_scc1 L_f52l
s_branch L_f52x
L_f53:
s_mov_b32 s65, 0
L_f53l:
buffer_load_dword v17, v16, s[12:15], 0 offen sc1
s_waitcnt vmcnt(0)
v_cmp_ne_u32 vcc, s63, v17
s_add_u32 s65, s65, 1
s_cmp_ge_u32 s65, 20000
s_cbranch_scc1 L_f53x
s_and_b32 s61, vcc_lo, -1
s_cbranch_scc1 L_f53l
s_branch L_f53x
L_ps1:
buffer_store_dwordx4 v[176:179], v1, s[12:15], s4 offen offset:1024 sc1
buffer_store_dwordx4 v[180:183], v1, s[12:15], s5 offen offset:1024 sc1
buffer_store_dwordx4 v[184:187], v1, s[12:15], s6 offen offset:1024 sc1
buffer_store_dwordx4 v[188:191], v1, s[12:15], s7 offen offset:1024 sc1
s_waitcnt vmcnt(0)
s_mov_b64 exec, 1
buffer_store_dword v18, off, s[12:15], s62 offset:32 sc1
s_branch L_ps1x
L_ps2:
buffer_store_dwordx4 v[208:211], v1, s[12:15], s4 offen offset:2048 sc1
buffer_store_dwordx4 v[212:215], v1, s[12:15], s5 offen offset:2048 sc1
buffer_store_dwordx4 v[216:219], v1, s[12:15], s6 offen offset:2048 sc1
buffer_store_dwordx4 v[220:223], v1, s[12:15], s7 offen offset:2048 sc1
buffer_store_dwordx2 v[240:241], v1, s[12:15], s40 offen sc1
buffer_store_dwordx2 v[244:245], v1, s[12:15], s41 offen sc1
buffer_store_dwordx2 v[248:249], v1, s[12:15], s42 offen sc1
buffer_store_dwordx2 v[252:253], v1, s[12:15], s43 offen sc1
s_waitcnt vmcnt(0)
s_mov_b64 exec, 1
buffer_store_dword v18, off, s[12:15], s62 offset:64 sc1
s_branch L_ps2x
L_s1:
buffer_store_dwordx4 v[64:67], v1, s[12:15], s40 offen sc1
buffer_store_dwordx4 v[68:71], v1, s[12:15], s41 offen sc1
buffer_store_dwordx4 v[72:75], v1, s[12:15], s42 offen sc1
buffer_store_dwordx4 v[76:79], v1, s[12:15], s43 offen sc1
s_branch L_s1x
L_rt3:
s_mov_b32 s65, 0
L_rt3l:
buffer_load_dwordx4 v[160:163], v3, s[12:15], s95 offen offset:0 sc1
buffer_load_dwordx4 v[164:167], v3, s[12:15], s95 offen offset:1024 sc1
buffer_load_dwordx4 v[168:171], v3, s[12:15], s95 offen offset:2048 sc1
buffer_load_dwordx4 v[172:175], v3, s[12:15], s95 offen offset:3072 sc1
s_waitcnt vmcnt(0)
v_perm_b32 v19, v161, v160, s92
v_perm_b32 v19, v162, v19, s93
v_perm_b32 v19, v163, v19, s94
v_cmp_eq_u32 vcc, s63, v19
v_perm_b32 v19, v165, v164, s92
v_perm_b32 v19, v166, v19, s93
v_perm_b32 v19, v167, v19, s94
v_cmp_eq_u32 s[8:9], s63, v19
s_or_b64 vcc, vcc, s[8:9]
v_perm_b32 v19, v169, v168, s92
v_perm_b32 v19, v170, v19, s93
v_perm_b32 v19, v171, v19, s94
v_cmp_eq_u32 s[8:9], s63, v19
s_or_b64 vcc, vcc, s[8:9]
v_perm_b32 v19, v173, v172, s92
v_perm_b32 v19, v174, v19, s93
v_perm_b32 v19, v175, v19, s94
v_cmp_eq_u32 s[8:9], s63, v19
s_or_b64 vcc, vcc, s[8:9]
s_add_u32 s65, s65, 1
s_cmp_ge_u32 s65, 20000
s_cbranch_scc1 L_ok3
s_cbranch_vccnz L_rt3l
s_branch L_ok3
L_rt2:
s_mov_b32 s65, 0
L_rt2l:
buffer_load_dwordx4 v[112:115], v1, s[12:15], s64 offen offset:0 sc1
buffer_load_dwordx4 v[116:119], v1, s[12:15], s64 offen offset:1024 sc1
buffer_load_dwordx4 v[120:123], v1, s[12:15], s55 offen offset:0 sc1
buffer_load_dwordx4 v[124:127], v1, s[12:15], s55 offen offset:1024 sc1
s_waitcnt vmcnt(0)
v_cmp_eq_u32 vcc, v112, v28
v_cmp_eq_u32 s[48:49], v116, v29
v_cmp_eq_u32 s[50:51], v120, v30
v_cmp_eq_u32 s[52:53], v124, v31
s_or_b64 vcc, vcc, s[48:49]
s_or_b64 s[50:51], s[50:51], s[52:53]
s_or_b64 vcc, vcc, s[50:51]
s_add_u32 s65, s65, 1
s_cmp_ge_u32 s65, 20000
s_cbranch_scc1 L_ok2
s_cbranch_vccnz L_rt2l
s_branch L_ok2
L_rt1:
s_mov_b32 s65, 0
L_rt1l:
buffer_load_dwordx4 v[80:83], v1, s[12:15], s88 offen sc1
buffer_load_dwordx4 v[84:87], v1, s[12:15], s89 offen sc1
buffer_load_dwordx4 v[88:91], v1, s[12:15], s90 offen sc1
buffer_load_dwordx4 v[92:95], v1, s[12:15], s91 offen sc1
s_waitcnt vmcnt(0)
v_cmp_eq_u32 vcc, v80, v24
v_cmp_eq_u32 s[48:49], v84, v25
v_cmp_eq_u32 s[50:51], v88, v26
v_cmp_eq_u32 s[52:53], v92, v27
s_or_b64 vcc, vcc, s[48:49]
s_or_b64 s[50:51], s[50:51], s[52:53]
s_or_b64 vcc, vcc, s[50:51]
s_add_u32 s65, s65, 1
s_cmp_ge_u32 s65, 20000
s_cbranch_scc1 L_ok1
s_cbranch_vccnz L_rt1l
s_branch L_ok1
L_fin:
L_text_fin:
.section .rodata,"a"
.p2align 6
.amdhsa_kernel sequential_preLN__linear_kernel_hedgehog__glu_gated_swiglu__prompt_kernel
  .amdhsa_next_free_vgpr 512
  .amdhsa_next_free_sgpr 100
  .amdhsa_accum_offset 256
  .amdhsa_group_segment_fixed_size 0
  .amdhsa_kernarg_size 88
  .amdhsa_user_sgpr_count 2
  .amdhsa_user_sgpr_kernarg_segment_ptr 1
  .amdhsa_system_sgpr_workgroup_id_x 1
  .amdhsa_float_denorm_mode_32 3
  .amdhsa_float_denorm_mode_16_64 3
.end_amdhsa_kernel
```
